```python
import torch

def _softmax(x, axis=-1):
    return torch.softmax(x, dim=axis)
def _gelu(x):
    return torch.nn.functional.gelu(x, approximate="tanh")
def _silu(x):
    return torch.nn.functional.silu(x)
def _sigmoid(x):
    return torch.sigmoid(x)
def _layernorm(x, axis=-1, eps=1e-5):
    m = x.mean(dim=axis, keepdim=True)
    v = x.var(dim=axis, keepdim=True, unbiased=False)
    return (x - m) / torch.sqrt(v + eps)
def _scatter_add(tgt, idx, src, axis=0):
    return tgt.clone().index_add_(axis, idx, src)
def _segment_sum(src, seg, n):
    out = torch.zeros((n,) + src.shape[1:], dtype=src.dtype)
    return out.index_add_(0, seg, src)
def _pad(x, pw):
    flat = tuple(v for pair in reversed(pw) for v in pair)
    return torch.nn.functional.pad(x, flat)

kernel_name = 'parallel_sum__ssm_conv_s4d__swiglu_ffn__prompt'

def setup_inputs():

    _w = (lambda a: (lambda t: t.to(torch.bfloat16) if t.is_floating_point() else t)(torch.as_tensor(a)))
    def _A_setup():
        Bsz, L, D, N = 1, 2048, 576, 128
        return {
            "u": _w((lambda *s: torch.randn(*s, dtype=torch.bfloat16) * 0.05)(Bsz, L, D)),
            "log_A_real": _w((lambda *s: torch.randn(*s, dtype=torch.bfloat16) * 3.2)(D, N) * 0.5),
            "A_imag": _w((lambda *s: torch.randn(*s, dtype=torch.bfloat16) * 0.2)(D, N) * 3.14),
            "C_real": _w((lambda *s: torch.randn(*s, dtype=torch.bfloat16) * 3.2)(D, N) / N ** 0.5),
            "C_imag": _w((lambda *s: torch.randn(*s, dtype=torch.bfloat16) * 3.2)(D, N) / N ** 0.5),
            "log_dt": _w((lambda *s: torch.randn(*s, dtype=torch.bfloat16) * 0.2)(D) * 0.5 - 4.0),
            "D_skip": _w((lambda *s: torch.randn(*s, dtype=torch.bfloat16) * 0.2)(D)),
        }
    _A_in = _A_setup()

    def _B_setup():
        B, S, D, F = 1, 2048, 576, 4608
        return {
            "x": _w((lambda *s: torch.randn(*s, dtype=torch.bfloat16) * 0.05)(B, S, D)),
            "w_gate": _w((lambda *s: torch.randn(*s, dtype=torch.bfloat16) * 0.05)(D, F)),
            "w_up": _w((lambda *s: torch.randn(*s, dtype=torch.bfloat16) * 0.05)(D, F)),
            "w_down": _w((lambda *s: torch.randn(*s, dtype=torch.bfloat16) * 0.05)(F, D)),
        }
    _B_in = _B_setup()

    return {
        "A_u": _A_in["u"],
        "A_log_A_real": _A_in["log_A_real"],
        "A_A_imag": _A_in["A_imag"],
        "A_C_real": _A_in["C_real"],
        "A_C_imag": _A_in["C_imag"],
        "A_log_dt": _A_in["log_dt"],
        "A_D_skip": _A_in["D_skip"],
        "B_x": _B_in["x"],
        "B_w_gate": _B_in["w_gate"],
        "B_w_up": _B_in["w_up"],
        "B_w_down": _B_in["w_down"],
    }

def reference(A_u, A_log_A_real, A_A_imag, A_C_real, A_C_imag, A_log_dt, A_D_skip, B_x, B_w_gate, B_w_up, B_w_down):
    def _A_ref(u, log_A_real, A_imag, C_real, C_imag, log_dt, D_skip):
        L = u.shape[1]
        dt = torch.exp(log_dt)
        A = -torch.exp(log_A_real) + 1j * A_imag
        C = (C_real + 1j * C_imag) * dt[:, None]
        pos = (lambda x, dt: x.to(dt))(torch.arange(L), log_dt.dtype)
        P = torch.exp((A * dt[:, None])[:, :, None] * pos[None, None, :])
        K = 2.0 * torch.einsum("dn,dnl->dl", C, P).real
        L2 = 2 * L
        u_t = (lambda x, *d: x.permute(*d))(u, 0, 2, 1)
        Kf = (lambda x, *a, **k: torch.fft.rfft(x.float(), *a, **k))(K, L2)
        Uf = (lambda x, *a, **k: torch.fft.rfft(x.float(), *a, **k))(u_t, L2)
        y = (lambda x, *a, **k: torch.fft.irfft(x, *a, **k).to(torch.bfloat16))(Uf * Kf[None, :, :], L2)[:, :, :L]
        y = (lambda x, *d: x.permute(*d))(y, 0, 2, 1)
        return y + u * D_skip[None, None, :]

    def _B_ref(x, w_gate, w_up, w_down):
        g = _silu(x @ w_gate)
        u = x @ w_up
        return (g * u) @ w_down

    x = A_u
    xn = _layernorm(x, axis=-1)
    return x + _A_ref(xn, A_log_A_real, A_A_imag, A_C_real, A_C_imag, A_log_dt, A_D_skip) + _B_ref(xn, B_w_gate, B_w_up, B_w_down)
```

```asm
; @launch grid=(256,1,1) block=(256,1,1) lds=163840
.amdgcn_target "amdgcn-amd-amdhsa--gfx950"
.text
.globl parallel_sum__ssm_conv_s4d__swiglu_ffn__prompt_kernel
.p2align 8
.type parallel_sum__ssm_conv_s4d__swiglu_ffn__prompt_kernel,@function
parallel_sum__ssm_conv_s4d__swiglu_ffn__prompt_kernel:
s_cmp_ge_u32 s2, 256
s_cbranch_scc1 KF_EXIT
KF_PF0:
s_load_dwordx16 s[32:47], s[0:1], 0
s_load_dwordx8 s[48:55], s[0:1], 64
s_load_dwordx4 s[4:7], s[0:1], 96
s_lshr_b32 s97, s2, 3
s_getpc_b64 s[56:57]
PF_1:
s_sub_u32 s56, s56, PF_1-KF_PF0
s_subb_u32 s57, s57, 0
v_and_b32 v58, 63, v0
v_min_u32 v58, 23, v58
s_mul_i32 s58, s97, 24
v_add_u32 v58, s58, v58
v_lshlrev_b32 v58, 7, v58
v_min_u32 v58, KF_EXIT-KF_PF0-4, v58
global_load_dword v35, v58, s[56:57]
v_lshrrev_b32 v20, 6, v0
s_and_b32 s96, s2, 7
v_readfirstlane_b32 s98, v20
v_lshrrev_b32 v65, 5, v0
v_and_b32 v66, 31, v0
v_mul_u32_u24 v67, 1152, v65
v_lshl_add_u32 v67, v66, 2, v67
s_mul_i32 s56, s2, 8*1152
v_add_u32 v67, s56, v67
v_and_b32 v68, 127, v0
v_lshlrev_b32 v68, 1, v68
s_waitcnt lgkmcnt(0)
global_load_dword v72, v67, s[32:33] offset:0
global_load_dword v73, v67, s[32:33] offset:128
global_load_dword v74, v67, s[32:33] offset:256
global_load_dword v75, v67, s[32:33] offset:384
global_load_dword v76, v67, s[32:33] offset:512
global_load_dword v77, v67, s[32:33] offset:640
global_load_dword v78, v67, s[32:33] offset:768
global_load_dword v79, v67, s[32:33] offset:896
global_load_dword v80, v67, s[32:33] offset:1024
s_add_u32 s57, s2, 256
s_sub_u32 s58, s2, 192
s_min_u32 s58, s58, 63
s_add_u32 s58, s58, 512
s_lshl_b32 s56, s2, 8
v_add_u32 v69, s56, v68
s_lshl_b32 s56, s2, 1
v_mov_b32 v70, s56
global_load_ushort v164, v69, s[34:35]
global_load_ushort v165, v69, s[36:37]
global_load_ushort v166, v69, s[38:39]
global_load_ushort v167, v69, s[40:41]
global_load_ushort v168, v70, s[42:43]
global_load_ushort v169, v70, s[44:45]
s_lshl_b32 s56, s57, 8
v_add_u32 v69, s56, v68
s_lshl_b32 s56, s57, 1
v_mov_b32 v70, s56
global_load_ushort v170, v69, s[34:35]
global_load_ushort v171, v69, s[36:37]
global_load_ushort v172, v69, s[38:39]
global_load_ushort v173, v69, s[40:41]
global_load_ushort v174, v70, s[42:43]
global_load_ushort v175, v70, s[44:45]
s_lshl_b32 s56, s58, 8
v_add_u32 v69, s56, v68
s_lshl_b32 s56, s58, 1
v_mov_b32 v70, s56
global_load_ushort v176, v69, s[34:35]
global_load_ushort v177, v69, s[36:37]
global_load_ushort v178, v69, s[38:39]
global_load_ushort v179, v69, s[40:41]
global_load_ushort v180, v70, s[42:43]
global_load_ushort v181, v70, s[44:45]
s_or_b32 s56, s2, s98
s_cmp_lg_u32 s56, 0
s_cbranch_scc1 TAG_NOPUB
s_memrealtime s[56:57]
s_waitcnt lgkmcnt(0)
s_or_b32 s56, s56, 1
v_mov_b32 v60, 0
v_mov_b32 v61, s56
s_mov_b64 exec, 1
global_store_dword v60, v61, s[4:5] sc1
s_mov_b64 exec, -1
TAG_NOPUB:
s_mov_b32 s86, s52
s_mov_b32 s87, s53
s_mov_b32 s92, s32
s_mov_b32 s93, s33
s_mov_b32 s94, s54
s_mov_b32 s95, s55
v_min_u32 v22, 161, v0
v_mul_u32_u24 v23, 7282, v22
v_lshrrev_b32 v23, 16, v23
v_mul_u32_u24 v24, 9, v23
v_sub_u32 v24, v22, v24
v_mul_u32_u24 v23, 9216, v23
v_lshl_add_u32 v23, v24, 7, v23
s_mul_i32 s42, s97, 18*9216
s_mul_i32 s43, s96, 1152
s_add_u32 s42, s42, s43
v_add_u32 v26, s42, v23
global_load_dword v27, v26, s[48:49]
global_load_dword v19, v26, s[50:51]
v_mov_b32 v56, 0
v_mov_b32 v36, 0
v_mov_b32 v37, 0
v_mov_b32 v38, 0
v_mov_b32 v39, 0
v_mov_b32 v40, 0
v_mov_b32 v41, 0
v_mov_b32 v42, 0
v_mov_b32 v43, 0
v_mov_b32 v44, 0
v_mov_b32 v45, 0
v_mov_b32 v46, 0
v_mov_b32 v47, 0
v_mov_b32 v48, 0
v_mov_b32 v49, 0
v_mov_b32 v50, 0
v_mov_b32 v51, 0
v_mov_b32 v52, 0
v_mov_b32 v53, 0
v_mov_b32 v54, 0
v_mov_b32 v55, 0
v_and_b32 v21, 63, v0
s_and_b32 s32, s97, 1
s_lshr_b32 s33, s97, 1
s_lshl_b32 s25, s98, 11
s_and_b32 s34, s98, 1
s_lshr_b32 s35, s98, 1
s_mul_i32 s36, s34, 16*9216
s_mul_i32 s37, s96, 1152
s_add_u32 s36, s36, s37
s_add_u32 s21, s36, 1024
s_lshl_b32 s37, s32, 9
s_add_u32 s20, s36, s37
s_lshl_b32 s36, s33, 3
s_lshl_b32 s37, s98, 1
s_add_u32 s37, s37, s36
s_mul_i32 s22, s37, 18432
s_mul_i32 s38, s96, 18
s_lshl_b32 s39, s32, 3
s_add_u32 s39, s39, s38
s_add_u32 s39, s39, s35
s_lshl_b32 s40, s34, 2
s_add_u32 s40, s40, s36
s_lshl_b32 s41, s35, 1
s_add_u32 s42, s41, 0
s_and_b32 s42, s42, 3
s_add_u32 s42, s42, s40
s_mul_i32 s42, s42, 144
s_add_u32 s43, s42, s38
s_add_u32 s43, s43, s32
s_add_u32 s43, s43, 16
s_lshl_b32 s23, s43, 10
s_add_u32 s42, s42, s39
s_lshl_b32 s28, s42, 10
s_add_u32 s42, s41, 1
s_and_b32 s42, s42, 3
s_add_u32 s42, s42, s40
s_mul_i32 s42, s42, 144
s_add_u32 s43, s42, s38
s_add_u32 s43, s43, s32
s_add_u32 s43, s43, 16
s_lshl_b32 s24, s43, 10
s_add_u32 s42, s42, s39
s_lshl_b32 s29, s42, 10
s_add_u32 s42, s41, 2
s_and_b32 s42, s42, 3
s_add_u32 s42, s42, s40
s_mul_i32 s42, s42, 144
s_add_u32 s42, s42, s39
s_lshl_b32 s30, s42, 10
s_add_u32 s42, s41, 3
s_and_b32 s42, s42, 3
s_add_u32 s42, s42, s40
s_mul_i32 s42, s42, 144
s_add_u32 s42, s42, s39
s_lshl_b32 s31, s42, 10
s_mov_b32 s26, 0xbfb8aa3b
v_lshlrev_b32 v15, 4, v21
v_add_u32 v16, 17408, v15
v_lshrrev_b32 v22, 3, v21
v_mul_u32_u24 v22, 9216, v22
v_bfe_u32 v23, v21, 1, 2
v_bfe_u32 v24, v21, 4, 1
v_xor_b32 v23, v23, v24
v_and_b32 v24, 1, v21
v_lshlrev_b32 v24, 4, v24
v_add_u32 v22, v22, v24
v_lshlrev_b32 v24, 5, v23
v_add_u32 v13, v22, v24
v_xor_b32 v23, 2, v23
v_lshlrev_b32 v24, 5, v23
v_add_u32 v22, v22, v24
v_add_u32 v14, 72704, v22
v_lshrrev_b32 v22, 4, v21
v_lshlrev_b32 v23, 10, v22
v_bfe_u32 v24, v21, 2, 2
v_lshlrev_b32 v25, 7, v24
v_add_u32 v23, v23, v25
v_lshrrev_b32 v24, 1, v24
v_and_b32 v22, 1, v22
v_lshl_or_b32 v24, v22, 1, v24
v_xor_b32 v24, s41, v24
v_lshlrev_b32 v24, 5, v24
v_add_u32 v23, v23, v24
v_and_b32 v24, 3, v21
v_lshlrev_b32 v24, 3, v24
v_add_u32 v1, v23, v24
v_xor_b32 v4, 32, v1
s_lshl_b32 s42, s34, 12
s_lshl_b32 s43, s35, 11
s_add_u32 s44, s42, s43
s_xor_b32 s45, s44, 2048
v_add_u32 v7, s44, v15
v_add_u32 v10, s45, v15
v_add_u32 v2, 65536, v1
v_add_u32 v5, 65536, v4
v_add_u32 v8, 65536, v7
v_add_u32 v11, 65536, v10
v_add_u32 v3, 131072, v1
v_add_u32 v6, 131072, v4
v_add_u32 v9, 131072, v7
v_add_u32 v12, 131072, v10
s_xor_b32 s99, s35, s32
s_lshl_b32 s99, s99, 6
s_lshr_b32 s42, s96, 1
s_mul_i32 s42, s42, 1152
s_mul_i32 s43, s97, 36
s_add_u32 s42, s42, s43
s_mul_i32 s42, s42, 1152
v_add_u32 v22, 0, v0
v_min_u32 v22, 323, v22
v_lshlrev_b32 v22, 7, v22
v_add_u32 v17, s42, v22
v_add_u32 v22, 256, v0
v_min_u32 v22, 323, v22
v_lshlrev_b32 v22, 7, v22
v_add_u32 v18, s42, v22
s_cmp_eq_u32 s35, 0
s_cselect_b32 s8, s48, s50
s_cselect_b32 s9, s49, s51
s_mov_b32 s10, 5308416
s_mov_b32 s11, 0x00020000
s_add_u32 s56, s6, 0
s_addc_u32 s57, s7, 0
s_mov_b32 s12, s56
s_mov_b32 s13, s57
s_mov_b32 s14, 2359296
s_mov_b32 s15, 0x00020000
s_add_u32 s56, s6, 22020096
s_addc_u32 s57, s7, 0
s_mov_b32 s16, s56
s_mov_b32 s17, s57
s_mov_b32 s18, 18874368
s_mov_b32 s19, 0x00020000
s_mov_b32 s88, 0x3fb8aa3b
s_mov_b32 s89, 0x32a57060
s_mov_b32 s90, 0x3f317218
v_lshrrev_b32 v184, 7, v0
v_cvt_f32_u32 v185, v184
v_mov_b32 v186, 1.0
v_mov_b32 v187, 0x40400000
v_fma_f32 v186, v185, v187, v186
v_mov_b32 v187, 0x41800000
v_mov_b32 v188, 0x42400000
v_fma_f32 v187, v185, v188, v187
v_mul_f32 v188, 0x44000000, v185
v_mul_u32_u24 v189, 26112, v184
v_and_b32 v190, 127, v0
v_lshl_add_u32 v189, v190, 2, v189
v_add_u32 v189, 106496, v189
v_lshrrev_b32 v190, 6, v0
v_and_b32 v191, 15, v0
v_bfe_u32 v192, v0, 4, 2
v_lshrrev_b32 v193, 1, v190
v_mul_u32_u24 v193, 26112, v193
v_mul_u32_u24 v194, 544, v191
v_add_u32 v193, v193, v194
v_lshl_add_u32 v193, v192, 4, v193
v_add_u32 v193, 106496, v193
v_and_b32 v194, 1, v190
v_mul_u32_u24 v194, 8704, v194
v_add_u32 v194, v193, v194
v_lshlrev_b32 v195, 10, v190
v_lshl_add_u32 v195, v192, 8, v195
v_lshl_add_u32 v195, v191, 2, v195
v_add_u32 v195, 158720, v195
v_lshlrev_b32 v207, 4, v0
v_add_u32 v208, 4224, v207
v_mul_u32_u24 v209, 4224, v0
v_add_u32 v209, 4096, v209
s_waitcnt vmcnt(20)
v_lshlrev_b32 v84, 16, v72
v_and_b32 v85, 0xffff0000, v72
v_lshlrev_b32 v86, 16, v73
v_and_b32 v87, 0xffff0000, v73
v_lshlrev_b32 v88, 16, v74
v_and_b32 v89, 0xffff0000, v74
v_lshlrev_b32 v90, 16, v75
v_and_b32 v91, 0xffff0000, v75
v_lshlrev_b32 v92, 16, v76
v_and_b32 v93, 0xffff0000, v76
v_lshlrev_b32 v94, 16, v77
v_and_b32 v95, 0xffff0000, v77
v_lshlrev_b32 v96, 16, v78
v_and_b32 v97, 0xffff0000, v78
v_lshlrev_b32 v98, 16, v79
v_and_b32 v99, 0xffff0000, v79
v_lshlrev_b32 v100, 16, v80
v_and_b32 v101, 0xffff0000, v80
v_add_f32 v104, v84, v85
v_add_f32 v105, v86, v87
v_add_f32 v104, v104, v88
v_add_f32 v105, v105, v89
v_add_f32 v104, v104, v90
v_add_f32 v105, v105, v91
v_add_f32 v104, v104, v92
v_add_f32 v105, v105, v93
v_add_f32 v104, v104, v94
v_add_f32 v105, v105, v95
v_add_f32 v104, v104, v96
v_add_f32 v105, v105, v97
v_add_f32 v104, v104, v98
v_add_f32 v105, v105, v99
v_add_f32 v104, v104, v100
v_add_f32 v105, v105, v101
v_add_f32 v104, v104, v105
s_nop 1
v_add_f32_dpp v104, v104, v104 quad_perm:[1,0,3,2] row_mask:0xf bank_mask:0xf
s_nop 1
v_add_f32_dpp v104, v104, v104 quad_perm:[2,3,0,1] row_mask:0xf bank_mask:0xf
s_nop 1
v_add_f32_dpp v104, v104, v104 row_half_mirror row_mask:0xf bank_mask:0xf
s_nop 1
v_add_f32_dpp v104, v104, v104 row_mirror row_mask:0xf bank_mask:0xf
v_mov_b32 v107, v104
s_nop 1
v_permlane16_swap_b32 v104, v107
s_nop 0
v_add_f32 v104, v104, v107
v_mul_f32 v104, 0x3ae38e39, v104
v_sub_f32 v106, v84, v104
v_sub_f32 v105, v85, v104
v_mul_f32 v108, v106, v106
v_mul_f32 v109, v105, v105
v_sub_f32 v106, v86, v104
v_sub_f32 v105, v87, v104
v_fmac_f32 v108, v106, v106
v_fmac_f32 v109, v105, v105
v_sub_f32 v106, v88, v104
v_sub_f32 v105, v89, v104
v_fmac_f32 v108, v106, v106
v_fmac_f32 v109, v105, v105
v_sub_f32 v106, v90, v104
v_sub_f32 v105, v91, v104
v_fmac_f32 v108, v106, v106
v_fmac_f32 v109, v105, v105
v_sub_f32 v106, v92, v104
v_sub_f32 v105, v93, v104
v_fmac_f32 v108, v106, v106
v_fmac_f32 v109, v105, v105
v_sub_f32 v106, v94, v104
v_sub_f32 v105, v95, v104
v_fmac_f32 v108, v106, v106
v_fmac_f32 v109, v105, v105
v_sub_f32 v106, v96, v104
v_sub_f32 v105, v97, v104
v_fmac_f32 v108, v106, v106
v_fmac_f32 v109, v105, v105
v_sub_f32 v106, v98, v104
v_sub_f32 v105, v99, v104
v_fmac_f32 v108, v106, v106
v_fmac_f32 v109, v105, v105
v_sub_f32 v106, v100, v104
v_sub_f32 v105, v101, v104
v_fmac_f32 v108, v106, v106
v_fmac_f32 v109, v105, v105
v_add_f32 v108, v108, v109
s_nop 1
v_add_f32_dpp v108, v108, v108 quad_perm:[1,0,3,2] row_mask:0xf bank_mask:0xf
s_nop 1
v_add_f32_dpp v108, v108, v108 quad_perm:[2,3,0,1] row_mask:0xf bank_mask:0xf
s_nop 1
v_add_f32_dpp v108, v108, v108 row_half_mirror row_mask:0xf bank_mask:0xf
s_nop 1
v_add_f32_dpp v108, v108, v108 row_mirror row_mask:0xf bank_mask:0xf
v_mov_b32 v107, v108
s_nop 1
v_permlane16_swap_b32 v108, v107
s_nop 0
v_add_f32 v108, v108, v107
v_mul_f32 v108, 0x3ae38e39, v108
v_cvt_pk_bf16_f32 v104, v104, v104
v_lshlrev_b32 v104, 16, v104
v_cvt_pk_bf16_f32 v108, v108, v108
v_lshlrev_b32 v108, 16, v108
v_add_f32 v108, 0x3727c5ac, v108
v_cvt_pk_bf16_f32 v108, v108, v108
v_lshlrev_b32 v108, 16, v108
v_sqrt_f32 v108, v108
s_nop 0
v_cvt_pk_bf16_f32 v108, v108, v108
v_lshlrev_b32 v108, 16, v108
v_rcp_f32 v108, v108
v_mul_u32_u24 v110, 1216, v65
v_lshl_add_u32 v110, v66, 2, v110
v_add_u32 v110, 106496, v110
v_sub_f32 v84, v84, v104
v_sub_f32 v85, v85, v104
v_cvt_pk_bf16_f32 v72, v84, v85
v_lshlrev_b32 v84, 16, v72
v_and_b32 v85, 0xffff0000, v72
v_mul_f32 v84, v84, v108
v_mul_f32 v85, v85, v108
v_cvt_pk_bf16_f32 v72, v84, v85
ds_write_b32 v110, v72 offset:0
v_sub_f32 v86, v86, v104
v_sub_f32 v87, v87, v104
v_cvt_pk_bf16_f32 v73, v86, v87
v_lshlrev_b32 v86, 16, v73
v_and_b32 v87, 0xffff0000, v73
v_mul_f32 v86, v86, v108
v_mul_f32 v87, v87, v108
v_cvt_pk_bf16_f32 v73, v86, v87
ds_write_b32 v110, v73 offset:128
v_sub_f32 v88, v88, v104
v_sub_f32 v89, v89, v104
v_cvt_pk_bf16_f32 v74, v88, v89
v_lshlrev_b32 v88, 16, v74
v_and_b32 v89, 0xffff0000, v74
v_mul_f32 v88, v88, v108
v_mul_f32 v89, v89, v108
v_cvt_pk_bf16_f32 v74, v88, v89
ds_write_b32 v110, v74 offset:256
v_sub_f32 v90, v90, v104
v_sub_f32 v91, v91, v104
v_cvt_pk_bf16_f32 v75, v90, v91
v_lshlrev_b32 v90, 16, v75
v_and_b32 v91, 0xffff0000, v75
v_mul_f32 v90, v90, v108
v_mul_f32 v91, v91, v108
v_cvt_pk_bf16_f32 v75, v90, v91
ds_write_b32 v110, v75 offset:384
v_sub_f32 v92, v92, v104
v_sub_f32 v93, v93, v104
v_cvt_pk_bf16_f32 v76, v92, v93
v_lshlrev_b32 v92, 16, v76
v_and_b32 v93, 0xffff0000, v76
v_mul_f32 v92, v92, v108
v_mul_f32 v93, v93, v108
v_cvt_pk_bf16_f32 v76, v92, v93
ds_write_b32 v110, v76 offset:512
v_sub_f32 v94, v94, v104
v_sub_f32 v95, v95, v104
v_cvt_pk_bf16_f32 v77, v94, v95
v_lshlrev_b32 v94, 16, v77
v_and_b32 v95, 0xffff0000, v77
v_mul_f32 v94, v94, v108
v_mul_f32 v95, v95, v108
v_cvt_pk_bf16_f32 v77, v94, v95
ds_write_b32 v110, v77 offset:640
v_sub_f32 v96, v96, v104
v_sub_f32 v97, v97, v104
v_cvt_pk_bf16_f32 v78, v96, v97
v_lshlrev_b32 v96, 16, v78
v_and_b32 v97, 0xffff0000, v78
v_mul_f32 v96, v96, v108
v_mul_f32 v97, v97, v108
v_cvt_pk_bf16_f32 v78, v96, v97
ds_write_b32 v110, v78 offset:768
v_sub_f32 v98, v98, v104
v_sub_f32 v99, v99, v104
v_cvt_pk_bf16_f32 v79, v98, v99
v_lshlrev_b32 v98, 16, v79
v_and_b32 v99, 0xffff0000, v79
v_mul_f32 v98, v98, v108
v_mul_f32 v99, v99, v108
v_cvt_pk_bf16_f32 v79, v98, v99
ds_write_b32 v110, v79 offset:896
v_sub_f32 v100, v100, v104
v_sub_f32 v101, v101, v104
v_cvt_pk_bf16_f32 v80, v100, v101
v_lshlrev_b32 v100, 16, v80
v_and_b32 v101, 0xffff0000, v80
v_mul_f32 v100, v100, v108
v_mul_f32 v101, v101, v108
v_cvt_pk_bf16_f32 v80, v100, v101
ds_write_b32 v110, v80 offset:1024
v_and_b32 v111, 63, v0
v_and_b32 v112, 7, v111
v_lshrrev_b32 v113, 3, v111
v_mul_u32_u24 v114, 1216, v112
v_lshl_add_u32 v114, v113, 4, v114
s_lshl_b32 s56, s98, 7
s_add_u32 s56, s56, 106496
v_add_u32 v114, s56, v114
v_lshrrev_b32 v115, 2, v113
v_lshlrev_b32 v115, 10, v115
v_and_b32 v113, 3, v113
v_lshl_add_u32 v115, v113, 8, v115
v_lshl_add_u32 v115, v112, 4, v115
s_lshr_b32 s56, s2, 1
s_mul_i32 s56, s56, 18432
s_and_b32 s57, s2, 1
s_lshl_b32 s57, s57, 7
s_add_u32 s56, s56, s57
s_lshl_b32 s57, s98, 11
s_add_u32 s56, s56, s57
v_add_u32 v115, s56, v115
v_bfe_u32 v112, v111, 2, 2
v_mul_u32_u24 v116, 1216, v112
v_lshrrev_b32 v112, 4, v111
v_lshl_add_u32 v116, v112, 5, v116
v_and_b32 v112, 3, v111
v_lshl_add_u32 v116, v112, 3, v116
s_lshl_b32 s56, s98, 7
s_add_u32 s56, s56, 106496
v_add_u32 v116, s56, v116
v_lshlrev_b32 v117, 4, v111
s_mul_i32 s56, s2, 9216
s_lshl_b32 s57, s98, 10
s_add_u32 s56, s56, s57
s_add_u32 s56, s56, 2359296
v_add_u32 v117, s56, v117
s_waitcnt lgkmcnt(0)
s_barrier
ds_read_b128 v[120:123], v114 offset:0
ds_read_b64_tr_b16 v[212:213], v116 offset:0
ds_read_b64_tr_b16 v[214:215], v116 offset:4864
ds_read_b128 v[124:127], v114 offset:512
ds_read_b64_tr_b16 v[216:217], v116 offset:512
ds_read_b64_tr_b16 v[218:219], v116 offset:5376
s_waitcnt lgkmcnt(3)
v_add_u32 v118, 0, v115
global_store_dwordx4 v118, v[120:123], s[6:7] sc1
s_waitcnt lgkmcnt(0)
v_add_u32 v118, 8192, v115
global_store_dwordx4 v118, v[124:127], s[6:7] sc1
s_cmp_lg_u32 s98, 0
s_cbranch_scc1 LN_NO3
ds_read_b128 v[128:131], v114 offset:1024
ds_read_b64_tr_b16 v[220:221], v116 offset:1024
ds_read_b64_tr_b16 v[222:223], v116 offset:5888
s_waitcnt lgkmcnt(0)
v_add_u32 v118, 16384, v115
global_store_dwordx4 v118, v[128:131], s[6:7] sc1
LN_NO3:
s_barrier
v_mov_b32 v62, 0
global_load_dword v63, v62, s[4:5] sc1
s_waitcnt vmcnt(5)
s_mov_b32 s91, s2
v_lshlrev_b32 v164, 16, v164
v_lshlrev_b32 v165, 16, v165
v_lshlrev_b32 v166, 16, v166
v_lshlrev_b32 v167, 16, v167
v_lshlrev_b32 v168, 16, v168
v_mul_f32 v127, s88, v168
v_fma_f32 v128, s88, v168, -v127
v_fmac_f32 v128, s89, v168
v_exp_f32 v124, v127
v_mul_f32 v128, s90, v128
v_fmac_f32 v124, v124, v128
v_cvt_pk_bf16_f32 v124, v124, v124
v_lshlrev_b32 v124, 16, v124
v_mul_f32 v127, s88, v164
v_fma_f32 v128, s88, v164, -v127
v_fmac_f32 v128, s89, v164
v_exp_f32 v125, v127
v_mul_f32 v128, s90, v128
v_fmac_f32 v125, v125, v128
v_cvt_pk_bf16_f32 v125, v125, v125
v_lshlrev_b32 v125, 16, v125
v_mul_f32 v125, v125, v124
v_mul_f32 v126, v165, v124
v_mul_f32 v125, s88, v125
v_sub_f32 v125, 0, v125
v_mul_f32 v126, 0.15915494, v126
v_add_f32 v124, v124, v124
v_mul_f32 v166, v166, v124
v_mul_f32 v167, v167, v124
v_mul_f32 v127, v125, v186
v_mul_f32 v128, v126, v186
v_exp_f32 v127, v127
v_fract_f32 v128, v128
v_cos_f32 v130, v128
v_sin_f32 v131, v128
s_nop 0
v_mul_f32 v130, v130, v127
v_mul_f32 v131, v131, v127
v_mul_f32 v127, v125, v187
v_mul_f32 v128, v126, v187
v_exp_f32 v127, v127
v_fract_f32 v128, v128
v_cos_f32 v132, v128
v_sin_f32 v133, v128
s_nop 0
v_mul_f32 v132, v132, v127
v_mul_f32 v133, v133, v127
v_mul_f32 v127, v125, v188
v_mul_f32 v128, v126, v188
v_exp_f32 v127, v127
v_fract_f32 v128, v128
v_cos_f32 v134, v128
v_sin_f32 v135, v128
s_nop 0
v_mul_f32 v134, v134, v127
v_mul_f32 v135, v135, v127
v_mul_f32 v136, v166, v134
v_mul_f32 v137, v166, v135
v_fma_f32 v136, -v167, v135, v136
v_fmac_f32 v137, v167, v134
v_sub_f32 v131, 0, v131
v_mov_b32 v140, 1.0
v_mov_b32 v141, 0
v_lshlrev_b32 v129, 16, v169
v_cvt_pk_bf16_f32 v144, v136, v137
v_pk_mul_f32 v[138:139], v[136:137], v[132:133] op_sel_hi:[0,1]
v_pk_fma_f32 v[138:139], v[136:137], v[132:133], v[138:139] op_sel:[1,1,0] op_sel_hi:[1,0,1] neg_lo:[1,0,0]
ds_write_b32 v189, v144 offset:8704
v_cvt_pk_bf16_f32 v148, v140, v141
v_pk_mul_f32 v[142:143], v[140:141], v[130:131] op_sel_hi:[0,1]
v_pk_fma_f32 v[142:143], v[140:141], v[130:131], v[142:143] op_sel:[1,1,0] op_sel_hi:[1,0,1] neg_lo:[1,0,0]
ds_write_b32 v189, v148 offset:0
v_cvt_pk_bf16_f32 v145, v138, v139
v_pk_mul_f32 v[136:137], v[138:139], v[132:133] op_sel_hi:[0,1]
v_pk_fma_f32 v[136:137], v[138:139], v[132:133], v[136:137] op_sel:[1,1,0] op_sel_hi:[1,0,1] neg_lo:[1,0,0]
ds_write_b32 v189, v145 offset:9248
v_cvt_pk_bf16_f32 v146, v136, v137
v_pk_mul_f32 v[138:139], v[136:137], v[132:133] op_sel_hi:[0,1]
v_pk_fma_f32 v[138:139], v[136:137], v[132:133], v[138:139] op_sel:[1,1,0] op_sel_hi:[1,0,1] neg_lo:[1,0,0]
ds_write_b32 v189, v146 offset:9792
v_cvt_pk_bf16_f32 v149, v142, v143
v_pk_mul_f32 v[140:141], v[142:143], v[130:131] op_sel_hi:[0,1]
v_pk_fma_f32 v[140:141], v[142:143], v[130:131], v[140:141] op_sel:[1,1,0] op_sel_hi:[1,0,1] neg_lo:[1,0,0]
ds_write_b32 v189, v149 offset:544
s_add_u32 m0, s25, 0
s_add_u32 s27, s20, 0
buffer_load_dwordx4 v13, s[8:11], s27 offen lds
v_cvt_pk_bf16_f32 v147, v138, v139
v_pk_mul_f32 v[136:137], v[138:139], v[132:133] op_sel_hi:[0,1]
v_pk_fma_f32 v[136:137], v[138:139], v[132:133], v[136:137] op_sel:[1,1,0] op_sel_hi:[1,0,1] neg_lo:[1,0,0]
ds_write_b32 v189, v147 offset:10336
v_cvt_pk_bf16_f32 v144, v136, v137
v_pk_mul_f32 v[138:139], v[136:137], v[132:133] op_sel_hi:[0,1]
v_pk_fma_f32 v[138:139], v[136:137], v[132:133], v[138:139] op_sel:[1,1,0] op_sel_hi:[1,0,1] neg_lo:[1,0,0]
ds_write_b32 v189, v144 offset:10880
v_cvt_pk_bf16_f32 v150, v140, v141
v_pk_mul_f32 v[142:143], v[140:141], v[130:131] op_sel_hi:[0,1]
v_pk_fma_f32 v[142:143], v[140:141], v[130:131], v[142:143] op_sel:[1,1,0] op_sel_hi:[1,0,1] neg_lo:[1,0,0]
ds_write_b32 v189, v150 offset:1088
v_cvt_pk_bf16_f32 v145, v138, v139
v_pk_mul_f32 v[136:137], v[138:139], v[132:133] op_sel_hi:[0,1]
v_pk_fma_f32 v[136:137], v[138:139], v[132:133], v[136:137] op_sel:[1,1,0] op_sel_hi:[1,0,1] neg_lo:[1,0,0]
ds_write_b32 v189, v145 offset:11424
v_cvt_pk_bf16_f32 v146, v136, v137
v_pk_mul_f32 v[138:139], v[136:137], v[132:133] op_sel_hi:[0,1]
v_pk_fma_f32 v[138:139], v[136:137], v[132:133], v[138:139] op_sel:[1,1,0] op_sel_hi:[1,0,1] neg_lo:[1,0,0]
ds_write_b32 v189, v146 offset:11968
v_cvt_pk_bf16_f32 v151, v142, v143
v_pk_mul_f32 v[140:141], v[142:143], v[130:131] op_sel_hi:[0,1]
v_pk_fma_f32 v[140:141], v[142:143], v[130:131], v[140:141] op_sel:[1,1,0] op_sel_hi:[1,0,1] neg_lo:[1,0,0]
ds_write_b32 v189, v151 offset:1632
buffer_load_dwordx4 v14, s[8:11], s27 offen offset:1024 lds
v_cvt_pk_bf16_f32 v147, v138, v139
v_pk_mul_f32 v[136:137], v[138:139], v[132:133] op_sel_hi:[0,1]
v_pk_fma_f32 v[136:137], v[138:139], v[132:133], v[136:137] op_sel:[1,1,0] op_sel_hi:[1,0,1] neg_lo:[1,0,0]
ds_write_b32 v189, v147 offset:12512
v_cvt_pk_bf16_f32 v144, v136, v137
v_pk_mul_f32 v[138:139], v[136:137], v[132:133] op_sel_hi:[0,1]
v_pk_fma_f32 v[138:139], v[136:137], v[132:133], v[138:139] op_sel:[1,1,0] op_sel_hi:[1,0,1] neg_lo:[1,0,0]
ds_write_b32 v189, v144 offset:13056
v_cvt_pk_bf16_f32 v148, v140, v141
v_pk_mul_f32 v[142:143], v[140:141], v[130:131] op_sel_hi:[0,1]
v_pk_fma_f32 v[142:143], v[140:141], v[130:131], v[142:143] op_sel:[1,1,0] op_sel_hi:[1,0,1] neg_lo:[1,0,0]
ds_write_b32 v189, v148 offset:2176
v_cvt_pk_bf16_f32 v145, v138, v139
v_pk_mul_f32 v[136:137], v[138:139], v[132:133] op_sel_hi:[0,1]
v_pk_fma_f32 v[136:137], v[138:139], v[132:133], v[136:137] op_sel:[1,1,0] op_sel_hi:[1,0,1] neg_lo:[1,0,0]
ds_write_b32 v189, v145 offset:13600
v_cvt_pk_bf16_f32 v146, v136, v137
v_pk_mul_f32 v[138:139], v[136:137], v[132:133] op_sel_hi:[0,1]
v_pk_fma_f32 v[138:139], v[136:137], v[132:133], v[138:139] op_sel:[1,1,0] op_sel_hi:[1,0,1] neg_lo:[1,0,0]
ds_write_b32 v189, v146 offset:14144
v_cvt_pk_bf16_f32 v149, v142, v143
v_pk_mul_f32 v[140:141], v[142:143], v[130:131] op_sel_hi:[0,1]
v_pk_fma_f32 v[140:141], v[142:143], v[130:131], v[140:141] op_sel:[1,1,0] op_sel_hi:[1,0,1] neg_lo:[1,0,0]
ds_write_b32 v189, v149 offset:2720
s_add_u32 m0, s25, 8192
s_add_u32 s27, s20, 294912
buffer_load_dwordx4 v13, s[8:11], s27 offen lds
v_cvt_pk_bf16_f32 v147, v138, v139
v_pk_mul_f32 v[136:137], v[138:139], v[132:133] op_sel_hi:[0,1]
v_pk_fma_f32 v[136:137], v[138:139], v[132:133], v[136:137] op_sel:[1,1,0] op_sel_hi:[1,0,1] neg_lo:[1,0,0]
ds_write_b32 v189, v147 offset:14688
v_cvt_pk_bf16_f32 v144, v136, v137
v_pk_mul_f32 v[138:139], v[136:137], v[132:133] op_sel_hi:[0,1]
v_pk_fma_f32 v[138:139], v[136:137], v[132:133], v[138:139] op_sel:[1,1,0] op_sel_hi:[1,0,1] neg_lo:[1,0,0]
ds_write_b32 v189, v144 offset:15232
v_cvt_pk_bf16_f32 v150, v140, v141
v_pk_mul_f32 v[142:143], v[140:141], v[130:131] op_sel_hi:[0,1]
v_pk_fma_f32 v[142:143], v[140:141], v[130:131], v[142:143] op_sel:[1,1,0] op_sel_hi:[1,0,1] neg_lo:[1,0,0]
ds_write_b32 v189, v150 offset:3264
v_cvt_pk_bf16_f32 v145, v138, v139
v_pk_mul_f32 v[136:137], v[138:139], v[132:133] op_sel_hi:[0,1]
v_pk_fma_f32 v[136:137], v[138:139], v[132:133], v[136:137] op_sel:[1,1,0] op_sel_hi:[1,0,1] neg_lo:[1,0,0]
ds_write_b32 v189, v145 offset:15776
v_cvt_pk_bf16_f32 v146, v136, v137
v_pk_mul_f32 v[138:139], v[136:137], v[132:133] op_sel_hi:[0,1]
v_pk_fma_f32 v[138:139], v[136:137], v[132:133], v[138:139] op_sel:[1,1,0] op_sel_hi:[1,0,1] neg_lo:[1,0,0]
ds_write_b32 v189, v146 offset:16320
v_cvt_pk_bf16_f32 v151, v142, v143
v_pk_mul_f32 v[140:141], v[142:143], v[130:131] op_sel_hi:[0,1]
v_pk_fma_f32 v[140:141], v[142:143], v[130:131], v[140:141] op_sel:[1,1,0] op_sel_hi:[1,0,1] neg_lo:[1,0,0]
ds_write_b32 v189, v151 offset:3808
buffer_load_dwordx4 v14, s[8:11], s27 offen offset:1024 lds
v_cvt_pk_bf16_f32 v147, v138, v139
v_pk_mul_f32 v[136:137], v[138:139], v[132:133] op_sel_hi:[0,1]
v_pk_fma_f32 v[136:137], v[138:139], v[132:133], v[136:137] op_sel:[1,1,0] op_sel_hi:[1,0,1] neg_lo:[1,0,0]
ds_write_b32 v189, v147 offset:16864
v_cvt_pk_bf16_f32 v144, v136, v137
v_pk_mul_f32 v[138:139], v[136:137], v[132:133] op_sel_hi:[0,1]
v_pk_fma_f32 v[138:139], v[136:137], v[132:133], v[138:139] op_sel:[1,1,0] op_sel_hi:[1,0,1] neg_lo:[1,0,0]
ds_write_b32 v189, v144 offset:17408
v_cvt_pk_bf16_f32 v148, v140, v141
v_pk_mul_f32 v[142:143], v[140:141], v[130:131] op_sel_hi:[0,1]
v_pk_fma_f32 v[142:143], v[140:141], v[130:131], v[142:143] op_sel:[1,1,0] op_sel_hi:[1,0,1] neg_lo:[1,0,0]
ds_write_b32 v189, v148 offset:4352
v_cvt_pk_bf16_f32 v145, v138, v139
v_pk_mul_f32 v[136:137], v[138:139], v[132:133] op_sel_hi:[0,1]
v_pk_fma_f32 v[136:137], v[138:139], v[132:133], v[136:137] op_sel:[1,1,0] op_sel_hi:[1,0,1] neg_lo:[1,0,0]
ds_write_b32 v189, v145 offset:17952
v_cvt_pk_bf16_f32 v146, v136, v137
v_pk_mul_f32 v[138:139], v[136:137], v[132:133] op_sel_hi:[0,1]
v_pk_fma_f32 v[138:139], v[136:137], v[132:133], v[138:139] op_sel:[1,1,0] op_sel_hi:[1,0,1] neg_lo:[1,0,0]
ds_write_b32 v189, v146 offset:18496
v_cvt_pk_bf16_f32 v149, v142, v143
v_pk_mul_f32 v[140:141], v[142:143], v[130:131] op_sel_hi:[0,1]
v_pk_fma_f32 v[140:141], v[142:143], v[130:131], v[140:141] op_sel:[1,1,0] op_sel_hi:[1,0,1] neg_lo:[1,0,0]
ds_write_b32 v189, v149 offset:4896
s_add_u32 m0, s25, 16384
s_add_u32 s27, s20, 589824
buffer_load_dwordx4 v13, s[8:11], s27 offen lds
v_cvt_pk_bf16_f32 v147, v138, v139
v_pk_mul_f32 v[136:137], v[138:139], v[132:133] op_sel_hi:[0,1]
v_pk_fma_f32 v[136:137], v[138:139], v[132:133], v[136:137] op_sel:[1,1,0] op_sel_hi:[1,0,1] neg_lo:[1,0,0]
ds_write_b32 v189, v147 offset:19040
v_cvt_pk_bf16_f32 v144, v136, v137
v_pk_mul_f32 v[138:139], v[136:137], v[132:133] op_sel_hi:[0,1]
v_pk_fma_f32 v[138:139], v[136:137], v[132:133], v[138:139] op_sel:[1,1,0] op_sel_hi:[1,0,1] neg_lo:[1,0,0]
ds_write_b32 v189, v144 offset:19584
v_cvt_pk_bf16_f32 v150, v140, v141
v_pk_mul_f32 v[142:143], v[140:141], v[130:131] op_sel_hi:[0,1]
v_pk_fma_f32 v[142:143], v[140:141], v[130:131], v[142:143] op_sel:[1,1,0] op_sel_hi:[1,0,1] neg_lo:[1,0,0]
ds_write_b32 v189, v150 offset:5440
v_cvt_pk_bf16_f32 v145, v138, v139
v_pk_mul_f32 v[136:137], v[138:139], v[132:133] op_sel_hi:[0,1]
v_pk_fma_f32 v[136:137], v[138:139], v[132:133], v[136:137] op_sel:[1,1,0] op_sel_hi:[1,0,1] neg_lo:[1,0,0]
ds_write_b32 v189, v145 offset:20128
v_cvt_pk_bf16_f32 v146, v136, v137
v_pk_mul_f32 v[138:139], v[136:137], v[132:133] op_sel_hi:[0,1]
v_pk_fma_f32 v[138:139], v[136:137], v[132:133], v[138:139] op_sel:[1,1,0] op_sel_hi:[1,0,1] neg_lo:[1,0,0]
ds_write_b32 v189, v146 offset:20672
v_cvt_pk_bf16_f32 v151, v142, v143
v_pk_mul_f32 v[140:141], v[142:143], v[130:131] op_sel_hi:[0,1]
v_pk_fma_f32 v[140:141], v[142:143], v[130:131], v[140:141] op_sel:[1,1,0] op_sel_hi:[1,0,1] neg_lo:[1,0,0]
ds_write_b32 v189, v151 offset:5984
buffer_load_dwordx4 v14, s[8:11], s27 offen offset:1024 lds
v_cvt_pk_bf16_f32 v147, v138, v139
v_pk_mul_f32 v[136:137], v[138:139], v[132:133] op_sel_hi:[0,1]
v_pk_fma_f32 v[136:137], v[138:139], v[132:133], v[136:137] op_sel:[1,1,0] op_sel_hi:[1,0,1] neg_lo:[1,0,0]
ds_write_b32 v189, v147 offset:21216
v_cvt_pk_bf16_f32 v144, v136, v137
v_pk_mul_f32 v[138:139], v[136:137], v[132:133] op_sel_hi:[0,1]
v_pk_fma_f32 v[138:139], v[136:137], v[132:133], v[138:139] op_sel:[1,1,0] op_sel_hi:[1,0,1] neg_lo:[1,0,0]
ds_write_b32 v189, v144 offset:21760
v_cvt_pk_bf16_f32 v148, v140, v141
v_pk_mul_f32 v[142:143], v[140:141], v[130:131] op_sel_hi:[0,1]
v_pk_fma_f32 v[142:143], v[140:141], v[130:131], v[142:143] op_sel:[1,1,0] op_sel_hi:[1,0,1] neg_lo:[1,0,0]
ds_write_b32 v189, v148 offset:6528
v_cvt_pk_bf16_f32 v145, v138, v139
v_pk_mul_f32 v[136:137], v[138:139], v[132:133] op_sel_hi:[0,1]
v_pk_fma_f32 v[136:137], v[138:139], v[132:133], v[136:137] op_sel:[1,1,0] op_sel_hi:[1,0,1] neg_lo:[1,0,0]
ds_write_b32 v189, v145 offset:22304
v_cvt_pk_bf16_f32 v146, v136, v137
v_pk_mul_f32 v[138:139], v[136:137], v[132:133] op_sel_hi:[0,1]
v_pk_fma_f32 v[138:139], v[136:137], v[132:133], v[138:139] op_sel:[1,1,0] op_sel_hi:[1,0,1] neg_lo:[1,0,0]
ds_write_b32 v189, v146 offset:22848
v_cvt_pk_bf16_f32 v149, v142, v143
v_pk_mul_f32 v[140:141], v[142:143], v[130:131] op_sel_hi:[0,1]
v_pk_fma_f32 v[140:141], v[142:143], v[130:131], v[140:141] op_sel:[1,1,0] op_sel_hi:[1,0,1] neg_lo:[1,0,0]
ds_write_b32 v189, v149 offset:7072
s_add_u32 m0, s25, 24576
s_add_u32 s27, s20, 884736
buffer_load_dwordx4 v13, s[8:11], s27 offen lds
v_cvt_pk_bf16_f32 v147, v138, v139
v_pk_mul_f32 v[136:137], v[138:139], v[132:133] op_sel_hi:[0,1]
v_pk_fma_f32 v[136:137], v[138:139], v[132:133], v[136:137] op_sel:[1,1,0] op_sel_hi:[1,0,1] neg_lo:[1,0,0]
ds_write_b32 v189, v147 offset:23392
v_cvt_pk_bf16_f32 v144, v136, v137
v_pk_mul_f32 v[138:139], v[136:137], v[132:133] op_sel_hi:[0,1]
v_pk_fma_f32 v[138:139], v[136:137], v[132:133], v[138:139] op_sel:[1,1,0] op_sel_hi:[1,0,1] neg_lo:[1,0,0]
ds_write_b32 v189, v144 offset:23936
v_cvt_pk_bf16_f32 v150, v140, v141
v_pk_mul_f32 v[142:143], v[140:141], v[130:131] op_sel_hi:[0,1]
v_pk_fma_f32 v[142:143], v[140:141], v[130:131], v[142:143] op_sel:[1,1,0] op_sel_hi:[1,0,1] neg_lo:[1,0,0]
ds_write_b32 v189, v150 offset:7616
v_cvt_pk_bf16_f32 v145, v138, v139
v_pk_mul_f32 v[136:137], v[138:139], v[132:133] op_sel_hi:[0,1]
v_pk_fma_f32 v[136:137], v[138:139], v[132:133], v[136:137] op_sel:[1,1,0] op_sel_hi:[1,0,1] neg_lo:[1,0,0]
ds_write_b32 v189, v145 offset:24480
v_cvt_pk_bf16_f32 v146, v136, v137
v_pk_mul_f32 v[138:139], v[136:137], v[132:133] op_sel_hi:[0,1]
v_pk_fma_f32 v[138:139], v[136:137], v[132:133], v[138:139] op_sel:[1,1,0] op_sel_hi:[1,0,1] neg_lo:[1,0,0]
ds_write_b32 v189, v146 offset:25024
v_cvt_pk_bf16_f32 v151, v142, v143
ds_write_b32 v189, v151 offset:8160
buffer_load_dwordx4 v14, s[8:11], s27 offen offset:1024 lds
v_cvt_pk_bf16_f32 v147, v138, v139
ds_write_b32 v189, v147 offset:25568
v_lshlrev_b32 v196, 3, v0
v_sub_u32 v196, 2047, v196
s_movk_i32 s56, 0x600
v_subrev_u32 v197, 0, v196
v_cvt_f32_u32 v197, v197
v_cvt_pk_bf16_f32 v197, v197, v197
v_lshlrev_b32 v197, 16, v197
v_cvt_u32_f32 v197, v197
v_and_b32 v206, -4, v197
v_add_u32 v206, s56, v206
v_lshlrev_b32 v197, 2, v197
v_min_u32 v197, v197, v206
v_add_u32 v197, 158720, v197
v_subrev_u32 v198, 1, v196
v_cvt_f32_u32 v198, v198
v_cvt_pk_bf16_f32 v198, v198, v198
v_lshlrev_b32 v198, 16, v198
v_cvt_u32_f32 v198, v198
v_and_b32 v206, -4, v198
v_add_u32 v206, s56, v206
v_lshlrev_b32 v198, 2, v198
v_min_u32 v198, v198, v206
v_add_u32 v198, 158720, v198
v_subrev_u32 v199, 2, v196
v_cvt_f32_u32 v199, v199
v_cvt_pk_bf16_f32 v199, v199, v199
v_lshlrev_b32 v199, 16, v199
v_cvt_u32_f32 v199, v199
v_and_b32 v206, -4, v199
v_add_u32 v206, s56, v206
v_lshlrev_b32 v199, 2, v199
v_min_u32 v199, v199, v206
v_add_u32 v199, 158720, v199
v_subrev_u32 v200, 3, v196
v_cvt_f32_u32 v200, v200
v_cvt_pk_bf16_f32 v200, v200, v200
v_lshlrev_b32 v200, 16, v200
v_cvt_u32_f32 v200, v200
v_and_b32 v206, -4, v200
v_add_u32 v206, s56, v206
v_lshlrev_b32 v200, 2, v200
v_min_u32 v200, v200, v206
v_add_u32 v200, 158720, v200
v_subrev_u32 v201, 4, v196
v_cvt_f32_u32 v201, v201
v_cvt_pk_bf16_f32 v201, v201, v201
v_lshlrev_b32 v201, 16, v201
v_cvt_u32_f32 v201, v201
v_and_b32 v206, -4, v201
v_add_u32 v206, s56, v206
v_lshlrev_b32 v201, 2, v201
v_min_u32 v201, v201, v206
v_add_u32 v201, 158720, v201
v_subrev_u32 v202, 5, v196
v_cvt_f32_u32 v202, v202
v_cvt_pk_bf16_f32 v202, v202, v202
v_lshlrev_b32 v202, 16, v202
v_cvt_u32_f32 v202, v202
v_and_b32 v206, -4, v202
v_add_u32 v206, s56, v206
v_lshlrev_b32 v202, 2, v202
v_min_u32 v202, v202, v206
v_add_u32 v202, 158720, v202
v_subrev_u32 v203, 6, v196
v_cvt_f32_u32 v203, v203
v_cvt_pk_bf16_f32 v203, v203, v203
v_lshlrev_b32 v203, 16, v203
v_cvt_u32_f32 v203, v203
v_and_b32 v206, -4, v203
v_add_u32 v206, s56, v206
v_lshlrev_b32 v203, 2, v203
v_min_u32 v203, v203, v206
v_add_u32 v203, 158720, v203
v_subrev_u32 v204, 7, v196
v_cvt_f32_u32 v204, v204
v_cvt_pk_bf16_f32 v204, v204, v204
v_lshlrev_b32 v204, 16, v204
v_cvt_u32_f32 v204, v204
v_and_b32 v206, -4, v204
v_add_u32 v206, s56, v206
v_lshlrev_b32 v204, 2, v204
v_min_u32 v204, v204, v206
v_add_u32 v204, 158720, v204
v_subrev_u32 v205, 8, v196
v_max_i32 v205, 0, v205
v_cvt_f32_u32 v205, v205
v_cvt_pk_bf16_f32 v205, v205, v205
v_lshlrev_b32 v205, 16, v205
v_cvt_u32_f32 v205, v205
v_and_b32 v206, -4, v205
v_add_u32 v206, s56, v206
v_lshlrev_b32 v205, 2, v205
v_min_u32 v205, v205, v206
v_add_u32 v205, 158720, v205
s_cmp_ge_u32 s97, 24
s_cbranch_scc1 KF_SET_CONV
s_lshr_b32 s33, s96, 1
s_mul_i32 s34, s97, 0x5556
s_lshr_b32 s34, s34, 16
s_mul_i32 s35, s34, 3
s_sub_u32 s35, s97, s35
s_and_b32 s39, s96, 1
s_lshl_b32 s39, s39, 3
s_add_u32 s34, s34, s39
v_and_b32 v49, 63, v0
s_mul_i32 s43, s98, 3072
s_mul_i32 s36, s33, 1152
s_lshl_b32 s37, s98, 3
s_add_u32 s36, s36, s37
s_mul_i32 s36, s36, 1152
s_mul_i32 s37, s35, 384
s_add_u32 s40, s36, s37
s_lshl_b32 s36, s34, 3
s_lshl_b32 s37, s98, 1
s_add_u32 s36, s36, s37
s_mul_i32 s37, s36, 144
s_mul_i32 s38, s33, 36
s_add_u32 s37, s37, s38
s_lshl_b32 s41, s37, 10
s_add_u32 s42, s41, 147456
s_lshl_b32 s37, s33, 7
s_add_u32 s37, s37, s36
s_mul_i32 s37, s37, 18
s_mul_i32 s38, s35, 6
s_add_u32 s37, s37, s38
s_lshl_b32 s46, s37, 10
v_lshrrev_b32 v50, 3, v49
v_mul_u32_u24 v51, 1152, v50
v_lshrrev_b32 v50, 1, v50
v_bfe_u32 v52, v49, 1, 2
v_xor_b32 v52, v52, v50
v_lshlrev_b32 v52, 5, v52
v_add_u32 v51, v51, v52
v_and_b32 v52, 1, v49
v_lshlrev_b32 v52, 4, v52
v_add_u32 v48, v51, v52
v_lshrrev_b32 v50, 5, v49
v_mul_u32_u24 v51, 3072, v50
v_bfe_u32 v50, v49, 4, 1
v_bfe_u32 v52, v49, 2, 2
v_lshl_add_u32 v53, v50, 2, v52
v_lshlrev_b32 v54, 7, v53
v_add_u32 v51, v51, v54
v_lshrrev_b32 v53, 1, v53
v_lshlrev_b32 v53, 5, v53
v_add_u32 v51, v51, v53
v_and_b32 v52, 3, v49
v_lshlrev_b32 v52, 3, v52
v_add_u32 v36, v51, v52
v_xor_b32 v39, 32, v36
v_xor_b32 v42, 64, v36
v_xor_b32 v45, 96, v36
v_add_u32 v37, 61440, v36
v_add_u32 v40, 61440, v39
v_add_u32 v43, 61440, v42
v_add_u32 v46, 61440, v45
v_add_u32 v38, 122880, v36
v_add_u32 v41, 122880, v39
v_add_u32 v44, 122880, v42
v_add_u32 v47, 122880, v45
v_add_u32 v48, 2048, v48
v_subrev_u32 v49, 896, v48
v_subrev_u32 v50, 1792, v48
v_add_u32 v51, 147456, v15
v_and_b32 v52, 1, v0
v_bfe_u32 v53, v0, 1, 1
v_lshl_add_u32 v52, v53, 3, v52
s_lshl_b32 s36, s34, 4
s_lshl_b32 s37, s33, 1
s_add_u32 s36, s36, s37
v_add_u32 v52, s36, v52
v_lshlrev_b32 v52, 7, v52
v_add_u32 v52, 40894484, v52
v_subrev_u32 v58, 12, v52
v_add_u32 v54, 4, v52
s_branch KF_SET_DONE
KF_SET_CONV:
s_sub_u32 s33, s2, 192
v_and_b32 v49, 63, v0
s_lshl_b32 s40, s33, 2
s_add_u32 s36, s40, s98
s_mul_i32 s41, s98, 16640
s_mul_i32 s43, s36, 8448
s_lshl_b32 s45, s36, 12
s_lshl_b32 s44, s40, 4
s_mul_i32 s37, s98, 589824
s_add_u32 s44, s44, s37
s_lshl_b32 s46, s98, 12
s_add_u32 s36, s33, 512
s_mul_i32 s47, s36, 8448
s_lshl_b32 s49, s36, 12
s_lshl_b32 s38, s98, 10
s_add_u32 s49, s49, s38
s_and_b32 s36, s36, 0xfffffffc
s_lshl_b32 s36, s36, 4
s_add_u32 s48, s36, s37
v_and_b32 v50, 15, v49
v_lshrrev_b32 v51, 4, v49
v_and_b32 v52, 3, v50
v_mul_u32_u24 v52, 4160, v52
v_lshrrev_b32 v53, 2, v50
v_lshlrev_b32 v53, 3, v53
v_sub_u32 v52, v52, v53
v_lshlrev_b32 v53, 4, v51
v_add_u32 v52, v52, v53
v_add_u32 v52, 24, v52
v_add_u32 v36, s41, v52
v_lshl_add_u32 v52, v50, 1, v51
v_add_u32 v52, 30, v52
v_lshrrev_b32 v53, 2, v52
v_add_u32 v53, s98, v53
v_lshlrev_b32 v52, 6, v52
v_add_u32 v52, 64768, v52
v_add_u32 v54, 0, v53
v_and_b32 v54, 3, v54
v_lshl_add_u32 v41, v54, 4, v52
v_add_u32 v54, 1, v53
v_and_b32 v54, 3, v54
v_lshl_add_u32 v42, v54, 4, v52
v_add_u32 v54, 2, v53
v_and_b32 v54, 3, v54
v_lshl_add_u32 v43, v54, 4, v52
v_add_u32 v54, 3, v53
v_and_b32 v54, 3, v54
v_lshl_add_u32 v44, v54, 4, v52
s_and_b32 s36, s33, 3
s_lshl_b32 s38, s98, 1
s_sub_u32 s36, s36, s38
v_add_u32 v54, s36, v53
v_and_b32 v54, 3, v54
v_lshl_add_u32 v54, v54, 4, v52
s_lshl_b32 s38, s98, 8
s_sub_u32 s38, 768, s38
v_add_u32 v38, s38, v54
s_lshl_b32 s38, s98, 6
s_add_u32 s38, s38, s41
s_sub_u32 s38, 103424, s38
v_add_u32 v37, s38, v36
s_and_b32 s36, s98, 1
s_xor_b32 s36, s36, 1
s_mul_i32 s36, s36, 4224
s_lshr_b32 s38, s98, 1
s_xor_b32 s38, s38, 1
s_lshl_b32 s38, s38, 2
s_add_u32 s36, s36, s38
s_add_u32 s47, s47, s36
v_lshlrev_b32 v52, 5, v50
v_lshlrev_b32 v53, 3, v51
v_add_u32 v39, v52, v53
v_lshrrev_b32 v52, 2, v49
v_mul_u32_u24 v52, 9216, v52
v_and_b32 v53, 3, v49
v_sub_u32 v53, v53, v51
v_and_b32 v53, 3, v53
v_lshl_add_u32 v40, v53, 4, v52
v_mov_b32 v52, v0
v_lshlrev_b32 v52, 7, v52
v_add_u32 v52, 40894468, v52
v_mov_b32 v58, 0
KF_SET_DONE:
s_waitcnt vmcnt(8) lgkmcnt(0)
v_readfirstlane_b32 s100, v63
s_mov_b32 s56, 0x40000
s_cmp_lg_u32 s100, 0
s_cbranch_scc1 TAG_DONE
TAG_POLL:
global_load_dword v63, v62, s[4:5] sc1
s_waitcnt vmcnt(0)
v_readfirstlane_b32 s100, v63
s_sub_u32 s56, s56, 1
s_cmp_eq_u32 s56, 0
s_cbranch_scc1 TAG_DONE
s_cmp_eq_u32 s100, 0
s_cbranch_scc1 TAG_POLL
TAG_DONE:
s_barrier
s_cmp_lg_u32 s98, 0
s_cbranch_scc1 SIG_1
s_lshl_b32 s56, s2, 7
s_add_u32 s56, s56, 40894464
v_mov_b32 v60, s56
v_mov_b32 v61, s100
s_mov_b64 exec, 1
global_store_dword v60, v61, s[6:7] sc1
s_mov_b64 exec, -1
SIG_1:
v_add_u32 v119, 0, v117
global_store_dwordx4 v119, v[212:215], s[6:7] sc1
v_add_u32 v119, 4096, v117
global_store_dwordx4 v119, v[216:219], s[6:7] sc1
s_cmp_lg_u32 s98, 0
s_cbranch_scc1 LN_NO3B
v_add_u32 v119, 8192, v117
global_store_dwordx4 v119, v[220:223], s[6:7] sc1
LN_NO3B:
KG_LOOP:
ds_read_b128 v[212:215], v194 offset:8704
ds_read_b128 v[72:75], v193 offset:0
ds_read_b128 v[216:219], v194 offset:8768
ds_read_b128 v[76:79], v193 offset:64
ds_read_b128 v[220:223], v194 offset:8832
ds_read_b128 v[80:83], v193 offset:128
ds_read_b128 v[224:227], v194 offset:8896
ds_read_b128 v[84:87], v193 offset:192
ds_read_b128 v[228:231], v194 offset:8960
ds_read_b128 v[88:91], v193 offset:256
ds_read_b128 v[232:235], v194 offset:9024
ds_read_b128 v[92:95], v193 offset:320
ds_read_b128 v[236:239], v194 offset:9088
ds_read_b128 v[96:99], v193 offset:384
ds_read_b128 v[240:243], v194 offset:9152
ds_read_b128 v[100:103], v193 offset:448
v_mov_b32 v164, v170
v_mov_b32 v165, v171
v_mov_b32 v166, v172
v_mov_b32 v167, v173
v_mov_b32 v168, v174
v_mov_b32 v169, v175
v_mov_b32 v170, v176
v_mov_b32 v171, v177
v_mov_b32 v172, v178
v_mov_b32 v173, v179
v_mov_b32 v174, v180
v_mov_b32 v175, v181
s_cmp_eq_u32 s91, s2
s_mov_b32 s101, 64
s_cselect_b32 s101, 256, s101
s_add_u32 s101, s91, s101
s_sub_u32 s57, s2, 192
s_cmp_lt_u32 s57, 64
s_cselect_b32 s57, 1, 0
s_add_u32 s56, s2, 256
s_cmp_eq_u32 s91, s56
s_cselect_b32 s57, s57, 0
s_cmp_eq_u32 s91, s2
s_cselect_b32 s57, 1, s57
s_cmp_eq_u32 s57, 0
s_cselect_b32 s101, 576, s101
s_cmp_ge_u32 s101, 576
s_cbranch_scc1 KG_NOS
v_lshlrev_b32 v164, 16, v164
v_lshlrev_b32 v165, 16, v165
v_lshlrev_b32 v166, 16, v166
v_lshlrev_b32 v167, 16, v167
v_lshlrev_b32 v168, 16, v168
v_mul_f32 v127, s88, v168
v_fma_f32 v128, s88, v168, -v127
v_fmac_f32 v128, s89, v168
v_exp_f32 v124, v127
v_mul_f32 v128, s90, v128
v_fmac_f32 v124, v124, v128
v_cvt_pk_bf16_f32 v124, v124, v124
v_lshlrev_b32 v124, 16, v124
v_mul_f32 v127, s88, v164
v_fma_f32 v128, s88, v164, -v127
v_fmac_f32 v128, s89, v164
v_exp_f32 v125, v127
v_mul_f32 v128, s90, v128
v_fmac_f32 v125, v125, v128
v_cvt_pk_bf16_f32 v125, v125, v125
v_lshlrev_b32 v125, 16, v125
v_mul_f32 v125, v125, v124
v_mul_f32 v126, v165, v124
v_mul_f32 v125, s88, v125
v_sub_f32 v125, 0, v125
v_mul_f32 v126, 0.15915494, v126
v_add_f32 v124, v124, v124
v_mul_f32 v166, v166, v124
v_mul_f32 v167, v167, v124
v_mul_f32 v127, v125, v186
v_mul_f32 v128, v126, v186
v_exp_f32 v127, v127
v_fract_f32 v128, v128
v_cos_f32 v130, v128
v_sin_f32 v131, v128
s_nop 0
v_mul_f32 v130, v130, v127
v_mul_f32 v131, v131, v127
v_mul_f32 v127, v125, v187
v_mul_f32 v128, v126, v187
v_exp_f32 v127, v127
v_fract_f32 v128, v128
v_cos_f32 v132, v128
v_sin_f32 v133, v128
s_nop 0
v_mul_f32 v132, v132, v127
v_mul_f32 v133, v133, v127
v_mul_f32 v127, v125, v188
v_mul_f32 v128, v126, v188
v_exp_f32 v127, v127
v_fract_f32 v128, v128
v_cos_f32 v134, v128
v_sin_f32 v135, v128
s_nop 0
v_mul_f32 v134, v134, v127
v_mul_f32 v135, v135, v127
v_mul_f32 v136, v166, v134
v_mul_f32 v137, v166, v135
v_fma_f32 v136, -v167, v135, v136
v_fmac_f32 v137, v167, v134
v_sub_f32 v131, 0, v131
v_mov_b32 v140, 1.0
v_mov_b32 v141, 0
KG_NOS:
s_waitcnt lgkmcnt(0)
v_mfma_f32_16x16x32_bf16 v[152:155], v[212:215], v[72:75], 0
v_mfma_f32_16x16x32_bf16 v[156:159], v[216:219], v[76:79], 0
v_mfma_f32_16x16x32_bf16 v[152:155], v[220:223], v[80:83], v[152:155]
v_mfma_f32_16x16x32_bf16 v[156:159], v[224:227], v[84:87], v[156:159]
v_mfma_f32_16x16x32_bf16 v[152:155], v[228:231], v[88:91], v[152:155]
v_mfma_f32_16x16x32_bf16 v[156:159], v[232:235], v[92:95], v[156:159]
v_mfma_f32_16x16x32_bf16 v[152:155], v[236:239], v[96:99], v[152:155]
v_mfma_f32_16x16x32_bf16 v[156:159], v[240:243], v[100:103], v[156:159]
s_mul_i32 s56, s91, 8448
s_add_u32 s56, s56, 4718592
s_add_u32 s58, s6, s56
s_addc_u32 s59, s7, 0
v_cmp_eq_u32 vcc, 255, v0
s_nop 3
v_add_f32 v152, v152, v156
v_add_f32 v153, v153, v157
v_add_f32 v154, v154, v158
v_add_f32 v155, v155, v159
ds_write_b32 v195, v152 offset:0
ds_write_b32 v195, v153 offset:64
ds_write_b32 v195, v154 offset:128
ds_write_b32 v195, v155 offset:192
v_cndmask_b32 v129, 0, v129, vcc
s_waitcnt lgkmcnt(0)
s_barrier
ds_read_b32 v154, v197
ds_read_b32 v155, v198
ds_read_b32 v156, v199
ds_read_b32 v157, v200
ds_read_b32 v158, v201
ds_read_b32 v159, v202
ds_read_b32 v160, v203
ds_read_b32 v161, v204
ds_read_b32 v162, v205
s_cmp_ge_u32 s101, 576
s_cbranch_scc1 KG_NOC1
v_cvt_pk_bf16_f32 v144, v136, v137
v_pk_mul_f32 v[138:139], v[136:137], v[132:133] op_sel_hi:[0,1]
v_pk_fma_f32 v[138:139], v[136:137], v[132:133], v[138:139] op_sel:[1,1,0] op_sel_hi:[1,0,1] neg_lo:[1,0,0]
ds_write_b32 v189, v144 offset:8704
v_cvt_pk_bf16_f32 v148, v140, v141
v_pk_mul_f32 v[142:143], v[140:141], v[130:131] op_sel_hi:[0,1]
v_pk_fma_f32 v[142:143], v[140:141], v[130:131], v[142:143] op_sel:[1,1,0] op_sel_hi:[1,0,1] neg_lo:[1,0,0]
ds_write_b32 v189, v148 offset:0
v_cvt_pk_bf16_f32 v145, v138, v139
v_pk_mul_f32 v[136:137], v[138:139], v[132:133] op_sel_hi:[0,1]
v_pk_fma_f32 v[136:137], v[138:139], v[132:133], v[136:137] op_sel:[1,1,0] op_sel_hi:[1,0,1] neg_lo:[1,0,0]
ds_write_b32 v189, v145 offset:9248
v_cvt_pk_bf16_f32 v146, v136, v137
v_pk_mul_f32 v[138:139], v[136:137], v[132:133] op_sel_hi:[0,1]
v_pk_fma_f32 v[138:139], v[136:137], v[132:133], v[138:139] op_sel:[1,1,0] op_sel_hi:[1,0,1] neg_lo:[1,0,0]
ds_write_b32 v189, v146 offset:9792
v_cvt_pk_bf16_f32 v149, v142, v143
v_pk_mul_f32 v[140:141], v[142:143], v[130:131] op_sel_hi:[0,1]
v_pk_fma_f32 v[140:141], v[142:143], v[130:131], v[140:141] op_sel:[1,1,0] op_sel_hi:[1,0,1] neg_lo:[1,0,0]
ds_write_b32 v189, v149 offset:544
v_cvt_pk_bf16_f32 v147, v138, v139
v_pk_mul_f32 v[136:137], v[138:139], v[132:133] op_sel_hi:[0,1]
v_pk_fma_f32 v[136:137], v[138:139], v[132:133], v[136:137] op_sel:[1,1,0] op_sel_hi:[1,0,1] neg_lo:[1,0,0]
ds_write_b32 v189, v147 offset:10336
v_cvt_pk_bf16_f32 v144, v136, v137
v_pk_mul_f32 v[138:139], v[136:137], v[132:133] op_sel_hi:[0,1]
v_pk_fma_f32 v[138:139], v[136:137], v[132:133], v[138:139] op_sel:[1,1,0] op_sel_hi:[1,0,1] neg_lo:[1,0,0]
ds_write_b32 v189, v144 offset:10880
v_cvt_pk_bf16_f32 v150, v140, v141
v_pk_mul_f32 v[142:143], v[140:141], v[130:131] op_sel_hi:[0,1]
v_pk_fma_f32 v[142:143], v[140:141], v[130:131], v[142:143] op_sel:[1,1,0] op_sel_hi:[1,0,1] neg_lo:[1,0,0]
ds_write_b32 v189, v150 offset:1088
v_cvt_pk_bf16_f32 v145, v138, v139
v_pk_mul_f32 v[136:137], v[138:139], v[132:133] op_sel_hi:[0,1]
v_pk_fma_f32 v[136:137], v[138:139], v[132:133], v[136:137] op_sel:[1,1,0] op_sel_hi:[1,0,1] neg_lo:[1,0,0]
ds_write_b32 v189, v145 offset:11424
s_waitcnt lgkmcnt(9)
v_cmp_eq_u32 vcc, 255, v0
v_add_f32 v161, v161, v129
s_nop 0
v_cndmask_b32_e64 v162, v162, 0, vcc
v_cvt_pk_bf16_f32 v108, v154, v155
v_cvt_pk_bf16_f32 v112, v155, v156
v_cvt_pk_bf16_f32 v109, v156, v157
v_cvt_pk_bf16_f32 v113, v157, v158
v_cvt_pk_bf16_f32 v110, v158, v159
v_cvt_pk_bf16_f32 v114, v159, v160
v_cvt_pk_bf16_f32 v111, v160, v161
v_cvt_pk_bf16_f32 v115, v161, v162
s_branch KG_G_DONE
KG_NOC1:
s_waitcnt lgkmcnt(0)
v_cmp_eq_u32 vcc, 255, v0
v_add_f32 v161, v161, v129
s_nop 0
v_cndmask_b32_e64 v162, v162, 0, vcc
v_cvt_pk_bf16_f32 v108, v154, v155
v_cvt_pk_bf16_f32 v112, v155, v156
v_cvt_pk_bf16_f32 v109, v156, v157
v_cvt_pk_bf16_f32 v113, v157, v158
v_cvt_pk_bf16_f32 v110, v158, v159
v_cvt_pk_bf16_f32 v114, v159, v160
v_cvt_pk_bf16_f32 v111, v160, v161
v_cvt_pk_bf16_f32 v115, v161, v162
global_store_dwordx4 v207, v[108:111], s[58:59] sc1
global_store_dwordx4 v208, v[112:115], s[58:59] sc1
v_mov_b32 v120, 0
v_mov_b32 v121, 0
v_mov_b32 v122, 0
v_mov_b32 v123, 0
v_cmp_gt_u32 vcc, 2, v0
s_nop 0
s_and_saveexec_b64 s[56:57], vcc
s_cbranch_execz KZ_2
global_store_dwordx4 v209, v[120:123], s[58:59] sc1
KZ_2:
s_mov_b64 exec, -1
s_branch KG_END
KG_G_DONE:
s_cmp_lg_u32 s91, s2
s_cbranch_scc1 KG_NOX
v_and_b32 v56, 15, v0
s_lshr_b32 s57, s97, 1
s_lshl_b32 s57, s57, 4
v_add_u32 v56, s57, v56
v_lshlrev_b32 v56, 7, v56
v_add_u32 v56, 40894464, v56
global_load_dword v57, v56, s[6:7] sc1
KG_NOX:
v_cvt_pk_bf16_f32 v146, v136, v137
v_pk_mul_f32 v[138:139], v[136:137], v[132:133] op_sel_hi:[0,1]
v_pk_fma_f32 v[138:139], v[136:137], v[132:133], v[138:139] op_sel:[1,1,0] op_sel_hi:[1,0,1] neg_lo:[1,0,0]
ds_write_b32 v189, v146 offset:11968
v_cvt_pk_bf16_f32 v151, v142, v143
v_pk_mul_f32 v[140:141], v[142:143], v[130:131] op_sel_hi:[0,1]
v_pk_fma_f32 v[140:141], v[142:143], v[130:131], v[140:141] op_sel:[1,1,0] op_sel_hi:[1,0,1] neg_lo:[1,0,0]
ds_write_b32 v189, v151 offset:1632
v_cvt_pk_bf16_f32 v147, v138, v139
v_pk_mul_f32 v[136:137], v[138:139], v[132:133] op_sel_hi:[0,1]
v_pk_fma_f32 v[136:137], v[138:139], v[132:133], v[136:137] op_sel:[1,1,0] op_sel_hi:[1,0,1] neg_lo:[1,0,0]
ds_write_b32 v189, v147 offset:12512
v_cvt_pk_bf16_f32 v144, v136, v137
v_pk_mul_f32 v[138:139], v[136:137], v[132:133] op_sel_hi:[0,1]
v_pk_fma_f32 v[138:139], v[136:137], v[132:133], v[138:139] op_sel:[1,1,0] op_sel_hi:[1,0,1] neg_lo:[1,0,0]
ds_write_b32 v189, v144 offset:13056
v_cvt_pk_bf16_f32 v148, v140, v141
v_pk_mul_f32 v[142:143], v[140:141], v[130:131] op_sel_hi:[0,1]
v_pk_fma_f32 v[142:143], v[140:141], v[130:131], v[142:143] op_sel:[1,1,0] op_sel_hi:[1,0,1] neg_lo:[1,0,0]
ds_write_b32 v189, v148 offset:2176
v_cvt_pk_bf16_f32 v145, v138, v139
v_pk_mul_f32 v[136:137], v[138:139], v[132:133] op_sel_hi:[0,1]
v_pk_fma_f32 v[136:137], v[138:139], v[132:133], v[136:137] op_sel:[1,1,0] op_sel_hi:[1,0,1] neg_lo:[1,0,0]
ds_write_b32 v189, v145 offset:13600
v_cvt_pk_bf16_f32 v146, v136, v137
v_pk_mul_f32 v[138:139], v[136:137], v[132:133] op_sel_hi:[0,1]
v_pk_fma_f32 v[138:139], v[136:137], v[132:133], v[138:139] op_sel:[1,1,0] op_sel_hi:[1,0,1] neg_lo:[1,0,0]
ds_write_b32 v189, v146 offset:14144
v_cvt_pk_bf16_f32 v149, v142, v143
v_pk_mul_f32 v[140:141], v[142:143], v[130:131] op_sel_hi:[0,1]
v_pk_fma_f32 v[140:141], v[142:143], v[130:131], v[140:141] op_sel:[1,1,0] op_sel_hi:[1,0,1] neg_lo:[1,0,0]
ds_write_b32 v189, v149 offset:2720
v_cvt_pk_bf16_f32 v147, v138, v139
v_pk_mul_f32 v[136:137], v[138:139], v[132:133] op_sel_hi:[0,1]
v_pk_fma_f32 v[136:137], v[138:139], v[132:133], v[136:137] op_sel:[1,1,0] op_sel_hi:[1,0,1] neg_lo:[1,0,0]
ds_write_b32 v189, v147 offset:14688
v_cvt_pk_bf16_f32 v144, v136, v137
v_pk_mul_f32 v[138:139], v[136:137], v[132:133] op_sel_hi:[0,1]
v_pk_fma_f32 v[138:139], v[136:137], v[132:133], v[138:139] op_sel:[1,1,0] op_sel_hi:[1,0,1] neg_lo:[1,0,0]
ds_write_b32 v189, v144 offset:15232
v_cvt_pk_bf16_f32 v150, v140, v141
v_pk_mul_f32 v[142:143], v[140:141], v[130:131] op_sel_hi:[0,1]
v_pk_fma_f32 v[142:143], v[140:141], v[130:131], v[142:143] op_sel:[1,1,0] op_sel_hi:[1,0,1] neg_lo:[1,0,0]
ds_write_b32 v189, v150 offset:3264
v_cvt_pk_bf16_f32 v145, v138, v139
v_pk_mul_f32 v[136:137], v[138:139], v[132:133] op_sel_hi:[0,1]
v_pk_fma_f32 v[136:137], v[138:139], v[132:133], v[136:137] op_sel:[1,1,0] op_sel_hi:[1,0,1] neg_lo:[1,0,0]
ds_write_b32 v189, v145 offset:15776
v_cvt_pk_bf16_f32 v146, v136, v137
v_pk_mul_f32 v[138:139], v[136:137], v[132:133] op_sel_hi:[0,1]
v_pk_fma_f32 v[138:139], v[136:137], v[132:133], v[138:139] op_sel:[1,1,0] op_sel_hi:[1,0,1] neg_lo:[1,0,0]
ds_write_b32 v189, v146 offset:16320
v_cvt_pk_bf16_f32 v151, v142, v143
v_pk_mul_f32 v[140:141], v[142:143], v[130:131] op_sel_hi:[0,1]
v_pk_fma_f32 v[140:141], v[142:143], v[130:131], v[140:141] op_sel:[1,1,0] op_sel_hi:[1,0,1] neg_lo:[1,0,0]
ds_write_b32 v189, v151 offset:3808
v_cvt_pk_bf16_f32 v147, v138, v139
v_pk_mul_f32 v[136:137], v[138:139], v[132:133] op_sel_hi:[0,1]
v_pk_fma_f32 v[136:137], v[138:139], v[132:133], v[136:137] op_sel:[1,1,0] op_sel_hi:[1,0,1] neg_lo:[1,0,0]
ds_write_b32 v189, v147 offset:16864
v_cvt_pk_bf16_f32 v144, v136, v137
v_pk_mul_f32 v[138:139], v[136:137], v[132:133] op_sel_hi:[0,1]
v_pk_fma_f32 v[138:139], v[136:137], v[132:133], v[138:139] op_sel:[1,1,0] op_sel_hi:[1,0,1] neg_lo:[1,0,0]
ds_write_b32 v189, v144 offset:17408
v_cvt_pk_bf16_f32 v148, v140, v141
v_pk_mul_f32 v[142:143], v[140:141], v[130:131] op_sel_hi:[0,1]
v_pk_fma_f32 v[142:143], v[140:141], v[130:131], v[142:143] op_sel:[1,1,0] op_sel_hi:[1,0,1] neg_lo:[1,0,0]
ds_write_b32 v189, v148 offset:4352
v_cvt_pk_bf16_f32 v145, v138, v139
v_pk_mul_f32 v[136:137], v[138:139], v[132:133] op_sel_hi:[0,1]
v_pk_fma_f32 v[136:137], v[138:139], v[132:133], v[136:137] op_sel:[1,1,0] op_sel_hi:[1,0,1] neg_lo:[1,0,0]
ds_write_b32 v189, v145 offset:17952
v_cvt_pk_bf16_f32 v146, v136, v137
v_pk_mul_f32 v[138:139], v[136:137], v[132:133] op_sel_hi:[0,1]
v_pk_fma_f32 v[138:139], v[136:137], v[132:133], v[138:139] op_sel:[1,1,0] op_sel_hi:[1,0,1] neg_lo:[1,0,0]
ds_write_b32 v189, v146 offset:18496
v_cvt_pk_bf16_f32 v149, v142, v143
v_pk_mul_f32 v[140:141], v[142:143], v[130:131] op_sel_hi:[0,1]
v_pk_fma_f32 v[140:141], v[142:143], v[130:131], v[140:141] op_sel:[1,1,0] op_sel_hi:[1,0,1] neg_lo:[1,0,0]
ds_write_b32 v189, v149 offset:4896
v_cvt_pk_bf16_f32 v147, v138, v139
v_pk_mul_f32 v[136:137], v[138:139], v[132:133] op_sel_hi:[0,1]
v_pk_fma_f32 v[136:137], v[138:139], v[132:133], v[136:137] op_sel:[1,1,0] op_sel_hi:[1,0,1] neg_lo:[1,0,0]
ds_write_b32 v189, v147 offset:19040
v_cvt_pk_bf16_f32 v144, v136, v137
v_pk_mul_f32 v[138:139], v[136:137], v[132:133] op_sel_hi:[0,1]
v_pk_fma_f32 v[138:139], v[136:137], v[132:133], v[138:139] op_sel:[1,1,0] op_sel_hi:[1,0,1] neg_lo:[1,0,0]
ds_write_b32 v189, v144 offset:19584
v_cvt_pk_bf16_f32 v150, v140, v141
v_pk_mul_f32 v[142:143], v[140:141], v[130:131] op_sel_hi:[0,1]
v_pk_fma_f32 v[142:143], v[140:141], v[130:131], v[142:143] op_sel:[1,1,0] op_sel_hi:[1,0,1] neg_lo:[1,0,0]
ds_write_b32 v189, v150 offset:5440
v_cvt_pk_bf16_f32 v145, v138, v139
v_pk_mul_f32 v[136:137], v[138:139], v[132:133] op_sel_hi:[0,1]
v_pk_fma_f32 v[136:137], v[138:139], v[132:133], v[136:137] op_sel:[1,1,0] op_sel_hi:[1,0,1] neg_lo:[1,0,0]
ds_write_b32 v189, v145 offset:20128
v_cvt_pk_bf16_f32 v146, v136, v137
v_pk_mul_f32 v[138:139], v[136:137], v[132:133] op_sel_hi:[0,1]
v_pk_fma_f32 v[138:139], v[136:137], v[132:133], v[138:139] op_sel:[1,1,0] op_sel_hi:[1,0,1] neg_lo:[1,0,0]
ds_write_b32 v189, v146 offset:20672
v_cvt_pk_bf16_f32 v151, v142, v143
v_pk_mul_f32 v[140:141], v[142:143], v[130:131] op_sel_hi:[0,1]
v_pk_fma_f32 v[140:141], v[142:143], v[130:131], v[140:141] op_sel:[1,1,0] op_sel_hi:[1,0,1] neg_lo:[1,0,0]
ds_write_b32 v189, v151 offset:5984
v_cvt_pk_bf16_f32 v147, v138, v139
v_pk_mul_f32 v[136:137], v[138:139], v[132:133] op_sel_hi:[0,1]
v_pk_fma_f32 v[136:137], v[138:139], v[132:133], v[136:137] op_sel:[1,1,0] op_sel_hi:[1,0,1] neg_lo:[1,0,0]
ds_write_b32 v189, v147 offset:21216
v_cvt_pk_bf16_f32 v144, v136, v137
v_pk_mul_f32 v[138:139], v[136:137], v[132:133] op_sel_hi:[0,1]
v_pk_fma_f32 v[138:139], v[136:137], v[132:133], v[138:139] op_sel:[1,1,0] op_sel_hi:[1,0,1] neg_lo:[1,0,0]
ds_write_b32 v189, v144 offset:21760
v_cvt_pk_bf16_f32 v148, v140, v141
v_pk_mul_f32 v[142:143], v[140:141], v[130:131] op_sel_hi:[0,1]
v_pk_fma_f32 v[142:143], v[140:141], v[130:131], v[142:143] op_sel:[1,1,0] op_sel_hi:[1,0,1] neg_lo:[1,0,0]
ds_write_b32 v189, v148 offset:6528
v_cvt_pk_bf16_f32 v145, v138, v139
v_pk_mul_f32 v[136:137], v[138:139], v[132:133] op_sel_hi:[0,1]
v_pk_fma_f32 v[136:137], v[138:139], v[132:133], v[136:137] op_sel:[1,1,0] op_sel_hi:[1,0,1] neg_lo:[1,0,0]
ds_write_b32 v189, v145 offset:22304
v_cvt_pk_bf16_f32 v146, v136, v137
v_pk_mul_f32 v[138:139], v[136:137], v[132:133] op_sel_hi:[0,1]
v_pk_fma_f32 v[138:139], v[136:137], v[132:133], v[138:139] op_sel:[1,1,0] op_sel_hi:[1,0,1] neg_lo:[1,0,0]
ds_write_b32 v189, v146 offset:22848
v_cvt_pk_bf16_f32 v149, v142, v143
v_pk_mul_f32 v[140:141], v[142:143], v[130:131] op_sel_hi:[0,1]
v_pk_fma_f32 v[140:141], v[142:143], v[130:131], v[140:141] op_sel:[1,1,0] op_sel_hi:[1,0,1] neg_lo:[1,0,0]
ds_write_b32 v189, v149 offset:7072
v_cvt_pk_bf16_f32 v147, v138, v139
v_pk_mul_f32 v[136:137], v[138:139], v[132:133] op_sel_hi:[0,1]
v_pk_fma_f32 v[136:137], v[138:139], v[132:133], v[136:137] op_sel:[1,1,0] op_sel_hi:[1,0,1] neg_lo:[1,0,0]
ds_write_b32 v189, v147 offset:23392
v_cvt_pk_bf16_f32 v144, v136, v137
v_pk_mul_f32 v[138:139], v[136:137], v[132:133] op_sel_hi:[0,1]
v_pk_fma_f32 v[138:139], v[136:137], v[132:133], v[138:139] op_sel:[1,1,0] op_sel_hi:[1,0,1] neg_lo:[1,0,0]
ds_write_b32 v189, v144 offset:23936
v_cvt_pk_bf16_f32 v150, v140, v141
v_pk_mul_f32 v[142:143], v[140:141], v[130:131] op_sel_hi:[0,1]
v_pk_fma_f32 v[142:143], v[140:141], v[130:131], v[142:143] op_sel:[1,1,0] op_sel_hi:[1,0,1] neg_lo:[1,0,0]
ds_write_b32 v189, v150 offset:7616
v_cvt_pk_bf16_f32 v145, v138, v139
v_pk_mul_f32 v[136:137], v[138:139], v[132:133] op_sel_hi:[0,1]
v_pk_fma_f32 v[136:137], v[138:139], v[132:133], v[136:137] op_sel:[1,1,0] op_sel_hi:[1,0,1] neg_lo:[1,0,0]
ds_write_b32 v189, v145 offset:24480
v_cvt_pk_bf16_f32 v146, v136, v137
v_pk_mul_f32 v[138:139], v[136:137], v[132:133] op_sel_hi:[0,1]
v_pk_fma_f32 v[138:139], v[136:137], v[132:133], v[138:139] op_sel:[1,1,0] op_sel_hi:[1,0,1] neg_lo:[1,0,0]
ds_write_b32 v189, v146 offset:25024
v_cvt_pk_bf16_f32 v151, v142, v143
ds_write_b32 v189, v151 offset:8160
v_cvt_pk_bf16_f32 v147, v138, v139
ds_write_b32 v189, v147 offset:25568
s_cmp_lg_u32 s91, s2
s_cbranch_scc1 KG_NOX2
s_waitcnt vmcnt(0)
v_cmp_ne_u32 vcc, s100, v57
s_mov_b32 s56, 0x40000
s_nop 3
s_cbranch_vccz FCD_3
FC_3:
global_load_dword v57, v56, s[6:7] sc1
s_waitcnt vmcnt(0)
v_cmp_ne_u32 vcc, s100, v57
s_sub_u32 s56, s56, 1
s_cmp_eq_u32 s56, 0
s_cbranch_scc1 FCD_3
s_nop 1
s_cbranch_vccnz FC_3
FCD_3:
s_add_u32 m0, s25, 32768
s_add_u32 s27, s22, 0
buffer_load_dwordx4 v15, s[12:15], s27 offen sc1 lds
buffer_load_dwordx4 v16, s[12:15], s27 offen offset:1024 sc1 lds
s_add_u32 m0, s25, 40960
s_add_u32 s27, s22, 1024
buffer_load_dwordx4 v15, s[12:15], s27 offen sc1 lds
buffer_load_dwordx4 v16, s[12:15], s27 offen offset:1024 sc1 lds
s_add_u32 m0, s25, 49152
s_add_u32 s27, s22, 2048
buffer_load_dwordx4 v15, s[12:15], s27 offen sc1 lds
buffer_load_dwordx4 v16, s[12:15], s27 offen offset:1024 sc1 lds
KG_NOX2:
global_store_dwordx4 v207, v[108:111], s[58:59] sc1
global_store_dwordx4 v208, v[112:115], s[58:59] sc1
v_mov_b32 v120, 0
v_mov_b32 v121, 0
v_mov_b32 v122, 0
v_mov_b32 v123, 0
v_cmp_gt_u32 vcc, 2, v0
s_nop 0
s_and_saveexec_b64 s[56:57], vcc
s_cbranch_execz KZ_4
global_store_dwordx4 v209, v[120:123], s[58:59] sc1
KZ_4:
s_mov_b64 exec, -1
v_lshlrev_b32 v129, 16, v169
s_mov_b32 s91, s101
s_waitcnt lgkmcnt(0)
s_barrier
s_branch KG_LOOP
KG_END:
s_barrier
s_add_u32 m0, s25, 57344
s_add_u32 s27, s22, 3072
buffer_load_dwordx4 v15, s[12:15], s27 offen sc1 lds
buffer_load_dwordx4 v16, s[12:15], s27 offen offset:1024 sc1 lds
s_add_u32 m0, s25, 65536
s_add_u32 s27, s22, 4096
buffer_load_dwordx4 v15, s[12:15], s27 offen sc1 lds
buffer_load_dwordx4 v16, s[12:15], s27 offen offset:1024 sc1 lds
s_add_u32 m0, s25, 73728
s_add_u32 s27, s20, 1179648
buffer_load_dwordx4 v13, s[8:11], s27 offen lds
buffer_load_dwordx4 v14, s[8:11], s27 offen offset:1024 lds
s_add_u32 m0, s25, 81920
s_add_u32 s27, s22, 5120
buffer_load_dwordx4 v15, s[12:15], s27 offen sc1 lds
buffer_load_dwordx4 v16, s[12:15], s27 offen offset:1024 sc1 lds
s_waitcnt vmcnt(14)
s_barrier
ds_read_b64_tr_b16 v[192:193], v1 offset:0
ds_read_b64_tr_b16 v[194:195], v1 offset:512
ds_read_b64_tr_b16 v[196:197], v4 offset:0
ds_read_b64_tr_b16 v[198:199], v4 offset:512
ds_read_b64_tr_b16 v[200:201], v1 offset:4096
ds_read_b64_tr_b16 v[202:203], v1 offset:4608
ds_read_b64_tr_b16 v[204:205], v4 offset:4096
ds_read_b64_tr_b16 v[206:207], v4 offset:4608
ds_read_b128 a[0:3], v7 offset:32768
ds_read_b128 a[72:75], v7 offset:33792
ds_read_b128 a[144:147], v10 offset:32768
ds_read_b128 a[216:219], v10 offset:33792
s_waitcnt vmcnt(12)
s_barrier
s_waitcnt lgkmcnt(10)
s_waitcnt lgkmcnt(3)
v_mfma_f32_16x16x32_bf16 v[64:67], v[192:195], a[0:3], 0
s_add_u32 m0, s25, 90112
s_add_u32 s27, s20, 1474560
ds_read_b64_tr_b16 v[208:209], v1 offset:8192
s_waitcnt lgkmcnt(3)
v_mfma_f32_16x16x32_bf16 v[68:71], v[192:195], a[72:75], 0
buffer_load_dwordx4 v13, s[8:11], s27 offen lds
s_waitcnt lgkmcnt(2)
v_mfma_f32_16x16x32_bf16 v[72:75], v[192:195], a[144:147], 0
ds_read_b64_tr_b16 v[210:211], v1 offset:8704
s_waitcnt lgkmcnt(2)
v_mfma_f32_16x16x32_bf16 v[76:79], v[192:195], a[216:219], 0
ds_read_b64_tr_b16 v[212:213], v4 offset:8192
v_mfma_f32_16x16x32_bf16 v[80:83], v[196:199], a[0:3], 0
ds_read_b64_tr_b16 v[214:215], v4 offset:8704
v_mfma_f32_16x16x32_bf16 v[84:87], v[196:199], a[72:75], 0
ds_read_b64_tr_b16 v[216:217], v1 offset:12288
v_mfma_f32_16x16x32_bf16 v[88:91], v[196:199], a[144:147], 0
ds_read_b64_tr_b16 v[218:219], v1 offset:12800
v_mfma_f32_16x16x32_bf16 v[92:95], v[196:199], a[216:219], 0
ds_read_b64_tr_b16 v[220:221], v4 offset:12288
v_mfma_f32_16x16x32_bf16 v[96:99], v[200:203], a[0:3], 0
ds_read_b64_tr_b16 v[222:223], v4 offset:12800
v_mfma_f32_16x16x32_bf16 v[100:103], v[200:203], a[72:75], 0
ds_read_b128 a[4:7], v7 offset:40960
v_mfma_f32_16x16x32_bf16 v[104:107], v[200:203], a[144:147], 0
ds_read_b128 a[76:79], v7 offset:41984
v_mfma_f32_16x16x32_bf16 v[108:111], v[200:203], a[216:219], 0
ds_read_b128 a[148:151], v10 offset:40960
v_mfma_f32_16x16x32_bf16 v[112:115], v[204:207], a[0:3], 0
ds_read_b128 a[220:223], v10 offset:41984
v_mfma_f32_16x16x32_bf16 v[116:119], v[204:207], a[72:75], 0
buffer_load_dwordx4 v14, s[8:11], s27 offen offset:1024 lds
v_mfma_f32_16x16x32_bf16 v[120:123], v[204:207], a[144:147], 0
s_add_u32 m0, s25, 98304
s_add_u32 s27, s22, 6144
v_mfma_f32_16x16x32_bf16 v[124:127], v[204:207], a[216:219], 0
buffer_load_dwordx4 v15, s[12:15], s27 offen sc1 lds
buffer_load_dwordx4 v16, s[12:15], s27 offen offset:1024 sc1 lds
s_waitcnt vmcnt(14)
s_barrier
s_waitcnt lgkmcnt(10)
s_waitcnt lgkmcnt(3)
v_mfma_f32_16x16x32_bf16 v[64:67], v[208:211], a[4:7], v[64:67]
s_add_u32 m0, s25, 106496
s_add_u32 s27, s20, 1769472
ds_read_b64_tr_b16 v[192:193], v1 offset:16384
s_waitcnt lgkmcnt(3)
v_mfma_f32_16x16x32_bf16 v[68:71], v[208:211], a[76:79], v[68:71]
buffer_load_dwordx4 v13, s[8:11], s27 offen lds
s_waitcnt lgkmcnt(2)
v_mfma_f32_16x16x32_bf16 v[72:75], v[208:211], a[148:151], v[72:75]
ds_read_b64_tr_b16 v[194:195], v1 offset:16896
s_waitcnt lgkmcnt(2)
v_mfma_f32_16x16x32_bf16 v[76:79], v[208:211], a[220:223], v[76:79]
ds_read_b64_tr_b16 v[196:197], v4 offset:16384
v_mfma_f32_16x16x32_bf16 v[80:83], v[212:215], a[4:7], v[80:83]
ds_read_b64_tr_b16 v[198:199], v4 offset:16896
v_mfma_f32_16x16x32_bf16 v[84:87], v[212:215], a[76:79], v[84:87]
ds_read_b64_tr_b16 v[200:201], v1 offset:20480
v_mfma_f32_16x16x32_bf16 v[88:91], v[212:215], a[148:151], v[88:91]
ds_read_b64_tr_b16 v[202:203], v1 offset:20992
v_mfma_f32_16x16x32_bf16 v[92:95], v[212:215], a[220:223], v[92:95]
ds_read_b64_tr_b16 v[204:205], v4 offset:20480
v_mfma_f32_16x16x32_bf16 v[96:99], v[216:219], a[4:7], v[96:99]
ds_read_b64_tr_b16 v[206:207], v4 offset:20992
v_mfma_f32_16x16x32_bf16 v[100:103], v[216:219], a[76:79], v[100:103]
ds_read_b128 a[8:11], v7 offset:49152
v_mfma_f32_16x16x32_bf16 v[104:107], v[216:219], a[148:151], v[104:107]
ds_read_b128 a[80:83], v7 offset:50176
v_mfma_f32_16x16x32_bf16 v[108:111], v[216:219], a[220:223], v[108:111]
ds_read_b128 a[152:155], v10 offset:49152
v_mfma_f32_16x16x32_bf16 v[112:115], v[220:223], a[4:7], v[112:115]
ds_read_b128 a[224:227], v10 offset:50176
v_mfma_f32_16x16x32_bf16 v[116:119], v[220:223], a[76:79], v[116:119]
buffer_load_dwordx4 v14, s[8:11], s27 offen offset:1024 lds
v_mfma_f32_16x16x32_bf16 v[120:123], v[220:223], a[148:151], v[120:123]
s_add_u32 m0, s25, 114688
s_add_u32 s27, s22, 7168
v_mfma_f32_16x16x32_bf16 v[124:127], v[220:223], a[220:223], v[124:127]
buffer_load_dwordx4 v15, s[12:15], s27 offen sc1 lds
buffer_load_dwordx4 v16, s[12:15], s27 offen offset:1024 sc1 lds
s_waitcnt vmcnt(14)
s_barrier
s_cmp_lg_u32 s98, 0
s_cbranch_scc1 SIG_5
s_lshl_b32 s56, s2, 7
s_add_u32 s56, s56, 40894468
v_mov_b32 v60, s56
v_mov_b32 v61, s100
s_mov_b64 exec, 1
global_store_dword v60, v61, s[6:7] sc1
s_mov_b64 exec, -1
SIG_5:
s_waitcnt lgkmcnt(10)
s_waitcnt lgkmcnt(3)
v_mfma_f32_16x16x32_bf16 v[64:67], v[192:195], a[8:11], v[64:67]
s_add_u32 m0, s25, 122880
s_add_u32 s27, s20, 2064384
ds_read_b64_tr_b16 v[208:209], v1 offset:24576
s_waitcnt lgkmcnt(3)
v_mfma_f32_16x16x32_bf16 v[68:71], v[192:195], a[80:83], v[68:71]
buffer_load_dwordx4 v13, s[8:11], s27 offen lds
s_waitcnt lgkmcnt(2)
v_mfma_f32_16x16x32_bf16 v[72:75], v[192:195], a[152:155], v[72:75]
ds_read_b64_tr_b16 v[210:211], v1 offset:25088
s_waitcnt lgkmcnt(2)
v_mfma_f32_16x16x32_bf16 v[76:79], v[192:195], a[224:227], v[76:79]
ds_read_b64_tr_b16 v[212:213], v4 offset:24576
v_mfma_f32_16x16x32_bf16 v[80:83], v[196:199], a[8:11], v[80:83]
ds_read_b64_tr_b16 v[214:215], v4 offset:25088
v_mfma_f32_16x16x32_bf16 v[84:87], v[196:199], a[80:83], v[84:87]
ds_read_b64_tr_b16 v[216:217], v1 offset:28672
v_mfma_f32_16x16x32_bf16 v[88:91], v[196:199], a[152:155], v[88:91]
ds_read_b64_tr_b16 v[218:219], v1 offset:29184
v_mfma_f32_16x16x32_bf16 v[92:95], v[196:199], a[224:227], v[92:95]
ds_read_b64_tr_b16 v[220:221], v4 offset:28672
v_mfma_f32_16x16x32_bf16 v[96:99], v[200:203], a[8:11], v[96:99]
ds_read_b64_tr_b16 v[222:223], v4 offset:29184
v_mfma_f32_16x16x32_bf16 v[100:103], v[200:203], a[80:83], v[100:103]
ds_read_b128 a[12:15], v7 offset:57344
v_mfma_f32_16x16x32_bf16 v[104:107], v[200:203], a[152:155], v[104:107]
ds_read_b128 a[84:87], v7 offset:58368
v_mfma_f32_16x16x32_bf16 v[108:111], v[200:203], a[224:227], v[108:111]
ds_read_b128 a[156:159], v10 offset:57344
v_mfma_f32_16x16x32_bf16 v[112:115], v[204:207], a[8:11], v[112:115]
ds_read_b128 a[228:231], v10 offset:58368
v_mfma_f32_16x16x32_bf16 v[116:119], v[204:207], a[80:83], v[116:119]
buffer_load_dwordx4 v14, s[8:11], s27 offen offset:1024 lds
v_mfma_f32_16x16x32_bf16 v[120:123], v[204:207], a[152:155], v[120:123]
s_add_u32 m0, s25, 131072
s_add_u32 s27, s22, 8192
v_mfma_f32_16x16x32_bf16 v[124:127], v[204:207], a[224:227], v[124:127]
buffer_load_dwordx4 v15, s[12:15], s27 offen sc1 lds
buffer_load_dwordx4 v16, s[12:15], s27 offen offset:1024 sc1 lds
s_waitcnt vmcnt(14)
s_barrier
s_waitcnt lgkmcnt(10)
s_waitcnt lgkmcnt(3)
v_mfma_f32_16x16x32_bf16 v[64:67], v[208:211], a[12:15], v[64:67]
s_add_u32 m0, s25, 139264
s_add_u32 s27, s20, 2359296
ds_read_b64_tr_b16 v[192:193], v2 offset:8192
s_waitcnt lgkmcnt(3)
v_mfma_f32_16x16x32_bf16 v[68:71], v[208:211], a[84:87], v[68:71]
buffer_load_dwordx4 v13, s[8:11], s27 offen lds
s_waitcnt lgkmcnt(2)
v_mfma_f32_16x16x32_bf16 v[72:75], v[208:211], a[156:159], v[72:75]
ds_read_b64_tr_b16 v[194:195], v2 offset:8704
s_waitcnt lgkmcnt(2)
v_mfma_f32_16x16x32_bf16 v[76:79], v[208:211], a[228:231], v[76:79]
ds_read_b64_tr_b16 v[196:197], v5 offset:8192
v_mfma_f32_16x16x32_bf16 v[80:83], v[212:215], a[12:15], v[80:83]
ds_read_b64_tr_b16 v[198:199], v5 offset:8704
v_mfma_f32_16x16x32_bf16 v[84:87], v[212:215], a[84:87], v[84:87]
ds_read_b64_tr_b16 v[200:201], v2 offset:12288
v_mfma_f32_16x16x32_bf16 v[88:91], v[212:215], a[156:159], v[88:91]
ds_read_b64_tr_b16 v[202:203], v2 offset:12800
v_mfma_f32_16x16x32_bf16 v[92:95], v[212:215], a[228:231], v[92:95]
ds_read_b64_tr_b16 v[204:205], v5 offset:12288
v_mfma_f32_16x16x32_bf16 v[96:99], v[216:219], a[12:15], v[96:99]
ds_read_b64_tr_b16 v[206:207], v5 offset:12800
v_mfma_f32_16x16x32_bf16 v[100:103], v[216:219], a[84:87], v[100:103]
ds_read_b128 a[16:19], v8 offset:0
v_mfma_f32_16x16x32_bf16 v[104:107], v[216:219], a[156:159], v[104:107]
ds_read_b128 a[88:91], v8 offset:1024
v_mfma_f32_16x16x32_bf16 v[108:111], v[216:219], a[228:231], v[108:111]
ds_read_b128 a[160:163], v11 offset:0
v_mfma_f32_16x16x32_bf16 v[112:115], v[220:223], a[12:15], v[112:115]
ds_read_b128 a[232:235], v11 offset:1024
v_mfma_f32_16x16x32_bf16 v[116:119], v[220:223], a[84:87], v[116:119]
buffer_load_dwordx4 v14, s[8:11], s27 offen offset:1024 lds
v_mfma_f32_16x16x32_bf16 v[120:123], v[220:223], a[156:159], v[120:123]
s_add_u32 m0, s25, 147456
s_add_u32 s27, s22, 9216
v_mfma_f32_16x16x32_bf16 v[124:127], v[220:223], a[228:231], v[124:127]
buffer_load_dwordx4 v15, s[12:15], s27 offen sc1 lds
buffer_load_dwordx4 v16, s[12:15], s27 offen offset:1024 sc1 lds
s_waitcnt vmcnt(14)
s_barrier
s_waitcnt lgkmcnt(10)
s_waitcnt lgkmcnt(3)
v_mfma_f32_16x16x32_bf16 v[64:67], v[192:195], a[16:19], v[64:67]
s_add_u32 m0, s25, 155648
s_add_u32 s27, s20, 2654208
ds_read_b64_tr_b16 v[208:209], v2 offset:24576
s_waitcnt lgkmcnt(3)
v_mfma_f32_16x16x32_bf16 v[68:71], v[192:195], a[88:91], v[68:71]
buffer_load_dwordx4 v13, s[8:11], s27 offen lds
s_waitcnt lgkmcnt(2)
v_mfma_f32_16x16x32_bf16 v[72:75], v[192:195], a[160:163], v[72:75]
ds_read_b64_tr_b16 v[210:211], v2 offset:25088
s_waitcnt lgkmcnt(2)
v_mfma_f32_16x16x32_bf16 v[76:79], v[192:195], a[232:235], v[76:79]
ds_read_b64_tr_b16 v[212:213], v5 offset:24576
v_mfma_f32_16x16x32_bf16 v[80:83], v[196:199], a[16:19], v[80:83]
ds_read_b64_tr_b16 v[214:215], v5 offset:25088
v_mfma_f32_16x16x32_bf16 v[84:87], v[196:199], a[88:91], v[84:87]
ds_read_b64_tr_b16 v[216:217], v2 offset:28672
v_mfma_f32_16x16x32_bf16 v[88:91], v[196:199], a[160:163], v[88:91]
ds_read_b64_tr_b16 v[218:219], v2 offset:29184
v_mfma_f32_16x16x32_bf16 v[92:95], v[196:199], a[232:235], v[92:95]
ds_read_b64_tr_b16 v[220:221], v5 offset:28672
v_mfma_f32_16x16x32_bf16 v[96:99], v[200:203], a[16:19], v[96:99]
ds_read_b64_tr_b16 v[222:223], v5 offset:29184
v_mfma_f32_16x16x32_bf16 v[100:103], v[200:203], a[88:91], v[100:103]
ds_read_b128 a[20:23], v8 offset:16384
v_mfma_f32_16x16x32_bf16 v[104:107], v[200:203], a[160:163], v[104:107]
ds_read_b128 a[92:95], v8 offset:17408
v_mfma_f32_16x16x32_bf16 v[108:111], v[200:203], a[232:235], v[108:111]
ds_read_b128 a[164:167], v11 offset:16384
v_mfma_f32_16x16x32_bf16 v[112:115], v[204:207], a[16:19], v[112:115]
ds_read_b128 a[236:239], v11 offset:17408
v_mfma_f32_16x16x32_bf16 v[116:119], v[204:207], a[88:91], v[116:119]
buffer_load_dwordx4 v14, s[8:11], s27 offen offset:1024 lds
v_mfma_f32_16x16x32_bf16 v[120:123], v[204:207], a[160:163], v[120:123]
s_add_u32 m0, s25, 0
s_add_u32 s27, s22, 10240
v_mfma_f32_16x16x32_bf16 v[124:127], v[204:207], a[232:235], v[124:127]
buffer_load_dwordx4 v15, s[12:15], s27 offen sc1 lds
buffer_load_dwordx4 v16, s[12:15], s27 offen offset:1024 sc1 lds
s_waitcnt vmcnt(14)
s_barrier
s_waitcnt lgkmcnt(10)
s_waitcnt lgkmcnt(3)
v_mfma_f32_16x16x32_bf16 v[64:67], v[208:211], a[20:23], v[64:67]
s_add_u32 m0, s25, 32768
s_add_u32 s27, s20, 2949120
ds_read_b64_tr_b16 v[192:193], v2 offset:40960
s_waitcnt lgkmcnt(3)
v_mfma_f32_16x16x32_bf16 v[68:71], v[208:211], a[92:95], v[68:71]
buffer_load_dwordx4 v13, s[8:11], s27 offen lds
s_waitcnt lgkmcnt(2)
v_mfma_f32_16x16x32_bf16 v[72:75], v[208:211], a[164:167], v[72:75]
ds_read_b64_tr_b16 v[194:195], v2 offset:41472
s_waitcnt lgkmcnt(2)
v_mfma_f32_16x16x32_bf16 v[76:79], v[208:211], a[236:239], v[76:79]
ds_read_b64_tr_b16 v[196:197], v5 offset:40960
v_mfma_f32_16x16x32_bf16 v[80:83], v[212:215], a[20:23], v[80:83]
ds_read_b64_tr_b16 v[198:199], v5 offset:41472
v_mfma_f32_16x16x32_bf16 v[84:87], v[212:215], a[92:95], v[84:87]
ds_read_b64_tr_b16 v[200:201], v2 offset:45056
v_mfma_f32_16x16x32_bf16 v[88:91], v[212:215], a[164:167], v[88:91]
ds_read_b64_tr_b16 v[202:203], v2 offset:45568
v_mfma_f32_16x16x32_bf16 v[92:95], v[212:215], a[236:239], v[92:95]
ds_read_b64_tr_b16 v[204:205], v5 offset:45056
v_mfma_f32_16x16x32_bf16 v[96:99], v[216:219], a[20:23], v[96:99]
ds_read_b64_tr_b16 v[206:207], v5 offset:45568
v_mfma_f32_16x16x32_bf16 v[100:103], v[216:219], a[92:95], v[100:103]
ds_read_b128 a[24:27], v8 offset:32768
v_mfma_f32_16x16x32_bf16 v[104:107], v[216:219], a[164:167], v[104:107]
ds_read_b128 a[96:99], v8 offset:33792
v_mfma_f32_16x16x32_bf16 v[108:111], v[216:219], a[236:239], v[108:111]
ds_read_b128 a[168:171], v11 offset:32768
v_mfma_f32_16x16x32_bf16 v[112:115], v[220:223], a[20:23], v[112:115]
ds_read_b128 a[240:243], v11 offset:33792
v_mfma_f32_16x16x32_bf16 v[116:119], v[220:223], a[92:95], v[116:119]
buffer_load_dwordx4 v14, s[8:11], s27 offen offset:1024 lds
v_mfma_f32_16x16x32_bf16 v[120:123], v[220:223], a[164:167], v[120:123]
s_add_u32 m0, s25, 8192
s_add_u32 s27, s22, 11264
v_mfma_f32_16x16x32_bf16 v[124:127], v[220:223], a[236:239], v[124:127]
buffer_load_dwordx4 v15, s[12:15], s27 offen sc1 lds
buffer_load_dwordx4 v16, s[12:15], s27 offen offset:1024 sc1 lds
s_waitcnt vmcnt(14)
s_barrier
s_waitcnt lgkmcnt(10)
s_waitcnt lgkmcnt(3)
v_mfma_f32_16x16x32_bf16 v[64:67], v[192:195], a[24:27], v[64:67]
s_add_u32 m0, s25, 40960
s_add_u32 s27, s20, 3244032
ds_read_b64_tr_b16 v[208:209], v2 offset:57344
s_waitcnt lgkmcnt(3)
v_mfma_f32_16x16x32_bf16 v[68:71], v[192:195], a[96:99], v[68:71]
buffer_load_dwordx4 v13, s[8:11], s27 offen lds
s_waitcnt lgkmcnt(2)
v_mfma_f32_16x16x32_bf16 v[72:75], v[192:195], a[168:171], v[72:75]
ds_read_b64_tr_b16 v[210:211], v2 offset:57856
s_waitcnt lgkmcnt(2)
v_mfma_f32_16x16x32_bf16 v[76:79], v[192:195], a[240:243], v[76:79]
ds_read_b64_tr_b16 v[212:213], v5 offset:57344
v_mfma_f32_16x16x32_bf16 v[80:83], v[196:199], a[24:27], v[80:83]
ds_read_b64_tr_b16 v[214:215], v5 offset:57856
v_mfma_f32_16x16x32_bf16 v[84:87], v[196:199], a[96:99], v[84:87]
ds_read_b64_tr_b16 v[216:217], v2 offset:61440
v_mfma_f32_16x16x32_bf16 v[88:91], v[196:199], a[168:171], v[88:91]
ds_read_b64_tr_b16 v[218:219], v2 offset:61952
v_mfma_f32_16x16x32_bf16 v[92:95], v[196:199], a[240:243], v[92:95]
ds_read_b64_tr_b16 v[220:221], v5 offset:61440
v_mfma_f32_16x16x32_bf16 v[96:99], v[200:203], a[24:27], v[96:99]
ds_read_b64_tr_b16 v[222:223], v5 offset:61952
v_mfma_f32_16x16x32_bf16 v[100:103], v[200:203], a[96:99], v[100:103]
ds_read_b128 a[28:31], v8 offset:49152
v_mfma_f32_16x16x32_bf16 v[104:107], v[200:203], a[168:171], v[104:107]
ds_read_b128 a[100:103], v8 offset:50176
v_mfma_f32_16x16x32_bf16 v[108:111], v[200:203], a[240:243], v[108:111]
ds_read_b128 a[172:175], v11 offset:49152
v_mfma_f32_16x16x32_bf16 v[112:115], v[204:207], a[24:27], v[112:115]
ds_read_b128 a[244:247], v11 offset:50176
v_mfma_f32_16x16x32_bf16 v[116:119], v[204:207], a[96:99], v[116:119]
buffer_load_dwordx4 v14, s[8:11], s27 offen offset:1024 lds
v_mfma_f32_16x16x32_bf16 v[120:123], v[204:207], a[168:171], v[120:123]
s_add_u32 m0, s25, 16384
s_add_u32 s27, s22, 12288
v_mfma_f32_16x16x32_bf16 v[124:127], v[204:207], a[240:243], v[124:127]
buffer_load_dwordx4 v15, s[12:15], s27 offen sc1 lds
buffer_load_dwordx4 v16, s[12:15], s27 offen offset:1024 sc1 lds
s_waitcnt vmcnt(14)
s_barrier
s_waitcnt lgkmcnt(10)
s_waitcnt lgkmcnt(3)
v_mfma_f32_16x16x32_bf16 v[64:67], v[208:211], a[28:31], v[64:67]
s_add_u32 m0, s25, 49152
s_add_u32 s27, s20, 3538944
ds_read_b64_tr_b16 v[192:193], v3 offset:8192
s_waitcnt lgkmcnt(3)
v_mfma_f32_16x16x32_bf16 v[68:71], v[208:211], a[100:103], v[68:71]
buffer_load_dwordx4 v13, s[8:11], s27 offen lds
s_waitcnt lgkmcnt(2)
v_mfma_f32_16x16x32_bf16 v[72:75], v[208:211], a[172:175], v[72:75]
ds_read_b64_tr_b16 v[194:195], v3 offset:8704
s_waitcnt lgkmcnt(2)
v_mfma_f32_16x16x32_bf16 v[76:79], v[208:211], a[244:247], v[76:79]
ds_read_b64_tr_b16 v[196:197], v6 offset:8192
v_mfma_f32_16x16x32_bf16 v[80:83], v[212:215], a[28:31], v[80:83]
ds_read_b64_tr_b16 v[198:199], v6 offset:8704
v_mfma_f32_16x16x32_bf16 v[84:87], v[212:215], a[100:103], v[84:87]
ds_read_b64_tr_b16 v[200:201], v3 offset:12288
v_mfma_f32_16x16x32_bf16 v[88:91], v[212:215], a[172:175], v[88:91]
ds_read_b64_tr_b16 v[202:203], v3 offset:12800
v_mfma_f32_16x16x32_bf16 v[92:95], v[212:215], a[244:247], v[92:95]
ds_read_b64_tr_b16 v[204:205], v6 offset:12288
v_mfma_f32_16x16x32_bf16 v[96:99], v[216:219], a[28:31], v[96:99]
ds_read_b64_tr_b16 v[206:207], v6 offset:12800
v_mfma_f32_16x16x32_bf16 v[100:103], v[216:219], a[100:103], v[100:103]
ds_read_b128 a[32:35], v9 offset:0
v_mfma_f32_16x16x32_bf16 v[104:107], v[216:219], a[172:175], v[104:107]
ds_read_b128 a[104:107], v9 offset:1024
v_mfma_f32_16x16x32_bf16 v[108:111], v[216:219], a[244:247], v[108:111]
ds_read_b128 a[176:179], v12 offset:0
v_mfma_f32_16x16x32_bf16 v[112:115], v[220:223], a[28:31], v[112:115]
ds_read_b128 a[248:251], v12 offset:1024
v_mfma_f32_16x16x32_bf16 v[116:119], v[220:223], a[100:103], v[116:119]
buffer_load_dwordx4 v14, s[8:11], s27 offen offset:1024 lds
v_mfma_f32_16x16x32_bf16 v[120:123], v[220:223], a[172:175], v[120:123]
s_add_u32 m0, s25, 24576
s_add_u32 s27, s22, 13312
v_mfma_f32_16x16x32_bf16 v[124:127], v[220:223], a[244:247], v[124:127]
buffer_load_dwordx4 v15, s[12:15], s27 offen sc1 lds
buffer_load_dwordx4 v16, s[12:15], s27 offen offset:1024 sc1 lds
s_waitcnt vmcnt(14)
s_barrier
s_waitcnt lgkmcnt(10)
s_waitcnt lgkmcnt(3)
v_mfma_f32_16x16x32_bf16 v[64:67], v[192:195], a[32:35], v[64:67]
s_add_u32 m0, s25, 57344
s_add_u32 s27, s20, 3833856
ds_read_b64_tr_b16 v[208:209], v3 offset:24576
s_waitcnt lgkmcnt(3)
v_mfma_f32_16x16x32_bf16 v[68:71], v[192:195], a[104:107], v[68:71]
buffer_load_dwordx4 v13, s[8:11], s27 offen lds
s_waitcnt lgkmcnt(2)
v_mfma_f32_16x16x32_bf16 v[72:75], v[192:195], a[176:179], v[72:75]
ds_read_b64_tr_b16 v[210:211], v3 offset:25088
s_waitcnt lgkmcnt(2)
v_mfma_f32_16x16x32_bf16 v[76:79], v[192:195], a[248:251], v[76:79]
ds_read_b64_tr_b16 v[212:213], v6 offset:24576
v_mfma_f32_16x16x32_bf16 v[80:83], v[196:199], a[32:35], v[80:83]
ds_read_b64_tr_b16 v[214:215], v6 offset:25088
v_mfma_f32_16x16x32_bf16 v[84:87], v[196:199], a[104:107], v[84:87]
ds_read_b64_tr_b16 v[216:217], v3 offset:28672
v_mfma_f32_16x16x32_bf16 v[88:91], v[196:199], a[176:179], v[88:91]
ds_read_b64_tr_b16 v[218:219], v3 offset:29184
v_mfma_f32_16x16x32_bf16 v[92:95], v[196:199], a[248:251], v[92:95]
ds_read_b64_tr_b16 v[220:221], v6 offset:28672
v_mfma_f32_16x16x32_bf16 v[96:99], v[200:203], a[32:35], v[96:99]
ds_read_b64_tr_b16 v[222:223], v6 offset:29184
v_mfma_f32_16x16x32_bf16 v[100:103], v[200:203], a[104:107], v[100:103]
ds_read_b128 a[36:39], v9 offset:16384
v_mfma_f32_16x16x32_bf16 v[104:107], v[200:203], a[176:179], v[104:107]
ds_read_b128 a[108:111], v9 offset:17408
v_mfma_f32_16x16x32_bf16 v[108:111], v[200:203], a[248:251], v[108:111]
ds_read_b128 a[180:183], v12 offset:16384
v_mfma_f32_16x16x32_bf16 v[112:115], v[204:207], a[32:35], v[112:115]
ds_read_b128 a[252:255], v12 offset:17408
v_mfma_f32_16x16x32_bf16 v[116:119], v[204:207], a[104:107], v[116:119]
buffer_load_dwordx4 v14, s[8:11], s27 offen offset:1024 lds
v_mfma_f32_16x16x32_bf16 v[120:123], v[204:207], a[176:179], v[120:123]
s_add_u32 m0, s25, 73728
s_add_u32 s27, s22, 14336
v_mfma_f32_16x16x32_bf16 v[124:127], v[204:207], a[248:251], v[124:127]
buffer_load_dwordx4 v15, s[12:15], s27 offen sc1 lds
buffer_load_dwordx4 v16, s[12:15], s27 offen offset:1024 sc1 lds
s_waitcnt vmcnt(14)
s_barrier
s_waitcnt lgkmcnt(10)
s_waitcnt lgkmcnt(3)
v_mfma_f32_16x16x32_bf16 v[64:67], v[208:211], a[36:39], v[64:67]
s_add_u32 m0, s25, 65536
s_add_u32 s27, s20, 4128768
ds_read_b64_tr_b16 v[192:193], v1 offset:32768
s_waitcnt lgkmcnt(3)
v_mfma_f32_16x16x32_bf16 v[68:71], v[208:211], a[108:111], v[68:71]
buffer_load_dwordx4 v13, s[8:11], s27 offen lds
s_waitcnt lgkmcnt(2)
v_mfma_f32_16x16x32_bf16 v[72:75], v[208:211], a[180:183], v[72:75]
ds_read_b64_tr_b16 v[194:195], v1 offset:33280
s_waitcnt lgkmcnt(2)
v_mfma_f32_16x16x32_bf16 v[76:79], v[208:211], a[252:255], v[76:79]
ds_read_b64_tr_b16 v[196:197], v4 offset:32768
v_mfma_f32_16x16x32_bf16 v[80:83], v[212:215], a[36:39], v[80:83]
ds_read_b64_tr_b16 v[198:199], v4 offset:33280
v_mfma_f32_16x16x32_bf16 v[84:87], v[212:215], a[108:111], v[84:87]
ds_read_b64_tr_b16 v[200:201], v1 offset:36864
v_mfma_f32_16x16x32_bf16 v[88:91], v[212:215], a[180:183], v[88:91]
ds_read_b64_tr_b16 v[202:203], v1 offset:37376
v_mfma_f32_16x16x32_bf16 v[92:95], v[212:215], a[252:255], v[92:95]
ds_read_b64_tr_b16 v[204:205], v4 offset:36864
v_mfma_f32_16x16x32_bf16 v[96:99], v[216:219], a[36:39], v[96:99]
ds_read_b64_tr_b16 v[206:207], v4 offset:37376
v_mfma_f32_16x16x32_bf16 v[100:103], v[216:219], a[108:111], v[100:103]
ds_read_b128 a[40:43], v7 offset:0
v_mfma_f32_16x16x32_bf16 v[104:107], v[216:219], a[180:183], v[104:107]
ds_read_b128 a[112:115], v7 offset:1024
v_mfma_f32_16x16x32_bf16 v[108:111], v[216:219], a[252:255], v[108:111]
ds_read_b128 a[184:187], v10 offset:0
v_mfma_f32_16x16x32_bf16 v[112:115], v[220:223], a[36:39], v[112:115]
ds_read_b128 v[224:227], v10 offset:1024
v_mfma_f32_16x16x32_bf16 v[116:119], v[220:223], a[108:111], v[116:119]
buffer_load_dwordx4 v14, s[8:11], s27 offen offset:1024 lds
v_mfma_f32_16x16x32_bf16 v[120:123], v[220:223], a[180:183], v[120:123]
s_add_u32 m0, s25, 90112
s_add_u32 s27, s22, 15360
v_mfma_f32_16x16x32_bf16 v[124:127], v[220:223], a[252:255], v[124:127]
buffer_load_dwordx4 v15, s[12:15], s27 offen sc1 lds
buffer_load_dwordx4 v16, s[12:15], s27 offen offset:1024 sc1 lds
s_waitcnt vmcnt(14)
s_barrier
s_waitcnt lgkmcnt(10)
s_waitcnt lgkmcnt(3)
v_mfma_f32_16x16x32_bf16 v[64:67], v[192:195], a[40:43], v[64:67]
s_add_u32 m0, s25, 81920
s_add_u32 s27, s20, 4423680
ds_read_b64_tr_b16 v[208:209], v1 offset:40960
s_waitcnt lgkmcnt(3)
v_mfma_f32_16x16x32_bf16 v[68:71], v[192:195], a[112:115], v[68:71]
buffer_load_dwordx4 v13, s[8:11], s27 offen lds
s_waitcnt lgkmcnt(2)
v_mfma_f32_16x16x32_bf16 v[72:75], v[192:195], a[184:187], v[72:75]
ds_read_b64_tr_b16 v[210:211], v1 offset:41472
s_waitcnt lgkmcnt(2)
v_mfma_f32_16x16x32_bf16 v[76:79], v[192:195], v[224:227], v[76:79]
ds_read_b64_tr_b16 v[212:213], v4 offset:40960
v_mfma_f32_16x16x32_bf16 v[80:83], v[196:199], a[40:43], v[80:83]
ds_read_b64_tr_b16 v[214:215], v4 offset:41472
v_mfma_f32_16x16x32_bf16 v[84:87], v[196:199], a[112:115], v[84:87]
ds_read_b64_tr_b16 v[216:217], v1 offset:45056
v_mfma_f32_16x16x32_bf16 v[88:91], v[196:199], a[184:187], v[88:91]
ds_read_b64_tr_b16 v[218:219], v1 offset:45568
v_mfma_f32_16x16x32_bf16 v[92:95], v[196:199], v[224:227], v[92:95]
ds_read_b64_tr_b16 v[220:221], v4 offset:45056
v_mfma_f32_16x16x32_bf16 v[96:99], v[200:203], a[40:43], v[96:99]
ds_read_b64_tr_b16 v[222:223], v4 offset:45568
v_mfma_f32_16x16x32_bf16 v[100:103], v[200:203], a[112:115], v[100:103]
ds_read_b128 a[44:47], v7 offset:8192
v_mfma_f32_16x16x32_bf16 v[104:107], v[200:203], a[184:187], v[104:107]
ds_read_b128 a[116:119], v7 offset:9216
v_mfma_f32_16x16x32_bf16 v[108:111], v[200:203], v[224:227], v[108:111]
ds_read_b128 a[188:191], v10 offset:8192
v_mfma_f32_16x16x32_bf16 v[112:115], v[204:207], a[40:43], v[112:115]
ds_read_b128 v[228:231], v10 offset:9216
v_mfma_f32_16x16x32_bf16 v[116:119], v[204:207], a[112:115], v[116:119]
buffer_load_dwordx4 v14, s[8:11], s27 offen offset:1024 lds
v_mfma_f32_16x16x32_bf16 v[120:123], v[204:207], a[184:187], v[120:123]
s_add_u32 m0, s25, 106496
s_add_u32 s27, s22, 16384
v_mfma_f32_16x16x32_bf16 v[124:127], v[204:207], v[224:227], v[124:127]
buffer_load_dwordx4 v15, s[12:15], s27 offen sc1 lds
buffer_load_dwordx4 v16, s[12:15], s27 offen offset:1024 sc1 lds
s_waitcnt vmcnt(14)
s_barrier
s_waitcnt lgkmcnt(10)
s_waitcnt lgkmcnt(3)
v_mfma_f32_16x16x32_bf16 v[64:67], v[208:211], a[44:47], v[64:67]
s_add_u32 m0, s25, 98304
s_add_u32 s27, s20, 4718592
ds_read_b64_tr_b16 v[192:193], v1 offset:49152
s_waitcnt lgkmcnt(3)
v_mfma_f32_16x16x32_bf16 v[68:71], v[208:211], a[116:119], v[68:71]
buffer_load_dwordx4 v13, s[8:11], s27 offen lds
s_waitcnt lgkmcnt(2)
v_mfma_f32_16x16x32_bf16 v[72:75], v[208:211], a[188:191], v[72:75]
ds_read_b64_tr_b16 v[194:195], v1 offset:49664
s_waitcnt lgkmcnt(2)
v_mfma_f32_16x16x32_bf16 v[76:79], v[208:211], v[228:231], v[76:79]
ds_read_b64_tr_b16 v[196:197], v4 offset:49152
v_mfma_f32_16x16x32_bf16 v[80:83], v[212:215], a[44:47], v[80:83]
ds_read_b64_tr_b16 v[198:199], v4 offset:49664
v_mfma_f32_16x16x32_bf16 v[84:87], v[212:215], a[116:119], v[84:87]
ds_read_b64_tr_b16 v[200:201], v1 offset:53248
v_mfma_f32_16x16x32_bf16 v[88:91], v[212:215], a[188:191], v[88:91]
ds_read_b64_tr_b16 v[202:203], v1 offset:53760
v_mfma_f32_16x16x32_bf16 v[92:95], v[212:215], v[228:231], v[92:95]
ds_read_b64_tr_b16 v[204:205], v4 offset:53248
v_mfma_f32_16x16x32_bf16 v[96:99], v[216:219], a[44:47], v[96:99]
ds_read_b64_tr_b16 v[206:207], v4 offset:53760
v_mfma_f32_16x16x32_bf16 v[100:103], v[216:219], a[116:119], v[100:103]
ds_read_b128 a[48:51], v7 offset:16384
v_mfma_f32_16x16x32_bf16 v[104:107], v[216:219], a[188:191], v[104:107]
ds_read_b128 a[120:123], v7 offset:17408
v_mfma_f32_16x16x32_bf16 v[108:111], v[216:219], v[228:231], v[108:111]
ds_read_b128 a[192:195], v10 offset:16384
v_mfma_f32_16x16x32_bf16 v[112:115], v[220:223], a[44:47], v[112:115]
ds_read_b128 v[232:235], v10 offset:17408
v_mfma_f32_16x16x32_bf16 v[116:119], v[220:223], a[116:119], v[116:119]
buffer_load_dwordx4 v14, s[8:11], s27 offen offset:1024 lds
v_mfma_f32_16x16x32_bf16 v[120:123], v[220:223], a[188:191], v[120:123]
s_add_u32 m0, s25, 122880
s_add_u32 s27, s22, 17408
v_mfma_f32_16x16x32_bf16 v[124:127], v[220:223], v[228:231], v[124:127]
buffer_load_dwordx4 v15, s[12:15], s27 offen sc1 lds
buffer_load_dwordx4 v16, s[12:15], s27 offen offset:1024 sc1 lds
s_waitcnt vmcnt(14)
s_barrier
s_waitcnt lgkmcnt(10)
s_waitcnt lgkmcnt(3)
v_mfma_f32_16x16x32_bf16 v[64:67], v[192:195], a[48:51], v[64:67]
s_add_u32 m0, s25, 114688
s_add_u32 s27, s20, 5013504
ds_read_b64_tr_b16 v[208:209], v1 offset:57344
s_waitcnt lgkmcnt(3)
v_mfma_f32_16x16x32_bf16 v[68:71], v[192:195], a[120:123], v[68:71]
buffer_load_dwordx4 v13, s[8:11], s27 offen lds
s_waitcnt lgkmcnt(2)
v_mfma_f32_16x16x32_bf16 v[72:75], v[192:195], a[192:195], v[72:75]
ds_read_b64_tr_b16 v[210:211], v1 offset:57856
s_waitcnt lgkmcnt(2)
v_mfma_f32_16x16x32_bf16 v[76:79], v[192:195], v[232:235], v[76:79]
ds_read_b64_tr_b16 v[212:213], v4 offset:57344
v_mfma_f32_16x16x32_bf16 v[80:83], v[196:199], a[48:51], v[80:83]
ds_read_b64_tr_b16 v[214:215], v4 offset:57856
v_mfma_f32_16x16x32_bf16 v[84:87], v[196:199], a[120:123], v[84:87]
ds_read_b64_tr_b16 v[216:217], v1 offset:61440
v_mfma_f32_16x16x32_bf16 v[88:91], v[196:199], a[192:195], v[88:91]
ds_read_b64_tr_b16 v[218:219], v1 offset:61952
v_mfma_f32_16x16x32_bf16 v[92:95], v[196:199], v[232:235], v[92:95]
ds_read_b64_tr_b16 v[220:221], v4 offset:61440
v_mfma_f32_16x16x32_bf16 v[96:99], v[200:203], a[48:51], v[96:99]
ds_read_b64_tr_b16 v[222:223], v4 offset:61952
v_mfma_f32_16x16x32_bf16 v[100:103], v[200:203], a[120:123], v[100:103]
ds_read_b128 a[52:55], v7 offset:24576
v_mfma_f32_16x16x32_bf16 v[104:107], v[200:203], a[192:195], v[104:107]
ds_read_b128 a[124:127], v7 offset:25600
v_mfma_f32_16x16x32_bf16 v[108:111], v[200:203], v[232:235], v[108:111]
ds_read_b128 a[196:199], v10 offset:24576
v_mfma_f32_16x16x32_bf16 v[112:115], v[204:207], a[48:51], v[112:115]
ds_read_b128 v[236:239], v10 offset:25600
v_mfma_f32_16x16x32_bf16 v[116:119], v[204:207], a[120:123], v[116:119]
buffer_load_dwordx4 v14, s[8:11], s27 offen offset:1024 lds
v_mfma_f32_16x16x32_bf16 v[120:123], v[204:207], a[192:195], v[120:123]
s_add_u32 m0, s25, 139264
s_add_u32 s27, s20, 128
v_mfma_f32_16x16x32_bf16 v[124:127], v[204:207], v[232:235], v[124:127]
buffer_load_dwordx4 v13, s[8:11], s27 offen lds
buffer_load_dwordx4 v14, s[8:11], s27 offen offset:1024 lds
s_waitcnt vmcnt(14)
s_barrier
s_waitcnt lgkmcnt(10)
s_waitcnt lgkmcnt(3)
v_mfma_f32_16x16x32_bf16 v[64:67], v[208:211], a[52:55], v[64:67]
s_add_u32 m0, s25, 131072
s_add_u32 s27, s20, 295040
ds_read_b64_tr_b16 v[192:193], v2 offset:0
s_waitcnt lgkmcnt(3)
v_mfma_f32_16x16x32_bf16 v[68:71], v[208:211], a[124:127], v[68:71]
buffer_load_dwordx4 v13, s[8:11], s27 offen lds
s_waitcnt lgkmcnt(2)
v_mfma_f32_16x16x32_bf16 v[72:75], v[208:211], a[196:199], v[72:75]
ds_read_b64_tr_b16 v[194:195], v2 offset:512
s_waitcnt lgkmcnt(2)
v_mfma_f32_16x16x32_bf16 v[76:79], v[208:211], v[236:239], v[76:79]
ds_read_b64_tr_b16 v[196:197], v5 offset:0
v_mfma_f32_16x16x32_bf16 v[80:83], v[212:215], a[52:55], v[80:83]
ds_read_b64_tr_b16 v[198:199], v5 offset:512
v_mfma_f32_16x16x32_bf16 v[84:87], v[212:215], a[124:127], v[84:87]
ds_read_b64_tr_b16 v[200:201], v2 offset:4096
v_mfma_f32_16x16x32_bf16 v[88:91], v[212:215], a[196:199], v[88:91]
ds_read_b64_tr_b16 v[202:203], v2 offset:4608
v_mfma_f32_16x16x32_bf16 v[92:95], v[212:215], v[236:239], v[92:95]
ds_read_b64_tr_b16 v[204:205], v5 offset:4096
v_mfma_f32_16x16x32_bf16 v[96:99], v[216:219], a[52:55], v[96:99]
ds_read_b64_tr_b16 v[206:207], v5 offset:4608
v_mfma_f32_16x16x32_bf16 v[100:103], v[216:219], a[124:127], v[100:103]
ds_read_b128 a[56:59], v8 offset:8192
v_mfma_f32_16x16x32_bf16 v[104:107], v[216:219], a[196:199], v[104:107]
ds_read_b128 a[128:131], v8 offset:9216
v_mfma_f32_16x16x32_bf16 v[108:111], v[216:219], v[236:239], v[108:111]
ds_read_b128 a[200:203], v11 offset:8192
v_mfma_f32_16x16x32_bf16 v[112:115], v[220:223], a[52:55], v[112:115]
ds_read_b128 v[240:243], v11 offset:9216
v_mfma_f32_16x16x32_bf16 v[116:119], v[220:223], a[124:127], v[116:119]
buffer_load_dwordx4 v14, s[8:11], s27 offen offset:1024 lds
v_mfma_f32_16x16x32_bf16 v[120:123], v[220:223], a[196:199], v[120:123]
s_add_u32 m0, s25, 155648
s_add_u32 s27, s20, 589952
v_mfma_f32_16x16x32_bf16 v[124:127], v[220:223], v[236:239], v[124:127]
buffer_load_dwordx4 v13, s[8:11], s27 offen lds
buffer_load_dwordx4 v14, s[8:11], s27 offen offset:1024 lds
s_waitcnt vmcnt(14)
s_barrier
s_waitcnt lgkmcnt(10)
s_waitcnt lgkmcnt(3)
v_mfma_f32_16x16x32_bf16 v[64:67], v[192:195], a[56:59], v[64:67]
s_add_u32 m0, s25, 147456
s_add_u32 s27, s20, 884864
ds_read_b64_tr_b16 v[208:209], v2 offset:16384
s_waitcnt lgkmcnt(3)
v_mfma_f32_16x16x32_bf16 v[68:71], v[192:195], a[128:131], v[68:71]
buffer_load_dwordx4 v13, s[8:11], s27 offen lds
s_waitcnt lgkmcnt(2)
v_mfma_f32_16x16x32_bf16 v[72:75], v[192:195], a[200:203], v[72:75]
ds_read_b64_tr_b16 v[210:211], v2 offset:16896
s_waitcnt lgkmcnt(2)
v_mfma_f32_16x16x32_bf16 v[76:79], v[192:195], v[240:243], v[76:79]
ds_read_b64_tr_b16 v[212:213], v5 offset:16384
v_mfma_f32_16x16x32_bf16 v[80:83], v[196:199], a[56:59], v[80:83]
ds_read_b64_tr_b16 v[214:215], v5 offset:16896
v_mfma_f32_16x16x32_bf16 v[84:87], v[196:199], a[128:131], v[84:87]
ds_read_b64_tr_b16 v[216:217], v2 offset:20480
v_mfma_f32_16x16x32_bf16 v[88:91], v[196:199], a[200:203], v[88:91]
ds_read_b64_tr_b16 v[218:219], v2 offset:20992
v_mfma_f32_16x16x32_bf16 v[92:95], v[196:199], v[240:243], v[92:95]
ds_read_b64_tr_b16 v[220:221], v5 offset:20480
v_mfma_f32_16x16x32_bf16 v[96:99], v[200:203], a[56:59], v[96:99]
ds_read_b64_tr_b16 v[222:223], v5 offset:20992
v_mfma_f32_16x16x32_bf16 v[100:103], v[200:203], a[128:131], v[100:103]
ds_read_b128 a[60:63], v8 offset:24576
v_mfma_f32_16x16x32_bf16 v[104:107], v[200:203], a[200:203], v[104:107]
ds_read_b128 a[132:135], v8 offset:25600
v_mfma_f32_16x16x32_bf16 v[108:111], v[200:203], v[240:243], v[108:111]
ds_read_b128 a[204:207], v11 offset:24576
v_mfma_f32_16x16x32_bf16 v[112:115], v[204:207], a[56:59], v[112:115]
ds_read_b128 v[244:247], v11 offset:25600
v_mfma_f32_16x16x32_bf16 v[116:119], v[204:207], a[128:131], v[116:119]
buffer_load_dwordx4 v14, s[8:11], s27 offen offset:1024 lds
v_mfma_f32_16x16x32_bf16 v[120:123], v[204:207], a[200:203], v[120:123]
s_add_u32 m0, s25, 32768
s_add_u32 s27, s20, 1179776
v_mfma_f32_16x16x32_bf16 v[124:127], v[204:207], v[240:243], v[124:127]
buffer_load_dwordx4 v13, s[8:11], s27 offen lds
buffer_load_dwordx4 v14, s[8:11], s27 offen offset:1024 lds
s_waitcnt vmcnt(14)
s_barrier
s_waitcnt lgkmcnt(10)
s_waitcnt lgkmcnt(3)
v_mfma_f32_16x16x32_bf16 v[64:67], v[208:211], a[60:63], v[64:67]
s_add_u32 m0, s25, 0
s_add_u32 s27, s20, 1474688
ds_read_b64_tr_b16 v[192:193], v2 offset:32768
s_waitcnt lgkmcnt(3)
v_mfma_f32_16x16x32_bf16 v[68:71], v[208:211], a[132:135], v[68:71]
buffer_load_dwordx4 v13, s[8:11], s27 offen lds
s_waitcnt lgkmcnt(2)
v_mfma_f32_16x16x32_bf16 v[72:75], v[208:211], a[204:207], v[72:75]
ds_read_b64_tr_b16 v[194:195], v2 offset:33280
s_waitcnt lgkmcnt(2)
v_mfma_f32_16x16x32_bf16 v[76:79], v[208:211], v[244:247], v[76:79]
ds_read_b64_tr_b16 v[196:197], v5 offset:32768
v_mfma_f32_16x16x32_bf16 v[80:83], v[212:215], a[60:63], v[80:83]
ds_read_b64_tr_b16 v[198:199], v5 offset:33280
v_mfma_f32_16x16x32_bf16 v[84:87], v[212:215], a[132:135], v[84:87]
ds_read_b64_tr_b16 v[200:201], v2 offset:36864
v_mfma_f32_16x16x32_bf16 v[88:91], v[212:215], a[204:207], v[88:91]
ds_read_b64_tr_b16 v[202:203], v2 offset:37376
v_mfma_f32_16x16x32_bf16 v[92:95], v[212:215], v[244:247], v[92:95]
ds_read_b64_tr_b16 v[204:205], v5 offset:36864
v_mfma_f32_16x16x32_bf16 v[96:99], v[216:219], a[60:63], v[96:99]
ds_read_b64_tr_b16 v[206:207], v5 offset:37376
v_mfma_f32_16x16x32_bf16 v[100:103], v[216:219], a[132:135], v[100:103]
ds_read_b128 a[64:67], v8 offset:40960
v_mfma_f32_16x16x32_bf16 v[104:107], v[216:219], a[204:207], v[104:107]
ds_read_b128 a[136:139], v8 offset:41984
v_mfma_f32_16x16x32_bf16 v[108:111], v[216:219], v[244:247], v[108:111]
ds_read_b128 a[208:211], v11 offset:40960
v_mfma_f32_16x16x32_bf16 v[112:115], v[220:223], a[60:63], v[112:115]
ds_read_b128 v[248:251], v11 offset:41984
v_mfma_f32_16x16x32_bf16 v[116:119], v[220:223], a[132:135], v[116:119]
buffer_load_dwordx4 v14, s[8:11], s27 offen offset:1024 lds
v_mfma_f32_16x16x32_bf16 v[120:123], v[220:223], a[204:207], v[120:123]
s_add_u32 m0, s25, 40960
s_add_u32 s27, s20, 1769600
v_mfma_f32_16x16x32_bf16 v[124:127], v[220:223], v[244:247], v[124:127]
buffer_load_dwordx4 v13, s[8:11], s27 offen lds
buffer_load_dwordx4 v14, s[8:11], s27 offen offset:1024 lds
s_waitcnt vmcnt(12)
s_barrier
s_waitcnt lgkmcnt(10)
s_waitcnt lgkmcnt(3)
v_mfma_f32_16x16x32_bf16 v[64:67], v[192:195], a[64:67], v[64:67]
s_add_u32 m0, s25, 8192
s_add_u32 s27, s20, 2064512
ds_read_b64_tr_b16 v[208:209], v2 offset:49152
s_waitcnt lgkmcnt(3)
v_mfma_f32_16x16x32_bf16 v[68:71], v[192:195], a[136:139], v[68:71]
buffer_load_dwordx4 v13, s[8:11], s27 offen lds
s_waitcnt lgkmcnt(2)
v_mfma_f32_16x16x32_bf16 v[72:75], v[192:195], a[208:211], v[72:75]
ds_read_b64_tr_b16 v[210:211], v2 offset:49664
s_waitcnt lgkmcnt(2)
v_mfma_f32_16x16x32_bf16 v[76:79], v[192:195], v[248:251], v[76:79]
ds_read_b64_tr_b16 v[212:213], v5 offset:49152
v_mfma_f32_16x16x32_bf16 v[80:83], v[196:199], a[64:67], v[80:83]
ds_read_b64_tr_b16 v[214:215], v5 offset:49664
v_mfma_f32_16x16x32_bf16 v[84:87], v[196:199], a[136:139], v[84:87]
ds_read_b64_tr_b16 v[216:217], v2 offset:53248
v_mfma_f32_16x16x32_bf16 v[88:91], v[196:199], a[208:211], v[88:91]
ds_read_b64_tr_b16 v[218:219], v2 offset:53760
v_mfma_f32_16x16x32_bf16 v[92:95], v[196:199], v[248:251], v[92:95]
ds_read_b64_tr_b16 v[220:221], v5 offset:53248
v_mfma_f32_16x16x32_bf16 v[96:99], v[200:203], a[64:67], v[96:99]
ds_read_b64_tr_b16 v[222:223], v5 offset:53760
v_mfma_f32_16x16x32_bf16 v[100:103], v[200:203], a[136:139], v[100:103]
ds_read_b128 a[68:71], v8 offset:57344
v_mfma_f32_16x16x32_bf16 v[104:107], v[200:203], a[208:211], v[104:107]
ds_read_b128 a[140:143], v8 offset:58368
v_mfma_f32_16x16x32_bf16 v[108:111], v[200:203], v[248:251], v[108:111]
ds_read_b128 a[212:215], v11 offset:57344
v_mfma_f32_16x16x32_bf16 v[112:115], v[204:207], a[64:67], v[112:115]
ds_read_b128 v[252:255], v11 offset:58368
v_mfma_f32_16x16x32_bf16 v[116:119], v[204:207], a[136:139], v[116:119]
buffer_load_dwordx4 v14, s[8:11], s27 offen offset:1024 lds
v_mfma_f32_16x16x32_bf16 v[120:123], v[204:207], a[208:211], v[120:123]
s_add_u32 m0, s25, 49152
s_add_u32 s27, s20, 2359424
v_mfma_f32_16x16x32_bf16 v[124:127], v[204:207], v[248:251], v[124:127]
buffer_load_dwordx4 v13, s[8:11], s27 offen lds
buffer_load_dwordx4 v14, s[8:11], s27 offen offset:1024 lds
s_waitcnt lgkmcnt(10)
s_waitcnt lgkmcnt(3)
v_mfma_f32_16x16x32_bf16 v[64:67], v[208:211], a[68:71], v[64:67]
s_add_u32 m0, s25, 16384
s_add_u32 s27, s20, 2654336
ds_read_b64_tr_b16 v[192:193], v3 offset:8192
s_waitcnt lgkmcnt(3)
v_mfma_f32_16x16x32_bf16 v[68:71], v[208:211], a[140:143], v[68:71]
buffer_load_dwordx4 v13, s[8:11], s27 offen lds
s_waitcnt lgkmcnt(2)
v_mfma_f32_16x16x32_bf16 v[72:75], v[208:211], a[212:215], v[72:75]
ds_read_b64_tr_b16 v[194:195], v3 offset:8704
s_waitcnt lgkmcnt(2)
v_mfma_f32_16x16x32_bf16 v[76:79], v[208:211], v[252:255], v[76:79]
ds_read_b64_tr_b16 v[196:197], v6 offset:8192
v_mfma_f32_16x16x32_bf16 v[80:83], v[212:215], a[68:71], v[80:83]
ds_read_b64_tr_b16 v[198:199], v6 offset:8704
v_mfma_f32_16x16x32_bf16 v[84:87], v[212:215], a[140:143], v[84:87]
buffer_load_dwordx4 v14, s[8:11], s27 offen offset:1024 lds
v_mfma_f32_16x16x32_bf16 v[88:91], v[212:215], a[212:215], v[88:91]
s_add_u32 m0, s25, 57344
s_add_u32 s27, s20, 2949248
ds_read_b64_tr_b16 v[200:201], v3 offset:12288
v_mfma_f32_16x16x32_bf16 v[92:95], v[212:215], v[252:255], v[92:95]
ds_read_b64_tr_b16 v[202:203], v3 offset:12800
v_mfma_f32_16x16x32_bf16 v[96:99], v[216:219], a[68:71], v[96:99]
ds_read_b64_tr_b16 v[204:205], v6 offset:12288
v_mfma_f32_16x16x32_bf16 v[100:103], v[216:219], a[140:143], v[100:103]
buffer_load_dwordx4 v13, s[8:11], s27 offen lds
v_mfma_f32_16x16x32_bf16 v[104:107], v[216:219], a[212:215], v[104:107]
ds_read_b64_tr_b16 v[206:207], v6 offset:12800
v_mfma_f32_16x16x32_bf16 v[108:111], v[216:219], v[252:255], v[108:111]
v_mfma_f32_16x16x32_bf16 v[112:115], v[220:223], a[68:71], v[112:115]
v_mfma_f32_16x16x32_bf16 v[116:119], v[220:223], a[140:143], v[116:119]
buffer_load_dwordx4 v14, s[8:11], s27 offen offset:1024 lds
v_mfma_f32_16x16x32_bf16 v[120:123], v[220:223], a[212:215], v[120:123]
v_mfma_f32_16x16x32_bf16 v[124:127], v[220:223], v[252:255], v[124:127]
s_waitcnt vmcnt(12)
s_barrier
s_waitcnt lgkmcnt(6)
v_mfma_f32_16x16x32_bf16 v[128:131], v[192:195], a[0:3], 0
s_add_u32 m0, s25, 24576
s_add_u32 s27, s20, 3244160
ds_read_b64_tr_b16 v[208:209], v3 offset:0
v_mfma_f32_16x16x32_bf16 v[132:135], v[192:195], a[72:75], 0
buffer_load_dwordx4 v13, s[8:11], s27 offen lds
v_mfma_f32_16x16x32_bf16 v[136:139], v[192:195], a[144:147], 0
ds_read_b64_tr_b16 v[210:211], v3 offset:512
v_mfma_f32_16x16x32_bf16 v[140:143], v[192:195], a[216:219], 0
ds_read_b64_tr_b16 v[212:213], v6 offset:0
s_waitcnt lgkmcnt(7)
v_mfma_f32_16x16x32_bf16 v[144:147], v[196:199], a[0:3], 0
ds_read_b64_tr_b16 v[214:215], v6 offset:512
v_mfma_f32_16x16x32_bf16 v[148:151], v[196:199], a[72:75], 0
buffer_load_dwordx4 v14, s[8:11], s27 offen offset:1024 lds
v_mfma_f32_16x16x32_bf16 v[152:155], v[196:199], a[144:147], 0
s_add_u32 m0, s25, 65536
s_add_u32 s27, s20, 3539072
ds_read_b64_tr_b16 v[216:217], v3 offset:4096
v_mfma_f32_16x16x32_bf16 v[156:159], v[196:199], a[216:219], 0
ds_read_b64_tr_b16 v[218:219], v3 offset:4608
s_waitcnt lgkmcnt(8)
v_mfma_f32_16x16x32_bf16 v[160:163], v[200:203], a[0:3], 0
ds_read_b64_tr_b16 v[220:221], v6 offset:4096
v_mfma_f32_16x16x32_bf16 v[164:167], v[200:203], a[72:75], 0
buffer_load_dwordx4 v13, s[8:11], s27 offen lds
v_mfma_f32_16x16x32_bf16 v[168:171], v[200:203], a[144:147], 0
ds_read_b64_tr_b16 v[222:223], v6 offset:4608
v_mfma_f32_16x16x32_bf16 v[172:175], v[200:203], a[216:219], 0
s_waitcnt lgkmcnt(8)
v_mfma_f32_16x16x32_bf16 v[176:179], v[204:207], a[0:3], 0
v_mfma_f32_16x16x32_bf16 v[180:183], v[204:207], a[72:75], 0
buffer_load_dwordx4 v14, s[8:11], s27 offen offset:1024 lds
v_mfma_f32_16x16x32_bf16 v[184:187], v[204:207], a[144:147], 0
v_mfma_f32_16x16x32_bf16 v[188:191], v[204:207], a[216:219], 0
s_waitcnt lgkmcnt(6)
v_mfma_f32_16x16x32_bf16 v[128:131], v[208:211], a[4:7], v[128:131]
s_add_u32 m0, s25, 73728
s_add_u32 s27, s20, 3833984
ds_read_b64_tr_b16 v[192:193], v3 offset:24576
v_mfma_f32_16x16x32_bf16 v[132:135], v[208:211], a[76:79], v[132:135]
buffer_load_dwordx4 v13, s[8:11], s27 offen lds
v_mfma_f32_16x16x32_bf16 v[136:139], v[208:211], a[148:151], v[136:139]
ds_read_b64_tr_b16 v[194:195], v3 offset:25088
v_mul_f32 v20, s26, v64
v_mfma_f32_16x16x32_bf16 v[140:143], v[208:211], a[220:223], v[140:143]
v_exp_f32 v20, v20
s_waitcnt lgkmcnt(6)
v_mfma_f32_16x16x32_bf16 v[144:147], v[212:215], a[4:7], v[144:147]
ds_read_b64_tr_b16 v[196:197], v6 offset:24576
v_mul_f32 v21, s26, v65
v_mfma_f32_16x16x32_bf16 v[148:151], v[212:215], a[76:79], v[148:151]
buffer_load_dwordx4 v14, s[8:11], s27 offen offset:1024 lds
v_mfma_f32_16x16x32_bf16 v[152:155], v[212:215], a[148:151], v[152:155]
v_exp_f32 v21, v21
v_mfma_f32_16x16x32_bf16 v[156:159], v[212:215], a[220:223], v[156:159]
ds_read_b64_tr_b16 v[198:199], v6 offset:25088
v_mul_f32 v22, s26, v66
s_waitcnt lgkmcnt(6)
v_mfma_f32_16x16x32_bf16 v[160:163], v[216:219], a[4:7], v[160:163]
v_exp_f32 v22, v22
v_mfma_f32_16x16x32_bf16 v[164:167], v[216:219], a[76:79], v[164:167]
ds_read_b64_tr_b16 v[200:201], v3 offset:28672
v_mul_f32 v23, s26, v67
v_mfma_f32_16x16x32_bf16 v[168:171], v[216:219], a[148:151], v[168:171]
ds_read_b64_tr_b16 v[202:203], v3 offset:29184
v_mul_f32 v96, v64, v96
v_mfma_f32_16x16x32_bf16 v[172:175], v[216:219], a[220:223], v[172:175]
ds_read_b64_tr_b16 v[204:205], v6 offset:28672
v_mul_f32 v97, v65, v97
s_waitcnt lgkmcnt(7)
v_mfma_f32_16x16x32_bf16 v[176:179], v[220:223], a[4:7], v[176:179]
ds_read_b64_tr_b16 v[206:207], v6 offset:29184
v_mul_f32 v98, v66, v98
v_mfma_f32_16x16x32_bf16 v[180:183], v[220:223], a[76:79], v[180:183]
v_exp_f32 v23, v23
v_mfma_f32_16x16x32_bf16 v[184:187], v[220:223], a[148:151], v[184:187]
v_mul_f32 v99, v67, v99
v_add_f32 v20, 1.0, v20
v_mfma_f32_16x16x32_bf16 v[188:191], v[220:223], a[220:223], v[188:191]
v_rcp_f32 v20, v20
s_waitcnt lgkmcnt(6)
v_mfma_f32_16x16x32_bf16 v[128:131], v[192:195], a[8:11], v[128:131]
s_add_u32 m0, s25, 81920
s_add_u32 s27, s20, 4128896
ds_read_b64_tr_b16 v[208:209], v3 offset:16384
v_mfma_f32_16x16x32_bf16 v[132:135], v[192:195], a[80:83], v[132:135]
buffer_load_dwordx4 v13, s[8:11], s27 offen lds
v_mfma_f32_16x16x32_bf16 v[136:139], v[192:195], a[152:155], v[136:139]
ds_read_b64_tr_b16 v[210:211], v3 offset:16896
v_add_f32 v21, 1.0, v21
v_mfma_f32_16x16x32_bf16 v[140:143], v[192:195], a[224:227], v[140:143]
v_rcp_f32 v21, v21
s_waitcnt lgkmcnt(6)
v_mfma_f32_16x16x32_bf16 v[144:147], v[196:199], a[8:11], v[144:147]
ds_read_b64_tr_b16 v[212:213], v6 offset:16384
v_add_f32 v22, 1.0, v22
v_mfma_f32_16x16x32_bf16 v[148:151], v[196:199], a[80:83], v[148:151]
buffer_load_dwordx4 v14, s[8:11], s27 offen offset:1024 lds
v_mfma_f32_16x16x32_bf16 v[152:155], v[196:199], a[152:155], v[152:155]
s_add_u32 m0, s25, 90112
s_add_u32 s27, s20, 4423808
ds_read_b64_tr_b16 v[214:215], v6 offset:16896
v_mfma_f32_16x16x32_bf16 v[156:159], v[196:199], a[224:227], v[156:159]
ds_read_b64_tr_b16 v[216:217], v3 offset:20480
v_add_f32 v23, 1.0, v23
s_waitcnt lgkmcnt(7)
v_mfma_f32_16x16x32_bf16 v[160:163], v[200:203], a[8:11], v[160:163]
ds_read_b64_tr_b16 v[218:219], v3 offset:20992
v_mul_f32 v96, v96, v20
v_mfma_f32_16x16x32_bf16 v[164:167], v[200:203], a[80:83], v[164:167]
buffer_load_dwordx4 v13, s[8:11], s27 offen lds
v_mfma_f32_16x16x32_bf16 v[168:171], v[200:203], a[152:155], v[168:171]
ds_read_b64_tr_b16 v[220:221], v6 offset:20480
v_mul_f32 v97, v97, v21
v_mfma_f32_16x16x32_bf16 v[172:175], v[200:203], a[224:227], v[172:175]
ds_read_b64_tr_b16 v[222:223], v6 offset:20992
v_cvt_pk_bf16_f32 v28, v96, v97
s_waitcnt lgkmcnt(8)
v_mfma_f32_16x16x32_bf16 v[176:179], v[204:207], a[8:11], v[176:179]
v_rcp_f32 v22, v22
v_mfma_f32_16x16x32_bf16 v[180:183], v[204:207], a[80:83], v[180:183]
buffer_load_dwordx4 v14, s[8:11], s27 offen offset:1024 lds
v_mfma_f32_16x16x32_bf16 v[184:187], v[204:207], a[152:155], v[184:187]
v_rcp_f32 v23, v23
v_mfma_f32_16x16x32_bf16 v[188:191], v[204:207], a[224:227], v[188:191]
v_mul_f32 v98, v98, v22
v_mul_f32 v99, v99, v23
s_waitcnt lgkmcnt(6)
v_mfma_f32_16x16x32_bf16 v[128:131], v[208:211], a[12:15], v[128:131]
s_add_u32 m0, s25, 98304
s_add_u32 s27, s20, 4718720
ds_read_b64_tr_b16 v[192:193], v1 offset:32768
v_mfma_f32_16x16x32_bf16 v[132:135], v[208:211], a[84:87], v[132:135]
buffer_load_dwordx4 v13, s[8:11], s27 offen lds
v_mfma_f32_16x16x32_bf16 v[136:139], v[208:211], a[156:159], v[136:139]
ds_read_b64_tr_b16 v[194:195], v1 offset:33280
v_cvt_pk_bf16_f32 v29, v98, v99
v_mfma_f32_16x16x32_bf16 v[140:143], v[208:211], a[228:231], v[140:143]
ds_read_b64_tr_b16 v[196:197], v4 offset:32768
v_mul_f32 v24, s26, v80
s_waitcnt lgkmcnt(7)
v_mfma_f32_16x16x32_bf16 v[144:147], v[212:215], a[12:15], v[144:147]
v_exp_f32 v24, v24
v_mfma_f32_16x16x32_bf16 v[148:151], v[212:215], a[84:87], v[148:151]
buffer_load_dwordx4 v14, s[8:11], s27 offen offset:1024 lds
v_mfma_f32_16x16x32_bf16 v[152:155], v[212:215], a[156:159], v[152:155]
ds_read_b64_tr_b16 v[198:199], v4 offset:33280
v_mul_f32 v25, s26, v81
v_mfma_f32_16x16x32_bf16 v[156:159], v[212:215], a[228:231], v[156:159]
v_exp_f32 v25, v25
s_waitcnt lgkmcnt(6)
v_mfma_f32_16x16x32_bf16 v[160:163], v[216:219], a[12:15], v[160:163]
ds_read_b64_tr_b16 v[200:201], v1 offset:36864
v_mul_f32 v26, s26, v82
v_mfma_f32_16x16x32_bf16 v[164:167], v[216:219], a[84:87], v[164:167]
v_exp_f32 v26, v26
v_mfma_f32_16x16x32_bf16 v[168:171], v[216:219], a[156:159], v[168:171]
ds_read_b64_tr_b16 v[202:203], v1 offset:37376
v_mul_f32 v27, s26, v83
v_mfma_f32_16x16x32_bf16 v[172:175], v[216:219], a[228:231], v[172:175]
ds_read_b64_tr_b16 v[204:205], v4 offset:36864
v_mul_f32 v112, v80, v112
s_waitcnt lgkmcnt(7)
v_mfma_f32_16x16x32_bf16 v[176:179], v[220:223], a[12:15], v[176:179]
ds_read_b64_tr_b16 v[206:207], v4 offset:37376
v_mul_f32 v113, v81, v113
v_mfma_f32_16x16x32_bf16 v[180:183], v[220:223], a[84:87], v[180:183]
v_exp_f32 v27, v27
v_mfma_f32_16x16x32_bf16 v[184:187], v[220:223], a[156:159], v[184:187]
v_mul_f32 v114, v82, v114
v_mul_f32 v115, v83, v115
v_mfma_f32_16x16x32_bf16 v[188:191], v[220:223], a[228:231], v[188:191]
s_waitcnt vmcnt(12)
s_barrier
s_waitcnt lgkmcnt(6)
v_mfma_f32_16x16x32_bf16 v[128:131], v[192:195], a[16:19], v[128:131]
s_add_u32 m0, s25, 106496
s_add_u32 s27, s20, 5013632
s_add_u32 s55, s28, 0
v_mfma_f32_16x16x32_bf16 v[132:135], v[192:195], a[88:91], v[132:135]
buffer_load_dwordx4 v13, s[8:11], s27 offen lds
v_mfma_f32_16x16x32_bf16 v[136:139], v[192:195], a[160:163], v[136:139]
ds_read_b64_tr_b16 v[208:209], v1 offset:0
v_add_f32 v24, 1.0, v24
v_mfma_f32_16x16x32_bf16 v[140:143], v[192:195], a[232:235], v[140:143]
ds_read_b64_tr_b16 v[210:211], v1 offset:512
v_add_f32 v25, 1.0, v25
s_waitcnt lgkmcnt(6)
v_mfma_f32_16x16x32_bf16 v[144:147], v[196:199], a[16:19], v[144:147]
ds_read_b64_tr_b16 v[212:213], v4 offset:0
v_add_f32 v26, 1.0, v26
v_mfma_f32_16x16x32_bf16 v[148:151], v[196:199], a[88:91], v[148:151]
buffer_load_dwordx4 v14, s[8:11], s27 offen offset:1024 lds
v_mfma_f32_16x16x32_bf16 v[152:155], v[196:199], a[160:163], v[152:155]
s_add_u32 m0, s25, 114688
s_add_u32 s27, s20, 256
ds_read_b64_tr_b16 v[214:215], v4 offset:512
v_mfma_f32_16x16x32_bf16 v[156:159], v[196:199], a[232:235], v[156:159]
ds_read_b64_tr_b16 v[216:217], v1 offset:4096
v_add_f32 v27, 1.0, v27
s_waitcnt lgkmcnt(7)
v_mfma_f32_16x16x32_bf16 v[160:163], v[200:203], a[16:19], v[160:163]
ds_read_b64_tr_b16 v[218:219], v1 offset:4608
v_mul_f32 v20, s26, v68
v_mfma_f32_16x16x32_bf16 v[164:167], v[200:203], a[88:91], v[164:167]
buffer_load_dwordx4 v13, s[8:11], s27 offen lds
v_mfma_f32_16x16x32_bf16 v[168:171], v[200:203], a[160:163], v[168:171]
ds_read_b64_tr_b16 v[220:221], v4 offset:4096
v_mul_f32 v21, s26, v69
v_mfma_f32_16x16x32_bf16 v[172:175], v[200:203], a[232:235], v[172:175]
ds_read_b64_tr_b16 v[222:223], v4 offset:4608
v_mul_f32 v22, s26, v70
s_waitcnt lgkmcnt(8)
v_mfma_f32_16x16x32_bf16 v[176:179], v[204:207], a[16:19], v[176:179]
v_rcp_f32 v24, v24
v_mfma_f32_16x16x32_bf16 v[180:183], v[204:207], a[88:91], v[180:183]
buffer_load_dwordx4 v14, s[8:11], s27 offen offset:1024 lds
v_mfma_f32_16x16x32_bf16 v[184:187], v[204:207], a[160:163], v[184:187]
v_rcp_f32 v25, v25
v_mfma_f32_16x16x32_bf16 v[188:191], v[204:207], a[232:235], v[188:191]
v_rcp_f32 v26, v26
s_waitcnt lgkmcnt(6)
v_mfma_f32_16x16x32_bf16 v[128:131], v[208:211], a[20:23], v[128:131]
s_add_u32 m0, s25, 122880
s_add_u32 s27, s20, 295168
ds_read_b64_tr_b16 v[192:193], v1 offset:40960
v_mfma_f32_16x16x32_bf16 v[132:135], v[208:211], a[92:95], v[132:135]
buffer_load_dwordx4 v13, s[8:11], s27 offen lds
v_mfma_f32_16x16x32_bf16 v[136:139], v[208:211], a[164:167], v[136:139]
v_rcp_f32 v27, v27
v_mfma_f32_16x16x32_bf16 v[140:143], v[208:211], a[236:239], v[140:143]
v_exp_f32 v20, v20
s_waitcnt lgkmcnt(5)
v_mfma_f32_16x16x32_bf16 v[144:147], v[212:215], a[20:23], v[144:147]
v_exp_f32 v21, v21
v_mfma_f32_16x16x32_bf16 v[148:151], v[212:215], a[92:95], v[148:151]
buffer_load_dwordx4 v14, s[8:11], s27 offen offset:1024 lds
v_mfma_f32_16x16x32_bf16 v[152:155], v[212:215], a[164:167], v[152:155]
ds_read_b64_tr_b16 v[194:195], v1 offset:41472
v_mul_f32 v112, v112, v24
v_mfma_f32_16x16x32_bf16 v[156:159], v[212:215], a[236:239], v[156:159]
ds_read_b64_tr_b16 v[196:197], v4 offset:40960
v_mul_f32 v113, v113, v25
s_waitcnt lgkmcnt(5)
v_mfma_f32_16x16x32_bf16 v[160:163], v[216:219], a[20:23], v[160:163]
ds_read_b64_tr_b16 v[198:199], v4 offset:41472
v_mul_f32 v114, v114, v26
v_mfma_f32_16x16x32_bf16 v[164:167], v[216:219], a[92:95], v[164:167]
ds_read_b64_tr_b16 v[200:201], v1 offset:45056
v_mul_f32 v115, v115, v27
v_mfma_f32_16x16x32_bf16 v[168:171], v[216:219], a[164:167], v[168:171]
ds_read_b64_tr_b16 v[202:203], v1 offset:45568
v_cvt_pk_bf16_f32 v30, v112, v113
v_mfma_f32_16x16x32_bf16 v[172:175], v[216:219], a[236:239], v[172:175]
ds_read_b64_tr_b16 v[204:205], v4 offset:45056
v_cvt_pk_bf16_f32 v31, v114, v115
s_waitcnt lgkmcnt(7)
v_mfma_f32_16x16x32_bf16 v[176:179], v[220:223], a[20:23], v[176:179]
ds_read_b64_tr_b16 v[206:207], v4 offset:45568
v_mul_f32 v23, s26, v71
v_mfma_f32_16x16x32_bf16 v[180:183], v[220:223], a[92:95], v[180:183]
buffer_store_dwordx4 v[28:31], v15, s[16:19], s55 offen sc1
v_mfma_f32_16x16x32_bf16 v[184:187], v[220:223], a[164:167], v[184:187]
v_exp_f32 v22, v22
v_mfma_f32_16x16x32_bf16 v[188:191], v[220:223], a[236:239], v[188:191]
v_exp_f32 v23, v23
s_waitcnt lgkmcnt(6)
v_mfma_f32_16x16x32_bf16 v[128:131], v[192:195], a[24:27], v[128:131]
s_add_u32 m0, s25, 139264
s_add_u32 s27, s20, 590080
ds_read_b64_tr_b16 v[208:209], v1 offset:8192
v_mfma_f32_16x16x32_bf16 v[132:135], v[192:195], a[96:99], v[132:135]
buffer_load_dwordx4 v13, s[8:11], s27 offen lds
v_mfma_f32_16x16x32_bf16 v[136:139], v[192:195], a[168:171], v[136:139]
ds_read_b64_tr_b16 v[210:211], v1 offset:8704
v_mul_f32 v100, v68, v100
v_mfma_f32_16x16x32_bf16 v[140:143], v[192:195], a[240:243], v[140:143]
ds_read_b64_tr_b16 v[212:213], v4 offset:8192
v_mul_f32 v101, v69, v101
s_waitcnt lgkmcnt(7)
v_mfma_f32_16x16x32_bf16 v[144:147], v[196:199], a[24:27], v[144:147]
ds_read_b64_tr_b16 v[214:215], v4 offset:8704
v_mul_f32 v102, v70, v102
v_mfma_f32_16x16x32_bf16 v[148:151], v[196:199], a[96:99], v[148:151]
buffer_load_dwordx4 v14, s[8:11], s27 offen offset:1024 lds
v_mfma_f32_16x16x32_bf16 v[152:155], v[196:199], a[168:171], v[152:155]
s_add_u32 m0, s25, 131072
s_add_u32 s27, s20, 884992
ds_read_b64_tr_b16 v[216:217], v1 offset:12288
v_mfma_f32_16x16x32_bf16 v[156:159], v[196:199], a[240:243], v[156:159]
ds_read_b64_tr_b16 v[218:219], v1 offset:12800
v_mul_f32 v103, v71, v103
s_waitcnt lgkmcnt(8)
v_mfma_f32_16x16x32_bf16 v[160:163], v[200:203], a[24:27], v[160:163]
ds_read_b64_tr_b16 v[220:221], v4 offset:12288
v_add_f32 v20, 1.0, v20
v_mfma_f32_16x16x32_bf16 v[164:167], v[200:203], a[96:99], v[164:167]
buffer_load_dwordx4 v13, s[8:11], s27 offen lds
v_mfma_f32_16x16x32_bf16 v[168:171], v[200:203], a[168:171], v[168:171]
v_rcp_f32 v20, v20
v_mfma_f32_16x16x32_bf16 v[172:175], v[200:203], a[240:243], v[172:175]
ds_read_b64_tr_b16 v[222:223], v4 offset:12800
v_add_f32 v21, 1.0, v21
s_waitcnt lgkmcnt(8)
v_mfma_f32_16x16x32_bf16 v[176:179], v[204:207], a[24:27], v[176:179]
v_rcp_f32 v21, v21
v_mfma_f32_16x16x32_bf16 v[180:183], v[204:207], a[96:99], v[180:183]
buffer_load_dwordx4 v14, s[8:11], s27 offen offset:1024 lds
v_mfma_f32_16x16x32_bf16 v[184:187], v[204:207], a[168:171], v[184:187]
v_add_f32 v22, 1.0, v22
v_add_f32 v23, 1.0, v23
v_mfma_f32_16x16x32_bf16 v[188:191], v[204:207], a[240:243], v[188:191]
v_rcp_f32 v22, v22
s_waitcnt lgkmcnt(6)
v_mfma_f32_16x16x32_bf16 v[128:131], v[208:211], a[28:31], v[128:131]
s_add_u32 m0, s25, 155648
s_add_u32 s27, s20, 1179904
ds_read_b64_tr_b16 v[192:193], v1 offset:49152
v_mfma_f32_16x16x32_bf16 v[132:135], v[208:211], a[100:103], v[132:135]
buffer_load_dwordx4 v13, s[8:11], s27 offen lds
v_mfma_f32_16x16x32_bf16 v[136:139], v[208:211], a[172:175], v[136:139]
v_rcp_f32 v23, v23
v_mfma_f32_16x16x32_bf16 v[140:143], v[208:211], a[244:247], v[140:143]
ds_read_b64_tr_b16 v[194:195], v1 offset:49664
v_mul_f32 v100, v100, v20
s_waitcnt lgkmcnt(6)
v_mfma_f32_16x16x32_bf16 v[144:147], v[212:215], a[28:31], v[144:147]
ds_read_b64_tr_b16 v[196:197], v4 offset:49152
v_mul_f32 v101, v101, v21
v_mfma_f32_16x16x32_bf16 v[148:151], v[212:215], a[100:103], v[148:151]
buffer_load_dwordx4 v14, s[8:11], s27 offen offset:1024 lds
v_mfma_f32_16x16x32_bf16 v[152:155], v[212:215], a[172:175], v[152:155]
ds_read_b64_tr_b16 v[198:199], v4 offset:49664
v_mul_f32 v102, v102, v22
v_mfma_f32_16x16x32_bf16 v[156:159], v[212:215], a[244:247], v[156:159]
ds_read_b64_tr_b16 v[200:201], v1 offset:53248
v_mul_f32 v103, v103, v23
s_waitcnt lgkmcnt(7)
v_mfma_f32_16x16x32_bf16 v[160:163], v[216:219], a[28:31], v[160:163]
ds_read_b64_tr_b16 v[202:203], v1 offset:53760
v_cvt_pk_bf16_f32 v32, v100, v101
v_mfma_f32_16x16x32_bf16 v[164:167], v[216:219], a[100:103], v[164:167]
ds_read_b64_tr_b16 v[204:205], v4 offset:53248
v_cvt_pk_bf16_f32 v33, v102, v103
v_mfma_f32_16x16x32_bf16 v[168:171], v[216:219], a[172:175], v[168:171]
ds_read_b64_tr_b16 v[206:207], v4 offset:53760
v_mul_f32 v24, s26, v84
v_mfma_f32_16x16x32_bf16 v[172:175], v[216:219], a[244:247], v[172:175]
v_exp_f32 v24, v24
s_waitcnt lgkmcnt(8)
v_mfma_f32_16x16x32_bf16 v[176:179], v[220:223], a[28:31], v[176:179]
v_mul_f32 v25, s26, v85
v_mul_f32 v26, s26, v86
v_mfma_f32_16x16x32_bf16 v[180:183], v[220:223], a[100:103], v[180:183]
v_exp_f32 v25, v25
v_mfma_f32_16x16x32_bf16 v[184:187], v[220:223], a[172:175], v[184:187]
v_exp_f32 v26, v26
v_mfma_f32_16x16x32_bf16 v[188:191], v[220:223], a[244:247], v[188:191]
v_mul_f32 v27, s26, v87
v_mul_f32 v116, v84, v116
s_waitcnt lgkmcnt(6)
v_mfma_f32_16x16x32_bf16 v[128:131], v[192:195], a[32:35], v[128:131]
s_add_u32 m0, s25, 147456
s_add_u32 s27, s20, 1474816
s_add_u32 s55, s29, 0
v_mfma_f32_16x16x32_bf16 v[132:135], v[192:195], a[104:107], v[132:135]
buffer_load_dwordx4 v13, s[8:11], s27 offen lds
v_mfma_f32_16x16x32_bf16 v[136:139], v[192:195], a[176:179], v[136:139]
v_exp_f32 v27, v27
v_mfma_f32_16x16x32_bf16 v[140:143], v[192:195], a[248:251], v[140:143]
ds_read_b64_tr_b16 v[208:209], v1 offset:16384
v_mul_f32 v117, v85, v117
s_waitcnt lgkmcnt(5)
v_mfma_f32_16x16x32_bf16 v[144:147], v[196:199], a[32:35], v[144:147]
ds_read_b64_tr_b16 v[210:211], v1 offset:16896
v_mul_f32 v118, v86, v118
v_mfma_f32_16x16x32_bf16 v[148:151], v[196:199], a[104:107], v[148:151]
buffer_load_dwordx4 v14, s[8:11], s27 offen offset:1024 lds
v_mfma_f32_16x16x32_bf16 v[152:155], v[196:199], a[176:179], v[152:155]
ds_read_b64_tr_b16 v[212:213], v4 offset:16384
v_mul_f32 v119, v87, v119
v_mfma_f32_16x16x32_bf16 v[156:159], v[196:199], a[248:251], v[156:159]
ds_read_b64_tr_b16 v[214:215], v4 offset:16896
v_add_f32 v24, 1.0, v24
s_waitcnt lgkmcnt(6)
v_mfma_f32_16x16x32_bf16 v[160:163], v[200:203], a[32:35], v[160:163]
v_rcp_f32 v24, v24
v_mfma_f32_16x16x32_bf16 v[164:167], v[200:203], a[104:107], v[164:167]
ds_read_b64_tr_b16 v[216:217], v1 offset:20480
v_add_f32 v25, 1.0, v25
v_mfma_f32_16x16x32_bf16 v[168:171], v[200:203], a[176:179], v[168:171]
ds_read_b64_tr_b16 v[218:219], v1 offset:20992
v_add_f32 v26, 1.0, v26
v_mfma_f32_16x16x32_bf16 v[172:175], v[200:203], a[248:251], v[172:175]
ds_read_b64_tr_b16 v[220:221], v4 offset:20480
v_add_f32 v27, 1.0, v27
s_waitcnt lgkmcnt(7)
v_mfma_f32_16x16x32_bf16 v[176:179], v[204:207], a[32:35], v[176:179]
ds_read_b64_tr_b16 v[222:223], v4 offset:20992
v_mul_f32 v116, v116, v24
v_mfma_f32_16x16x32_bf16 v[180:183], v[204:207], a[104:107], v[180:183]
v_rcp_f32 v25, v25
v_mfma_f32_16x16x32_bf16 v[184:187], v[204:207], a[176:179], v[184:187]
v_rcp_f32 v26, v26
v_mfma_f32_16x16x32_bf16 v[188:191], v[204:207], a[248:251], v[188:191]
v_rcp_f32 v27, v27
s_waitcnt lgkmcnt(6)
v_mfma_f32_16x16x32_bf16 v[128:131], v[208:211], a[36:39], v[128:131]
ds_read_b64_tr_b16 v[192:193], v1 offset:57344
v_mul_f32 v117, v117, v25
v_mfma_f32_16x16x32_bf16 v[132:135], v[208:211], a[108:111], v[132:135]
ds_read_b64_tr_b16 v[194:195], v1 offset:57856
v_mul_f32 v118, v118, v26
v_mfma_f32_16x16x32_bf16 v[136:139], v[208:211], a[180:183], v[136:139]
ds_read_b64_tr_b16 v[196:197], v4 offset:57344
v_mul_f32 v119, v119, v27
v_mfma_f32_16x16x32_bf16 v[140:143], v[208:211], a[252:255], v[140:143]
ds_read_b64_tr_b16 v[198:199], v4 offset:57856
v_cvt_pk_bf16_f32 v34, v116, v117
s_waitcnt lgkmcnt(8)
v_mfma_f32_16x16x32_bf16 v[144:147], v[212:215], a[36:39], v[144:147]
ds_read_b64_tr_b16 v[200:201], v1 offset:61440
v_cvt_pk_bf16_f32 v35, v118, v119
v_mfma_f32_16x16x32_bf16 v[148:151], v[212:215], a[108:111], v[148:151]
buffer_store_dwordx4 v[32:35], v15, s[16:19], s55 offen sc1
v_mfma_f32_16x16x32_bf16 v[152:155], v[212:215], a[180:183], v[152:155]
ds_read_b64_tr_b16 v[202:203], v1 offset:61952
v_mul_f32 v20, s26, v72
v_mfma_f32_16x16x32_bf16 v[156:159], v[212:215], a[252:255], v[156:159]
v_exp_f32 v20, v20
s_waitcnt lgkmcnt(8)
v_mfma_f32_16x16x32_bf16 v[160:163], v[216:219], a[36:39], v[160:163]
ds_read_b64_tr_b16 v[204:205], v4 offset:61440
v_mul_f32 v21, s26, v73
v_mfma_f32_16x16x32_bf16 v[164:167], v[216:219], a[108:111], v[164:167]
v_exp_f32 v21, v21
v_mfma_f32_16x16x32_bf16 v[168:171], v[216:219], a[180:183], v[168:171]
ds_read_b64_tr_b16 v[206:207], v4 offset:61952
v_mul_f32 v22, s26, v74
v_mfma_f32_16x16x32_bf16 v[172:175], v[216:219], a[252:255], v[172:175]
v_exp_f32 v22, v22
s_waitcnt lgkmcnt(8)
v_mfma_f32_16x16x32_bf16 v[176:179], v[220:223], a[36:39], v[176:179]
v_mul_f32 v23, s26, v75
v_mul_f32 v104, v72, v104
v_mfma_f32_16x16x32_bf16 v[180:183], v[220:223], a[108:111], v[180:183]
v_exp_f32 v23, v23
v_mfma_f32_16x16x32_bf16 v[184:187], v[220:223], a[180:183], v[184:187]
v_mul_f32 v105, v73, v105
v_mul_f32 v106, v74, v106
v_mfma_f32_16x16x32_bf16 v[188:191], v[220:223], a[252:255], v[188:191]
s_waitcnt vmcnt(16)
s_barrier
s_waitcnt lgkmcnt(6)
v_mfma_f32_16x16x32_bf16 v[128:131], v[192:195], a[40:43], v[128:131]
s_add_u32 m0, s25, 32768
s_add_u32 s27, s20, 1769728
ds_read_b64_tr_b16 v[208:209], v1 offset:24576
v_mfma_f32_16x16x32_bf16 v[132:135], v[192:195], a[112:115], v[132:135]
buffer_load_dwordx4 v13, s[8:11], s27 offen lds
v_mfma_f32_16x16x32_bf16 v[136:139], v[192:195], a[184:187], v[136:139]
ds_read_b64_tr_b16 v[210:211], v1 offset:25088
v_mul_f32 v107, v75, v107
v_mfma_f32_16x16x32_bf16 v[140:143], v[192:195], v[224:227], v[140:143]
ds_read_b64_tr_b16 v[212:213], v4 offset:24576
v_add_f32 v20, 1.0, v20
s_waitcnt lgkmcnt(7)
v_mfma_f32_16x16x32_bf16 v[144:147], v[196:199], a[40:43], v[144:147]
v_rcp_f32 v20, v20
v_mfma_f32_16x16x32_bf16 v[148:151], v[196:199], a[112:115], v[148:151]
buffer_load_dwordx4 v14, s[8:11], s27 offen offset:1024 lds
v_mfma_f32_16x16x32_bf16 v[152:155], v[196:199], a[184:187], v[152:155]
s_add_u32 m0, s25, 0
s_add_u32 s27, s20, 2064640
ds_read_b64_tr_b16 v[214:215], v4 offset:25088
v_mfma_f32_16x16x32_bf16 v[156:159], v[196:199], v[224:227], v[156:159]
ds_read_b64_tr_b16 v[216:217], v1 offset:28672
v_add_f32 v21, 1.0, v21
s_waitcnt lgkmcnt(7)
v_mfma_f32_16x16x32_bf16 v[160:163], v[200:203], a[40:43], v[160:163]
ds_read_b64_tr_b16 v[218:219], v1 offset:29184
v_add_f32 v22, 1.0, v22
v_mfma_f32_16x16x32_bf16 v[164:167], v[200:203], a[112:115], v[164:167]
buffer_load_dwordx4 v13, s[8:11], s27 offen lds
v_mfma_f32_16x16x32_bf16 v[168:171], v[200:203], a[184:187], v[168:171]
ds_read_b64_tr_b16 v[220:221], v4 offset:28672
v_add_f32 v23, 1.0, v23
v_mfma_f32_16x16x32_bf16 v[172:175], v[200:203], v[224:227], v[172:175]
ds_read_b64_tr_b16 v[222:223], v4 offset:29184
v_mul_f32 v104, v104, v20
s_waitcnt lgkmcnt(8)
v_mfma_f32_16x16x32_bf16 v[176:179], v[204:207], a[40:43], v[176:179]
v_rcp_f32 v21, v21
v_mfma_f32_16x16x32_bf16 v[180:183], v[204:207], a[112:115], v[180:183]
buffer_load_dwordx4 v14, s[8:11], s27 offen offset:1024 lds
v_mfma_f32_16x16x32_bf16 v[184:187], v[204:207], a[184:187], v[184:187]
v_rcp_f32 v22, v22
v_mfma_f32_16x16x32_bf16 v[188:191], v[204:207], v[224:227], v[188:191]
v_rcp_f32 v23, v23
s_waitcnt lgkmcnt(6)
v_mfma_f32_16x16x32_bf16 v[128:131], v[208:211], a[44:47], v[128:131]
s_add_u32 m0, s25, 40960
s_add_u32 s27, s20, 2359552
ds_read_b64_tr_b16 v[192:193], v2 offset:0
v_mfma_f32_16x16x32_bf16 v[132:135], v[208:211], a[116:119], v[132:135]
buffer_load_dwordx4 v13, s[8:11], s27 offen lds
v_mfma_f32_16x16x32_bf16 v[136:139], v[208:211], a[188:191], v[136:139]
ds_read_b64_tr_b16 v[194:195], v2 offset:512
v_mul_f32 v105, v105, v21
v_mfma_f32_16x16x32_bf16 v[140:143], v[208:211], v[228:231], v[140:143]
ds_read_b64_tr_b16 v[196:197], v5 offset:0
v_mul_f32 v106, v106, v22
s_waitcnt lgkmcnt(7)
v_mfma_f32_16x16x32_bf16 v[144:147], v[212:215], a[44:47], v[144:147]
ds_read_b64_tr_b16 v[198:199], v5 offset:512
v_mul_f32 v107, v107, v23
v_mfma_f32_16x16x32_bf16 v[148:151], v[212:215], a[116:119], v[148:151]
buffer_load_dwordx4 v14, s[8:11], s27 offen offset:1024 lds
v_mfma_f32_16x16x32_bf16 v[152:155], v[212:215], a[188:191], v[152:155]
ds_read_b64_tr_b16 v[200:201], v2 offset:4096
v_cvt_pk_bf16_f32 v28, v104, v105
v_mfma_f32_16x16x32_bf16 v[156:159], v[212:215], v[228:231], v[156:159]
ds_read_b64_tr_b16 v[202:203], v2 offset:4608
v_cvt_pk_bf16_f32 v29, v106, v107
s_waitcnt lgkmcnt(8)
v_mfma_f32_16x16x32_bf16 v[160:163], v[216:219], a[44:47], v[160:163]
ds_read_b64_tr_b16 v[204:205], v5 offset:4096
v_mul_f32 v24, s26, v88
v_mfma_f32_16x16x32_bf16 v[164:167], v[216:219], a[116:119], v[164:167]
v_exp_f32 v24, v24
v_mfma_f32_16x16x32_bf16 v[168:171], v[216:219], a[188:191], v[168:171]
ds_read_b64_tr_b16 v[206:207], v5 offset:4608
v_mul_f32 v25, s26, v89
v_mfma_f32_16x16x32_bf16 v[172:175], v[216:219], v[228:231], v[172:175]
v_exp_f32 v25, v25
s_waitcnt lgkmcnt(8)
v_mfma_f32_16x16x32_bf16 v[176:179], v[220:223], a[44:47], v[176:179]
v_mul_f32 v26, s26, v90
v_mul_f32 v27, s26, v91
v_mfma_f32_16x16x32_bf16 v[180:183], v[220:223], a[116:119], v[180:183]
v_exp_f32 v26, v26
v_mfma_f32_16x16x32_bf16 v[184:187], v[220:223], a[188:191], v[184:187]
v_exp_f32 v27, v27
v_mfma_f32_16x16x32_bf16 v[188:191], v[220:223], v[228:231], v[188:191]
v_mul_f32 v120, v88, v120
v_mul_f32 v121, v89, v121
s_waitcnt lgkmcnt(6)
v_mfma_f32_16x16x32_bf16 v[128:131], v[192:195], a[48:51], v[128:131]
s_add_u32 m0, s25, 8192
s_add_u32 s27, s20, 2654464
s_add_u32 s55, s30, 0
v_mfma_f32_16x16x32_bf16 v[132:135], v[192:195], a[120:123], v[132:135]
buffer_load_dwordx4 v13, s[8:11], s27 offen lds
v_mfma_f32_16x16x32_bf16 v[136:139], v[192:195], a[192:195], v[136:139]
ds_read_b64_tr_b16 v[208:209], v2 offset:8192
v_mul_f32 v122, v90, v122
v_mfma_f32_16x16x32_bf16 v[140:143], v[192:195], v[232:235], v[140:143]
ds_read_b64_tr_b16 v[210:211], v2 offset:8704
v_mul_f32 v123, v91, v123
s_waitcnt lgkmcnt(6)
v_mfma_f32_16x16x32_bf16 v[144:147], v[196:199], a[48:51], v[144:147]
ds_read_b64_tr_b16 v[212:213], v5 offset:8192
v_add_f32 v24, 1.0, v24
v_mfma_f32_16x16x32_bf16 v[148:151], v[196:199], a[120:123], v[148:151]
buffer_load_dwordx4 v14, s[8:11], s27 offen offset:1024 lds
v_mfma_f32_16x16x32_bf16 v[152:155], v[196:199], a[192:195], v[152:155]
s_add_u32 m0, s25, 49152
s_add_u32 s27, s20, 2949376
ds_read_b64_tr_b16 v[214:215], v5 offset:8704
v_mfma_f32_16x16x32_bf16 v[156:159], v[196:199], v[232:235], v[156:159]
ds_read_b64_tr_b16 v[216:217], v2 offset:12288
v_add_f32 v25, 1.0, v25
s_waitcnt lgkmcnt(7)
v_mfma_f32_16x16x32_bf16 v[160:163], v[200:203], a[48:51], v[160:163]
ds_read_b64_tr_b16 v[218:219], v2 offset:12800
v_add_f32 v26, 1.0, v26
v_mfma_f32_16x16x32_bf16 v[164:167], v[200:203], a[120:123], v[164:167]
buffer_load_dwordx4 v13, s[8:11], s27 offen lds
v_mfma_f32_16x16x32_bf16 v[168:171], v[200:203], a[192:195], v[168:171]
ds_read_b64_tr_b16 v[220:221], v5 offset:12288
v_add_f32 v27, 1.0, v27
v_mfma_f32_16x16x32_bf16 v[172:175], v[200:203], v[232:235], v[172:175]
ds_read_b64_tr_b16 v[222:223], v5 offset:12800
v_mul_f32 v20, s26, v76
s_waitcnt lgkmcnt(8)
v_mfma_f32_16x16x32_bf16 v[176:179], v[204:207], a[48:51], v[176:179]
v_rcp_f32 v24, v24
v_mfma_f32_16x16x32_bf16 v[180:183], v[204:207], a[120:123], v[180:183]
buffer_load_dwordx4 v14, s[8:11], s27 offen offset:1024 lds
v_mfma_f32_16x16x32_bf16 v[184:187], v[204:207], a[192:195], v[184:187]
v_rcp_f32 v25, v25
v_mfma_f32_16x16x32_bf16 v[188:191], v[204:207], v[232:235], v[188:191]
v_rcp_f32 v26, v26
s_waitcnt lgkmcnt(6)
v_mfma_f32_16x16x32_bf16 v[128:131], v[208:211], a[52:55], v[128:131]
s_add_u32 m0, s25, 16384
s_add_u32 s27, s20, 3244288
ds_read_b64_tr_b16 v[192:193], v2 offset:16384
v_mfma_f32_16x16x32_bf16 v[132:135], v[208:211], a[124:127], v[132:135]
buffer_load_dwordx4 v13, s[8:11], s27 offen lds
v_mfma_f32_16x16x32_bf16 v[136:139], v[208:211], a[196:199], v[136:139]
v_rcp_f32 v27, v27
v_mfma_f32_16x16x32_bf16 v[140:143], v[208:211], v[236:239], v[140:143]
v_exp_f32 v20, v20
s_waitcnt lgkmcnt(5)
v_mfma_f32_16x16x32_bf16 v[144:147], v[212:215], a[52:55], v[144:147]
ds_read_b64_tr_b16 v[194:195], v2 offset:16896
v_mul_f32 v120, v120, v24
v_mfma_f32_16x16x32_bf16 v[148:151], v[212:215], a[124:127], v[148:151]
buffer_load_dwordx4 v14, s[8:11], s27 offen offset:1024 lds
v_mfma_f32_16x16x32_bf16 v[152:155], v[212:215], a[196:199], v[152:155]
ds_read_b64_tr_b16 v[196:197], v5 offset:16384
v_mul_f32 v121, v121, v25
v_mfma_f32_16x16x32_bf16 v[156:159], v[212:215], v[236:239], v[156:159]
ds_read_b64_tr_b16 v[198:199], v5 offset:16896
v_mul_f32 v122, v122, v26
s_waitcnt lgkmcnt(6)
v_mfma_f32_16x16x32_bf16 v[160:163], v[216:219], a[52:55], v[160:163]
ds_read_b64_tr_b16 v[200:201], v2 offset:20480
v_mul_f32 v123, v123, v27
v_mfma_f32_16x16x32_bf16 v[164:167], v[216:219], a[124:127], v[164:167]
ds_read_b64_tr_b16 v[202:203], v2 offset:20992
v_cvt_pk_bf16_f32 v30, v120, v121
v_mfma_f32_16x16x32_bf16 v[168:171], v[216:219], a[196:199], v[168:171]
ds_read_b64_tr_b16 v[204:205], v5 offset:20480
v_cvt_pk_bf16_f32 v31, v122, v123
v_mfma_f32_16x16x32_bf16 v[172:175], v[216:219], v[236:239], v[172:175]
ds_read_b64_tr_b16 v[206:207], v5 offset:20992
v_mul_f32 v21, s26, v77
s_waitcnt lgkmcnt(8)
v_mfma_f32_16x16x32_bf16 v[176:179], v[220:223], a[52:55], v[176:179]
buffer_store_dwordx4 v[28:31], v15, s[16:19], s55 offen sc1
v_mfma_f32_16x16x32_bf16 v[180:183], v[220:223], a[124:127], v[180:183]
v_exp_f32 v21, v21
v_mfma_f32_16x16x32_bf16 v[184:187], v[220:223], a[196:199], v[184:187]
v_mul_f32 v22, s26, v78
v_mul_f32 v23, s26, v79
v_mfma_f32_16x16x32_bf16 v[188:191], v[220:223], v[236:239], v[188:191]
v_exp_f32 v22, v22
s_waitcnt lgkmcnt(6)
v_mfma_f32_16x16x32_bf16 v[128:131], v[192:195], a[56:59], v[128:131]
v_exp_f32 v23, v23
v_mfma_f32_16x16x32_bf16 v[132:135], v[192:195], a[128:131], v[132:135]
ds_read_b64_tr_b16 v[208:209], v2 offset:24576
v_mul_f32 v108, v76, v108
v_mfma_f32_16x16x32_bf16 v[136:139], v[192:195], a[200:203], v[136:139]
ds_read_b64_tr_b16 v[210:211], v2 offset:25088
v_mul_f32 v109, v77, v109
v_mfma_f32_16x16x32_bf16 v[140:143], v[192:195], v[240:243], v[140:143]
ds_read_b64_tr_b16 v[212:213], v5 offset:24576
v_mul_f32 v110, v78, v110
s_waitcnt lgkmcnt(7)
v_mfma_f32_16x16x32_bf16 v[144:147], v[196:199], a[56:59], v[144:147]
ds_read_b64_tr_b16 v[214:215], v5 offset:25088
v_mul_f32 v111, v79, v111
v_mfma_f32_16x16x32_bf16 v[148:151], v[196:199], a[128:131], v[148:151]
ds_read_b64_tr_b16 v[216:217], v2 offset:28672
v_add_f32 v20, 1.0, v20
v_mfma_f32_16x16x32_bf16 v[152:155], v[196:199], a[200:203], v[152:155]
v_rcp_f32 v20, v20
v_mfma_f32_16x16x32_bf16 v[156:159], v[196:199], v[240:243], v[156:159]
ds_read_b64_tr_b16 v[218:219], v2 offset:29184
v_add_f32 v21, 1.0, v21
s_waitcnt lgkmcnt(8)
v_mfma_f32_16x16x32_bf16 v[160:163], v[200:203], a[56:59], v[160:163]
v_rcp_f32 v21, v21
v_mfma_f32_16x16x32_bf16 v[164:167], v[200:203], a[128:131], v[164:167]
ds_read_b64_tr_b16 v[220:221], v5 offset:28672
v_add_f32 v22, 1.0, v22
v_mfma_f32_16x16x32_bf16 v[168:171], v[200:203], a[200:203], v[168:171]
v_rcp_f32 v22, v22
v_mfma_f32_16x16x32_bf16 v[172:175], v[200:203], v[240:243], v[172:175]
ds_read_b64_tr_b16 v[222:223], v5 offset:29184
v_add_f32 v23, 1.0, v23
s_waitcnt lgkmcnt(8)
v_mfma_f32_16x16x32_bf16 v[176:179], v[204:207], a[56:59], v[176:179]
v_rcp_f32 v23, v23
v_mfma_f32_16x16x32_bf16 v[180:183], v[204:207], a[128:131], v[180:183]
v_mul_f32 v108, v108, v20
v_mul_f32 v109, v109, v21
v_mfma_f32_16x16x32_bf16 v[184:187], v[204:207], a[200:203], v[184:187]
v_mul_f32 v110, v110, v22
v_mul_f32 v111, v111, v23
v_mfma_f32_16x16x32_bf16 v[188:191], v[204:207], v[240:243], v[188:191]
v_cvt_pk_bf16_f32 v32, v108, v109
v_cvt_pk_bf16_f32 v33, v110, v111
s_waitcnt lgkmcnt(6)
v_mfma_f32_16x16x32_bf16 v[128:131], v[208:211], a[60:63], v[128:131]
ds_read_b64_tr_b16 v[192:193], v2 offset:32768
v_mul_f32 v24, s26, v92
v_mfma_f32_16x16x32_bf16 v[132:135], v[208:211], a[132:135], v[132:135]
v_exp_f32 v24, v24
v_mfma_f32_16x16x32_bf16 v[136:139], v[208:211], a[204:207], v[136:139]
ds_read_b64_tr_b16 v[194:195], v2 offset:33280
v_mul_f32 v25, s26, v93
v_mfma_f32_16x16x32_bf16 v[140:143], v[208:211], v[244:247], v[140:143]
v_exp_f32 v25, v25
s_waitcnt lgkmcnt(6)
v_mfma_f32_16x16x32_bf16 v[144:147], v[212:215], a[60:63], v[144:147]
ds_read_b64_tr_b16 v[196:197], v5 offset:32768
v_mul_f32 v26, s26, v94
v_mfma_f32_16x16x32_bf16 v[148:151], v[212:215], a[132:135], v[148:151]
v_exp_f32 v26, v26
v_mfma_f32_16x16x32_bf16 v[152:155], v[212:215], a[204:207], v[152:155]
ds_read_b64_tr_b16 v[198:199], v5 offset:33280
v_mul_f32 v27, s26, v95
v_mfma_f32_16x16x32_bf16 v[156:159], v[212:215], v[244:247], v[156:159]
v_exp_f32 v27, v27
s_waitcnt lgkmcnt(6)
v_mfma_f32_16x16x32_bf16 v[160:163], v[216:219], a[60:63], v[160:163]
ds_read_b64_tr_b16 v[200:201], v2 offset:36864
v_mul_f32 v124, v92, v124
v_mfma_f32_16x16x32_bf16 v[164:167], v[216:219], a[132:135], v[164:167]
ds_read_b64_tr_b16 v[202:203], v2 offset:37376
v_mul_f32 v125, v93, v125
v_mfma_f32_16x16x32_bf16 v[168:171], v[216:219], a[204:207], v[168:171]
ds_read_b64_tr_b16 v[204:205], v5 offset:36864
v_mul_f32 v126, v94, v126
v_mfma_f32_16x16x32_bf16 v[172:175], v[216:219], v[244:247], v[172:175]
ds_read_b64_tr_b16 v[206:207], v5 offset:37376
v_mul_f32 v127, v95, v127
s_waitcnt lgkmcnt(8)
v_mfma_f32_16x16x32_bf16 v[176:179], v[220:223], a[60:63], v[176:179]
v_add_f32 v24, 1.0, v24
v_add_f32 v25, 1.0, v25
v_mfma_f32_16x16x32_bf16 v[180:183], v[220:223], a[132:135], v[180:183]
v_rcp_f32 v24, v24
v_mfma_f32_16x16x32_bf16 v[184:187], v[220:223], a[204:207], v[184:187]
v_rcp_f32 v25, v25
v_mfma_f32_16x16x32_bf16 v[188:191], v[220:223], v[244:247], v[188:191]
s_waitcnt vmcnt(16)
s_barrier
s_waitcnt lgkmcnt(6)
v_mfma_f32_16x16x32_bf16 v[128:131], v[192:195], a[64:67], v[128:131]
s_add_u32 m0, s25, 57344
s_add_u32 s27, s20, 3539200
s_add_u32 s55, s31, 0
v_mfma_f32_16x16x32_bf16 v[132:135], v[192:195], a[136:139], v[132:135]
buffer_load_dwordx4 v13, s[8:11], s27 offen lds
v_mfma_f32_16x16x32_bf16 v[136:139], v[192:195], a[208:211], v[136:139]
ds_read_b64_tr_b16 v[208:209], v2 offset:40960
v_add_f32 v26, 1.0, v26
v_mfma_f32_16x16x32_bf16 v[140:143], v[192:195], v[248:251], v[140:143]
ds_read_b64_tr_b16 v[210:211], v2 offset:41472
v_add_f32 v27, 1.0, v27
s_waitcnt lgkmcnt(6)
v_mfma_f32_16x16x32_bf16 v[144:147], v[196:199], a[64:67], v[144:147]
ds_read_b64_tr_b16 v[212:213], v5 offset:40960
v_mul_f32 v124, v124, v24
v_mfma_f32_16x16x32_bf16 v[148:151], v[196:199], a[136:139], v[148:151]
buffer_load_dwordx4 v14, s[8:11], s27 offen offset:1024 lds
v_mfma_f32_16x16x32_bf16 v[152:155], v[196:199], a[208:211], v[152:155]
s_add_u32 m0, s25, 24576
s_add_u32 s27, s20, 3834112
ds_read_b64_tr_b16 v[214:215], v5 offset:41472
v_mfma_f32_16x16x32_bf16 v[156:159], v[196:199], v[248:251], v[156:159]
ds_read_b64_tr_b16 v[216:217], v2 offset:45056
v_mul_f32 v125, v125, v25
s_waitcnt lgkmcnt(7)
v_mfma_f32_16x16x32_bf16 v[160:163], v[200:203], a[64:67], v[160:163]
ds_read_b64_tr_b16 v[218:219], v2 offset:45568
v_cvt_pk_bf16_f32 v34, v124, v125
v_mfma_f32_16x16x32_bf16 v[164:167], v[200:203], a[136:139], v[164:167]
buffer_load_dwordx4 v13, s[8:11], s27 offen lds
v_mfma_f32_16x16x32_bf16 v[168:171], v[200:203], a[208:211], v[168:171]
ds_read_b64_tr_b16 v[220:221], v5 offset:45056
v_mfma_f32_16x16x32_bf16 v[172:175], v[200:203], v[248:251], v[172:175]
ds_read_b64_tr_b16 v[222:223], v5 offset:45568
s_waitcnt lgkmcnt(8)
v_mfma_f32_16x16x32_bf16 v[176:179], v[204:207], a[64:67], v[176:179]
v_rcp_f32 v26, v26
v_mfma_f32_16x16x32_bf16 v[180:183], v[204:207], a[136:139], v[180:183]
buffer_load_dwordx4 v14, s[8:11], s27 offen offset:1024 lds
v_mfma_f32_16x16x32_bf16 v[184:187], v[204:207], a[208:211], v[184:187]
v_rcp_f32 v27, v27
v_mfma_f32_16x16x32_bf16 v[188:191], v[204:207], v[248:251], v[188:191]
v_mul_f32 v126, v126, v26
v_mul_f32 v127, v127, v27
s_waitcnt lgkmcnt(6)
v_mfma_f32_16x16x32_bf16 v[128:131], v[208:211], a[68:71], v[128:131]
s_add_u32 m0, s25, 65536
s_add_u32 s27, s20, 4129024
ds_read_b64_tr_b16 v[192:193], v2 offset:49152
v_mfma_f32_16x16x32_bf16 v[132:135], v[208:211], a[140:143], v[132:135]
buffer_load_dwordx4 v13, s[8:11], s27 offen lds
v_mfma_f32_16x16x32_bf16 v[136:139], v[208:211], a[212:215], v[136:139]
ds_read_b64_tr_b16 v[194:195], v2 offset:49664
v_cvt_pk_bf16_f32 v35, v126, v127
v_mfma_f32_16x16x32_bf16 v[140:143], v[208:211], v[252:255], v[140:143]
ds_read_b64_tr_b16 v[196:197], v5 offset:49152
s_waitcnt lgkmcnt(7)
v_mfma_f32_16x16x32_bf16 v[144:147], v[212:215], a[68:71], v[144:147]
buffer_store_dwordx4 v[32:35], v15, s[16:19], s55 offen sc1
v_mfma_f32_16x16x32_bf16 v[148:151], v[212:215], a[140:143], v[148:151]
buffer_load_dwordx4 v14, s[8:11], s27 offen offset:1024 lds
v_mfma_f32_16x16x32_bf16 v[152:155], v[212:215], a[212:215], v[152:155]
ds_read_b64_tr_b16 v[198:199], v5 offset:49664
v_mfma_f32_16x16x32_bf16 v[156:159], v[212:215], v[252:255], v[156:159]
ds_read_b64_tr_b16 v[200:201], v2 offset:53248
s_waitcnt lgkmcnt(7)
v_mfma_f32_16x16x32_bf16 v[160:163], v[216:219], a[68:71], v[160:163]
ds_read_b64_tr_b16 v[202:203], v2 offset:53760
v_mfma_f32_16x16x32_bf16 v[164:167], v[216:219], a[140:143], v[164:167]
ds_read_b64_tr_b16 v[204:205], v5 offset:53248
v_mfma_f32_16x16x32_bf16 v[168:171], v[216:219], a[212:215], v[168:171]
ds_read_b64_tr_b16 v[206:207], v5 offset:53760
v_mfma_f32_16x16x32_bf16 v[172:175], v[216:219], v[252:255], v[172:175]
s_waitcnt lgkmcnt(8)
v_mfma_f32_16x16x32_bf16 v[176:179], v[220:223], a[68:71], v[176:179]
v_mfma_f32_16x16x32_bf16 v[180:183], v[220:223], a[140:143], v[180:183]
v_mfma_f32_16x16x32_bf16 v[184:187], v[220:223], a[212:215], v[184:187]
v_mfma_f32_16x16x32_bf16 v[188:191], v[220:223], v[252:255], v[188:191]
s_waitcnt lgkmcnt(6)
v_mfma_f32_16x16x32_bf16 v[64:67], v[192:195], a[0:3], 0
s_add_u32 m0, s25, 73728
s_add_u32 s27, s20, 4423936
ds_read_b64_tr_b16 v[208:209], v2 offset:57344
v_mfma_f32_16x16x32_bf16 v[68:71], v[192:195], a[72:75], 0
buffer_load_dwordx4 v13, s[8:11], s27 offen lds
v_mfma_f32_16x16x32_bf16 v[72:75], v[192:195], a[144:147], 0
ds_read_b64_tr_b16 v[210:211], v2 offset:57856
v_mfma_f32_16x16x32_bf16 v[76:79], v[192:195], a[216:219], 0
ds_read_b64_tr_b16 v[212:213], v5 offset:57344
s_waitcnt lgkmcnt(7)
v_mfma_f32_16x16x32_bf16 v[80:83], v[196:199], a[0:3], 0
ds_read_b64_tr_b16 v[214:215], v5 offset:57856
v_mfma_f32_16x16x32_bf16 v[84:87], v[196:199], a[72:75], 0
buffer_load_dwordx4 v14, s[8:11], s27 offen offset:1024 lds
v_mfma_f32_16x16x32_bf16 v[88:91], v[196:199], a[144:147], 0
s_add_u32 m0, s25, 81920
s_add_u32 s27, s20, 4718848
ds_read_b64_tr_b16 v[216:217], v2 offset:61440
v_mfma_f32_16x16x32_bf16 v[92:95], v[196:199], a[216:219], 0
ds_read_b64_tr_b16 v[218:219], v2 offset:61952
s_waitcnt lgkmcnt(8)
v_mfma_f32_16x16x32_bf16 v[96:99], v[200:203], a[0:3], 0
ds_read_b64_tr_b16 v[220:221], v5 offset:61440
v_mfma_f32_16x16x32_bf16 v[100:103], v[200:203], a[72:75], 0
buffer_load_dwordx4 v13, s[8:11], s27 offen lds
v_mfma_f32_16x16x32_bf16 v[104:107], v[200:203], a[144:147], 0
ds_read_b64_tr_b16 v[222:223], v5 offset:61952
v_mfma_f32_16x16x32_bf16 v[108:111], v[200:203], a[216:219], 0
s_waitcnt lgkmcnt(8)
v_mfma_f32_16x16x32_bf16 v[112:115], v[204:207], a[0:3], 0
v_mfma_f32_16x16x32_bf16 v[116:119], v[204:207], a[72:75], 0
buffer_load_dwordx4 v14, s[8:11], s27 offen offset:1024 lds
v_mfma_f32_16x16x32_bf16 v[120:123], v[204:207], a[144:147], 0
v_mfma_f32_16x16x32_bf16 v[124:127], v[204:207], a[216:219], 0
s_waitcnt lgkmcnt(6)
v_mfma_f32_16x16x32_bf16 v[64:67], v[208:211], a[4:7], v[64:67]
s_add_u32 m0, s25, 90112
s_add_u32 s27, s20, 5013760
ds_read_b64_tr_b16 v[192:193], v3 offset:8192
v_mfma_f32_16x16x32_bf16 v[68:71], v[208:211], a[76:79], v[68:71]
buffer_load_dwordx4 v13, s[8:11], s27 offen lds
v_mfma_f32_16x16x32_bf16 v[72:75], v[208:211], a[148:151], v[72:75]
ds_read_b64_tr_b16 v[194:195], v3 offset:8704
v_mul_f32 v20, s26, v128
v_mfma_f32_16x16x32_bf16 v[76:79], v[208:211], a[220:223], v[76:79]
v_exp_f32 v20, v20
s_waitcnt lgkmcnt(6)
v_mfma_f32_16x16x32_bf16 v[80:83], v[212:215], a[4:7], v[80:83]
ds_read_b64_tr_b16 v[196:197], v6 offset:8192
v_mul_f32 v21, s26, v129
v_mfma_f32_16x16x32_bf16 v[84:87], v[212:215], a[76:79], v[84:87]
buffer_load_dwordx4 v14, s[8:11], s27 offen offset:1024 lds
v_mfma_f32_16x16x32_bf16 v[88:91], v[212:215], a[148:151], v[88:91]
v_exp_f32 v21, v21
v_mfma_f32_16x16x32_bf16 v[92:95], v[212:215], a[220:223], v[92:95]
ds_read_b64_tr_b16 v[198:199], v6 offset:8704
v_mul_f32 v22, s26, v130
s_waitcnt lgkmcnt(6)
v_mfma_f32_16x16x32_bf16 v[96:99], v[216:219], a[4:7], v[96:99]
v_exp_f32 v22, v22
v_mfma_f32_16x16x32_bf16 v[100:103], v[216:219], a[76:79], v[100:103]
ds_read_b64_tr_b16 v[200:201], v3 offset:12288
v_mul_f32 v23, s26, v131
v_mfma_f32_16x16x32_bf16 v[104:107], v[216:219], a[148:151], v[104:107]
ds_read_b64_tr_b16 v[202:203], v3 offset:12800
v_mul_f32 v160, v128, v160
v_mfma_f32_16x16x32_bf16 v[108:111], v[216:219], a[220:223], v[108:111]
ds_read_b64_tr_b16 v[204:205], v6 offset:12288
v_mul_f32 v161, v129, v161
s_waitcnt lgkmcnt(7)
v_mfma_f32_16x16x32_bf16 v[112:115], v[220:223], a[4:7], v[112:115]
ds_read_b64_tr_b16 v[206:207], v6 offset:12800
v_mul_f32 v162, v130, v162
v_mfma_f32_16x16x32_bf16 v[116:119], v[220:223], a[76:79], v[116:119]
v_exp_f32 v23, v23
v_mfma_f32_16x16x32_bf16 v[120:123], v[220:223], a[148:151], v[120:123]
v_mul_f32 v163, v131, v163
v_add_f32 v20, 1.0, v20
v_mfma_f32_16x16x32_bf16 v[124:127], v[220:223], a[220:223], v[124:127]
v_rcp_f32 v20, v20
s_waitcnt lgkmcnt(6)
v_mfma_f32_16x16x32_bf16 v[64:67], v[192:195], a[8:11], v[64:67]
ds_read_b64_tr_b16 v[208:209], v3 offset:0
v_add_f32 v21, 1.0, v21
v_mfma_f32_16x16x32_bf16 v[68:71], v[192:195], a[80:83], v[68:71]
v_rcp_f32 v21, v21
v_mfma_f32_16x16x32_bf16 v[72:75], v[192:195], a[152:155], v[72:75]
ds_read_b64_tr_b16 v[210:211], v3 offset:512
v_add_f32 v22, 1.0, v22
v_mfma_f32_16x16x32_bf16 v[76:79], v[192:195], a[224:227], v[76:79]
v_rcp_f32 v22, v22
s_waitcnt lgkmcnt(6)
v_mfma_f32_16x16x32_bf16 v[80:83], v[196:199], a[8:11], v[80:83]
ds_read_b64_tr_b16 v[212:213], v6 offset:0
v_add_f32 v23, 1.0, v23
v_mfma_f32_16x16x32_bf16 v[84:87], v[196:199], a[80:83], v[84:87]
v_rcp_f32 v23, v23
v_mfma_f32_16x16x32_bf16 v[88:91], v[196:199], a[152:155], v[88:91]
ds_read_b64_tr_b16 v[214:215], v6 offset:512
v_mul_f32 v160, v160, v20
v_mfma_f32_16x16x32_bf16 v[92:95], v[196:199], a[224:227], v[92:95]
ds_read_b64_tr_b16 v[216:217], v3 offset:4096
v_mul_f32 v161, v161, v21
s_waitcnt lgkmcnt(7)
v_mfma_f32_16x16x32_bf16 v[96:99], v[200:203], a[8:11], v[96:99]
ds_read_b64_tr_b16 v[218:219], v3 offset:4608
v_mul_f32 v162, v162, v22
v_mfma_f32_16x16x32_bf16 v[100:103], v[200:203], a[80:83], v[100:103]
ds_read_b64_tr_b16 v[220:221], v6 offset:4096
v_mul_f32 v163, v163, v23
v_mfma_f32_16x16x32_bf16 v[104:107], v[200:203], a[152:155], v[104:107]
ds_read_b64_tr_b16 v[222:223], v6 offset:4608
v_cvt_pk_bf16_f32 v28, v160, v161
v_mfma_f32_16x16x32_bf16 v[108:111], v[200:203], a[224:227], v[108:111]
v_cvt_pk_bf16_f32 v29, v162, v163
v_mul_f32 v24, s26, v144
s_waitcnt lgkmcnt(8)
v_mfma_f32_16x16x32_bf16 v[112:115], v[204:207], a[8:11], v[112:115]
v_exp_f32 v24, v24
v_mfma_f32_16x16x32_bf16 v[116:119], v[204:207], a[80:83], v[116:119]
v_mul_f32 v25, s26, v145
v_mul_f32 v26, s26, v146
v_mfma_f32_16x16x32_bf16 v[120:123], v[204:207], a[152:155], v[120:123]
v_exp_f32 v25, v25
v_mfma_f32_16x16x32_bf16 v[124:127], v[204:207], a[224:227], v[124:127]
v_exp_f32 v26, v26
s_waitcnt lgkmcnt(6)
v_mfma_f32_16x16x32_bf16 v[64:67], v[208:211], a[12:15], v[64:67]
ds_read_b64_tr_b16 v[192:193], v3 offset:24576
v_mul_f32 v27, s26, v147
v_mfma_f32_16x16x32_bf16 v[68:71], v[208:211], a[84:87], v[68:71]
v_exp_f32 v27, v27
v_mfma_f32_16x16x32_bf16 v[72:75], v[208:211], a[156:159], v[72:75]
ds_read_b64_tr_b16 v[194:195], v3 offset:25088
v_mul_f32 v176, v144, v176
v_mfma_f32_16x16x32_bf16 v[76:79], v[208:211], a[228:231], v[76:79]
ds_read_b64_tr_b16 v[196:197], v6 offset:24576
v_mul_f32 v177, v145, v177
s_waitcnt lgkmcnt(7)
v_mfma_f32_16x16x32_bf16 v[80:83], v[212:215], a[12:15], v[80:83]
ds_read_b64_tr_b16 v[198:199], v6 offset:25088
v_mul_f32 v178, v146, v178
v_mfma_f32_16x16x32_bf16 v[84:87], v[212:215], a[84:87], v[84:87]
ds_read_b64_tr_b16 v[200:201], v3 offset:28672
v_mul_f32 v179, v147, v179
v_mfma_f32_16x16x32_bf16 v[88:91], v[212:215], a[156:159], v[88:91]
ds_read_b64_tr_b16 v[202:203], v3 offset:29184
v_add_f32 v24, 1.0, v24
v_mfma_f32_16x16x32_bf16 v[92:95], v[212:215], a[228:231], v[92:95]
v_rcp_f32 v24, v24
s_waitcnt lgkmcnt(8)
v_mfma_f32_16x16x32_bf16 v[96:99], v[216:219], a[12:15], v[96:99]
ds_read_b64_tr_b16 v[204:205], v6 offset:28672
v_add_f32 v25, 1.0, v25
v_mfma_f32_16x16x32_bf16 v[100:103], v[216:219], a[84:87], v[100:103]
v_rcp_f32 v25, v25
v_mfma_f32_16x16x32_bf16 v[104:107], v[216:219], a[156:159], v[104:107]
ds_read_b64_tr_b16 v[206:207], v6 offset:29184
v_add_f32 v26, 1.0, v26
v_mfma_f32_16x16x32_bf16 v[108:111], v[216:219], a[228:231], v[108:111]
v_rcp_f32 v26, v26
s_waitcnt lgkmcnt(8)
v_mfma_f32_16x16x32_bf16 v[112:115], v[220:223], a[12:15], v[112:115]
v_add_f32 v27, 1.0, v27
v_mul_f32 v176, v176, v24
v_mfma_f32_16x16x32_bf16 v[116:119], v[220:223], a[84:87], v[116:119]
v_rcp_f32 v27, v27
v_mfma_f32_16x16x32_bf16 v[120:123], v[220:223], a[156:159], v[120:123]
v_mul_f32 v177, v177, v25
v_mul_f32 v178, v178, v26
v_mfma_f32_16x16x32_bf16 v[124:127], v[220:223], a[228:231], v[124:127]
s_waitcnt vmcnt(16)
s_barrier
s_waitcnt lgkmcnt(6)
v_mfma_f32_16x16x32_bf16 v[64:67], v[192:195], a[16:19], v[64:67]
s_add_u32 m0, s25, 98304
s_add_u32 s27, s20, 384
s_add_u32 s55, s28, 2048
v_mfma_f32_16x16x32_bf16 v[68:71], v[192:195], a[88:91], v[68:71]
buffer_load_dwordx4 v13, s[8:11], s27 offen lds
v_mfma_f32_16x16x32_bf16 v[72:75], v[192:195], a[160:163], v[72:75]
ds_read_b64_tr_b16 v[208:209], v3 offset:16384
v_mul_f32 v179, v179, v27
v_mfma_f32_16x16x32_bf16 v[76:79], v[192:195], a[232:235], v[76:79]
ds_read_b64_tr_b16 v[210:211], v3 offset:16896
v_cvt_pk_bf16_f32 v30, v176, v177
s_waitcnt lgkmcnt(6)
v_mfma_f32_16x16x32_bf16 v[80:83], v[196:199], a[16:19], v[80:83]
ds_read_b64_tr_b16 v[212:213], v6 offset:16384
v_cvt_pk_bf16_f32 v31, v178, v179
v_mfma_f32_16x16x32_bf16 v[84:87], v[196:199], a[88:91], v[84:87]
buffer_load_dwordx4 v14, s[8:11], s27 offen offset:1024 lds
v_mfma_f32_16x16x32_bf16 v[88:91], v[196:199], a[160:163], v[88:91]
buffer_store_dwordx4 v[28:31], v15, s[16:19], s55 offen sc1
v_mfma_f32_16x16x32_bf16 v[92:95], v[196:199], a[232:235], v[92:95]
s_add_u32 m0, s25, 106496
ds_read_b64_tr_b16 v[214:215], v6 offset:16896
s_waitcnt lgkmcnt(6)
v_mfma_f32_16x16x32_bf16 v[96:99], v[200:203], a[16:19], v[96:99]
s_add_u32 s27, s20, 295296
ds_read_b64_tr_b16 v[216:217], v3 offset:20480
v_mul_f32 v20, s26, v132
v_mfma_f32_16x16x32_bf16 v[100:103], v[200:203], a[88:91], v[100:103]
buffer_load_dwordx4 v13, s[8:11], s27 offen lds
v_mfma_f32_16x16x32_bf16 v[104:107], v[200:203], a[160:163], v[104:107]
ds_read_b64_tr_b16 v[218:219], v3 offset:20992
v_mul_f32 v21, s26, v133
v_mfma_f32_16x16x32_bf16 v[108:111], v[200:203], a[232:235], v[108:111]
ds_read_b64_tr_b16 v[220:221], v6 offset:20480
v_mul_f32 v22, s26, v134
s_waitcnt lgkmcnt(7)
v_mfma_f32_16x16x32_bf16 v[112:115], v[204:207], a[16:19], v[112:115]
ds_read_b64_tr_b16 v[222:223], v6 offset:20992
v_mul_f32 v23, s26, v135
v_mfma_f32_16x16x32_bf16 v[116:119], v[204:207], a[88:91], v[116:119]
buffer_load_dwordx4 v14, s[8:11], s27 offen offset:1024 lds
v_mfma_f32_16x16x32_bf16 v[120:123], v[204:207], a[160:163], v[120:123]
v_exp_f32 v20, v20
v_mfma_f32_16x16x32_bf16 v[124:127], v[204:207], a[232:235], v[124:127]
v_exp_f32 v21, v21
s_waitcnt lgkmcnt(6)
v_mfma_f32_16x16x32_bf16 v[64:67], v[208:211], a[20:23], v[64:67]
s_add_u32 m0, s25, 114688
s_add_u32 s27, s20, 590208
ds_read_b64_tr_b16 v[192:193], v1 offset:32768
v_mfma_f32_16x16x32_bf16 v[68:71], v[208:211], a[92:95], v[68:71]
buffer_load_dwordx4 v13, s[8:11], s27 offen lds
v_mfma_f32_16x16x32_bf16 v[72:75], v[208:211], a[164:167], v[72:75]
v_exp_f32 v22, v22
v_mfma_f32_16x16x32_bf16 v[76:79], v[208:211], a[236:239], v[76:79]
v_exp_f32 v23, v23
s_waitcnt lgkmcnt(5)
v_mfma_f32_16x16x32_bf16 v[80:83], v[212:215], a[20:23], v[80:83]
ds_read_b64_tr_b16 v[194:195], v1 offset:33280
v_mul_f32 v164, v132, v164
v_mfma_f32_16x16x32_bf16 v[84:87], v[212:215], a[92:95], v[84:87]
buffer_load_dwordx4 v14, s[8:11], s27 offen offset:1024 lds
v_mfma_f32_16x16x32_bf16 v[88:91], v[212:215], a[164:167], v[88:91]
ds_read_b64_tr_b16 v[196:197], v4 offset:32768
v_mul_f32 v165, v133, v165
v_mfma_f32_16x16x32_bf16 v[92:95], v[212:215], a[236:239], v[92:95]
ds_read_b64_tr_b16 v[198:199], v4 offset:33280
v_mul_f32 v166, v134, v166
s_waitcnt lgkmcnt(6)
v_mfma_f32_16x16x32_bf16 v[96:99], v[216:219], a[20:23], v[96:99]
ds_read_b64_tr_b16 v[200:201], v1 offset:36864
v_mul_f32 v167, v135, v167
v_mfma_f32_16x16x32_bf16 v[100:103], v[216:219], a[92:95], v[100:103]
ds_read_b64_tr_b16 v[202:203], v1 offset:37376
v_add_f32 v20, 1.0, v20
v_mfma_f32_16x16x32_bf16 v[104:107], v[216:219], a[164:167], v[104:107]
v_rcp_f32 v20, v20
v_mfma_f32_16x16x32_bf16 v[108:111], v[216:219], a[236:239], v[108:111]
ds_read_b64_tr_b16 v[204:205], v4 offset:36864
v_add_f32 v21, 1.0, v21
s_waitcnt lgkmcnt(7)
v_mfma_f32_16x16x32_bf16 v[112:115], v[220:223], a[20:23], v[112:115]
ds_read_b64_tr_b16 v[206:207], v4 offset:37376
v_add_f32 v22, 1.0, v22
v_mfma_f32_16x16x32_bf16 v[116:119], v[220:223], a[92:95], v[116:119]
v_rcp_f32 v21, v21
v_mfma_f32_16x16x32_bf16 v[120:123], v[220:223], a[164:167], v[120:123]
v_rcp_f32 v22, v22
v_mfma_f32_16x16x32_bf16 v[124:127], v[220:223], a[236:239], v[124:127]
v_add_f32 v23, 1.0, v23
v_mul_f32 v164, v164, v20
s_waitcnt lgkmcnt(6)
v_mfma_f32_16x16x32_bf16 v[64:67], v[192:195], a[24:27], v[64:67]
s_add_u32 m0, s25, 122880
s_add_u32 s27, s20, 885120
ds_read_b64_tr_b16 v[208:209], v1 offset:0
v_mfma_f32_16x16x32_bf16 v[68:71], v[192:195], a[96:99], v[68:71]
buffer_load_dwordx4 v13, s[8:11], s27 offen lds
v_mfma_f32_16x16x32_bf16 v[72:75], v[192:195], a[168:171], v[72:75]
v_rcp_f32 v23, v23
v_mfma_f32_16x16x32_bf16 v[76:79], v[192:195], a[240:243], v[76:79]
ds_read_b64_tr_b16 v[210:211], v1 offset:512
v_mul_f32 v165, v165, v21
s_waitcnt lgkmcnt(6)
v_mfma_f32_16x16x32_bf16 v[80:83], v[196:199], a[24:27], v[80:83]
ds_read_b64_tr_b16 v[212:213], v4 offset:0
v_mul_f32 v166, v166, v22
v_mfma_f32_16x16x32_bf16 v[84:87], v[196:199], a[96:99], v[84:87]
buffer_load_dwordx4 v14, s[8:11], s27 offen offset:1024 lds
v_mfma_f32_16x16x32_bf16 v[88:91], v[196:199], a[168:171], v[88:91]
s_add_u32 m0, s25, 139264
s_add_u32 s27, s20, 1180032
ds_read_b64_tr_b16 v[214:215], v4 offset:512
v_mfma_f32_16x16x32_bf16 v[92:95], v[196:199], a[240:243], v[92:95]
ds_read_b64_tr_b16 v[216:217], v1 offset:4096
v_mul_f32 v167, v167, v23
s_waitcnt lgkmcnt(7)
v_mfma_f32_16x16x32_bf16 v[96:99], v[200:203], a[24:27], v[96:99]
ds_read_b64_tr_b16 v[218:219], v1 offset:4608
v_cvt_pk_bf16_f32 v32, v164, v165
v_mfma_f32_16x16x32_bf16 v[100:103], v[200:203], a[96:99], v[100:103]
buffer_load_dwordx4 v13, s[8:11], s27 offen lds
v_mfma_f32_16x16x32_bf16 v[104:107], v[200:203], a[168:171], v[104:107]
ds_read_b64_tr_b16 v[220:221], v4 offset:4096
v_cvt_pk_bf16_f32 v33, v166, v167
v_mfma_f32_16x16x32_bf16 v[108:111], v[200:203], a[240:243], v[108:111]
ds_read_b64_tr_b16 v[222:223], v4 offset:4608
v_mul_f32 v24, s26, v148
s_waitcnt lgkmcnt(8)
v_mfma_f32_16x16x32_bf16 v[112:115], v[204:207], a[24:27], v[112:115]
v_exp_f32 v24, v24
v_mfma_f32_16x16x32_bf16 v[116:119], v[204:207], a[96:99], v[116:119]
buffer_load_dwordx4 v14, s[8:11], s27 offen offset:1024 lds
v_mfma_f32_16x16x32_bf16 v[120:123], v[204:207], a[168:171], v[120:123]
v_mul_f32 v25, s26, v149
v_mul_f32 v26, s26, v150
v_mfma_f32_16x16x32_bf16 v[124:127], v[204:207], a[240:243], v[124:127]
v_exp_f32 v25, v25
s_waitcnt lgkmcnt(6)
v_mfma_f32_16x16x32_bf16 v[64:67], v[208:211], a[28:31], v[64:67]
s_add_u32 m0, s25, 131072
s_add_u32 s27, s20, 1474944
ds_read_b64_tr_b16 v[192:193], v1 offset:40960
v_mfma_f32_16x16x32_bf16 v[68:71], v[208:211], a[100:103], v[68:71]
buffer_load_dwordx4 v13, s[8:11], s27 offen lds
v_mfma_f32_16x16x32_bf16 v[72:75], v[208:211], a[172:175], v[72:75]
v_exp_f32 v26, v26
v_mfma_f32_16x16x32_bf16 v[76:79], v[208:211], a[244:247], v[76:79]
ds_read_b64_tr_b16 v[194:195], v1 offset:41472
v_mul_f32 v27, s26, v151
s_waitcnt lgkmcnt(6)
v_mfma_f32_16x16x32_bf16 v[80:83], v[212:215], a[28:31], v[80:83]
v_exp_f32 v27, v27
v_mfma_f32_16x16x32_bf16 v[84:87], v[212:215], a[100:103], v[84:87]
buffer_load_dwordx4 v14, s[8:11], s27 offen offset:1024 lds
v_mfma_f32_16x16x32_bf16 v[88:91], v[212:215], a[172:175], v[88:91]
ds_read_b64_tr_b16 v[196:197], v4 offset:40960
v_mul_f32 v180, v148, v180
v_mfma_f32_16x16x32_bf16 v[92:95], v[212:215], a[244:247], v[92:95]
ds_read_b64_tr_b16 v[198:199], v4 offset:41472
v_mul_f32 v181, v149, v181
s_waitcnt lgkmcnt(6)
v_mfma_f32_16x16x32_bf16 v[96:99], v[216:219], a[28:31], v[96:99]
ds_read_b64_tr_b16 v[200:201], v1 offset:45056
v_mul_f32 v182, v150, v182
v_mfma_f32_16x16x32_bf16 v[100:103], v[216:219], a[100:103], v[100:103]
ds_read_b64_tr_b16 v[202:203], v1 offset:45568
v_mul_f32 v183, v151, v183
v_mfma_f32_16x16x32_bf16 v[104:107], v[216:219], a[172:175], v[104:107]
ds_read_b64_tr_b16 v[204:205], v4 offset:45056
v_add_f32 v24, 1.0, v24
v_mfma_f32_16x16x32_bf16 v[108:111], v[216:219], a[244:247], v[108:111]
v_rcp_f32 v24, v24
s_waitcnt lgkmcnt(7)
v_mfma_f32_16x16x32_bf16 v[112:115], v[220:223], a[28:31], v[112:115]
ds_read_b64_tr_b16 v[206:207], v4 offset:45568
v_add_f32 v25, 1.0, v25
v_mfma_f32_16x16x32_bf16 v[116:119], v[220:223], a[100:103], v[116:119]
v_rcp_f32 v25, v25
v_mfma_f32_16x16x32_bf16 v[120:123], v[220:223], a[172:175], v[120:123]
v_add_f32 v26, 1.0, v26
v_add_f32 v27, 1.0, v27
v_mfma_f32_16x16x32_bf16 v[124:127], v[220:223], a[244:247], v[124:127]
v_rcp_f32 v26, v26
s_waitcnt lgkmcnt(6)
v_mfma_f32_16x16x32_bf16 v[64:67], v[192:195], a[32:35], v[64:67]
s_add_u32 s55, s29, 2048
v_rcp_f32 v27, v27
v_mfma_f32_16x16x32_bf16 v[68:71], v[192:195], a[104:107], v[68:71]
ds_read_b64_tr_b16 v[208:209], v1 offset:8192
v_mul_f32 v180, v180, v24
v_mfma_f32_16x16x32_bf16 v[72:75], v[192:195], a[176:179], v[72:75]
ds_read_b64_tr_b16 v[210:211], v1 offset:8704
v_mul_f32 v181, v181, v25
v_mfma_f32_16x16x32_bf16 v[76:79], v[192:195], a[248:251], v[76:79]
ds_read_b64_tr_b16 v[212:213], v4 offset:8192
v_mul_f32 v182, v182, v26
s_waitcnt lgkmcnt(7)
v_mfma_f32_16x16x32_bf16 v[80:83], v[196:199], a[32:35], v[80:83]
ds_read_b64_tr_b16 v[214:215], v4 offset:8704
v_mul_f32 v183, v183, v27
v_mfma_f32_16x16x32_bf16 v[84:87], v[196:199], a[104:107], v[84:87]
ds_read_b64_tr_b16 v[216:217], v1 offset:12288
v_cvt_pk_bf16_f32 v34, v180, v181
v_mfma_f32_16x16x32_bf16 v[88:91], v[196:199], a[176:179], v[88:91]
ds_read_b64_tr_b16 v[218:219], v1 offset:12800
v_cvt_pk_bf16_f32 v35, v182, v183
v_mfma_f32_16x16x32_bf16 v[92:95], v[196:199], a[248:251], v[92:95]
ds_read_b64_tr_b16 v[220:221], v4 offset:12288
v_mul_f32 v20, s26, v136
s_waitcnt lgkmcnt(9)
v_mfma_f32_16x16x32_bf16 v[96:99], v[200:203], a[32:35], v[96:99]
buffer_store_dwordx4 v[32:35], v15, s[16:19], s55 offen sc1
v_mfma_f32_16x16x32_bf16 v[100:103], v[200:203], a[104:107], v[100:103]
v_exp_f32 v20, v20
v_mfma_f32_16x16x32_bf16 v[104:107], v[200:203], a[176:179], v[104:107]
ds_read_b64_tr_b16 v[222:223], v4 offset:12800
v_mul_f32 v21, s26, v137
v_mfma_f32_16x16x32_bf16 v[108:111], v[200:203], a[248:251], v[108:111]
v_exp_f32 v21, v21
s_waitcnt lgkmcnt(8)
v_mfma_f32_16x16x32_bf16 v[112:115], v[204:207], a[32:35], v[112:115]
v_mul_f32 v22, s26, v138
v_mul_f32 v23, s26, v139
v_mfma_f32_16x16x32_bf16 v[116:119], v[204:207], a[104:107], v[116:119]
v_exp_f32 v22, v22
v_mfma_f32_16x16x32_bf16 v[120:123], v[204:207], a[176:179], v[120:123]
v_exp_f32 v23, v23
v_mfma_f32_16x16x32_bf16 v[124:127], v[204:207], a[248:251], v[124:127]
v_mul_f32 v168, v136, v168
v_mul_f32 v169, v137, v169
s_waitcnt lgkmcnt(6)
v_mfma_f32_16x16x32_bf16 v[64:67], v[208:211], a[36:39], v[64:67]
ds_read_b64_tr_b16 v[192:193], v1 offset:49152
v_mul_f32 v170, v138, v170
v_mfma_f32_16x16x32_bf16 v[68:71], v[208:211], a[108:111], v[68:71]
ds_read_b64_tr_b16 v[194:195], v1 offset:49664
v_mul_f32 v171, v139, v171
v_mfma_f32_16x16x32_bf16 v[72:75], v[208:211], a[180:183], v[72:75]
ds_read_b64_tr_b16 v[196:197], v4 offset:49152
v_add_f32 v20, 1.0, v20
v_mfma_f32_16x16x32_bf16 v[76:79], v[208:211], a[252:255], v[76:79]
v_rcp_f32 v20, v20
s_waitcnt lgkmcnt(7)
v_mfma_f32_16x16x32_bf16 v[80:83], v[212:215], a[36:39], v[80:83]
ds_read_b64_tr_b16 v[198:199], v4 offset:49664
v_add_f32 v21, 1.0, v21
v_mfma_f32_16x16x32_bf16 v[84:87], v[212:215], a[108:111], v[84:87]
v_rcp_f32 v21, v21
v_mfma_f32_16x16x32_bf16 v[88:91], v[212:215], a[180:183], v[88:91]
ds_read_b64_tr_b16 v[200:201], v1 offset:53248
v_add_f32 v22, 1.0, v22
v_mfma_f32_16x16x32_bf16 v[92:95], v[212:215], a[252:255], v[92:95]
v_rcp_f32 v22, v22
s_waitcnt lgkmcnt(7)
v_mfma_f32_16x16x32_bf16 v[96:99], v[216:219], a[36:39], v[96:99]
ds_read_b64_tr_b16 v[202:203], v1 offset:53760
v_add_f32 v23, 1.0, v23
v_mfma_f32_16x16x32_bf16 v[100:103], v[216:219], a[108:111], v[100:103]
v_rcp_f32 v23, v23
v_mfma_f32_16x16x32_bf16 v[104:107], v[216:219], a[180:183], v[104:107]
ds_read_b64_tr_b16 v[204:205], v4 offset:53248
v_mul_f32 v168, v168, v20
v_mfma_f32_16x16x32_bf16 v[108:111], v[216:219], a[252:255], v[108:111]
ds_read_b64_tr_b16 v[206:207], v4 offset:53760
v_mul_f32 v169, v169, v21
s_waitcnt lgkmcnt(8)
v_mfma_f32_16x16x32_bf16 v[112:115], v[220:223], a[36:39], v[112:115]
v_mul_f32 v170, v170, v22
v_mul_f32 v171, v171, v23
v_mfma_f32_16x16x32_bf16 v[116:119], v[220:223], a[108:111], v[116:119]
v_cvt_pk_bf16_f32 v28, v168, v169
v_cvt_pk_bf16_f32 v29, v170, v171
v_mfma_f32_16x16x32_bf16 v[120:123], v[220:223], a[180:183], v[120:123]
v_mul_f32 v24, s26, v152
v_mul_f32 v25, s26, v153
v_mfma_f32_16x16x32_bf16 v[124:127], v[220:223], a[252:255], v[124:127]
s_waitcnt vmcnt(16)
s_barrier
s_waitcnt lgkmcnt(6)
v_mfma_f32_16x16x32_bf16 v[64:67], v[192:195], a[40:43], v[64:67]
s_add_u32 m0, s25, 155648
s_add_u32 s27, s20, 1769856
ds_read_b64_tr_b16 v[208:209], v1 offset:16384
v_mfma_f32_16x16x32_bf16 v[68:71], v[192:195], a[112:115], v[68:71]
buffer_load_dwordx4 v13, s[8:11], s27 offen lds
v_mfma_f32_16x16x32_bf16 v[72:75], v[192:195], a[184:187], v[72:75]
v_exp_f32 v24, v24
v_mfma_f32_16x16x32_bf16 v[76:79], v[192:195], v[224:227], v[76:79]
ds_read_b64_tr_b16 v[210:211], v1 offset:16896
v_mul_f32 v26, s26, v154
s_waitcnt lgkmcnt(6)
v_mfma_f32_16x16x32_bf16 v[80:83], v[196:199], a[40:43], v[80:83]
ds_read_b64_tr_b16 v[212:213], v4 offset:16384
v_mul_f32 v27, s26, v155
v_mfma_f32_16x16x32_bf16 v[84:87], v[196:199], a[112:115], v[84:87]
buffer_load_dwordx4 v14, s[8:11], s27 offen offset:1024 lds
v_mfma_f32_16x16x32_bf16 v[88:91], v[196:199], a[184:187], v[88:91]
s_add_u32 m0, s25, 147456
s_add_u32 s27, s20, 2064768
ds_read_b64_tr_b16 v[214:215], v4 offset:16896
v_mfma_f32_16x16x32_bf16 v[92:95], v[196:199], v[224:227], v[92:95]
ds_read_b64_tr_b16 v[216:217], v1 offset:20480
v_mul_f32 v184, v152, v184
s_waitcnt lgkmcnt(7)
v_mfma_f32_16x16x32_bf16 v[96:99], v[200:203], a[40:43], v[96:99]
ds_read_b64_tr_b16 v[218:219], v1 offset:20992
v_mul_f32 v185, v153, v185
v_mfma_f32_16x16x32_bf16 v[100:103], v[200:203], a[112:115], v[100:103]
buffer_load_dwordx4 v13, s[8:11], s27 offen lds
v_mfma_f32_16x16x32_bf16 v[104:107], v[200:203], a[184:187], v[104:107]
ds_read_b64_tr_b16 v[220:221], v4 offset:20480
v_mul_f32 v186, v154, v186
v_mfma_f32_16x16x32_bf16 v[108:111], v[200:203], v[224:227], v[108:111]
ds_read_b64_tr_b16 v[222:223], v4 offset:20992
v_mul_f32 v187, v155, v187
s_waitcnt lgkmcnt(8)
v_mfma_f32_16x16x32_bf16 v[112:115], v[204:207], a[40:43], v[112:115]
v_exp_f32 v25, v25
v_mfma_f32_16x16x32_bf16 v[116:119], v[204:207], a[112:115], v[116:119]
buffer_load_dwordx4 v14, s[8:11], s27 offen offset:1024 lds
v_mfma_f32_16x16x32_bf16 v[120:123], v[204:207], a[184:187], v[120:123]
v_exp_f32 v26, v26
v_mfma_f32_16x16x32_bf16 v[124:127], v[204:207], v[224:227], v[124:127]
v_exp_f32 v27, v27
s_waitcnt lgkmcnt(6)
v_mfma_f32_16x16x32_bf16 v[64:67], v[208:211], a[44:47], v[64:67]
s_add_u32 m0, s25, 32768
s_add_u32 s27, s20, 2359680
s_add_u32 s55, s30, 2048
v_mfma_f32_16x16x32_bf16 v[68:71], v[208:211], a[116:119], v[68:71]
buffer_load_dwordx4 v13, s[8:11], s27 offen lds
v_mfma_f32_16x16x32_bf16 v[72:75], v[208:211], a[188:191], v[72:75]
ds_read_b64_tr_b16 v[192:193], v1 offset:57344
v_add_f32 v24, 1.0, v24
v_mfma_f32_16x16x32_bf16 v[76:79], v[208:211], v[228:231], v[76:79]
v_rcp_f32 v24, v24
s_waitcnt lgkmcnt(5)
v_mfma_f32_16x16x32_bf16 v[80:83], v[212:215], a[44:47], v[80:83]
ds_read_b64_tr_b16 v[194:195], v1 offset:57856
v_add_f32 v25, 1.0, v25
v_mfma_f32_16x16x32_bf16 v[84:87], v[212:215], a[116:119], v[84:87]
buffer_load_dwordx4 v14, s[8:11], s27 offen offset:1024 lds
v_mfma_f32_16x16x32_bf16 v[88:91], v[212:215], a[188:191], v[88:91]
v_rcp_f32 v25, v25
v_mfma_f32_16x16x32_bf16 v[92:95], v[212:215], v[228:231], v[92:95]
ds_read_b64_tr_b16 v[196:197], v4 offset:57344
v_add_f32 v26, 1.0, v26
s_waitcnt lgkmcnt(5)
v_mfma_f32_16x16x32_bf16 v[96:99], v[216:219], a[44:47], v[96:99]
ds_read_b64_tr_b16 v[198:199], v4 offset:57856
v_add_f32 v27, 1.0, v27
v_mfma_f32_16x16x32_bf16 v[100:103], v[216:219], a[116:119], v[100:103]
ds_read_b64_tr_b16 v[200:201], v1 offset:61440
v_mul_f32 v184, v184, v24
v_mfma_f32_16x16x32_bf16 v[104:107], v[216:219], a[188:191], v[104:107]
ds_read_b64_tr_b16 v[202:203], v1 offset:61952
v_mul_f32 v185, v185, v25
v_mfma_f32_16x16x32_bf16 v[108:111], v[216:219], v[228:231], v[108:111]
ds_read_b64_tr_b16 v[204:205], v4 offset:61440
v_cvt_pk_bf16_f32 v30, v184, v185
s_waitcnt lgkmcnt(7)
v_mfma_f32_16x16x32_bf16 v[112:115], v[220:223], a[44:47], v[112:115]
ds_read_b64_tr_b16 v[206:207], v4 offset:61952
v_mul_f32 v20, s26, v140
v_mfma_f32_16x16x32_bf16 v[116:119], v[220:223], a[116:119], v[116:119]
v_rcp_f32 v26, v26
v_mfma_f32_16x16x32_bf16 v[120:123], v[220:223], a[188:191], v[120:123]
v_rcp_f32 v27, v27
v_mfma_f32_16x16x32_bf16 v[124:127], v[220:223], v[228:231], v[124:127]
v_mul_f32 v186, v186, v26
v_mul_f32 v187, v187, v27
s_waitcnt lgkmcnt(6)
v_mfma_f32_16x16x32_bf16 v[64:67], v[192:195], a[48:51], v[64:67]
s_add_u32 m0, s25, 0
s_add_u32 s27, s20, 2654592
ds_read_b64_tr_b16 v[208:209], v1 offset:24576
v_mfma_f32_16x16x32_bf16 v[68:71], v[192:195], a[120:123], v[68:71]
buffer_load_dwordx4 v13, s[8:11], s27 offen lds
v_mfma_f32_16x16x32_bf16 v[72:75], v[192:195], a[192:195], v[72:75]
v_exp_f32 v20, v20
v_mfma_f32_16x16x32_bf16 v[76:79], v[192:195], v[232:235], v[76:79]
ds_read_b64_tr_b16 v[210:211], v1 offset:25088
v_cvt_pk_bf16_f32 v31, v186, v187
s_waitcnt lgkmcnt(6)
v_mfma_f32_16x16x32_bf16 v[80:83], v[196:199], a[48:51], v[80:83]
buffer_store_dwordx4 v[28:31], v15, s[16:19], s55 offen sc1
v_mfma_f32_16x16x32_bf16 v[84:87], v[196:199], a[120:123], v[84:87]
buffer_load_dwordx4 v14, s[8:11], s27 offen offset:1024 lds
v_mfma_f32_16x16x32_bf16 v[88:91], v[196:199], a[192:195], v[88:91]
s_add_u32 m0, s25, 40960
s_add_u32 s27, s20, 2949504
ds_read_b64_tr_b16 v[212:213], v4 offset:24576
v_mfma_f32_16x16x32_bf16 v[92:95], v[196:199], v[232:235], v[92:95]
ds_read_b64_tr_b16 v[214:215], v4 offset:25088
v_mul_f32 v21, s26, v141
s_waitcnt lgkmcnt(6)
v_mfma_f32_16x16x32_bf16 v[96:99], v[200:203], a[48:51], v[96:99]
ds_read_b64_tr_b16 v[216:217], v1 offset:28672
v_mul_f32 v22, s26, v142
v_mfma_f32_16x16x32_bf16 v[100:103], v[200:203], a[120:123], v[100:103]
buffer_load_dwordx4 v13, s[8:11], s27 offen lds
v_mfma_f32_16x16x32_bf16 v[104:107], v[200:203], a[192:195], v[104:107]
ds_read_b64_tr_b16 v[218:219], v1 offset:29184
v_mul_f32 v23, s26, v143
v_mfma_f32_16x16x32_bf16 v[108:111], v[200:203], v[232:235], v[108:111]
ds_read_b64_tr_b16 v[220:221], v4 offset:28672
v_mul_f32 v172, v140, v172
s_waitcnt lgkmcnt(7)
v_mfma_f32_16x16x32_bf16 v[112:115], v[204:207], a[48:51], v[112:115]
ds_read_b64_tr_b16 v[222:223], v4 offset:29184
v_mul_f32 v173, v141, v173
v_mfma_f32_16x16x32_bf16 v[116:119], v[204:207], a[120:123], v[116:119]
buffer_load_dwordx4 v14, s[8:11], s27 offen offset:1024 lds
v_mfma_f32_16x16x32_bf16 v[120:123], v[204:207], a[192:195], v[120:123]
v_exp_f32 v21, v21
v_mfma_f32_16x16x32_bf16 v[124:127], v[204:207], v[232:235], v[124:127]
v_exp_f32 v22, v22
s_waitcnt lgkmcnt(6)
v_mfma_f32_16x16x32_bf16 v[64:67], v[208:211], a[52:55], v[64:67]
s_add_u32 m0, s25, 8192
s_add_u32 s27, s20, 3244416
ds_read_b64_tr_b16 v[192:193], v2 offset:0
v_mfma_f32_16x16x32_bf16 v[68:71], v[208:211], a[124:127], v[68:71]
buffer_load_dwordx4 v13, s[8:11], s27 offen lds
v_mfma_f32_16x16x32_bf16 v[72:75], v[208:211], a[196:199], v[72:75]
v_exp_f32 v23, v23
v_mfma_f32_16x16x32_bf16 v[76:79], v[208:211], v[236:239], v[76:79]
ds_read_b64_tr_b16 v[194:195], v2 offset:512
v_mul_f32 v174, v142, v174
s_waitcnt lgkmcnt(6)
v_mfma_f32_16x16x32_bf16 v[80:83], v[212:215], a[52:55], v[80:83]
ds_read_b64_tr_b16 v[196:197], v5 offset:0
v_mul_f32 v175, v143, v175
v_mfma_f32_16x16x32_bf16 v[84:87], v[212:215], a[124:127], v[84:87]
buffer_load_dwordx4 v14, s[8:11], s27 offen offset:1024 lds
v_mfma_f32_16x16x32_bf16 v[88:91], v[212:215], a[196:199], v[88:91]
ds_read_b64_tr_b16 v[198:199], v5 offset:512
v_add_f32 v20, 1.0, v20
v_mfma_f32_16x16x32_bf16 v[92:95], v[212:215], v[236:239], v[92:95]
v_rcp_f32 v20, v20
s_waitcnt lgkmcnt(6)
v_mfma_f32_16x16x32_bf16 v[96:99], v[216:219], a[52:55], v[96:99]
ds_read_b64_tr_b16 v[200:201], v2 offset:4096
v_add_f32 v21, 1.0, v21
v_mfma_f32_16x16x32_bf16 v[100:103], v[216:219], a[124:127], v[100:103]
v_rcp_f32 v21, v21
v_mfma_f32_16x16x32_bf16 v[104:107], v[216:219], a[196:199], v[104:107]
ds_read_b64_tr_b16 v[202:203], v2 offset:4608
v_add_f32 v22, 1.0, v22
v_mfma_f32_16x16x32_bf16 v[108:111], v[216:219], v[236:239], v[108:111]
ds_read_b64_tr_b16 v[204:205], v5 offset:4096
v_add_f32 v23, 1.0, v23
s_waitcnt lgkmcnt(7)
v_mfma_f32_16x16x32_bf16 v[112:115], v[220:223], a[52:55], v[112:115]
ds_read_b64_tr_b16 v[206:207], v5 offset:4608
v_mul_f32 v172, v172, v20
v_mfma_f32_16x16x32_bf16 v[116:119], v[220:223], a[124:127], v[116:119]
v_rcp_f32 v22, v22
v_mfma_f32_16x16x32_bf16 v[120:123], v[220:223], a[196:199], v[120:123]
v_rcp_f32 v23, v23
v_mfma_f32_16x16x32_bf16 v[124:127], v[220:223], v[236:239], v[124:127]
v_mul_f32 v173, v173, v21
v_mul_f32 v174, v174, v22
s_waitcnt lgkmcnt(6)
v_mfma_f32_16x16x32_bf16 v[64:67], v[192:195], a[56:59], v[64:67]
ds_read_b64_tr_b16 v[208:209], v2 offset:8192
v_mul_f32 v175, v175, v23
v_mfma_f32_16x16x32_bf16 v[68:71], v[192:195], a[128:131], v[68:71]
ds_read_b64_tr_b16 v[210:211], v2 offset:8704
v_cvt_pk_bf16_f32 v32, v172, v173
v_mfma_f32_16x16x32_bf16 v[72:75], v[192:195], a[200:203], v[72:75]
ds_read_b64_tr_b16 v[212:213], v5 offset:8192
v_cvt_pk_bf16_f32 v33, v174, v175
v_mfma_f32_16x16x32_bf16 v[76:79], v[192:195], v[240:243], v[76:79]
ds_read_b64_tr_b16 v[214:215], v5 offset:8704
v_mul_f32 v24, s26, v156
s_waitcnt lgkmcnt(8)
v_mfma_f32_16x16x32_bf16 v[80:83], v[196:199], a[56:59], v[80:83]
v_exp_f32 v24, v24
v_mfma_f32_16x16x32_bf16 v[84:87], v[196:199], a[128:131], v[84:87]
ds_read_b64_tr_b16 v[216:217], v2 offset:12288
v_mul_f32 v25, s26, v157
v_mfma_f32_16x16x32_bf16 v[88:91], v[196:199], a[200:203], v[88:91]
v_exp_f32 v25, v25
v_mfma_f32_16x16x32_bf16 v[92:95], v[196:199], v[240:243], v[92:95]
ds_read_b64_tr_b16 v[218:219], v2 offset:12800
v_mul_f32 v26, s26, v158
s_waitcnt lgkmcnt(8)
v_mfma_f32_16x16x32_bf16 v[96:99], v[200:203], a[56:59], v[96:99]
v_exp_f32 v26, v26
v_mfma_f32_16x16x32_bf16 v[100:103], v[200:203], a[128:131], v[100:103]
ds_read_b64_tr_b16 v[220:221], v5 offset:12288
v_mul_f32 v27, s26, v159
v_mfma_f32_16x16x32_bf16 v[104:107], v[200:203], a[200:203], v[104:107]
v_exp_f32 v27, v27
v_mfma_f32_16x16x32_bf16 v[108:111], v[200:203], v[240:243], v[108:111]
ds_read_b64_tr_b16 v[222:223], v5 offset:12800
v_mul_f32 v188, v156, v188
s_waitcnt lgkmcnt(8)
v_mfma_f32_16x16x32_bf16 v[112:115], v[204:207], a[56:59], v[112:115]
v_mul_f32 v189, v157, v189
v_mul_f32 v190, v158, v190
v_mfma_f32_16x16x32_bf16 v[116:119], v[204:207], a[128:131], v[116:119]
v_mul_f32 v191, v159, v191
v_add_f32 v24, 1.0, v24
v_mfma_f32_16x16x32_bf16 v[120:123], v[204:207], a[200:203], v[120:123]
v_add_f32 v25, 1.0, v25
v_mfma_f32_16x16x32_bf16 v[124:127], v[204:207], v[240:243], v[124:127]
s_waitcnt lgkmcnt(6)
v_mfma_f32_16x16x32_bf16 v[64:67], v[208:211], a[60:63], v[64:67]
s_add_u32 s55, s31, 2048
v_rcp_f32 v24, v24
v_mfma_f32_16x16x32_bf16 v[68:71], v[208:211], a[132:135], v[68:71]
v_rcp_f32 v25, v25
v_mfma_f32_16x16x32_bf16 v[72:75], v[208:211], a[204:207], v[72:75]
ds_read_b64_tr_b16 v[192:193], v2 offset:16384
v_add_f32 v26, 1.0, v26
v_mfma_f32_16x16x32_bf16 v[76:79], v[208:211], v[244:247], v[76:79]
v_rcp_f32 v26, v26
s_waitcnt lgkmcnt(5)
v_mfma_f32_16x16x32_bf16 v[80:83], v[212:215], a[60:63], v[80:83]
ds_read_b64_tr_b16 v[194:195], v2 offset:16896
v_add_f32 v27, 1.0, v27
v_mfma_f32_16x16x32_bf16 v[84:87], v[212:215], a[132:135], v[84:87]
v_rcp_f32 v27, v27
v_mfma_f32_16x16x32_bf16 v[88:91], v[212:215], a[204:207], v[88:91]
ds_read_b64_tr_b16 v[196:197], v5 offset:16384
v_mul_f32 v188, v188, v24
v_mfma_f32_16x16x32_bf16 v[92:95], v[212:215], v[244:247], v[92:95]
ds_read_b64_tr_b16 v[198:199], v5 offset:16896
v_mul_f32 v189, v189, v25
s_waitcnt lgkmcnt(6)
v_mfma_f32_16x16x32_bf16 v[96:99], v[216:219], a[60:63], v[96:99]
ds_read_b64_tr_b16 v[200:201], v2 offset:20480
v_mul_f32 v190, v190, v26
v_mfma_f32_16x16x32_bf16 v[100:103], v[216:219], a[132:135], v[100:103]
ds_read_b64_tr_b16 v[202:203], v2 offset:20992
v_mul_f32 v191, v191, v27
v_mfma_f32_16x16x32_bf16 v[104:107], v[216:219], a[204:207], v[104:107]
ds_read_b64_tr_b16 v[204:205], v5 offset:20480
v_cvt_pk_bf16_f32 v34, v188, v189
v_mfma_f32_16x16x32_bf16 v[108:111], v[216:219], v[244:247], v[108:111]
ds_read_b64_tr_b16 v[206:207], v5 offset:20992
v_cvt_pk_bf16_f32 v35, v190, v191
s_waitcnt lgkmcnt(8)
v_mfma_f32_16x16x32_bf16 v[112:115], v[220:223], a[60:63], v[112:115]
v_mfma_f32_16x16x32_bf16 v[116:119], v[220:223], a[132:135], v[116:119]
v_mfma_f32_16x16x32_bf16 v[120:123], v[220:223], a[204:207], v[120:123]
v_mfma_f32_16x16x32_bf16 v[124:127], v[220:223], v[244:247], v[124:127]
s_waitcnt vmcnt(16)
s_barrier
s_waitcnt lgkmcnt(6)
v_mfma_f32_16x16x32_bf16 v[64:67], v[192:195], a[64:67], v[64:67]
buffer_store_dwordx4 v[32:35], v15, s[16:19], s55 offen sc1
v_mfma_f32_16x16x32_bf16 v[68:71], v[192:195], a[136:139], v[68:71]
s_add_u32 m0, s25, 49152
s_add_u32 s27, s20, 3539328
ds_read_b64_tr_b16 v[208:209], v2 offset:24576
v_mfma_f32_16x16x32_bf16 v[72:75], v[192:195], a[208:211], v[72:75]
buffer_load_dwordx4 v13, s[8:11], s27 offen lds
v_mfma_f32_16x16x32_bf16 v[76:79], v[192:195], v[248:251], v[76:79]
ds_read_b64_tr_b16 v[210:211], v2 offset:25088
s_waitcnt lgkmcnt(6)
v_mfma_f32_16x16x32_bf16 v[80:83], v[196:199], a[64:67], v[80:83]
ds_read_b64_tr_b16 v[212:213], v5 offset:24576
v_mfma_f32_16x16x32_bf16 v[84:87], v[196:199], a[136:139], v[84:87]
ds_read_b64_tr_b16 v[214:215], v5 offset:25088
v_mfma_f32_16x16x32_bf16 v[88:91], v[196:199], a[208:211], v[88:91]
buffer_load_dwordx4 v14, s[8:11], s27 offen offset:1024 lds
v_mfma_f32_16x16x32_bf16 v[92:95], v[196:199], v[248:251], v[92:95]
s_add_u32 m0, s25, 16384
ds_read_b64_tr_b16 v[216:217], v2 offset:28672
s_waitcnt lgkmcnt(7)
v_mfma_f32_16x16x32_bf16 v[96:99], v[200:203], a[64:67], v[96:99]
s_add_u32 s27, s20, 3834240
ds_read_b64_tr_b16 v[218:219], v2 offset:29184
v_mfma_f32_16x16x32_bf16 v[100:103], v[200:203], a[136:139], v[100:103]
ds_read_b64_tr_b16 v[220:221], v5 offset:28672
v_mfma_f32_16x16x32_bf16 v[104:107], v[200:203], a[208:211], v[104:107]
buffer_load_dwordx4 v13, s[8:11], s27 offen lds
v_mfma_f32_16x16x32_bf16 v[108:111], v[200:203], v[248:251], v[108:111]
ds_read_b64_tr_b16 v[222:223], v5 offset:29184
s_waitcnt lgkmcnt(8)
v_mfma_f32_16x16x32_bf16 v[112:115], v[204:207], a[64:67], v[112:115]
v_mfma_f32_16x16x32_bf16 v[116:119], v[204:207], a[136:139], v[116:119]
v_mfma_f32_16x16x32_bf16 v[120:123], v[204:207], a[208:211], v[120:123]
buffer_load_dwordx4 v14, s[8:11], s27 offen offset:1024 lds
v_mfma_f32_16x16x32_bf16 v[124:127], v[204:207], v[248:251], v[124:127]
s_waitcnt lgkmcnt(6)
v_mfma_f32_16x16x32_bf16 v[64:67], v[208:211], a[68:71], v[64:67]
s_add_u32 m0, s25, 57344
s_add_u32 s27, s20, 4129152
ds_read_b64_tr_b16 v[192:193], v2 offset:32768
v_mfma_f32_16x16x32_bf16 v[68:71], v[208:211], a[140:143], v[68:71]
ds_read_b64_tr_b16 v[194:195], v2 offset:33280
v_mfma_f32_16x16x32_bf16 v[72:75], v[208:211], a[212:215], v[72:75]
buffer_load_dwordx4 v13, s[8:11], s27 offen lds
v_mfma_f32_16x16x32_bf16 v[76:79], v[208:211], v[252:255], v[76:79]
ds_read_b64_tr_b16 v[196:197], v5 offset:32768
s_waitcnt lgkmcnt(7)
v_mfma_f32_16x16x32_bf16 v[80:83], v[212:215], a[68:71], v[80:83]
ds_read_b64_tr_b16 v[198:199], v5 offset:33280
v_mfma_f32_16x16x32_bf16 v[84:87], v[212:215], a[140:143], v[84:87]
ds_read_b64_tr_b16 v[200:201], v2 offset:36864
v_mfma_f32_16x16x32_bf16 v[88:91], v[212:215], a[212:215], v[88:91]
buffer_load_dwordx4 v14, s[8:11], s27 offen offset:1024 lds
v_mfma_f32_16x16x32_bf16 v[92:95], v[212:215], v[252:255], v[92:95]
ds_read_b64_tr_b16 v[202:203], v2 offset:37376
s_waitcnt lgkmcnt(8)
v_mfma_f32_16x16x32_bf16 v[96:99], v[216:219], a[68:71], v[96:99]
ds_read_b64_tr_b16 v[204:205], v5 offset:36864
v_mfma_f32_16x16x32_bf16 v[100:103], v[216:219], a[140:143], v[100:103]
ds_read_b64_tr_b16 v[206:207], v5 offset:37376
v_mfma_f32_16x16x32_bf16 v[104:107], v[216:219], a[212:215], v[104:107]
v_mfma_f32_16x16x32_bf16 v[108:111], v[216:219], v[252:255], v[108:111]
s_waitcnt lgkmcnt(8)
v_mfma_f32_16x16x32_bf16 v[112:115], v[220:223], a[68:71], v[112:115]
v_mfma_f32_16x16x32_bf16 v[116:119], v[220:223], a[140:143], v[116:119]
v_mfma_f32_16x16x32_bf16 v[120:123], v[220:223], a[212:215], v[120:123]
v_mfma_f32_16x16x32_bf16 v[124:127], v[220:223], v[252:255], v[124:127]
s_waitcnt lgkmcnt(6)
v_mfma_f32_16x16x32_bf16 v[128:131], v[192:195], a[0:3], 0
s_add_u32 m0, s25, 24576
s_add_u32 s27, s20, 4424064
ds_read_b64_tr_b16 v[208:209], v2 offset:40960
v_mfma_f32_16x16x32_bf16 v[132:135], v[192:195], a[72:75], 0
buffer_load_dwordx4 v13, s[8:11], s27 offen lds
v_mfma_f32_16x16x32_bf16 v[136:139], v[192:195], a[144:147], 0
ds_read_b64_tr_b16 v[210:211], v2 offset:41472
v_mfma_f32_16x16x32_bf16 v[140:143], v[192:195], a[216:219], 0
ds_read_b64_tr_b16 v[212:213], v5 offset:40960
s_waitcnt lgkmcnt(7)
v_mfma_f32_16x16x32_bf16 v[144:147], v[196:199], a[0:3], 0
ds_read_b64_tr_b16 v[214:215], v5 offset:41472
v_mfma_f32_16x16x32_bf16 v[148:151], v[196:199], a[72:75], 0
buffer_load_dwordx4 v14, s[8:11], s27 offen offset:1024 lds
v_mfma_f32_16x16x32_bf16 v[152:155], v[196:199], a[144:147], 0
s_add_u32 m0, s25, 65536
s_add_u32 s27, s20, 4718976
ds_read_b64_tr_b16 v[216:217], v2 offset:45056
v_mfma_f32_16x16x32_bf16 v[156:159], v[196:199], a[216:219], 0
ds_read_b64_tr_b16 v[218:219], v2 offset:45568
s_waitcnt lgkmcnt(8)
v_mfma_f32_16x16x32_bf16 v[160:163], v[200:203], a[0:3], 0
ds_read_b64_tr_b16 v[220:221], v5 offset:45056
v_mfma_f32_16x16x32_bf16 v[164:167], v[200:203], a[72:75], 0
buffer_load_dwordx4 v13, s[8:11], s27 offen lds
v_mfma_f32_16x16x32_bf16 v[168:171], v[200:203], a[144:147], 0
ds_read_b64_tr_b16 v[222:223], v5 offset:45568
v_mfma_f32_16x16x32_bf16 v[172:175], v[200:203], a[216:219], 0
s_waitcnt lgkmcnt(8)
v_mfma_f32_16x16x32_bf16 v[176:179], v[204:207], a[0:3], 0
v_mfma_f32_16x16x32_bf16 v[180:183], v[204:207], a[72:75], 0
buffer_load_dwordx4 v14, s[8:11], s27 offen offset:1024 lds
v_mfma_f32_16x16x32_bf16 v[184:187], v[204:207], a[144:147], 0
v_mfma_f32_16x16x32_bf16 v[188:191], v[204:207], a[216:219], 0
s_waitcnt lgkmcnt(6)
v_mfma_f32_16x16x32_bf16 v[128:131], v[208:211], a[4:7], v[128:131]
s_add_u32 m0, s25, 73728
s_add_u32 s27, s20, 5013888
ds_read_b64_tr_b16 v[192:193], v2 offset:49152
v_mfma_f32_16x16x32_bf16 v[132:135], v[208:211], a[76:79], v[132:135]
buffer_load_dwordx4 v13, s[8:11], s27 offen lds
v_mfma_f32_16x16x32_bf16 v[136:139], v[208:211], a[148:151], v[136:139]
ds_read_b64_tr_b16 v[194:195], v2 offset:49664
v_mul_f32 v20, s26, v64
v_mfma_f32_16x16x32_bf16 v[140:143], v[208:211], a[220:223], v[140:143]
v_exp_f32 v20, v20
s_waitcnt lgkmcnt(6)
v_mfma_f32_16x16x32_bf16 v[144:147], v[212:215], a[4:7], v[144:147]
ds_read_b64_tr_b16 v[196:197], v5 offset:49152
v_mul_f32 v21, s26, v65
v_mfma_f32_16x16x32_bf16 v[148:151], v[212:215], a[76:79], v[148:151]
buffer_load_dwordx4 v14, s[8:11], s27 offen offset:1024 lds
v_mfma_f32_16x16x32_bf16 v[152:155], v[212:215], a[148:151], v[152:155]
v_exp_f32 v21, v21
v_mfma_f32_16x16x32_bf16 v[156:159], v[212:215], a[220:223], v[156:159]
ds_read_b64_tr_b16 v[198:199], v5 offset:49664
v_mul_f32 v22, s26, v66
s_waitcnt lgkmcnt(6)
v_mfma_f32_16x16x32_bf16 v[160:163], v[216:219], a[4:7], v[160:163]
v_exp_f32 v22, v22
v_mfma_f32_16x16x32_bf16 v[164:167], v[216:219], a[76:79], v[164:167]
ds_read_b64_tr_b16 v[200:201], v2 offset:53248
v_mul_f32 v23, s26, v67
v_mfma_f32_16x16x32_bf16 v[168:171], v[216:219], a[148:151], v[168:171]
ds_read_b64_tr_b16 v[202:203], v2 offset:53760
v_mul_f32 v96, v64, v96
v_mfma_f32_16x16x32_bf16 v[172:175], v[216:219], a[220:223], v[172:175]
ds_read_b64_tr_b16 v[204:205], v5 offset:53248
v_mul_f32 v97, v65, v97
s_waitcnt lgkmcnt(7)
v_mfma_f32_16x16x32_bf16 v[176:179], v[220:223], a[4:7], v[176:179]
ds_read_b64_tr_b16 v[206:207], v5 offset:53760
v_mul_f32 v98, v66, v98
v_mfma_f32_16x16x32_bf16 v[180:183], v[220:223], a[76:79], v[180:183]
v_exp_f32 v23, v23
v_mfma_f32_16x16x32_bf16 v[184:187], v[220:223], a[148:151], v[184:187]
v_mul_f32 v99, v67, v99
v_add_f32 v20, 1.0, v20
v_mfma_f32_16x16x32_bf16 v[188:191], v[220:223], a[220:223], v[188:191]
v_rcp_f32 v20, v20
s_waitcnt lgkmcnt(6)
v_mfma_f32_16x16x32_bf16 v[128:131], v[192:195], a[8:11], v[128:131]
global_load_dword v19, v17, s[86:87]
v_mfma_f32_16x16x32_bf16 v[132:135], v[192:195], a[80:83], v[132:135]
ds_read_b64_tr_b16 v[208:209], v2 offset:57344
v_add_f32 v21, 1.0, v21
v_mfma_f32_16x16x32_bf16 v[136:139], v[192:195], a[152:155], v[136:139]
v_rcp_f32 v21, v21
v_mfma_f32_16x16x32_bf16 v[140:143], v[192:195], a[224:227], v[140:143]
ds_read_b64_tr_b16 v[210:211], v2 offset:57856
v_add_f32 v22, 1.0, v22
s_waitcnt lgkmcnt(6)
v_mfma_f32_16x16x32_bf16 v[144:147], v[196:199], a[8:11], v[144:147]
global_load_dword v55, v18, s[86:87]
v_mfma_f32_16x16x32_bf16 v[148:151], v[196:199], a[80:83], v[148:151]
v_rcp_f32 v22, v22
v_mfma_f32_16x16x32_bf16 v[152:155], v[196:199], a[152:155], v[152:155]
ds_read_b64_tr_b16 v[212:213], v5 offset:57344
v_add_f32 v23, 1.0, v23
v_mfma_f32_16x16x32_bf16 v[156:159], v[196:199], a[224:227], v[156:159]
v_rcp_f32 v23, v23
s_waitcnt lgkmcnt(5)
v_mfma_f32_16x16x32_bf16 v[160:163], v[200:203], a[8:11], v[160:163]
ds_read_b64_tr_b16 v[214:215], v5 offset:57856
v_mul_f32 v96, v96, v20
v_mfma_f32_16x16x32_bf16 v[164:167], v[200:203], a[80:83], v[164:167]
ds_read_b64_tr_b16 v[216:217], v2 offset:61440
v_mul_f32 v97, v97, v21
v_mfma_f32_16x16x32_bf16 v[168:171], v[200:203], a[152:155], v[168:171]
ds_read_b64_tr_b16 v[218:219], v2 offset:61952
v_mul_f32 v98, v98, v22
v_mfma_f32_16x16x32_bf16 v[172:175], v[200:203], a[224:227], v[172:175]
ds_read_b64_tr_b16 v[220:221], v5 offset:61440
v_mul_f32 v99, v99, v23
s_waitcnt lgkmcnt(7)
v_mfma_f32_16x16x32_bf16 v[176:179], v[204:207], a[8:11], v[176:179]
ds_read_b64_tr_b16 v[222:223], v5 offset:61952
v_cvt_pk_bf16_f32 v28, v96, v97
v_mfma_f32_16x16x32_bf16 v[180:183], v[204:207], a[80:83], v[180:183]
v_cvt_pk_bf16_f32 v29, v98, v99
v_mul_f32 v24, s26, v80
v_mfma_f32_16x16x32_bf16 v[184:187], v[204:207], a[152:155], v[184:187]
v_exp_f32 v24, v24
v_mfma_f32_16x16x32_bf16 v[188:191], v[204:207], a[224:227], v[188:191]
v_mul_f32 v25, s26, v81
v_mul_f32 v26, s26, v82
s_waitcnt lgkmcnt(6)
v_mfma_f32_16x16x32_bf16 v[128:131], v[208:211], a[12:15], v[128:131]
v_exp_f32 v25, v25
v_mfma_f32_16x16x32_bf16 v[132:135], v[208:211], a[84:87], v[132:135]
v_exp_f32 v26, v26
v_mfma_f32_16x16x32_bf16 v[136:139], v[208:211], a[156:159], v[136:139]
ds_read_b64_tr_b16 v[192:193], v3 offset:8192
v_mul_f32 v27, s26, v83
v_mfma_f32_16x16x32_bf16 v[140:143], v[208:211], a[228:231], v[140:143]
v_exp_f32 v27, v27
s_waitcnt lgkmcnt(5)
v_mfma_f32_16x16x32_bf16 v[144:147], v[212:215], a[12:15], v[144:147]
ds_read_b64_tr_b16 v[194:195], v3 offset:8704
v_mul_f32 v112, v80, v112
v_mfma_f32_16x16x32_bf16 v[148:151], v[212:215], a[84:87], v[148:151]
ds_read_b64_tr_b16 v[196:197], v6 offset:8192
v_mul_f32 v113, v81, v113
v_mfma_f32_16x16x32_bf16 v[152:155], v[212:215], a[156:159], v[152:155]
ds_read_b64_tr_b16 v[198:199], v6 offset:8704
v_mul_f32 v114, v82, v114
v_mfma_f32_16x16x32_bf16 v[156:159], v[212:215], a[228:231], v[156:159]
ds_read_b64_tr_b16 v[200:201], v3 offset:12288
v_mul_f32 v115, v83, v115
s_waitcnt lgkmcnt(7)
v_mfma_f32_16x16x32_bf16 v[160:163], v[216:219], a[12:15], v[160:163]
ds_read_b64_tr_b16 v[202:203], v3 offset:12800
v_add_f32 v24, 1.0, v24
v_mfma_f32_16x16x32_bf16 v[164:167], v[216:219], a[84:87], v[164:167]
v_rcp_f32 v24, v24
v_mfma_f32_16x16x32_bf16 v[168:171], v[216:219], a[156:159], v[168:171]
ds_read_b64_tr_b16 v[204:205], v6 offset:12288
v_add_f32 v25, 1.0, v25
v_mfma_f32_16x16x32_bf16 v[172:175], v[216:219], a[228:231], v[172:175]
v_rcp_f32 v25, v25
s_waitcnt lgkmcnt(7)
v_mfma_f32_16x16x32_bf16 v[176:179], v[220:223], a[12:15], v[176:179]
ds_read_b64_tr_b16 v[206:207], v6 offset:12800
v_add_f32 v26, 1.0, v26
v_mfma_f32_16x16x32_bf16 v[180:183], v[220:223], a[84:87], v[180:183]
v_rcp_f32 v26, v26
v_mfma_f32_16x16x32_bf16 v[184:187], v[220:223], a[156:159], v[184:187]
v_add_f32 v27, 1.0, v27
v_mul_f32 v112, v112, v24
v_mfma_f32_16x16x32_bf16 v[188:191], v[220:223], a[228:231], v[188:191]
s_waitcnt vmcnt(17)
s_barrier
s_waitcnt lgkmcnt(6)
v_mfma_f32_16x16x32_bf16 v[128:131], v[192:195], a[16:19], v[128:131]
s_add_u32 m0, s25, 81920
s_add_u32 s27, s21, 0
s_add_u32 s55, s28, 4096
v_mfma_f32_16x16x32_bf16 v[132:135], v[192:195], a[88:91], v[132:135]
buffer_load_dwordx4 v13, s[8:11], s27 offen lds
v_mfma_f32_16x16x32_bf16 v[136:139], v[192:195], a[160:163], v[136:139]
ds_read_b64_tr_b16 v[208:209], v3 offset:0
v_mul_f32 v113, v113, v25
v_mfma_f32_16x16x32_bf16 v[140:143], v[192:195], a[232:235], v[140:143]
ds_read_b64_tr_b16 v[210:211], v3 offset:512
v_mul_f32 v114, v114, v26
s_waitcnt lgkmcnt(6)
v_mfma_f32_16x16x32_bf16 v[144:147], v[196:199], a[16:19], v[144:147]
ds_read_b64_tr_b16 v[212:213], v6 offset:0
v_cvt_pk_bf16_f32 v30, v112, v113
v_mfma_f32_16x16x32_bf16 v[148:151], v[196:199], a[88:91], v[148:151]
buffer_load_dwordx4 v14, s[8:11], s27 offen offset:1024 lds
v_mfma_f32_16x16x32_bf16 v[152:155], v[196:199], a[160:163], v[152:155]
s_add_u32 m0, s25, 90112
s_add_u32 s27, s21, 294912
ds_read_b64_tr_b16 v[214:215], v6 offset:512
v_mfma_f32_16x16x32_bf16 v[156:159], v[196:199], a[232:235], v[156:159]
ds_read_b64_tr_b16 v[216:217], v3 offset:4096
v_mul_f32 v20, s26, v68
s_waitcnt lgkmcnt(7)
v_mfma_f32_16x16x32_bf16 v[160:163], v[200:203], a[16:19], v[160:163]
ds_read_b64_tr_b16 v[218:219], v3 offset:4608
v_mul_f32 v21, s26, v69
v_mfma_f32_16x16x32_bf16 v[164:167], v[200:203], a[88:91], v[164:167]
buffer_load_dwordx4 v13, s[8:11], s27 offen lds
v_mfma_f32_16x16x32_bf16 v[168:171], v[200:203], a[160:163], v[168:171]
ds_read_b64_tr_b16 v[220:221], v6 offset:4096
v_mul_f32 v22, s26, v70
v_mfma_f32_16x16x32_bf16 v[172:175], v[200:203], a[232:235], v[172:175]
ds_read_b64_tr_b16 v[222:223], v6 offset:4608
v_mul_f32 v23, s26, v71
s_waitcnt lgkmcnt(8)
v_mfma_f32_16x16x32_bf16 v[176:179], v[204:207], a[16:19], v[176:179]
v_rcp_f32 v27, v27
v_mfma_f32_16x16x32_bf16 v[180:183], v[204:207], a[88:91], v[180:183]
buffer_load_dwordx4 v14, s[8:11], s27 offen offset:1024 lds
v_mfma_f32_16x16x32_bf16 v[184:187], v[204:207], a[160:163], v[184:187]
v_exp_f32 v20, v20
v_mfma_f32_16x16x32_bf16 v[188:191], v[204:207], a[232:235], v[188:191]
v_exp_f32 v21, v21
s_waitcnt lgkmcnt(6)
v_mfma_f32_16x16x32_bf16 v[128:131], v[208:211], a[20:23], v[128:131]
s_add_u32 m0, s25, 98304
s_add_u32 s27, s21, 589824
ds_read_b64_tr_b16 v[192:193], v3 offset:24576
v_mfma_f32_16x16x32_bf16 v[132:135], v[208:211], a[92:95], v[132:135]
buffer_load_dwordx4 v13, s[8:11], s27 offen lds
v_mfma_f32_16x16x32_bf16 v[136:139], v[208:211], a[164:167], v[136:139]
v_exp_f32 v22, v22
v_mfma_f32_16x16x32_bf16 v[140:143], v[208:211], a[236:239], v[140:143]
v_exp_f32 v23, v23
s_waitcnt lgkmcnt(5)
v_mfma_f32_16x16x32_bf16 v[144:147], v[212:215], a[20:23], v[144:147]
ds_read_b64_tr_b16 v[194:195], v3 offset:25088
v_mul_f32 v115, v115, v27
v_mfma_f32_16x16x32_bf16 v[148:151], v[212:215], a[92:95], v[148:151]
buffer_load_dwordx4 v14, s[8:11], s27 offen offset:1024 lds
v_mfma_f32_16x16x32_bf16 v[152:155], v[212:215], a[164:167], v[152:155]
ds_read_b64_tr_b16 v[196:197], v6 offset:24576
v_cvt_pk_bf16_f32 v31, v114, v115
v_mfma_f32_16x16x32_bf16 v[156:159], v[212:215], a[236:239], v[156:159]
ds_read_b64_tr_b16 v[198:199], v6 offset:25088
v_mul_f32 v100, v68, v100
s_waitcnt lgkmcnt(6)
v_mfma_f32_16x16x32_bf16 v[160:163], v[216:219], a[20:23], v[160:163]
buffer_store_dwordx4 v[28:31], v15, s[16:19], s55 offen sc1
v_mfma_f32_16x16x32_bf16 v[164:167], v[216:219], a[92:95], v[164:167]
ds_read_b64_tr_b16 v[200:201], v3 offset:28672
v_mul_f32 v101, v69, v101
v_mfma_f32_16x16x32_bf16 v[168:171], v[216:219], a[164:167], v[168:171]
ds_read_b64_tr_b16 v[202:203], v3 offset:29184
v_mul_f32 v102, v70, v102
v_mfma_f32_16x16x32_bf16 v[172:175], v[216:219], a[236:239], v[172:175]
ds_read_b64_tr_b16 v[204:205], v6 offset:28672
v_mul_f32 v103, v71, v103
s_waitcnt lgkmcnt(7)
v_mfma_f32_16x16x32_bf16 v[176:179], v[220:223], a[20:23], v[176:179]
ds_read_b64_tr_b16 v[206:207], v6 offset:29184
v_add_f32 v20, 1.0, v20
v_mfma_f32_16x16x32_bf16 v[180:183], v[220:223], a[92:95], v[180:183]
v_rcp_f32 v20, v20
v_mfma_f32_16x16x32_bf16 v[184:187], v[220:223], a[164:167], v[184:187]
v_add_f32 v21, 1.0, v21
v_add_f32 v22, 1.0, v22
v_mfma_f32_16x16x32_bf16 v[188:191], v[220:223], a[236:239], v[188:191]
v_rcp_f32 v21, v21
s_waitcnt lgkmcnt(6)
v_mfma_f32_16x16x32_bf16 v[128:131], v[192:195], a[24:27], v[128:131]
s_add_u32 m0, s25, 106496
s_add_u32 s27, s21, 884736
ds_read_b64_tr_b16 v[208:209], v3 offset:16384
v_mfma_f32_16x16x32_bf16 v[132:135], v[192:195], a[96:99], v[132:135]
buffer_load_dwordx4 v13, s[8:11], s27 offen lds
v_mfma_f32_16x16x32_bf16 v[136:139], v[192:195], a[168:171], v[136:139]
v_rcp_f32 v22, v22
v_mfma_f32_16x16x32_bf16 v[140:143], v[192:195], a[240:243], v[140:143]
ds_read_b64_tr_b16 v[210:211], v3 offset:16896
v_add_f32 v23, 1.0, v23
s_waitcnt lgkmcnt(6)
v_mfma_f32_16x16x32_bf16 v[144:147], v[196:199], a[24:27], v[144:147]
ds_read_b64_tr_b16 v[212:213], v6 offset:16384
v_mul_f32 v100, v100, v20
v_mfma_f32_16x16x32_bf16 v[148:151], v[196:199], a[96:99], v[148:151]
buffer_load_dwordx4 v14, s[8:11], s27 offen offset:1024 lds
v_mfma_f32_16x16x32_bf16 v[152:155], v[196:199], a[168:171], v[152:155]
s_add_u32 m0, s25, 114688
s_add_u32 s27, s21, 1179648
ds_read_b64_tr_b16 v[214:215], v6 offset:16896
v_mfma_f32_16x16x32_bf16 v[156:159], v[196:199], a[240:243], v[156:159]
ds_read_b64_tr_b16 v[216:217], v3 offset:20480
v_mul_f32 v101, v101, v21
s_waitcnt lgkmcnt(7)
v_mfma_f32_16x16x32_bf16 v[160:163], v[200:203], a[24:27], v[160:163]
ds_read_b64_tr_b16 v[218:219], v3 offset:20992
v_mul_f32 v102, v102, v22
v_mfma_f32_16x16x32_bf16 v[164:167], v[200:203], a[96:99], v[164:167]
buffer_load_dwordx4 v13, s[8:11], s27 offen lds
v_mfma_f32_16x16x32_bf16 v[168:171], v[200:203], a[168:171], v[168:171]
ds_read_b64_tr_b16 v[220:221], v6 offset:20480
v_cvt_pk_bf16_f32 v32, v100, v101
v_mfma_f32_16x16x32_bf16 v[172:175], v[200:203], a[240:243], v[172:175]
ds_read_b64_tr_b16 v[222:223], v6 offset:20992
v_mul_f32 v24, s26, v84
s_waitcnt lgkmcnt(8)
v_mfma_f32_16x16x32_bf16 v[176:179], v[204:207], a[24:27], v[176:179]
v_rcp_f32 v23, v23
v_mfma_f32_16x16x32_bf16 v[180:183], v[204:207], a[96:99], v[180:183]
buffer_load_dwordx4 v14, s[8:11], s27 offen offset:1024 lds
v_mfma_f32_16x16x32_bf16 v[184:187], v[204:207], a[168:171], v[184:187]
v_exp_f32 v24, v24
v_mfma_f32_16x16x32_bf16 v[188:191], v[204:207], a[240:243], v[188:191]
v_mul_f32 v103, v103, v23
v_cvt_pk_bf16_f32 v33, v102, v103
s_waitcnt lgkmcnt(6)
v_mfma_f32_16x16x32_bf16 v[128:131], v[208:211], a[28:31], v[128:131]
s_add_u32 m0, s25, 122880
s_add_u32 s27, s21, 1474560
ds_read_b64_tr_b16 v[192:193], v1 offset:32768
v_mfma_f32_16x16x32_bf16 v[132:135], v[208:211], a[100:103], v[132:135]
buffer_load_dwordx4 v13, s[8:11], s27 offen lds
v_mfma_f32_16x16x32_bf16 v[136:139], v[208:211], a[172:175], v[136:139]
ds_read_b64_tr_b16 v[194:195], v1 offset:33280
v_mul_f32 v25, s26, v85
v_mfma_f32_16x16x32_bf16 v[140:143], v[208:211], a[244:247], v[140:143]
v_exp_f32 v25, v25
s_waitcnt lgkmcnt(6)
v_mfma_f32_16x16x32_bf16 v[144:147], v[212:215], a[28:31], v[144:147]
ds_read_b64_tr_b16 v[196:197], v4 offset:32768
v_mul_f32 v26, s26, v86
v_mfma_f32_16x16x32_bf16 v[148:151], v[212:215], a[100:103], v[148:151]
buffer_load_dwordx4 v14, s[8:11], s27 offen offset:1024 lds
v_mfma_f32_16x16x32_bf16 v[152:155], v[212:215], a[172:175], v[152:155]
v_exp_f32 v26, v26
v_mfma_f32_16x16x32_bf16 v[156:159], v[212:215], a[244:247], v[156:159]
ds_read_b64_tr_b16 v[198:199], v4 offset:33280
v_mul_f32 v27, s26, v87
s_waitcnt lgkmcnt(6)
v_mfma_f32_16x16x32_bf16 v[160:163], v[216:219], a[28:31], v[160:163]
v_exp_f32 v27, v27
v_mfma_f32_16x16x32_bf16 v[164:167], v[216:219], a[100:103], v[164:167]
ds_read_b64_tr_b16 v[200:201], v1 offset:36864
v_mul_f32 v116, v84, v116
v_mfma_f32_16x16x32_bf16 v[168:171], v[216:219], a[172:175], v[168:171]
ds_read_b64_tr_b16 v[202:203], v1 offset:37376
v_mul_f32 v117, v85, v117
v_mfma_f32_16x16x32_bf16 v[172:175], v[216:219], a[244:247], v[172:175]
ds_read_b64_tr_b16 v[204:205], v4 offset:36864
v_mul_f32 v118, v86, v118
s_waitcnt lgkmcnt(7)
v_mfma_f32_16x16x32_bf16 v[176:179], v[220:223], a[28:31], v[176:179]
ds_read_b64_tr_b16 v[206:207], v4 offset:37376
v_mul_f32 v119, v87, v119
v_mfma_f32_16x16x32_bf16 v[180:183], v[220:223], a[100:103], v[180:183]
v_add_f32 v24, 1.0, v24
v_add_f32 v25, 1.0, v25
v_mfma_f32_16x16x32_bf16 v[184:187], v[220:223], a[172:175], v[184:187]
v_rcp_f32 v24, v24
v_mfma_f32_16x16x32_bf16 v[188:191], v[220:223], a[244:247], v[188:191]
v_rcp_f32 v25, v25
s_waitcnt lgkmcnt(6)
v_mfma_f32_16x16x32_bf16 v[128:131], v[192:195], a[32:35], v[128:131]
s_add_u32 s55, s29, 4096
ds_read_b64_tr_b16 v[208:209], v1 offset:0
v_add_f32 v26, 1.0, v26
v_mfma_f32_16x16x32_bf16 v[132:135], v[192:195], a[104:107], v[132:135]
v_rcp_f32 v26, v26
v_mfma_f32_16x16x32_bf16 v[136:139], v[192:195], a[176:179], v[136:139]
ds_read_b64_tr_b16 v[210:211], v1 offset:512
v_add_f32 v27, 1.0, v27
v_mfma_f32_16x16x32_bf16 v[140:143], v[192:195], a[248:251], v[140:143]
v_rcp_f32 v27, v27
s_waitcnt lgkmcnt(6)
v_mfma_f32_16x16x32_bf16 v[144:147], v[196:199], a[32:35], v[144:147]
ds_read_b64_tr_b16 v[212:213], v4 offset:0
v_mul_f32 v116, v116, v24
v_mfma_f32_16x16x32_bf16 v[148:151], v[196:199], a[104:107], v[148:151]
ds_read_b64_tr_b16 v[214:215], v4 offset:512
v_mul_f32 v117, v117, v25
v_mfma_f32_16x16x32_bf16 v[152:155], v[196:199], a[176:179], v[152:155]
ds_read_b64_tr_b16 v[216:217], v1 offset:4096
v_mul_f32 v118, v118, v26
v_mfma_f32_16x16x32_bf16 v[156:159], v[196:199], a[248:251], v[156:159]
ds_read_b64_tr_b16 v[218:219], v1 offset:4608
v_mul_f32 v119, v119, v27
s_waitcnt lgkmcnt(8)
v_mfma_f32_16x16x32_bf16 v[160:163], v[200:203], a[32:35], v[160:163]
ds_read_b64_tr_b16 v[220:221], v4 offset:4096
v_cvt_pk_bf16_f32 v34, v116, v117
v_mfma_f32_16x16x32_bf16 v[164:167], v[200:203], a[104:107], v[164:167]
ds_read_b64_tr_b16 v[222:223], v4 offset:4608
v_cvt_pk_bf16_f32 v35, v118, v119
v_mfma_f32_16x16x32_bf16 v[168:171], v[200:203], a[176:179], v[168:171]
buffer_store_dwordx4 v[32:35], v15, s[16:19], s55 offen sc1
v_mfma_f32_16x16x32_bf16 v[172:175], v[200:203], a[248:251], v[172:175]
v_mul_f32 v20, s26, v72
v_mul_f32 v21, s26, v73
s_waitcnt lgkmcnt(8)
v_mfma_f32_16x16x32_bf16 v[176:179], v[204:207], a[32:35], v[176:179]
v_exp_f32 v20, v20
v_mfma_f32_16x16x32_bf16 v[180:183], v[204:207], a[104:107], v[180:183]
v_exp_f32 v21, v21
v_mfma_f32_16x16x32_bf16 v[184:187], v[204:207], a[176:179], v[184:187]
v_mul_f32 v22, s26, v74
v_mul_f32 v23, s26, v75
v_mfma_f32_16x16x32_bf16 v[188:191], v[204:207], a[248:251], v[188:191]
v_exp_f32 v22, v22
s_waitcnt lgkmcnt(6)
v_mfma_f32_16x16x32_bf16 v[128:131], v[208:211], a[36:39], v[128:131]
v_exp_f32 v23, v23
v_mfma_f32_16x16x32_bf16 v[132:135], v[208:211], a[108:111], v[132:135]
ds_read_b64_tr_b16 v[192:193], v1 offset:40960
v_mul_f32 v104, v72, v104
v_mfma_f32_16x16x32_bf16 v[136:139], v[208:211], a[180:183], v[136:139]
ds_read_b64_tr_b16 v[194:195], v1 offset:41472
v_mul_f32 v105, v73, v105
v_mfma_f32_16x16x32_bf16 v[140:143], v[208:211], a[252:255], v[140:143]
ds_read_b64_tr_b16 v[196:197], v4 offset:40960
v_mul_f32 v106, v74, v106
s_waitcnt lgkmcnt(7)
v_mfma_f32_16x16x32_bf16 v[144:147], v[212:215], a[36:39], v[144:147]
ds_read_b64_tr_b16 v[198:199], v4 offset:41472
v_mul_f32 v107, v75, v107
v_mfma_f32_16x16x32_bf16 v[148:151], v[212:215], a[108:111], v[148:151]
ds_read_b64_tr_b16 v[200:201], v1 offset:45056
v_add_f32 v20, 1.0, v20
v_mfma_f32_16x16x32_bf16 v[152:155], v[212:215], a[180:183], v[152:155]
v_rcp_f32 v20, v20
v_mfma_f32_16x16x32_bf16 v[156:159], v[212:215], a[252:255], v[156:159]
ds_read_b64_tr_b16 v[202:203], v1 offset:45568
v_add_f32 v21, 1.0, v21
s_waitcnt lgkmcnt(8)
v_mfma_f32_16x16x32_bf16 v[160:163], v[216:219], a[36:39], v[160:163]
v_rcp_f32 v21, v21
v_mfma_f32_16x16x32_bf16 v[164:167], v[216:219], a[108:111], v[164:167]
ds_read_b64_tr_b16 v[204:205], v4 offset:45056
v_add_f32 v22, 1.0, v22
v_mfma_f32_16x16x32_bf16 v[168:171], v[216:219], a[180:183], v[168:171]
v_rcp_f32 v22, v22
v_mfma_f32_16x16x32_bf16 v[172:175], v[216:219], a[252:255], v[172:175]
ds_read_b64_tr_b16 v[206:207], v4 offset:45568
v_add_f32 v23, 1.0, v23
s_waitcnt lgkmcnt(8)
v_mfma_f32_16x16x32_bf16 v[176:179], v[220:223], a[36:39], v[176:179]
v_rcp_f32 v23, v23
v_mfma_f32_16x16x32_bf16 v[180:183], v[220:223], a[108:111], v[180:183]
v_mul_f32 v104, v104, v20
v_mul_f32 v105, v105, v21
v_mfma_f32_16x16x32_bf16 v[184:187], v[220:223], a[180:183], v[184:187]
v_mul_f32 v106, v106, v22
v_mul_f32 v107, v107, v23
v_mfma_f32_16x16x32_bf16 v[188:191], v[220:223], a[252:255], v[188:191]
s_waitcnt vmcnt(18)
s_barrier
s_cmp_lg_u32 s98, 0
s_cbranch_scc1 SIG_6
s_lshl_b32 s56, s2, 7
s_add_u32 s56, s56, 40894484
v_mov_b32 v60, s56
v_mov_b32 v61, s100
s_mov_b64 exec, 1
global_store_dword v60, v61, s[6:7] sc1
s_mov_b64 exec, -1
SIG_6:
s_waitcnt lgkmcnt(6)
v_mfma_f32_16x16x32_bf16 v[128:131], v[192:195], a[40:43], v[128:131]
s_add_u32 m0, s25, 139264
s_add_u32 s27, s21, 1769472
ds_read_b64_tr_b16 v[208:209], v1 offset:8192
v_mfma_f32_16x16x32_bf16 v[132:135], v[192:195], a[112:115], v[132:135]
buffer_load_dwordx4 v13, s[8:11], s27 offen lds
v_mfma_f32_16x16x32_bf16 v[136:139], v[192:195], a[184:187], v[136:139]
ds_read_b64_tr_b16 v[210:211], v1 offset:8704
v_cvt_pk_bf16_f32 v28, v104, v105
v_mfma_f32_16x16x32_bf16 v[140:143], v[192:195], v[224:227], v[140:143]
ds_read_b64_tr_b16 v[212:213], v4 offset:8192
v_cvt_pk_bf16_f32 v29, v106, v107
s_waitcnt lgkmcnt(7)
v_mfma_f32_16x16x32_bf16 v[144:147], v[196:199], a[40:43], v[144:147]
ds_read_b64_tr_b16 v[214:215], v4 offset:8704
v_mul_f32 v24, s26, v88
v_mfma_f32_16x16x32_bf16 v[148:151], v[196:199], a[112:115], v[148:151]
buffer_load_dwordx4 v14, s[8:11], s27 offen offset:1024 lds
v_mfma_f32_16x16x32_bf16 v[152:155], v[196:199], a[184:187], v[152:155]
s_add_u32 m0, s25, 131072
s_add_u32 s27, s21, 2064384
ds_read_b64_tr_b16 v[216:217], v1 offset:12288
v_mfma_f32_16x16x32_bf16 v[156:159], v[196:199], v[224:227], v[156:159]
v_exp_f32 v24, v24
s_waitcnt lgkmcnt(7)
v_mfma_f32_16x16x32_bf16 v[160:163], v[200:203], a[40:43], v[160:163]
ds_read_b64_tr_b16 v[218:219], v1 offset:12800
v_mul_f32 v25, s26, v89
v_mfma_f32_16x16x32_bf16 v[164:167], v[200:203], a[112:115], v[164:167]
buffer_load_dwordx4 v13, s[8:11], s27 offen lds
v_mfma_f32_16x16x32_bf16 v[168:171], v[200:203], a[184:187], v[168:171]
ds_read_b64_tr_b16 v[220:221], v4 offset:12288
v_mul_f32 v26, s26, v90
v_mfma_f32_16x16x32_bf16 v[172:175], v[200:203], v[224:227], v[172:175]
ds_read_b64_tr_b16 v[222:223], v4 offset:12800
v_mul_f32 v27, s26, v91
s_waitcnt lgkmcnt(8)
v_mfma_f32_16x16x32_bf16 v[176:179], v[204:207], a[40:43], v[176:179]
v_exp_f32 v25, v25
v_mfma_f32_16x16x32_bf16 v[180:183], v[204:207], a[112:115], v[180:183]
buffer_load_dwordx4 v14, s[8:11], s27 offen offset:1024 lds
v_mfma_f32_16x16x32_bf16 v[184:187], v[204:207], a[184:187], v[184:187]
v_exp_f32 v26, v26
v_mfma_f32_16x16x32_bf16 v[188:191], v[204:207], v[224:227], v[188:191]
v_exp_f32 v27, v27
s_waitcnt lgkmcnt(6)
v_mfma_f32_16x16x32_bf16 v[128:131], v[208:211], a[44:47], v[128:131]
s_add_u32 m0, s25, 155648
s_add_u32 s27, s21, 2359296
s_add_u32 s55, s30, 4096
v_mfma_f32_16x16x32_bf16 v[132:135], v[208:211], a[116:119], v[132:135]
buffer_load_dwordx4 v13, s[8:11], s27 offen lds
v_mfma_f32_16x16x32_bf16 v[136:139], v[208:211], a[188:191], v[136:139]
ds_read_b64_tr_b16 v[192:193], v1 offset:49152
v_mul_f32 v120, v88, v120
v_mfma_f32_16x16x32_bf16 v[140:143], v[208:211], v[228:231], v[140:143]
ds_read_b64_tr_b16 v[194:195], v1 offset:49664
v_mul_f32 v121, v89, v121
s_waitcnt lgkmcnt(6)
v_mfma_f32_16x16x32_bf16 v[144:147], v[212:215], a[44:47], v[144:147]
ds_read_b64_tr_b16 v[196:197], v4 offset:49152
v_mul_f32 v122, v90, v122
v_mfma_f32_16x16x32_bf16 v[148:151], v[212:215], a[116:119], v[148:151]
buffer_load_dwordx4 v14, s[8:11], s27 offen offset:1024 lds
v_mfma_f32_16x16x32_bf16 v[152:155], v[212:215], a[188:191], v[152:155]
ds_read_b64_tr_b16 v[198:199], v4 offset:49664
v_mul_f32 v123, v91, v123
v_mfma_f32_16x16x32_bf16 v[156:159], v[212:215], v[228:231], v[156:159]
ds_read_b64_tr_b16 v[200:201], v1 offset:53248
v_add_f32 v24, 1.0, v24
s_waitcnt lgkmcnt(7)
v_mfma_f32_16x16x32_bf16 v[160:163], v[216:219], a[44:47], v[160:163]
v_rcp_f32 v24, v24
v_mfma_f32_16x16x32_bf16 v[164:167], v[216:219], a[116:119], v[164:167]
ds_read_b64_tr_b16 v[202:203], v1 offset:53760
v_add_f32 v25, 1.0, v25
v_mfma_f32_16x16x32_bf16 v[168:171], v[216:219], a[188:191], v[168:171]
v_rcp_f32 v25, v25
v_mfma_f32_16x16x32_bf16 v[172:175], v[216:219], v[228:231], v[172:175]
ds_read_b64_tr_b16 v[204:205], v4 offset:53248
v_add_f32 v26, 1.0, v26
s_waitcnt lgkmcnt(7)
v_mfma_f32_16x16x32_bf16 v[176:179], v[220:223], a[44:47], v[176:179]
ds_read_b64_tr_b16 v[206:207], v4 offset:53760
v_add_f32 v27, 1.0, v27
v_mfma_f32_16x16x32_bf16 v[180:183], v[220:223], a[116:119], v[180:183]
v_rcp_f32 v26, v26
v_mfma_f32_16x16x32_bf16 v[184:187], v[220:223], a[188:191], v[184:187]
v_rcp_f32 v27, v27
v_mfma_f32_16x16x32_bf16 v[188:191], v[220:223], v[228:231], v[188:191]
v_mul_f32 v120, v120, v24
v_mul_f32 v121, v121, v25
s_waitcnt lgkmcnt(6)
v_mfma_f32_16x16x32_bf16 v[128:131], v[192:195], a[48:51], v[128:131]
s_add_u32 m0, s25, 147456
s_add_u32 s27, s21, 2654208
ds_read_b64_tr_b16 v[208:209], v1 offset:16384
v_mfma_f32_16x16x32_bf16 v[132:135], v[192:195], a[120:123], v[132:135]
buffer_load_dwordx4 v13, s[8:11], s27 offen lds
v_mfma_f32_16x16x32_bf16 v[136:139], v[192:195], a[192:195], v[136:139]
ds_read_b64_tr_b16 v[210:211], v1 offset:16896
v_mul_f32 v122, v122, v26
v_mfma_f32_16x16x32_bf16 v[140:143], v[192:195], v[232:235], v[140:143]
ds_read_b64_tr_b16 v[212:213], v4 offset:16384
v_mul_f32 v123, v123, v27
s_waitcnt lgkmcnt(7)
v_mfma_f32_16x16x32_bf16 v[144:147], v[196:199], a[48:51], v[144:147]
ds_read_b64_tr_b16 v[214:215], v4 offset:16896
v_cvt_pk_bf16_f32 v30, v120, v121
v_mfma_f32_16x16x32_bf16 v[148:151], v[196:199], a[120:123], v[148:151]
buffer_load_dwordx4 v14, s[8:11], s27 offen offset:1024 lds
v_mfma_f32_16x16x32_bf16 v[152:155], v[196:199], a[192:195], v[152:155]
s_add_u32 m0, s25, 32768
s_add_u32 s27, s21, 2949120
ds_read_b64_tr_b16 v[216:217], v1 offset:20480
v_mfma_f32_16x16x32_bf16 v[156:159], v[196:199], v[232:235], v[156:159]
ds_read_b64_tr_b16 v[218:219], v1 offset:20992
v_cvt_pk_bf16_f32 v31, v122, v123
s_waitcnt lgkmcnt(8)
v_mfma_f32_16x16x32_bf16 v[160:163], v[200:203], a[48:51], v[160:163]
buffer_store_dwordx4 v[28:31], v15, s[16:19], s55 offen sc1
v_mfma_f32_16x16x32_bf16 v[164:167], v[200:203], a[120:123], v[164:167]
buffer_load_dwordx4 v13, s[8:11], s27 offen lds
v_mfma_f32_16x16x32_bf16 v[168:171], v[200:203], a[192:195], v[168:171]
ds_read_b64_tr_b16 v[220:221], v4 offset:20480
v_mul_f32 v20, s26, v76
v_mfma_f32_16x16x32_bf16 v[172:175], v[200:203], v[232:235], v[172:175]
ds_read_b64_tr_b16 v[222:223], v4 offset:20992
v_mul_f32 v21, s26, v77
s_waitcnt lgkmcnt(8)
v_mfma_f32_16x16x32_bf16 v[176:179], v[204:207], a[48:51], v[176:179]
v_exp_f32 v20, v20
v_mfma_f32_16x16x32_bf16 v[180:183], v[204:207], a[120:123], v[180:183]
buffer_load_dwordx4 v14, s[8:11], s27 offen offset:1024 lds
v_mfma_f32_16x16x32_bf16 v[184:187], v[204:207], a[192:195], v[184:187]
v_exp_f32 v21, v21
v_mfma_f32_16x16x32_bf16 v[188:191], v[204:207], v[232:235], v[188:191]
v_mul_f32 v22, s26, v78
v_mul_f32 v23, s26, v79
s_waitcnt lgkmcnt(6)
v_mfma_f32_16x16x32_bf16 v[128:131], v[208:211], a[52:55], v[128:131]
s_add_u32 m0, s25, 0
s_add_u32 s27, s21, 3244032
ds_read_b64_tr_b16 v[192:193], v1 offset:57344
v_mfma_f32_16x16x32_bf16 v[132:135], v[208:211], a[124:127], v[132:135]
buffer_load_dwordx4 v13, s[8:11], s27 offen lds
v_mfma_f32_16x16x32_bf16 v[136:139], v[208:211], a[196:199], v[136:139]
v_exp_f32 v22, v22
v_mfma_f32_16x16x32_bf16 v[140:143], v[208:211], v[236:239], v[140:143]
v_exp_f32 v23, v23
s_waitcnt lgkmcnt(5)
v_mfma_f32_16x16x32_bf16 v[144:147], v[212:215], a[52:55], v[144:147]
ds_read_b64_tr_b16 v[194:195], v1 offset:57856
v_mul_f32 v108, v76, v108
v_mfma_f32_16x16x32_bf16 v[148:151], v[212:215], a[124:127], v[148:151]
buffer_load_dwordx4 v14, s[8:11], s27 offen offset:1024 lds
v_mfma_f32_16x16x32_bf16 v[152:155], v[212:215], a[196:199], v[152:155]
ds_read_b64_tr_b16 v[196:197], v4 offset:57344
v_mul_f32 v109, v77, v109
v_mfma_f32_16x16x32_bf16 v[156:159], v[212:215], v[236:239], v[156:159]
ds_read_b64_tr_b16 v[198:199], v4 offset:57856
v_mul_f32 v110, v78, v110
s_waitcnt lgkmcnt(6)
v_mfma_f32_16x16x32_bf16 v[160:163], v[216:219], a[52:55], v[160:163]
ds_read_b64_tr_b16 v[200:201], v1 offset:61440
v_mul_f32 v111, v79, v111
v_mfma_f32_16x16x32_bf16 v[164:167], v[216:219], a[124:127], v[164:167]
ds_read_b64_tr_b16 v[202:203], v1 offset:61952
v_add_f32 v20, 1.0, v20
v_mfma_f32_16x16x32_bf16 v[168:171], v[216:219], a[196:199], v[168:171]
v_rcp_f32 v20, v20
v_mfma_f32_16x16x32_bf16 v[172:175], v[216:219], v[236:239], v[172:175]
ds_read_b64_tr_b16 v[204:205], v4 offset:61440
v_add_f32 v21, 1.0, v21
s_waitcnt lgkmcnt(7)
v_mfma_f32_16x16x32_bf16 v[176:179], v[220:223], a[52:55], v[176:179]
ds_read_b64_tr_b16 v[206:207], v4 offset:61952
v_add_f32 v22, 1.0, v22
v_mfma_f32_16x16x32_bf16 v[180:183], v[220:223], a[124:127], v[180:183]
v_rcp_f32 v21, v21
v_mfma_f32_16x16x32_bf16 v[184:187], v[220:223], a[196:199], v[184:187]
v_rcp_f32 v22, v22
v_mfma_f32_16x16x32_bf16 v[188:191], v[220:223], v[236:239], v[188:191]
v_add_f32 v23, 1.0, v23
v_mul_f32 v108, v108, v20
s_waitcnt lgkmcnt(6)
v_mfma_f32_16x16x32_bf16 v[128:131], v[192:195], a[56:59], v[128:131]
v_rcp_f32 v23, v23
v_mfma_f32_16x16x32_bf16 v[132:135], v[192:195], a[128:131], v[132:135]
ds_read_b64_tr_b16 v[208:209], v1 offset:24576
v_mul_f32 v109, v109, v21
v_mfma_f32_16x16x32_bf16 v[136:139], v[192:195], a[200:203], v[136:139]
ds_read_b64_tr_b16 v[210:211], v1 offset:25088
v_mul_f32 v110, v110, v22
v_mfma_f32_16x16x32_bf16 v[140:143], v[192:195], v[240:243], v[140:143]
ds_read_b64_tr_b16 v[212:213], v4 offset:24576
v_mul_f32 v111, v111, v23
s_waitcnt lgkmcnt(7)
v_mfma_f32_16x16x32_bf16 v[144:147], v[196:199], a[56:59], v[144:147]
ds_read_b64_tr_b16 v[214:215], v4 offset:25088
v_cvt_pk_bf16_f32 v32, v108, v109
v_mfma_f32_16x16x32_bf16 v[148:151], v[196:199], a[128:131], v[148:151]
ds_read_b64_tr_b16 v[216:217], v1 offset:28672
v_cvt_pk_bf16_f32 v33, v110, v111
v_mfma_f32_16x16x32_bf16 v[152:155], v[196:199], a[200:203], v[152:155]
ds_read_b64_tr_b16 v[218:219], v1 offset:29184
v_mul_f32 v24, s26, v92
v_mfma_f32_16x16x32_bf16 v[156:159], v[196:199], v[240:243], v[156:159]
v_exp_f32 v24, v24
s_waitcnt lgkmcnt(8)
v_mfma_f32_16x16x32_bf16 v[160:163], v[200:203], a[56:59], v[160:163]
ds_read_b64_tr_b16 v[220:221], v4 offset:28672
v_mul_f32 v25, s26, v93
v_mfma_f32_16x16x32_bf16 v[164:167], v[200:203], a[128:131], v[164:167]
v_exp_f32 v25, v25
v_mfma_f32_16x16x32_bf16 v[168:171], v[200:203], a[200:203], v[168:171]
ds_read_b64_tr_b16 v[222:223], v4 offset:29184
v_mul_f32 v26, s26, v94
v_mfma_f32_16x16x32_bf16 v[172:175], v[200:203], v[240:243], v[172:175]
v_exp_f32 v26, v26
s_waitcnt lgkmcnt(8)
v_mfma_f32_16x16x32_bf16 v[176:179], v[204:207], a[56:59], v[176:179]
v_mul_f32 v27, s26, v95
v_mul_f32 v124, v92, v124
v_mfma_f32_16x16x32_bf16 v[180:183], v[204:207], a[128:131], v[180:183]
v_exp_f32 v27, v27
v_mfma_f32_16x16x32_bf16 v[184:187], v[204:207], a[200:203], v[184:187]
v_mul_f32 v125, v93, v125
v_mul_f32 v126, v94, v126
v_mfma_f32_16x16x32_bf16 v[188:191], v[204:207], v[240:243], v[188:191]
v_mul_f32 v127, v95, v127
s_waitcnt lgkmcnt(6)
v_mfma_f32_16x16x32_bf16 v[128:131], v[208:211], a[60:63], v[128:131]
ds_read_b64_tr_b16 v[192:193], v2 offset:0
v_add_f32 v24, 1.0, v24
v_mfma_f32_16x16x32_bf16 v[132:135], v[208:211], a[132:135], v[132:135]
v_rcp_f32 v24, v24
v_mfma_f32_16x16x32_bf16 v[136:139], v[208:211], a[204:207], v[136:139]
ds_read_b64_tr_b16 v[194:195], v2 offset:512
v_add_f32 v25, 1.0, v25
v_mfma_f32_16x16x32_bf16 v[140:143], v[208:211], v[244:247], v[140:143]
v_rcp_f32 v25, v25
s_waitcnt lgkmcnt(6)
v_mfma_f32_16x16x32_bf16 v[144:147], v[212:215], a[60:63], v[144:147]
ds_read_b64_tr_b16 v[196:197], v5 offset:0
v_add_f32 v26, 1.0, v26
v_mfma_f32_16x16x32_bf16 v[148:151], v[212:215], a[132:135], v[148:151]
v_rcp_f32 v26, v26
v_mfma_f32_16x16x32_bf16 v[152:155], v[212:215], a[204:207], v[152:155]
ds_read_b64_tr_b16 v[198:199], v5 offset:512
v_add_f32 v27, 1.0, v27
v_mfma_f32_16x16x32_bf16 v[156:159], v[212:215], v[244:247], v[156:159]
v_rcp_f32 v27, v27
s_waitcnt lgkmcnt(6)
v_mfma_f32_16x16x32_bf16 v[160:163], v[216:219], a[60:63], v[160:163]
ds_read_b64_tr_b16 v[200:201], v2 offset:4096
v_mul_f32 v124, v124, v24
v_mfma_f32_16x16x32_bf16 v[164:167], v[216:219], a[132:135], v[164:167]
ds_read_b64_tr_b16 v[202:203], v2 offset:4608
v_mul_f32 v125, v125, v25
v_mfma_f32_16x16x32_bf16 v[168:171], v[216:219], a[204:207], v[168:171]
ds_read_b64_tr_b16 v[204:205], v5 offset:4096
v_mul_f32 v126, v126, v26
v_mfma_f32_16x16x32_bf16 v[172:175], v[216:219], v[244:247], v[172:175]
ds_read_b64_tr_b16 v[206:207], v5 offset:4608
v_mul_f32 v127, v127, v27
s_waitcnt lgkmcnt(8)
v_mfma_f32_16x16x32_bf16 v[176:179], v[220:223], a[60:63], v[176:179]
v_cvt_pk_bf16_f32 v34, v124, v125
v_cvt_pk_bf16_f32 v35, v126, v127
v_mfma_f32_16x16x32_bf16 v[180:183], v[220:223], a[132:135], v[180:183]
v_mfma_f32_16x16x32_bf16 v[184:187], v[220:223], a[204:207], v[184:187]
v_mfma_f32_16x16x32_bf16 v[188:191], v[220:223], v[244:247], v[188:191]
s_waitcnt vmcnt(16)
s_barrier
s_waitcnt lgkmcnt(6)
v_mfma_f32_16x16x32_bf16 v[128:131], v[192:195], a[64:67], v[128:131]
s_add_u32 m0, s25, 40960
s_add_u32 s27, s21, 3538944
s_add_u32 s55, s31, 4096
v_mfma_f32_16x16x32_bf16 v[132:135], v[192:195], a[136:139], v[132:135]
buffer_load_dwordx4 v13, s[8:11], s27 offen lds
v_mfma_f32_16x16x32_bf16 v[136:139], v[192:195], a[208:211], v[136:139]
buffer_store_dwordx4 v[32:35], v15, s[16:19], s55 offen sc1
v_mfma_f32_16x16x32_bf16 v[140:143], v[192:195], v[248:251], v[140:143]
ds_read_b64_tr_b16 v[208:209], v2 offset:8192
s_waitcnt lgkmcnt(5)
v_mfma_f32_16x16x32_bf16 v[144:147], v[196:199], a[64:67], v[144:147]
ds_read_b64_tr_b16 v[210:211], v2 offset:8704
v_mfma_f32_16x16x32_bf16 v[148:151], v[196:199], a[136:139], v[148:151]
buffer_load_dwordx4 v14, s[8:11], s27 offen offset:1024 lds
v_mfma_f32_16x16x32_bf16 v[152:155], v[196:199], a[208:211], v[152:155]
s_add_u32 m0, s25, 8192
s_add_u32 s27, s21, 3833856
ds_read_b64_tr_b16 v[212:213], v5 offset:8192
v_mfma_f32_16x16x32_bf16 v[156:159], v[196:199], v[248:251], v[156:159]
ds_read_b64_tr_b16 v[214:215], v5 offset:8704
s_waitcnt lgkmcnt(6)
v_mfma_f32_16x16x32_bf16 v[160:163], v[200:203], a[64:67], v[160:163]
ds_read_b64_tr_b16 v[216:217], v2 offset:12288
v_mfma_f32_16x16x32_bf16 v[164:167], v[200:203], a[136:139], v[164:167]
buffer_load_dwordx4 v13, s[8:11], s27 offen lds
v_mfma_f32_16x16x32_bf16 v[168:171], v[200:203], a[208:211], v[168:171]
ds_read_b64_tr_b16 v[218:219], v2 offset:12800
v_mfma_f32_16x16x32_bf16 v[172:175], v[200:203], v[248:251], v[172:175]
ds_read_b64_tr_b16 v[220:221], v5 offset:12288
s_waitcnt lgkmcnt(7)
v_mfma_f32_16x16x32_bf16 v[176:179], v[204:207], a[64:67], v[176:179]
ds_read_b64_tr_b16 v[222:223], v5 offset:12800
v_mfma_f32_16x16x32_bf16 v[180:183], v[204:207], a[136:139], v[180:183]
buffer_load_dwordx4 v14, s[8:11], s27 offen offset:1024 lds
v_mfma_f32_16x16x32_bf16 v[184:187], v[204:207], a[208:211], v[184:187]
v_mfma_f32_16x16x32_bf16 v[188:191], v[204:207], v[248:251], v[188:191]
s_waitcnt lgkmcnt(6)
v_mfma_f32_16x16x32_bf16 v[128:131], v[208:211], a[68:71], v[128:131]
v_xor_b32 v1, s99, v1
v_xor_b32 v4, s99, v4
v_mfma_f32_16x16x32_bf16 v[132:135], v[208:211], a[140:143], v[132:135]
v_xor_b32 v2, s99, v2
v_xor_b32 v5, s99, v5
v_mfma_f32_16x16x32_bf16 v[136:139], v[208:211], a[212:215], v[136:139]
v_xor_b32 v3, s99, v3
v_xor_b32 v6, s99, v6
v_mfma_f32_16x16x32_bf16 v[140:143], v[208:211], v[252:255], v[140:143]
s_add_u32 m0, s25, 49152
ds_read_b64_tr_b16 v[192:193], v2 offset:16384
s_waitcnt lgkmcnt(5)
v_mfma_f32_16x16x32_bf16 v[144:147], v[212:215], a[68:71], v[144:147]
s_add_u32 s27, s21, 4128768
ds_read_b64_tr_b16 v[194:195], v2 offset:16896
v_mfma_f32_16x16x32_bf16 v[148:151], v[212:215], a[140:143], v[148:151]
buffer_load_dwordx4 v13, s[8:11], s27 offen lds
v_mfma_f32_16x16x32_bf16 v[152:155], v[212:215], a[212:215], v[152:155]
ds_read_b64_tr_b16 v[196:197], v5 offset:16384
v_mfma_f32_16x16x32_bf16 v[156:159], v[212:215], v[252:255], v[156:159]
ds_read_b64_tr_b16 v[198:199], v5 offset:16896
s_waitcnt lgkmcnt(6)
v_mfma_f32_16x16x32_bf16 v[160:163], v[216:219], a[68:71], v[160:163]
ds_read_b64_tr_b16 v[200:201], v2 offset:20480
v_mfma_f32_16x16x32_bf16 v[164:167], v[216:219], a[140:143], v[164:167]
buffer_load_dwordx4 v14, s[8:11], s27 offen offset:1024 lds
v_mfma_f32_16x16x32_bf16 v[168:171], v[216:219], a[212:215], v[168:171]
ds_read_b64_tr_b16 v[202:203], v2 offset:20992
v_mfma_f32_16x16x32_bf16 v[172:175], v[216:219], v[252:255], v[172:175]
ds_read_b64_tr_b16 v[204:205], v5 offset:20480
s_waitcnt lgkmcnt(7)
v_mfma_f32_16x16x32_bf16 v[176:179], v[220:223], a[68:71], v[176:179]
ds_read_b64_tr_b16 v[206:207], v5 offset:20992
v_mfma_f32_16x16x32_bf16 v[180:183], v[220:223], a[140:143], v[180:183]
v_mfma_f32_16x16x32_bf16 v[184:187], v[220:223], a[212:215], v[184:187]
v_mfma_f32_16x16x32_bf16 v[188:191], v[220:223], v[252:255], v[188:191]
s_waitcnt lgkmcnt(6)
v_mfma_f32_16x16x32_bf16 v[64:67], v[192:195], a[0:3], 0
s_add_u32 m0, s25, 16384
s_add_u32 s27, s21, 4423680
ds_read_b64_tr_b16 v[208:209], v2 offset:24576
v_mfma_f32_16x16x32_bf16 v[68:71], v[192:195], a[72:75], 0
ds_read_b64_tr_b16 v[210:211], v2 offset:25088
ds_read_b64_tr_b16 v[212:213], v5 offset:24576
s_waitcnt lgkmcnt(7)
v_mfma_f32_16x16x32_bf16 v[80:83], v[196:199], a[0:3], 0
buffer_load_dwordx4 v13, s[8:11], s27 offen lds
v_mfma_f32_16x16x32_bf16 v[84:87], v[196:199], a[72:75], 0
ds_read_b64_tr_b16 v[214:215], v5 offset:25088
ds_read_b64_tr_b16 v[216:217], v2 offset:28672
s_waitcnt lgkmcnt(7)
v_mfma_f32_16x16x32_bf16 v[96:99], v[200:203], a[0:3], 0
buffer_load_dwordx4 v14, s[8:11], s27 offen offset:1024 lds
v_mfma_f32_16x16x32_bf16 v[100:103], v[200:203], a[72:75], 0
s_add_u32 m0, s25, 57344
ds_read_b64_tr_b16 v[218:219], v2 offset:29184
s_waitcnt lgkmcnt(6)
v_mfma_f32_16x16x32_bf16 v[112:115], v[204:207], a[0:3], 0
s_add_u32 s27, s21, 4718592
ds_read_b64_tr_b16 v[220:221], v5 offset:28672
ds_read_b64_tr_b16 v[222:223], v5 offset:29184
v_mfma_f32_16x16x32_bf16 v[116:119], v[204:207], a[72:75], 0
buffer_load_dwordx4 v13, s[8:11], s27 offen lds
buffer_load_dwordx4 v14, s[8:11], s27 offen offset:1024 lds
s_waitcnt lgkmcnt(6)
v_mfma_f32_16x16x32_bf16 v[64:67], v[208:211], a[4:7], v[64:67]
s_add_u32 m0, s25, 24576
s_add_u32 s27, s21, 5013504
ds_read_b64_tr_b16 v[192:193], v2 offset:32768
v_mfma_f32_16x16x32_bf16 v[68:71], v[208:211], a[76:79], v[68:71]
ds_read_b64_tr_b16 v[194:195], v2 offset:33280
ds_read_b64_tr_b16 v[196:197], v5 offset:32768
s_waitcnt lgkmcnt(7)
v_mfma_f32_16x16x32_bf16 v[80:83], v[212:215], a[4:7], v[80:83]
buffer_load_dwordx4 v13, s[8:11], s27 offen lds
v_mfma_f32_16x16x32_bf16 v[84:87], v[212:215], a[76:79], v[84:87]
ds_read_b64_tr_b16 v[198:199], v5 offset:33280
ds_read_b64_tr_b16 v[200:201], v2 offset:36864
s_waitcnt lgkmcnt(7)
v_mfma_f32_16x16x32_bf16 v[96:99], v[216:219], a[4:7], v[96:99]
ds_read_b64_tr_b16 v[202:203], v2 offset:37376
v_mul_f32 v20, s26, v128
v_mfma_f32_16x16x32_bf16 v[100:103], v[216:219], a[76:79], v[100:103]
ds_read_b64_tr_b16 v[204:205], v5 offset:36864
v_mul_f32 v21, s26, v129
s_waitcnt lgkmcnt(7)
v_mfma_f32_16x16x32_bf16 v[112:115], v[220:223], a[4:7], v[112:115]
buffer_load_dwordx4 v14, s[8:11], s27 offen offset:1024 lds
v_mfma_f32_16x16x32_bf16 v[116:119], v[220:223], a[76:79], v[116:119]
ds_read_b64_tr_b16 v[206:207], v5 offset:37376
v_mul_f32 v22, s26, v130
s_waitcnt lgkmcnt(6)
v_mfma_f32_16x16x32_bf16 v[64:67], v[192:195], a[8:11], v[64:67]
ds_read_b64_tr_b16 v[208:209], v2 offset:40960
ds_read_b64_tr_b16 v[210:211], v2 offset:41472
v_mfma_f32_16x16x32_bf16 v[68:71], v[192:195], a[80:83], v[68:71]
v_exp_f32 v20, v20
s_waitcnt lgkmcnt(6)
v_mfma_f32_16x16x32_bf16 v[80:83], v[196:199], a[8:11], v[80:83]
ds_read_b64_tr_b16 v[212:213], v5 offset:40960
ds_read_b64_tr_b16 v[214:215], v5 offset:41472
v_mfma_f32_16x16x32_bf16 v[84:87], v[196:199], a[80:83], v[84:87]
v_exp_f32 v21, v21
s_waitcnt lgkmcnt(6)
v_mfma_f32_16x16x32_bf16 v[96:99], v[200:203], a[8:11], v[96:99]
ds_read_b64_tr_b16 v[216:217], v2 offset:45056
ds_read_b64_tr_b16 v[218:219], v2 offset:45568
v_mfma_f32_16x16x32_bf16 v[100:103], v[200:203], a[80:83], v[100:103]
v_exp_f32 v22, v22
s_waitcnt lgkmcnt(6)
v_mfma_f32_16x16x32_bf16 v[112:115], v[204:207], a[8:11], v[112:115]
ds_read_b64_tr_b16 v[220:221], v5 offset:45056
ds_read_b64_tr_b16 v[222:223], v5 offset:45568
v_mfma_f32_16x16x32_bf16 v[116:119], v[204:207], a[80:83], v[116:119]
v_mul_f32 v23, s26, v131
v_mul_f32 v160, v128, v160
s_waitcnt lgkmcnt(6)
v_mfma_f32_16x16x32_bf16 v[64:67], v[208:211], a[12:15], v[64:67]
ds_read_b64_tr_b16 v[192:193], v2 offset:49152
ds_read_b64_tr_b16 v[194:195], v2 offset:49664
v_mfma_f32_16x16x32_bf16 v[68:71], v[208:211], a[84:87], v[68:71]
v_exp_f32 v23, v23
s_waitcnt lgkmcnt(6)
v_mfma_f32_16x16x32_bf16 v[80:83], v[212:215], a[12:15], v[80:83]
ds_read_b64_tr_b16 v[196:197], v5 offset:49152
ds_read_b64_tr_b16 v[198:199], v5 offset:49664
v_mfma_f32_16x16x32_bf16 v[84:87], v[212:215], a[84:87], v[84:87]
ds_read_b64_tr_b16 v[200:201], v2 offset:53248
v_mul_f32 v161, v129, v161
s_waitcnt lgkmcnt(7)
v_mfma_f32_16x16x32_bf16 v[96:99], v[216:219], a[12:15], v[96:99]
ds_read_b64_tr_b16 v[202:203], v2 offset:53760
v_mul_f32 v162, v130, v162
v_mfma_f32_16x16x32_bf16 v[100:103], v[216:219], a[84:87], v[100:103]
ds_read_b64_tr_b16 v[204:205], v5 offset:53248
v_mul_f32 v163, v131, v163
s_waitcnt lgkmcnt(7)
v_mfma_f32_16x16x32_bf16 v[112:115], v[220:223], a[12:15], v[112:115]
ds_read_b64_tr_b16 v[206:207], v5 offset:53760
v_add_f32 v20, 1.0, v20
v_mfma_f32_16x16x32_bf16 v[116:119], v[220:223], a[84:87], v[116:119]
s_waitcnt vmcnt(15)
s_barrier
s_waitcnt lgkmcnt(6)
v_mfma_f32_16x16x32_bf16 v[64:67], v[192:195], a[16:19], v[64:67]
ds_read_b64_tr_b16 v[208:209], v2 offset:57344
ds_read_b64_tr_b16 v[210:211], v2 offset:57856
v_mfma_f32_16x16x32_bf16 v[68:71], v[192:195], a[88:91], v[68:71]
v_rcp_f32 v20, v20
s_waitcnt lgkmcnt(6)
v_mfma_f32_16x16x32_bf16 v[80:83], v[196:199], a[16:19], v[80:83]
ds_read_b64_tr_b16 v[212:213], v5 offset:57344
ds_read_b64_tr_b16 v[214:215], v5 offset:57856
v_mfma_f32_16x16x32_bf16 v[84:87], v[196:199], a[88:91], v[84:87]
ds_read_b64_tr_b16 v[216:217], v2 offset:61440
v_add_f32 v21, 1.0, v21
s_waitcnt lgkmcnt(7)
v_mfma_f32_16x16x32_bf16 v[96:99], v[200:203], a[16:19], v[96:99]
v_rcp_f32 v21, v21
v_mfma_f32_16x16x32_bf16 v[100:103], v[200:203], a[88:91], v[100:103]
ds_read_b64_tr_b16 v[218:219], v2 offset:61952
ds_read_b64_tr_b16 v[220:221], v5 offset:61440
s_waitcnt lgkmcnt(7)
v_mfma_f32_16x16x32_bf16 v[112:115], v[204:207], a[16:19], v[112:115]
ds_read_b64_tr_b16 v[222:223], v5 offset:61952
v_add_f32 v22, 1.0, v22
v_mfma_f32_16x16x32_bf16 v[116:119], v[204:207], a[88:91], v[116:119]
v_rcp_f32 v22, v22
s_waitcnt lgkmcnt(6)
v_mfma_f32_16x16x32_bf16 v[64:67], v[208:211], a[20:23], v[64:67]
ds_read_b64_tr_b16 v[192:193], v3 offset:8192
ds_read_b64_tr_b16 v[194:195], v3 offset:8704
v_mfma_f32_16x16x32_bf16 v[68:71], v[208:211], a[92:95], v[68:71]
ds_read_b64_tr_b16 v[196:197], v6 offset:8192
v_add_f32 v23, 1.0, v23
s_waitcnt lgkmcnt(7)
v_mfma_f32_16x16x32_bf16 v[80:83], v[212:215], a[20:23], v[80:83]
v_rcp_f32 v23, v23
v_mfma_f32_16x16x32_bf16 v[84:87], v[212:215], a[92:95], v[84:87]
ds_read_b64_tr_b16 v[198:199], v6 offset:8704
ds_read_b64_tr_b16 v[200:201], v3 offset:12288
s_waitcnt lgkmcnt(7)
v_mfma_f32_16x16x32_bf16 v[96:99], v[216:219], a[20:23], v[96:99]
ds_read_b64_tr_b16 v[202:203], v3 offset:12800
v_mul_f32 v160, v160, v20
v_mfma_f32_16x16x32_bf16 v[100:103], v[216:219], a[92:95], v[100:103]
ds_read_b64_tr_b16 v[204:205], v6 offset:12288
v_mul_f32 v161, v161, v21
s_waitcnt lgkmcnt(7)
v_mfma_f32_16x16x32_bf16 v[112:115], v[220:223], a[20:23], v[112:115]
ds_read_b64_tr_b16 v[206:207], v6 offset:12800
v_mul_f32 v162, v162, v22
v_mfma_f32_16x16x32_bf16 v[116:119], v[220:223], a[92:95], v[116:119]
v_mul_f32 v163, v163, v23
v_cvt_pk_bf16_f32 v28, v160, v161
s_waitcnt lgkmcnt(6)
v_mfma_f32_16x16x32_bf16 v[64:67], v[192:195], a[24:27], v[64:67]
ds_read_b64_tr_b16 v[208:209], v3 offset:0
ds_read_b64_tr_b16 v[210:211], v3 offset:512
v_mfma_f32_16x16x32_bf16 v[68:71], v[192:195], a[96:99], v[68:71]
ds_read_b64_tr_b16 v[212:213], v6 offset:0
v_cvt_pk_bf16_f32 v29, v162, v163
s_waitcnt lgkmcnt(7)
v_mfma_f32_16x16x32_bf16 v[80:83], v[196:199], a[24:27], v[80:83]
ds_read_b64_tr_b16 v[214:215], v6 offset:512
v_mul_f32 v24, s26, v144
v_mfma_f32_16x16x32_bf16 v[84:87], v[196:199], a[96:99], v[84:87]
v_exp_f32 v24, v24
s_waitcnt lgkmcnt(6)
v_mfma_f32_16x16x32_bf16 v[96:99], v[200:203], a[24:27], v[96:99]
ds_read_b64_tr_b16 v[216:217], v3 offset:4096
ds_read_b64_tr_b16 v[218:219], v3 offset:4608
v_mfma_f32_16x16x32_bf16 v[100:103], v[200:203], a[96:99], v[100:103]
ds_read_b64_tr_b16 v[220:221], v6 offset:4096
v_mul_f32 v25, s26, v145
s_waitcnt lgkmcnt(7)
v_mfma_f32_16x16x32_bf16 v[112:115], v[204:207], a[24:27], v[112:115]
v_exp_f32 v25, v25
v_mfma_f32_16x16x32_bf16 v[116:119], v[204:207], a[96:99], v[116:119]
ds_read_b64_tr_b16 v[222:223], v6 offset:4608
v_mul_f32 v26, s26, v146
s_waitcnt lgkmcnt(6)
v_mfma_f32_16x16x32_bf16 v[64:67], v[208:211], a[28:31], v[64:67]
ds_read_b64_tr_b16 v[192:193], v3 offset:24576
ds_read_b64_tr_b16 v[194:195], v3 offset:25088
v_mfma_f32_16x16x32_bf16 v[68:71], v[208:211], a[100:103], v[68:71]
v_exp_f32 v26, v26
s_waitcnt lgkmcnt(6)
v_mfma_f32_16x16x32_bf16 v[80:83], v[212:215], a[28:31], v[80:83]
ds_read_b64_tr_b16 v[196:197], v6 offset:24576
ds_read_b64_tr_b16 v[198:199], v6 offset:25088
v_mfma_f32_16x16x32_bf16 v[84:87], v[212:215], a[100:103], v[84:87]
ds_read_b64_tr_b16 v[200:201], v3 offset:28672
v_mul_f32 v27, s26, v147
s_waitcnt lgkmcnt(7)
v_mfma_f32_16x16x32_bf16 v[96:99], v[216:219], a[28:31], v[96:99]
v_exp_f32 v27, v27
v_mfma_f32_16x16x32_bf16 v[100:103], v[216:219], a[100:103], v[100:103]
ds_read_b64_tr_b16 v[202:203], v3 offset:29184
ds_read_b64_tr_b16 v[204:205], v6 offset:28672
s_waitcnt lgkmcnt(7)
v_mfma_f32_16x16x32_bf16 v[112:115], v[220:223], a[28:31], v[112:115]
ds_read_b64_tr_b16 v[206:207], v6 offset:29184
v_mul_f32 v176, v144, v176
v_mfma_f32_16x16x32_bf16 v[116:119], v[220:223], a[100:103], v[116:119]
v_mul_f32 v177, v145, v177
v_mul_f32 v178, v146, v178
s_waitcnt lgkmcnt(6)
v_mfma_f32_16x16x32_bf16 v[64:67], v[192:195], a[32:35], v[64:67]
ds_read_b64_tr_b16 v[208:209], v3 offset:16384
ds_read_b64_tr_b16 v[210:211], v3 offset:16896
v_mfma_f32_16x16x32_bf16 v[68:71], v[192:195], a[104:107], v[68:71]
ds_read_b64_tr_b16 v[212:213], v6 offset:16384
v_mul_f32 v179, v147, v179
s_waitcnt lgkmcnt(7)
v_mfma_f32_16x16x32_bf16 v[80:83], v[196:199], a[32:35], v[80:83]
global_load_dword v53, v52, s[6:7] sc1
v_mfma_f32_16x16x32_bf16 v[84:87], v[196:199], a[104:107], v[84:87]
ds_read_b64_tr_b16 v[214:215], v6 offset:16896
ds_read_b64_tr_b16 v[216:217], v3 offset:20480
s_waitcnt lgkmcnt(7)
v_mfma_f32_16x16x32_bf16 v[96:99], v[200:203], a[32:35], v[96:99]
ds_read_b64_tr_b16 v[218:219], v3 offset:20992
v_add_f32 v24, 1.0, v24
v_mfma_f32_16x16x32_bf16 v[100:103], v[200:203], a[104:107], v[100:103]
v_rcp_f32 v24, v24
s_waitcnt lgkmcnt(6)
v_mfma_f32_16x16x32_bf16 v[112:115], v[204:207], a[32:35], v[112:115]
ds_read_b64_tr_b16 v[220:221], v6 offset:20480
ds_read_b64_tr_b16 v[222:223], v6 offset:20992
v_mfma_f32_16x16x32_bf16 v[116:119], v[204:207], a[104:107], v[116:119]
v_add_f32 v25, 1.0, v25
v_add_f32 v26, 1.0, v26
s_waitcnt lgkmcnt(6)
v_mfma_f32_16x16x32_bf16 v[64:67], v[208:211], a[36:39], v[64:67]
s_add_u32 s55, s28, 6144
ds_read_b64_tr_b16 v[192:193], v1 offset:32768
ds_read_b64_tr_b16 v[194:195], v1 offset:33280
v_mfma_f32_16x16x32_bf16 v[68:71], v[208:211], a[108:111], v[68:71]
v_rcp_f32 v25, v25
s_waitcnt lgkmcnt(6)
v_mfma_f32_16x16x32_bf16 v[80:83], v[212:215], a[36:39], v[80:83]
ds_read_b64_tr_b16 v[196:197], v4 offset:32768
ds_read_b64_tr_b16 v[198:199], v4 offset:33280
v_mfma_f32_16x16x32_bf16 v[84:87], v[212:215], a[108:111], v[84:87]
v_rcp_f32 v26, v26
s_waitcnt lgkmcnt(6)
v_mfma_f32_16x16x32_bf16 v[96:99], v[216:219], a[36:39], v[96:99]
ds_read_b64_tr_b16 v[200:201], v1 offset:36864
ds_read_b64_tr_b16 v[202:203], v1 offset:37376
v_mfma_f32_16x16x32_bf16 v[100:103], v[216:219], a[108:111], v[100:103]
ds_read_b64_tr_b16 v[204:205], v4 offset:36864
v_add_f32 v27, 1.0, v27
s_waitcnt lgkmcnt(7)
v_mfma_f32_16x16x32_bf16 v[112:115], v[220:223], a[36:39], v[112:115]
v_rcp_f32 v27, v27
v_mfma_f32_16x16x32_bf16 v[116:119], v[220:223], a[108:111], v[116:119]
ds_read_b64_tr_b16 v[206:207], v4 offset:37376
s_waitcnt vmcnt(3)
s_barrier
s_cmp_lg_u32 s98, 0
s_cbranch_scc1 SIG_7
s_lshl_b32 s56, s2, 7
s_add_u32 s56, s56, 40894488
v_mov_b32 v60, s56
v_mov_b32 v61, s100
s_mov_b64 exec, 1
global_store_dword v60, v61, s[6:7] sc1
s_mov_b64 exec, -1
SIG_7:
s_waitcnt lgkmcnt(6)
v_mfma_f32_16x16x32_bf16 v[64:67], v[192:195], a[40:43], v[64:67]
ds_read_b64_tr_b16 v[208:209], v1 offset:0
ds_read_b64_tr_b16 v[210:211], v1 offset:512
v_mfma_f32_16x16x32_bf16 v[68:71], v[192:195], a[112:115], v[68:71]
ds_read_b64_tr_b16 v[212:213], v4 offset:0
v_mul_f32 v176, v176, v24
s_waitcnt lgkmcnt(7)
v_mfma_f32_16x16x32_bf16 v[80:83], v[196:199], a[40:43], v[80:83]
ds_read_b64_tr_b16 v[214:215], v4 offset:512
v_mul_f32 v177, v177, v25
v_mfma_f32_16x16x32_bf16 v[84:87], v[196:199], a[112:115], v[84:87]
ds_read_b64_tr_b16 v[216:217], v1 offset:4096
v_mul_f32 v178, v178, v26
s_waitcnt lgkmcnt(7)
v_mfma_f32_16x16x32_bf16 v[96:99], v[200:203], a[40:43], v[96:99]
ds_read_b64_tr_b16 v[218:219], v1 offset:4608
v_mul_f32 v179, v179, v27
v_mfma_f32_16x16x32_bf16 v[100:103], v[200:203], a[112:115], v[100:103]
ds_read_b64_tr_b16 v[220:221], v4 offset:4096
v_cvt_pk_bf16_f32 v30, v176, v177
s_waitcnt lgkmcnt(7)
v_mfma_f32_16x16x32_bf16 v[112:115], v[204:207], a[40:43], v[112:115]
ds_read_b64_tr_b16 v[222:223], v4 offset:4608
v_cvt_pk_bf16_f32 v31, v178, v179
v_mfma_f32_16x16x32_bf16 v[116:119], v[204:207], a[112:115], v[116:119]
v_mul_f32 v20, s26, v132
v_mul_f32 v21, s26, v133
s_waitcnt lgkmcnt(6)
v_mfma_f32_16x16x32_bf16 v[64:67], v[208:211], a[44:47], v[64:67]
ds_read_b64_tr_b16 v[192:193], v1 offset:40960
ds_read_b64_tr_b16 v[194:195], v1 offset:41472
v_mfma_f32_16x16x32_bf16 v[68:71], v[208:211], a[116:119], v[68:71]
v_exp_f32 v20, v20
s_waitcnt lgkmcnt(6)
v_mfma_f32_16x16x32_bf16 v[80:83], v[212:215], a[44:47], v[80:83]
ds_read_b64_tr_b16 v[196:197], v4 offset:40960
ds_read_b64_tr_b16 v[198:199], v4 offset:41472
v_mfma_f32_16x16x32_bf16 v[84:87], v[212:215], a[116:119], v[84:87]
v_exp_f32 v21, v21
s_waitcnt lgkmcnt(6)
v_mfma_f32_16x16x32_bf16 v[96:99], v[216:219], a[44:47], v[96:99]
ds_read_b64_tr_b16 v[200:201], v1 offset:45056
ds_read_b64_tr_b16 v[202:203], v1 offset:45568
v_mfma_f32_16x16x32_bf16 v[100:103], v[216:219], a[116:119], v[100:103]
ds_read_b64_tr_b16 v[204:205], v4 offset:45056
v_mul_f32 v22, s26, v134
s_waitcnt lgkmcnt(7)
v_mfma_f32_16x16x32_bf16 v[112:115], v[220:223], a[44:47], v[112:115]
buffer_store_dwordx4 v[28:31], v15, s[16:19], s55 offen sc1
v_mfma_f32_16x16x32_bf16 v[116:119], v[220:223], a[116:119], v[116:119]
ds_read_b64_tr_b16 v[206:207], v4 offset:45568
v_mul_f32 v23, s26, v135
s_waitcnt lgkmcnt(6)
v_mfma_f32_16x16x32_bf16 v[64:67], v[192:195], a[48:51], v[64:67]
ds_read_b64_tr_b16 v[208:209], v1 offset:8192
ds_read_b64_tr_b16 v[210:211], v1 offset:8704
v_mfma_f32_16x16x32_bf16 v[68:71], v[192:195], a[120:123], v[68:71]
v_exp_f32 v22, v22
s_waitcnt lgkmcnt(6)
v_mfma_f32_16x16x32_bf16 v[80:83], v[196:199], a[48:51], v[80:83]
ds_read_b64_tr_b16 v[212:213], v4 offset:8192
ds_read_b64_tr_b16 v[214:215], v4 offset:8704
v_mfma_f32_16x16x32_bf16 v[84:87], v[196:199], a[120:123], v[84:87]
v_exp_f32 v23, v23
s_waitcnt lgkmcnt(6)
v_mfma_f32_16x16x32_bf16 v[96:99], v[200:203], a[48:51], v[96:99]
ds_read_b64_tr_b16 v[216:217], v1 offset:12288
ds_read_b64_tr_b16 v[218:219], v1 offset:12800
v_mfma_f32_16x16x32_bf16 v[100:103], v[200:203], a[120:123], v[100:103]
ds_read_b64_tr_b16 v[220:221], v4 offset:12288
v_mul_f32 v164, v132, v164
s_waitcnt lgkmcnt(7)
v_mfma_f32_16x16x32_bf16 v[112:115], v[204:207], a[48:51], v[112:115]
ds_read_b64_tr_b16 v[222:223], v4 offset:12800
v_mul_f32 v165, v133, v165
v_mfma_f32_16x16x32_bf16 v[116:119], v[204:207], a[120:123], v[116:119]
v_mul_f32 v166, v134, v166
v_mul_f32 v167, v135, v167
s_waitcnt lgkmcnt(6)
v_mfma_f32_16x16x32_bf16 v[64:67], v[208:211], a[52:55], v[64:67]
ds_read_b64_tr_b16 v[192:193], v1 offset:49152
ds_read_b64_tr_b16 v[194:195], v1 offset:49664
v_mfma_f32_16x16x32_bf16 v[68:71], v[208:211], a[124:127], v[68:71]
ds_read_b64_tr_b16 v[196:197], v4 offset:49152
v_add_f32 v20, 1.0, v20
s_waitcnt lgkmcnt(7)
v_mfma_f32_16x16x32_bf16 v[80:83], v[212:215], a[52:55], v[80:83]
v_rcp_f32 v20, v20
v_mfma_f32_16x16x32_bf16 v[84:87], v[212:215], a[124:127], v[84:87]
ds_read_b64_tr_b16 v[198:199], v4 offset:49664
ds_read_b64_tr_b16 v[200:201], v1 offset:53248
s_waitcnt lgkmcnt(7)
v_mfma_f32_16x16x32_bf16 v[96:99], v[216:219], a[52:55], v[96:99]
ds_read_b64_tr_b16 v[202:203], v1 offset:53760
v_add_f32 v21, 1.0, v21
v_mfma_f32_16x16x32_bf16 v[100:103], v[216:219], a[124:127], v[100:103]
v_rcp_f32 v21, v21
s_waitcnt lgkmcnt(6)
v_mfma_f32_16x16x32_bf16 v[112:115], v[220:223], a[52:55], v[112:115]
ds_read_b64_tr_b16 v[204:205], v4 offset:53248
ds_read_b64_tr_b16 v[206:207], v4 offset:53760
v_mfma_f32_16x16x32_bf16 v[116:119], v[220:223], a[124:127], v[116:119]
v_add_f32 v22, 1.0, v22
v_add_f32 v23, 1.0, v23
s_waitcnt lgkmcnt(6)
v_mfma_f32_16x16x32_bf16 v[64:67], v[192:195], a[56:59], v[64:67]
ds_read_b64_tr_b16 v[208:209], v1 offset:16384
ds_read_b64_tr_b16 v[210:211], v1 offset:16896
v_mfma_f32_16x16x32_bf16 v[68:71], v[192:195], a[128:131], v[68:71]
v_rcp_f32 v22, v22
s_waitcnt lgkmcnt(6)
v_mfma_f32_16x16x32_bf16 v[80:83], v[196:199], a[56:59], v[80:83]
ds_read_b64_tr_b16 v[212:213], v4 offset:16384
ds_read_b64_tr_b16 v[214:215], v4 offset:16896
v_mfma_f32_16x16x32_bf16 v[84:87], v[196:199], a[128:131], v[84:87]
v_rcp_f32 v23, v23
s_waitcnt lgkmcnt(6)
v_mfma_f32_16x16x32_bf16 v[96:99], v[200:203], a[56:59], v[96:99]
ds_read_b64_tr_b16 v[216:217], v1 offset:20480
ds_read_b64_tr_b16 v[218:219], v1 offset:20992
v_mfma_f32_16x16x32_bf16 v[100:103], v[200:203], a[128:131], v[100:103]
ds_read_b64_tr_b16 v[220:221], v4 offset:20480
v_mul_f32 v164, v164, v20
s_waitcnt lgkmcnt(7)
v_mfma_f32_16x16x32_bf16 v[112:115], v[204:207], a[56:59], v[112:115]
ds_read_b64_tr_b16 v[222:223], v4 offset:20992
v_mul_f32 v165, v165, v21
v_mfma_f32_16x16x32_bf16 v[116:119], v[204:207], a[128:131], v[116:119]
v_mul_f32 v166, v166, v22
v_mul_f32 v167, v167, v23
s_waitcnt lgkmcnt(6)
v_mfma_f32_16x16x32_bf16 v[64:67], v[208:211], a[60:63], v[64:67]
ds_read_b64_tr_b16 v[192:193], v1 offset:57344
ds_read_b64_tr_b16 v[194:195], v1 offset:57856
v_mfma_f32_16x16x32_bf16 v[68:71], v[208:211], a[132:135], v[68:71]
ds_read_b64_tr_b16 v[196:197], v4 offset:57344
v_cvt_pk_bf16_f32 v32, v164, v165
s_waitcnt lgkmcnt(7)
v_mfma_f32_16x16x32_bf16 v[80:83], v[212:215], a[60:63], v[80:83]
ds_read_b64_tr_b16 v[198:199], v4 offset:57856
v_cvt_pk_bf16_f32 v33, v166, v167
v_mfma_f32_16x16x32_bf16 v[84:87], v[212:215], a[132:135], v[84:87]
ds_read_b64_tr_b16 v[200:201], v1 offset:61440
v_mul_f32 v24, s26, v148
s_waitcnt lgkmcnt(7)
v_mfma_f32_16x16x32_bf16 v[96:99], v[216:219], a[60:63], v[96:99]
v_exp_f32 v24, v24
v_mfma_f32_16x16x32_bf16 v[100:103], v[216:219], a[132:135], v[100:103]
ds_read_b64_tr_b16 v[202:203], v1 offset:61952
ds_read_b64_tr_b16 v[204:205], v4 offset:61440
s_waitcnt lgkmcnt(7)
v_mfma_f32_16x16x32_bf16 v[112:115], v[220:223], a[60:63], v[112:115]
ds_read_b64_tr_b16 v[206:207], v4 offset:61952
v_mul_f32 v25, s26, v149
v_mfma_f32_16x16x32_bf16 v[116:119], v[220:223], a[132:135], v[116:119]
s_waitcnt vmcnt(2)
s_barrier
s_waitcnt lgkmcnt(6)
v_mfma_f32_16x16x32_bf16 v[64:67], v[192:195], a[64:67], v[64:67]
ds_read_b64_tr_b16 v[208:209], v1 offset:24576
ds_read_b64_tr_b16 v[210:211], v1 offset:25088
v_mfma_f32_16x16x32_bf16 v[68:71], v[192:195], a[136:139], v[68:71]
v_exp_f32 v25, v25
s_waitcnt lgkmcnt(6)
v_mfma_f32_16x16x32_bf16 v[80:83], v[196:199], a[64:67], v[80:83]
ds_read_b64_tr_b16 v[212:213], v4 offset:24576
ds_read_b64_tr_b16 v[214:215], v4 offset:25088
v_mfma_f32_16x16x32_bf16 v[84:87], v[196:199], a[136:139], v[84:87]
ds_read_b64_tr_b16 v[216:217], v1 offset:28672
v_mul_f32 v26, s26, v150
s_waitcnt lgkmcnt(7)
v_mfma_f32_16x16x32_bf16 v[96:99], v[200:203], a[64:67], v[96:99]
v_exp_f32 v26, v26
v_mfma_f32_16x16x32_bf16 v[100:103], v[200:203], a[136:139], v[100:103]
ds_read_b64_tr_b16 v[218:219], v1 offset:29184
ds_read_b64_tr_b16 v[220:221], v4 offset:28672
s_waitcnt lgkmcnt(7)
v_mfma_f32_16x16x32_bf16 v[112:115], v[204:207], a[64:67], v[112:115]
ds_read_b64_tr_b16 v[222:223], v4 offset:29184
v_mul_f32 v27, s26, v151
v_mfma_f32_16x16x32_bf16 v[116:119], v[204:207], a[136:139], v[116:119]
v_exp_f32 v27, v27
s_waitcnt lgkmcnt(6)
v_mfma_f32_16x16x32_bf16 v[64:67], v[208:211], a[68:71], v[64:67]
v_mul_f32 v180, v148, v180
v_mul_f32 v181, v149, v181
v_mfma_f32_16x16x32_bf16 v[68:71], v[208:211], a[140:143], v[68:71]
v_mul_f32 v182, v150, v182
v_mul_f32 v183, v151, v183
s_waitcnt lgkmcnt(4)
v_mfma_f32_16x16x32_bf16 v[80:83], v[212:215], a[68:71], v[80:83]
v_add_f32 v24, 1.0, v24
v_add_f32 v25, 1.0, v25
v_mfma_f32_16x16x32_bf16 v[84:87], v[212:215], a[140:143], v[84:87]
v_rcp_f32 v24, v24
s_waitcnt lgkmcnt(2)
v_mfma_f32_16x16x32_bf16 v[96:99], v[216:219], a[68:71], v[96:99]
v_rcp_f32 v25, v25
v_mfma_f32_16x16x32_bf16 v[100:103], v[216:219], a[140:143], v[100:103]
v_add_f32 v26, 1.0, v26
v_add_f32 v27, 1.0, v27
s_waitcnt lgkmcnt(0)
v_mfma_f32_16x16x32_bf16 v[112:115], v[220:223], a[68:71], v[112:115]
v_rcp_f32 v26, v26
v_mfma_f32_16x16x32_bf16 v[116:119], v[220:223], a[140:143], v[116:119]
v_rcp_f32 v27, v27
s_barrier
s_cmp_ge_u32 s97, 24
s_cbranch_scc1 KF_CONV
s_sub_u32 s56, s86, 2048
s_subb_u32 s57, s87, 0
s_mov_b32 s12, s56
s_mov_b32 s13, s57
s_mov_b32 s14, 5310464
s_mov_b32 s15, 0x00020000
s_add_u32 s56, s6, 12582912
s_addc_u32 s57, s7, 0
s_mov_b32 s8, s56
s_mov_b32 s9, s57
s_mov_b32 s10, 9437184
s_mov_b32 s11, 0x00020000
s_add_u32 m0, s43, 0
s_add_u32 s44, s40, 0
buffer_load_dwordx4 v48, s[12:15], s44 offen lds
buffer_load_dwordx4 v49, s[12:15], s44 offen offset:1024 lds
buffer_load_dwordx4 v50, s[12:15], s44 offen offset:2048 lds
s_add_u32 m0, s43, 12288
s_add_u32 s44, s40, 36864
buffer_load_dwordx4 v48, s[12:15], s44 offen lds
buffer_load_dwordx4 v49, s[12:15], s44 offen offset:1024 lds
buffer_load_dwordx4 v50, s[12:15], s44 offen offset:2048 lds
s_add_u32 m0, s43, 24576
s_add_u32 s44, s40, 294912
buffer_load_dwordx4 v48, s[12:15], s44 offen lds
buffer_load_dwordx4 v49, s[12:15], s44 offen offset:1024 lds
buffer_load_dwordx4 v50, s[12:15], s44 offen offset:2048 lds
s_add_u32 m0, s43, 36864
s_add_u32 s44, s40, 331776
buffer_load_dwordx4 v48, s[12:15], s44 offen lds
buffer_load_dwordx4 v49, s[12:15], s44 offen offset:1024 lds
buffer_load_dwordx4 v50, s[12:15], s44 offen offset:2048 lds
s_add_u32 m0, s43, 49152
s_add_u32 s44, s40, 663552
buffer_load_dwordx4 v48, s[12:15], s44 offen lds
buffer_load_dwordx4 v49, s[12:15], s44 offen offset:1024 lds
buffer_load_dwordx4 v50, s[12:15], s44 offen offset:2048 lds
s_waitcnt vmcnt(16)
v_cmp_ne_u32 vcc, s100, v53
s_mov_b32 s56, 0x40000
s_nop 3
s_cbranch_vccz FCD_8
FC_8:
global_load_dword v53, v52, s[6:7] sc1
s_waitcnt vmcnt(0)
v_cmp_ne_u32 vcc, s100, v53
s_sub_u32 s56, s56, 1
s_cmp_eq_u32 s56, 0
s_cbranch_scc1 FCD_8
s_nop 1
s_cbranch_vccnz FC_8
FCD_8:
s_add_u32 s45, s41, 0
buffer_load_dwordx4 v[192:195], v15, s[16:19], s45 offen sc1
buffer_load_dwordx4 v[196:199], v51, s[16:19], s45 offen sc1
s_add_u32 s45, s41, 1024
buffer_load_dwordx4 v[200:203], v15, s[16:19], s45 offen sc1
buffer_load_dwordx4 v[204:207], v51, s[16:19], s45 offen sc1
s_add_u32 s45, s41, 8192
buffer_load_dwordx4 v[208:211], v15, s[16:19], s45 offen sc1
buffer_load_dwordx4 v[212:215], v51, s[16:19], s45 offen sc1
s_add_u32 s45, s41, 9216
buffer_load_dwordx4 v[216:219], v15, s[16:19], s45 offen sc1
buffer_load_dwordx4 v[220:223], v51, s[16:19], s45 offen sc1
s_add_u32 s45, s41, 18432
buffer_load_dwordx4 v[224:227], v15, s[16:19], s45 offen sc1
buffer_load_dwordx4 v[228:231], v51, s[16:19], s45 offen sc1
s_nop 7
v_mul_f32 v180, v180, v24
v_mul_f32 v181, v181, v25
v_mul_f32 v182, v182, v26
v_mul_f32 v183, v183, v27
v_cvt_pk_bf16_f32 v34, v180, v181
v_cvt_pk_bf16_f32 v35, v182, v183
s_add_u32 s55, s29, 6144
buffer_store_dwordx4 v[32:35], v15, s[16:19], s55 offen sc1
v_mul_f32 v20, s26, v136
v_mul_f32 v21, s26, v137
v_mul_f32 v22, s26, v138
v_mul_f32 v23, s26, v139
v_exp_f32 v20, v20
v_exp_f32 v21, v21
v_exp_f32 v22, v22
v_exp_f32 v23, v23
v_mul_f32 v168, v136, v168
v_mul_f32 v169, v137, v169
v_mul_f32 v170, v138, v170
v_mul_f32 v171, v139, v171
v_add_f32 v20, 1.0, v20
v_add_f32 v21, 1.0, v21
v_add_f32 v22, 1.0, v22
v_add_f32 v23, 1.0, v23
v_rcp_f32 v20, v20
v_rcp_f32 v21, v21
v_rcp_f32 v22, v22
v_rcp_f32 v23, v23
v_mul_f32 v168, v168, v20
v_mul_f32 v169, v169, v21
v_mul_f32 v170, v170, v22
v_mul_f32 v171, v171, v23
v_cvt_pk_bf16_f32 v28, v168, v169
v_cvt_pk_bf16_f32 v29, v170, v171
v_mul_f32 v24, s26, v152
v_mul_f32 v25, s26, v153
v_mul_f32 v26, s26, v154
v_mul_f32 v27, s26, v155
v_exp_f32 v24, v24
v_exp_f32 v25, v25
v_exp_f32 v26, v26
v_exp_f32 v27, v27
v_mul_f32 v184, v152, v184
v_mul_f32 v185, v153, v185
v_mul_f32 v186, v154, v186
v_mul_f32 v187, v155, v187
v_add_f32 v24, 1.0, v24
v_add_f32 v25, 1.0, v25
v_add_f32 v26, 1.0, v26
v_add_f32 v27, 1.0, v27
v_rcp_f32 v24, v24
v_rcp_f32 v25, v25
v_rcp_f32 v26, v26
v_rcp_f32 v27, v27
v_mul_f32 v184, v184, v24
v_mul_f32 v185, v185, v25
v_mul_f32 v186, v186, v26
v_mul_f32 v187, v187, v27
v_cvt_pk_bf16_f32 v30, v184, v185
v_cvt_pk_bf16_f32 v31, v186, v187
s_add_u32 s55, s30, 6144
buffer_store_dwordx4 v[28:31], v15, s[16:19], s55 offen sc1
v_mul_f32 v20, s26, v140
v_mul_f32 v21, s26, v141
v_mul_f32 v22, s26, v142
v_mul_f32 v23, s26, v143
v_exp_f32 v20, v20
v_exp_f32 v21, v21
v_exp_f32 v22, v22
v_exp_f32 v23, v23
v_mul_f32 v172, v140, v172
v_mul_f32 v173, v141, v173
v_mul_f32 v174, v142, v174
v_mul_f32 v175, v143, v175
v_add_f32 v20, 1.0, v20
v_add_f32 v21, 1.0, v21
v_add_f32 v22, 1.0, v22
v_add_f32 v23, 1.0, v23
v_rcp_f32 v20, v20
v_rcp_f32 v21, v21
v_rcp_f32 v22, v22
v_rcp_f32 v23, v23
v_mul_f32 v172, v172, v20
v_mul_f32 v173, v173, v21
v_mul_f32 v174, v174, v22
v_mul_f32 v175, v175, v23
v_cvt_pk_bf16_f32 v32, v172, v173
v_cvt_pk_bf16_f32 v33, v174, v175
v_mul_f32 v24, s26, v156
v_mul_f32 v25, s26, v157
v_mul_f32 v26, s26, v158
v_mul_f32 v27, s26, v159
v_exp_f32 v24, v24
v_exp_f32 v25, v25
v_exp_f32 v26, v26
v_exp_f32 v27, v27
v_mul_f32 v188, v156, v188
v_mul_f32 v189, v157, v189
v_mul_f32 v190, v158, v190
v_mul_f32 v191, v159, v191
v_add_f32 v24, 1.0, v24
v_add_f32 v25, 1.0, v25
v_add_f32 v26, 1.0, v26
v_add_f32 v27, 1.0, v27
v_rcp_f32 v24, v24
v_rcp_f32 v25, v25
v_rcp_f32 v26, v26
v_rcp_f32 v27, v27
v_mul_f32 v188, v188, v24
v_mul_f32 v189, v189, v25
v_mul_f32 v190, v190, v26
v_mul_f32 v191, v191, v27
v_cvt_pk_bf16_f32 v34, v188, v189
v_cvt_pk_bf16_f32 v35, v190, v191
s_add_u32 s55, s31, 6144
buffer_store_dwordx4 v[32:35], v15, s[16:19], s55 offen sc1
v_mul_f32 v20, s26, v64
v_mul_f32 v21, s26, v65
v_mul_f32 v22, s26, v66
v_mul_f32 v23, s26, v67
v_exp_f32 v20, v20
v_exp_f32 v21, v21
v_exp_f32 v22, v22
v_exp_f32 v23, v23
v_mul_f32 v96, v64, v96
v_mul_f32 v97, v65, v97
v_mul_f32 v98, v66, v98
v_mul_f32 v99, v67, v99
v_add_f32 v20, 1.0, v20
v_add_f32 v21, 1.0, v21
v_add_f32 v22, 1.0, v22
v_add_f32 v23, 1.0, v23
v_rcp_f32 v20, v20
v_rcp_f32 v21, v21
v_rcp_f32 v22, v22
v_rcp_f32 v23, v23
v_mul_f32 v96, v96, v20
v_mul_f32 v97, v97, v21
v_mul_f32 v98, v98, v22
v_mul_f32 v99, v99, v23
v_cvt_pk_bf16_f32 v28, v96, v97
v_cvt_pk_bf16_f32 v29, v98, v99
v_mul_f32 v24, s26, v80
v_mul_f32 v25, s26, v81
v_mul_f32 v26, s26, v82
v_mul_f32 v27, s26, v83
v_exp_f32 v24, v24
v_exp_f32 v25, v25
v_exp_f32 v26, v26
v_exp_f32 v27, v27
v_mul_f32 v112, v80, v112
v_mul_f32 v113, v81, v113
v_mul_f32 v114, v82, v114
v_mul_f32 v115, v83, v115
v_add_f32 v24, 1.0, v24
v_add_f32 v25, 1.0, v25
v_add_f32 v26, 1.0, v26
v_add_f32 v27, 1.0, v27
v_rcp_f32 v24, v24
v_rcp_f32 v25, v25
v_rcp_f32 v26, v26
v_rcp_f32 v27, v27
v_mul_f32 v112, v112, v24
v_mul_f32 v113, v113, v25
v_mul_f32 v114, v114, v26
v_mul_f32 v115, v115, v27
v_cvt_pk_bf16_f32 v30, v112, v113
v_cvt_pk_bf16_f32 v31, v114, v115
buffer_store_dwordx4 v[28:31], v15, s[16:19], s23 offen sc1
v_mul_f32 v20, s26, v68
v_mul_f32 v21, s26, v69
v_mul_f32 v22, s26, v70
v_mul_f32 v23, s26, v71
v_exp_f32 v20, v20
v_exp_f32 v21, v21
v_exp_f32 v22, v22
v_exp_f32 v23, v23
v_mul_f32 v100, v68, v100
v_mul_f32 v101, v69, v101
v_mul_f32 v102, v70, v102
v_mul_f32 v103, v71, v103
v_add_f32 v20, 1.0, v20
v_add_f32 v21, 1.0, v21
v_add_f32 v22, 1.0, v22
v_add_f32 v23, 1.0, v23
v_rcp_f32 v20, v20
v_rcp_f32 v21, v21
v_rcp_f32 v22, v22
v_rcp_f32 v23, v23
v_mul_f32 v100, v100, v20
v_mul_f32 v101, v101, v21
v_mul_f32 v102, v102, v22
v_mul_f32 v103, v103, v23
v_cvt_pk_bf16_f32 v32, v100, v101
v_cvt_pk_bf16_f32 v33, v102, v103
v_mul_f32 v24, s26, v84
v_mul_f32 v25, s26, v85
v_mul_f32 v26, s26, v86
v_mul_f32 v27, s26, v87
v_exp_f32 v24, v24
v_exp_f32 v25, v25
v_exp_f32 v26, v26
v_exp_f32 v27, v27
v_mul_f32 v116, v84, v116
v_mul_f32 v117, v85, v117
v_mul_f32 v118, v86, v118
v_mul_f32 v119, v87, v119
v_add_f32 v24, 1.0, v24
v_add_f32 v25, 1.0, v25
v_add_f32 v26, 1.0, v26
v_add_f32 v27, 1.0, v27
v_rcp_f32 v24, v24
v_rcp_f32 v25, v25
v_rcp_f32 v26, v26
v_rcp_f32 v27, v27
v_mul_f32 v116, v116, v24
v_mul_f32 v117, v117, v25
v_mul_f32 v118, v118, v26
v_mul_f32 v119, v119, v27
v_cvt_pk_bf16_f32 v34, v116, v117
v_cvt_pk_bf16_f32 v35, v118, v119
buffer_store_dwordx4 v[32:35], v15, s[16:19], s24 offen sc1
s_waitcnt vmcnt(24)
s_barrier
ds_read_b64_tr_b16 v[160:161], v36 offset:0
ds_read_b64_tr_b16 v[162:163], v36 offset:6144
ds_read_b64_tr_b16 v[164:165], v39 offset:0
ds_read_b64_tr_b16 v[166:167], v39 offset:6144
ds_read_b64_tr_b16 v[168:169], v42 offset:0
ds_read_b64_tr_b16 v[170:171], v42 offset:6144
ds_read_b64_tr_b16 v[172:173], v45 offset:0
ds_read_b64_tr_b16 v[174:175], v45 offset:6144
s_waitcnt lgkmcnt(6)
s_waitcnt vmcnt(14)
v_mfma_f32_16x16x32_bf16 v[64:67], v[160:163], v[192:195], 0
s_add_u32 m0, s43, 61440
s_add_u32 s44, s40, 700416
ds_read_b64_tr_b16 v[176:177], v36 offset:1024
s_waitcnt vmcnt(13)
v_mfma_f32_16x16x32_bf16 v[68:71], v[160:163], v[196:199], 0
ds_read_b64_tr_b16 v[178:179], v36 offset:7168
s_waitcnt lgkmcnt(6)
v_mfma_f32_16x16x32_bf16 v[72:75], v[164:167], v[192:195], 0
buffer_load_dwordx4 v48, s[12:15], s44 offen lds
v_mfma_f32_16x16x32_bf16 v[76:79], v[164:167], v[196:199], 0
ds_read_b64_tr_b16 v[160:161], v39 offset:1024
ds_read_b64_tr_b16 v[162:163], v39 offset:7168
s_waitcnt lgkmcnt(6)
v_mfma_f32_16x16x32_bf16 v[80:83], v[168:171], v[192:195], 0
buffer_load_dwordx4 v49, s[12:15], s44 offen offset:1024 lds
v_mfma_f32_16x16x32_bf16 v[84:87], v[168:171], v[196:199], 0
ds_read_b64_tr_b16 v[164:165], v42 offset:1024
ds_read_b64_tr_b16 v[166:167], v42 offset:7168
s_waitcnt lgkmcnt(6)
v_mfma_f32_16x16x32_bf16 v[88:91], v[172:175], v[192:195], 0
buffer_load_dwordx4 v50, s[12:15], s44 offen offset:2048 lds
v_mfma_f32_16x16x32_bf16 v[92:95], v[172:175], v[196:199], 0
ds_read_b64_tr_b16 v[168:169], v45 offset:1024
ds_read_b64_tr_b16 v[170:171], v45 offset:7168
s_waitcnt lgkmcnt(6)
v_mfma_f32_16x16x32_bf16 v[96:99], v[176:179], v[192:195], 0
s_add_u32 m0, s43, 73728
s_add_u32 s44, s40, 958464
ds_read_b64_tr_b16 v[172:173], v36 offset:2048
v_mfma_f32_16x16x32_bf16 v[100:103], v[176:179], v[196:199], 0
ds_read_b64_tr_b16 v[174:175], v36 offset:8192
s_waitcnt lgkmcnt(6)
v_mfma_f32_16x16x32_bf16 v[104:107], v[160:163], v[192:195], 0
buffer_load_dwordx4 v48, s[12:15], s44 offen lds
v_mfma_f32_16x16x32_bf16 v[108:111], v[160:163], v[196:199], 0
ds_read_b64_tr_b16 v[176:177], v39 offset:2048
ds_read_b64_tr_b16 v[178:179], v39 offset:8192
s_waitcnt lgkmcnt(6)
v_mfma_f32_16x16x32_bf16 v[112:115], v[164:167], v[192:195], 0
buffer_load_dwordx4 v49, s[12:15], s44 offen offset:1024 lds
v_mfma_f32_16x16x32_bf16 v[116:119], v[164:167], v[196:199], 0
ds_read_b64_tr_b16 v[160:161], v42 offset:2048
ds_read_b64_tr_b16 v[162:163], v42 offset:8192
s_waitcnt lgkmcnt(6)
v_mfma_f32_16x16x32_bf16 v[120:123], v[168:171], v[192:195], 0
buffer_load_dwordx4 v50, s[12:15], s44 offen offset:2048 lds
v_mfma_f32_16x16x32_bf16 v[124:127], v[168:171], v[196:199], 0
ds_read_b64_tr_b16 v[164:165], v45 offset:2048
ds_read_b64_tr_b16 v[166:167], v45 offset:8192
s_waitcnt lgkmcnt(6)
v_mfma_f32_16x16x32_bf16 v[128:131], v[172:175], v[192:195], 0
ds_read_b64_tr_b16 v[168:169], v36 offset:12288
v_mfma_f32_16x16x32_bf16 v[132:135], v[172:175], v[196:199], 0
ds_read_b64_tr_b16 v[170:171], v36 offset:18432
s_waitcnt lgkmcnt(6)
v_mfma_f32_16x16x32_bf16 v[136:139], v[176:179], v[192:195], 0
ds_read_b64_tr_b16 v[172:173], v39 offset:12288
v_mfma_f32_16x16x32_bf16 v[140:143], v[176:179], v[196:199], 0
ds_read_b64_tr_b16 v[174:175], v39 offset:18432
s_waitcnt lgkmcnt(6)
v_mfma_f32_16x16x32_bf16 v[144:147], v[160:163], v[192:195], 0
ds_read_b64_tr_b16 v[176:177], v42 offset:12288
v_mfma_f32_16x16x32_bf16 v[148:151], v[160:163], v[196:199], 0
ds_read_b64_tr_b16 v[178:179], v42 offset:18432
s_waitcnt lgkmcnt(6)
v_mfma_f32_16x16x32_bf16 v[152:155], v[164:167], v[192:195], 0
ds_read_b64_tr_b16 v[160:161], v45 offset:12288
v_mfma_f32_16x16x32_bf16 v[156:159], v[164:167], v[196:199], 0
ds_read_b64_tr_b16 v[162:163], v45 offset:18432
s_barrier
s_waitcnt lgkmcnt(6)
s_waitcnt vmcnt(18)
v_mfma_f32_16x16x32_bf16 v[64:67], v[168:171], v[200:203], v[64:67]
s_add_u32 m0, s43, 86016
s_add_u32 s44, s40, 995328
ds_read_b64_tr_b16 v[164:165], v36 offset:13312
s_waitcnt vmcnt(17)
v_mfma_f32_16x16x32_bf16 v[68:71], v[168:171], v[204:207], v[68:71]
ds_read_b64_tr_b16 v[166:167], v36 offset:19456
s_waitcnt lgkmcnt(6)
v_mfma_f32_16x16x32_bf16 v[72:75], v[172:175], v[200:203], v[72:75]
buffer_load_dwordx4 v48, s[12:15], s44 offen lds
v_mfma_f32_16x16x32_bf16 v[76:79], v[172:175], v[204:207], v[76:79]
ds_read_b64_tr_b16 v[168:169], v39 offset:13312
ds_read_b64_tr_b16 v[170:171], v39 offset:19456
s_waitcnt lgkmcnt(6)
v_mfma_f32_16x16x32_bf16 v[80:83], v[176:179], v[200:203], v[80:83]
buffer_load_dwordx4 v49, s[12:15], s44 offen offset:1024 lds
v_mfma_f32_16x16x32_bf16 v[84:87], v[176:179], v[204:207], v[84:87]
ds_read_b64_tr_b16 v[172:173], v42 offset:13312
ds_read_b64_tr_b16 v[174:175], v42 offset:19456
s_waitcnt lgkmcnt(6)
v_mfma_f32_16x16x32_bf16 v[88:91], v[160:163], v[200:203], v[88:91]
buffer_load_dwordx4 v50, s[12:15], s44 offen offset:2048 lds
v_mfma_f32_16x16x32_bf16 v[92:95], v[160:163], v[204:207], v[92:95]
ds_read_b64_tr_b16 v[176:177], v45 offset:13312
ds_read_b64_tr_b16 v[178:179], v45 offset:19456
s_waitcnt lgkmcnt(6)
v_mfma_f32_16x16x32_bf16 v[96:99], v[164:167], v[200:203], v[96:99]
s_add_u32 m0, s43, 98304
s_add_u32 s44, s40, 73728
ds_read_b64_tr_b16 v[160:161], v36 offset:14336
v_mfma_f32_16x16x32_bf16 v[100:103], v[164:167], v[204:207], v[100:103]
ds_read_b64_tr_b16 v[162:163], v36 offset:20480
s_waitcnt lgkmcnt(6)
v_mfma_f32_16x16x32_bf16 v[104:107], v[168:171], v[200:203], v[104:107]
buffer_load_dwordx4 v48, s[12:15], s44 offen lds
v_mfma_f32_16x16x32_bf16 v[108:111], v[168:171], v[204:207], v[108:111]
ds_read_b64_tr_b16 v[164:165], v39 offset:14336
ds_read_b64_tr_b16 v[166:167], v39 offset:20480
s_waitcnt lgkmcnt(6)
v_mfma_f32_16x16x32_bf16 v[112:115], v[172:175], v[200:203], v[112:115]
buffer_load_dwordx4 v49, s[12:15], s44 offen offset:1024 lds
v_mfma_f32_16x16x32_bf16 v[116:119], v[172:175], v[204:207], v[116:119]
ds_read_b64_tr_b16 v[168:169], v42 offset:14336
ds_read_b64_tr_b16 v[170:171], v42 offset:20480
s_waitcnt lgkmcnt(6)
v_mfma_f32_16x16x32_bf16 v[120:123], v[176:179], v[200:203], v[120:123]
buffer_load_dwordx4 v50, s[12:15], s44 offen offset:2048 lds
v_mfma_f32_16x16x32_bf16 v[124:127], v[176:179], v[204:207], v[124:127]
ds_read_b64_tr_b16 v[172:173], v45 offset:14336
ds_read_b64_tr_b16 v[174:175], v45 offset:20480
s_waitcnt lgkmcnt(6)
v_mfma_f32_16x16x32_bf16 v[128:131], v[160:163], v[200:203], v[128:131]
s_add_u32 s45, s41, 19456
ds_read_b64_tr_b16 v[176:177], v36 offset:24576
v_mfma_f32_16x16x32_bf16 v[132:135], v[160:163], v[204:207], v[132:135]
ds_read_b64_tr_b16 v[178:179], v36 offset:30720
s_waitcnt lgkmcnt(6)
v_mfma_f32_16x16x32_bf16 v[136:139], v[164:167], v[200:203], v[136:139]
buffer_load_dwordx4 v[192:195], v15, s[16:19], s45 offen sc1
v_mfma_f32_16x16x32_bf16 v[140:143], v[164:167], v[204:207], v[140:143]
ds_read_b64_tr_b16 v[160:161], v39 offset:24576
ds_read_b64_tr_b16 v[162:163], v39 offset:30720
s_waitcnt lgkmcnt(6)
v_mfma_f32_16x16x32_bf16 v[144:147], v[168:171], v[200:203], v[144:147]
buffer_load_dwordx4 v[196:199], v51, s[16:19], s45 offen sc1
v_mfma_f32_16x16x32_bf16 v[148:151], v[168:171], v[204:207], v[148:151]
ds_read_b64_tr_b16 v[164:165], v42 offset:24576
ds_read_b64_tr_b16 v[166:167], v42 offset:30720
s_waitcnt lgkmcnt(6)
v_mfma_f32_16x16x32_bf16 v[152:155], v[172:175], v[200:203], v[152:155]
ds_read_b64_tr_b16 v[168:169], v45 offset:24576
v_and_b32 v21, 63, v0
s_mov_b32 s24, s92
s_mov_b32 s25, s93
s_mov_b32 s26, 2359296
s_mov_b32 s27, 0x00020000
s_mov_b32 s20, s94
s_mov_b32 s21, s95
s_mov_b32 s22, 2359296
s_mov_b32 s23, 0x00020000
v_and_b32 v22, 15, v21
v_mfma_f32_16x16x32_bf16 v[156:159], v[172:175], v[204:207], v[156:159]
ds_read_b64_tr_b16 v[170:171], v45 offset:30720
s_waitcnt lgkmcnt(6)
s_waitcnt vmcnt(24)
v_mfma_f32_16x16x32_bf16 v[64:67], v[176:179], v[208:211], v[64:67]
s_add_u32 m0, s43, 110592
s_add_u32 s44, s40, 110592
ds_read_b64_tr_b16 v[172:173], v36 offset:25600
s_waitcnt vmcnt(23)
v_mfma_f32_16x16x32_bf16 v[68:71], v[176:179], v[212:215], v[68:71]
ds_read_b64_tr_b16 v[174:175], v36 offset:31744
s_waitcnt lgkmcnt(6)
v_mfma_f32_16x16x32_bf16 v[72:75], v[160:163], v[208:211], v[72:75]
buffer_load_dwordx4 v48, s[12:15], s44 offen lds
v_mfma_f32_16x16x32_bf16 v[76:79], v[160:163], v[212:215], v[76:79]
ds_read_b64_tr_b16 v[176:177], v39 offset:25600
ds_read_b64_tr_b16 v[178:179], v39 offset:31744
s_waitcnt lgkmcnt(6)
v_mfma_f32_16x16x32_bf16 v[80:83], v[164:167], v[208:211], v[80:83]
buffer_load_dwordx4 v49, s[12:15], s44 offen offset:1024 lds
v_mfma_f32_16x16x32_bf16 v[84:87], v[164:167], v[212:215], v[84:87]
ds_read_b64_tr_b16 v[160:161], v42 offset:25600
ds_read_b64_tr_b16 v[162:163], v42 offset:31744
s_waitcnt lgkmcnt(6)
v_mfma_f32_16x16x32_bf16 v[88:91], v[168:171], v[208:211], v[88:91]
buffer_load_dwordx4 v50, s[12:15], s44 offen offset:2048 lds
v_mfma_f32_16x16x32_bf16 v[92:95], v[168:171], v[212:215], v[92:95]
ds_read_b64_tr_b16 v[164:165], v45 offset:25600
ds_read_b64_tr_b16 v[166:167], v45 offset:31744
s_waitcnt lgkmcnt(6)
v_mfma_f32_16x16x32_bf16 v[96:99], v[172:175], v[208:211], v[96:99]
s_add_u32 m0, s43, 122880
s_add_u32 s44, s40, 368640
ds_read_b64_tr_b16 v[168:169], v36 offset:26624
v_mfma_f32_16x16x32_bf16 v[100:103], v[172:175], v[212:215], v[100:103]
ds_read_b64_tr_b16 v[170:171], v36 offset:32768
s_waitcnt lgkmcnt(6)
v_mfma_f32_16x16x32_bf16 v[104:107], v[176:179], v[208:211], v[104:107]
buffer_load_dwordx4 v48, s[12:15], s44 offen lds
v_mfma_f32_16x16x32_bf16 v[108:111], v[176:179], v[212:215], v[108:111]
ds_read_b64_tr_b16 v[172:173], v39 offset:26624
ds_read_b64_tr_b16 v[174:175], v39 offset:32768
s_waitcnt lgkmcnt(6)
v_mfma_f32_16x16x32_bf16 v[112:115], v[160:163], v[208:211], v[112:115]
buffer_load_dwordx4 v49, s[12:15], s44 offen offset:1024 lds
v_mfma_f32_16x16x32_bf16 v[116:119], v[160:163], v[212:215], v[116:119]
ds_read_b64_tr_b16 v[176:177], v42 offset:26624
ds_read_b64_tr_b16 v[178:179], v42 offset:32768
s_waitcnt lgkmcnt(6)
v_mfma_f32_16x16x32_bf16 v[120:123], v[164:167], v[208:211], v[120:123]
buffer_load_dwordx4 v50, s[12:15], s44 offen offset:2048 lds
v_mfma_f32_16x16x32_bf16 v[124:127], v[164:167], v[212:215], v[124:127]
ds_read_b64_tr_b16 v[160:161], v45 offset:26624
ds_read_b64_tr_b16 v[162:163], v45 offset:32768
s_waitcnt lgkmcnt(6)
v_mfma_f32_16x16x32_bf16 v[128:131], v[168:171], v[208:211], v[128:131]
s_add_u32 s45, s41, 26624
ds_read_b64_tr_b16 v[164:165], v36 offset:36864
v_mfma_f32_16x16x32_bf16 v[132:135], v[168:171], v[212:215], v[132:135]
ds_read_b64_tr_b16 v[166:167], v36 offset:43008
s_waitcnt lgkmcnt(6)
v_mfma_f32_16x16x32_bf16 v[136:139], v[172:175], v[208:211], v[136:139]
buffer_load_dwordx4 v[200:203], v15, s[16:19], s45 offen sc1
v_mfma_f32_16x16x32_bf16 v[140:143], v[172:175], v[212:215], v[140:143]
ds_read_b64_tr_b16 v[168:169], v39 offset:36864
ds_read_b64_tr_b16 v[170:171], v39 offset:43008
s_waitcnt lgkmcnt(6)
v_mfma_f32_16x16x32_bf16 v[144:147], v[176:179], v[208:211], v[144:147]
buffer_load_dwordx4 v[204:207], v51, s[16:19], s45 offen sc1
v_mfma_f32_16x16x32_bf16 v[148:151], v[176:179], v[212:215], v[148:151]
ds_read_b64_tr_b16 v[172:173], v42 offset:36864
ds_read_b64_tr_b16 v[174:175], v42 offset:43008
s_waitcnt lgkmcnt(6)
v_mfma_f32_16x16x32_bf16 v[152:155], v[160:163], v[208:211], v[152:155]
ds_read_b64_tr_b16 v[176:177], v45 offset:36864
v_mul_u32_u24 v23, 1152, v22
v_bfe_u32 v24, v21, 4, 1
v_lshl_add_u32 v23, v24, 5, v23
v_lshrrev_b32 v24, 5, v21
v_lshl_add_u32 v23, v24, 4, v23
s_lshl_b32 s36, s34, 3
s_lshl_b32 s37, s33, 1
s_add_u32 s36, s36, s37
s_mul_i32 s37, s36, 16*1152
s_mul_i32 s38, s35, 384
v_mfma_f32_16x16x32_bf16 v[156:159], v[160:163], v[212:215], v[156:159]
ds_read_b64_tr_b16 v[178:179], v45 offset:43008
s_waitcnt lgkmcnt(6)
s_waitcnt vmcnt(30)
v_mfma_f32_16x16x32_bf16 v[64:67], v[164:167], v[216:219], v[64:67]
s_add_u32 m0, s43, 135168
s_add_u32 s44, s40, 405504
ds_read_b64_tr_b16 v[160:161], v36 offset:37888
s_waitcnt vmcnt(29)
v_mfma_f32_16x16x32_bf16 v[68:71], v[164:167], v[220:223], v[68:71]
ds_read_b64_tr_b16 v[162:163], v36 offset:44032
s_waitcnt lgkmcnt(6)
v_mfma_f32_16x16x32_bf16 v[72:75], v[168:171], v[216:219], v[72:75]
buffer_load_dwordx4 v48, s[12:15], s44 offen lds
v_mfma_f32_16x16x32_bf16 v[76:79], v[168:171], v[220:223], v[76:79]
ds_read_b64_tr_b16 v[164:165], v39 offset:37888
ds_read_b64_tr_b16 v[166:167], v39 offset:44032
s_waitcnt lgkmcnt(6)
v_mfma_f32_16x16x32_bf16 v[80:83], v[172:175], v[216:219], v[80:83]
buffer_load_dwordx4 v49, s[12:15], s44 offen offset:1024 lds
v_mfma_f32_16x16x32_bf16 v[84:87], v[172:175], v[220:223], v[84:87]
ds_read_b64_tr_b16 v[168:169], v42 offset:37888
ds_read_b64_tr_b16 v[170:171], v42 offset:44032
s_waitcnt lgkmcnt(6)
v_mfma_f32_16x16x32_bf16 v[88:91], v[176:179], v[216:219], v[88:91]
buffer_load_dwordx4 v50, s[12:15], s44 offen offset:2048 lds
v_mfma_f32_16x16x32_bf16 v[92:95], v[176:179], v[220:223], v[92:95]
ds_read_b64_tr_b16 v[172:173], v45 offset:37888
ds_read_b64_tr_b16 v[174:175], v45 offset:44032
s_waitcnt lgkmcnt(6)
v_mfma_f32_16x16x32_bf16 v[96:99], v[160:163], v[216:219], v[96:99]
s_add_u32 s45, s41, 27648
ds_read_b64_tr_b16 v[176:177], v36 offset:38912
v_mfma_f32_16x16x32_bf16 v[100:103], v[160:163], v[220:223], v[100:103]
ds_read_b64_tr_b16 v[178:179], v36 offset:45056
s_waitcnt lgkmcnt(6)
v_mfma_f32_16x16x32_bf16 v[104:107], v[164:167], v[216:219], v[104:107]
buffer_load_dwordx4 v[208:211], v15, s[16:19], s45 offen sc1
v_mfma_f32_16x16x32_bf16 v[108:111], v[164:167], v[220:223], v[108:111]
ds_read_b64_tr_b16 v[160:161], v39 offset:38912
ds_read_b64_tr_b16 v[162:163], v39 offset:45056
s_waitcnt lgkmcnt(6)
v_mfma_f32_16x16x32_bf16 v[112:115], v[168:171], v[216:219], v[112:115]
buffer_load_dwordx4 v[212:215], v51, s[16:19], s45 offen sc1
v_mfma_f32_16x16x32_bf16 v[116:119], v[168:171], v[220:223], v[116:119]
ds_read_b64_tr_b16 v[164:165], v42 offset:38912
ds_read_b64_tr_b16 v[166:167], v42 offset:45056
s_waitcnt lgkmcnt(6)
v_mfma_f32_16x16x32_bf16 v[120:123], v[172:175], v[216:219], v[120:123]
ds_read_b64_tr_b16 v[168:169], v45 offset:38912
s_add_u32 s37, s37, s38
s_mul_i32 s38, s98, 3
v_mfma_f32_16x16x32_bf16 v[124:127], v[172:175], v[220:223], v[124:127]
ds_read_b64_tr_b16 v[170:171], v45 offset:45056
s_waitcnt lgkmcnt(6)
v_mfma_f32_16x16x32_bf16 v[128:131], v[176:179], v[216:219], v[128:131]
ds_read_b64_tr_b16 v[172:173], v36 offset:49152
s_add_u32 s38, s38, 0
s_and_b32 s39, s38, 1
v_mfma_f32_16x16x32_bf16 v[132:135], v[176:179], v[220:223], v[132:135]
ds_read_b64_tr_b16 v[174:175], v36 offset:55296
s_waitcnt lgkmcnt(6)
v_mfma_f32_16x16x32_bf16 v[136:139], v[160:163], v[216:219], v[136:139]
ds_read_b64_tr_b16 v[176:177], v39 offset:49152
s_lshr_b32 s38, s38, 1
s_mul_i32 s50, s39, 16*1152
v_mfma_f32_16x16x32_bf16 v[140:143], v[160:163], v[220:223], v[140:143]
ds_read_b64_tr_b16 v[178:179], v39 offset:55296
s_waitcnt lgkmcnt(6)
v_mfma_f32_16x16x32_bf16 v[144:147], v[164:167], v[216:219], v[144:147]
ds_read_b64_tr_b16 v[160:161], v42 offset:49152
s_lshl_b32 s47, s38, 6
s_add_u32 s50, s50, s47
v_mfma_f32_16x16x32_bf16 v[148:151], v[164:167], v[220:223], v[148:151]
ds_read_b64_tr_b16 v[162:163], v42 offset:55296
s_waitcnt lgkmcnt(6)
v_mfma_f32_16x16x32_bf16 v[152:155], v[168:171], v[216:219], v[152:155]
ds_read_b64_tr_b16 v[164:165], v45 offset:49152
s_add_u32 s50, s50, s37
v_add_u32 v24, s50, v23
v_mfma_f32_16x16x32_bf16 v[156:159], v[168:171], v[220:223], v[156:159]
ds_read_b64_tr_b16 v[166:167], v45 offset:55296
s_waitcnt vmcnt(15)
s_barrier
s_cmp_lg_u32 s98, 0
s_cbranch_scc1 SIG_9
s_lshl_b32 s56, s2, 7
s_add_u32 s56, s56, 40894472
v_mov_b32 v60, s56
v_mov_b32 v61, s100
s_mov_b64 exec, 1
global_store_dword v60, v61, s[6:7] sc1
s_mov_b64 exec, -1
SIG_9:
s_waitcnt lgkmcnt(6)
v_mfma_f32_16x16x32_bf16 v[64:67], v[172:175], v[224:227], v[64:67]
s_add_u32 m0, s43, 147456
s_add_u32 s44, s40, 737280
ds_read_b64_tr_b16 v[168:169], v36 offset:50176
v_mfma_f32_16x16x32_bf16 v[68:71], v[172:175], v[228:231], v[68:71]
ds_read_b64_tr_b16 v[170:171], v36 offset:56320
s_waitcnt lgkmcnt(6)
v_mfma_f32_16x16x32_bf16 v[72:75], v[176:179], v[224:227], v[72:75]
buffer_load_dwordx4 v48, s[12:15], s44 offen lds
v_mfma_f32_16x16x32_bf16 v[76:79], v[176:179], v[228:231], v[76:79]
ds_read_b64_tr_b16 v[172:173], v39 offset:50176
ds_read_b64_tr_b16 v[174:175], v39 offset:56320
s_waitcnt lgkmcnt(6)
v_mfma_f32_16x16x32_bf16 v[80:83], v[160:163], v[224:227], v[80:83]
buffer_load_dwordx4 v49, s[12:15], s44 offen offset:1024 lds
v_mfma_f32_16x16x32_bf16 v[84:87], v[160:163], v[228:231], v[84:87]
ds_read_b64_tr_b16 v[176:177], v42 offset:50176
ds_read_b64_tr_b16 v[178:179], v42 offset:56320
s_waitcnt lgkmcnt(6)
v_mfma_f32_16x16x32_bf16 v[88:91], v[164:167], v[224:227], v[88:91]
buffer_load_dwordx4 v50, s[12:15], s44 offen offset:2048 lds
v_mfma_f32_16x16x32_bf16 v[92:95], v[164:167], v[228:231], v[92:95]
ds_read_b64_tr_b16 v[160:161], v45 offset:50176
ds_read_b64_tr_b16 v[162:163], v45 offset:56320
s_waitcnt lgkmcnt(6)
v_mfma_f32_16x16x32_bf16 v[96:99], v[168:171], v[224:227], v[96:99]
s_add_u32 s45, s41, 2048
ds_read_b64_tr_b16 v[164:165], v36 offset:51200
v_mfma_f32_16x16x32_bf16 v[100:103], v[168:171], v[228:231], v[100:103]
ds_read_b64_tr_b16 v[166:167], v36 offset:57344
s_waitcnt lgkmcnt(6)
v_mfma_f32_16x16x32_bf16 v[104:107], v[172:175], v[224:227], v[104:107]
buffer_load_dwordx4 v[216:219], v15, s[16:19], s45 offen sc1
v_mfma_f32_16x16x32_bf16 v[108:111], v[172:175], v[228:231], v[108:111]
ds_read_b64_tr_b16 v[168:169], v39 offset:51200
ds_read_b64_tr_b16 v[170:171], v39 offset:57344
s_waitcnt lgkmcnt(6)
v_mfma_f32_16x16x32_bf16 v[112:115], v[176:179], v[224:227], v[112:115]
buffer_load_dwordx4 v[220:223], v51, s[16:19], s45 offen sc1
v_mfma_f32_16x16x32_bf16 v[116:119], v[176:179], v[228:231], v[116:119]
ds_read_b64_tr_b16 v[172:173], v42 offset:51200
ds_read_b64_tr_b16 v[174:175], v42 offset:57344
s_waitcnt lgkmcnt(6)
v_mfma_f32_16x16x32_bf16 v[120:123], v[160:163], v[224:227], v[120:123]
buffer_load_dwordx4 v[180:183], v24, s[24:27], 0 offen
v_mfma_f32_16x16x32_bf16 v[124:127], v[160:163], v[228:231], v[124:127]
ds_read_b64_tr_b16 v[176:177], v45 offset:51200
ds_read_b64_tr_b16 v[178:179], v45 offset:57344
s_waitcnt lgkmcnt(6)
v_mfma_f32_16x16x32_bf16 v[128:131], v[164:167], v[224:227], v[128:131]
ds_read_b64_tr_b16 v[160:161], v37 offset:0
v_mfma_f32_16x16x32_bf16 v[132:135], v[164:167], v[228:231], v[132:135]
ds_read_b64_tr_b16 v[162:163], v37 offset:6144
s_waitcnt lgkmcnt(6)
v_mfma_f32_16x16x32_bf16 v[136:139], v[168:171], v[224:227], v[136:139]
ds_read_b64_tr_b16 v[164:165], v40 offset:0
v_mfma_f32_16x16x32_bf16 v[140:143], v[168:171], v[228:231], v[140:143]
ds_read_b64_tr_b16 v[166:167], v40 offset:6144
s_waitcnt lgkmcnt(6)
v_mfma_f32_16x16x32_bf16 v[144:147], v[172:175], v[224:227], v[144:147]
ds_read_b64_tr_b16 v[168:169], v43 offset:0
v_mfma_f32_16x16x32_bf16 v[148:151], v[172:175], v[228:231], v[148:151]
ds_read_b64_tr_b16 v[170:171], v43 offset:6144
s_waitcnt lgkmcnt(6)
v_mfma_f32_16x16x32_bf16 v[152:155], v[176:179], v[224:227], v[152:155]
ds_read_b64_tr_b16 v[172:173], v46 offset:0
v_mfma_f32_16x16x32_bf16 v[156:159], v[176:179], v[228:231], v[156:159]
ds_read_b64_tr_b16 v[174:175], v46 offset:6144
s_waitcnt lgkmcnt(6)
s_waitcnt vmcnt(20)
v_mfma_f32_16x16x32_bf16 v[64:67], v[160:163], v[192:195], v[64:67]
s_add_u32 m0, s43, 0
s_add_u32 s44, s40, 774144
ds_read_b64_tr_b16 v[176:177], v37 offset:1024
s_waitcnt vmcnt(19)
v_mfma_f32_16x16x32_bf16 v[68:71], v[160:163], v[196:199], v[68:71]
ds_read_b64_tr_b16 v[178:179], v37 offset:7168
s_waitcnt lgkmcnt(6)
v_mfma_f32_16x16x32_bf16 v[72:75], v[164:167], v[192:195], v[72:75]
buffer_load_dwordx4 v48, s[12:15], s44 offen lds
v_mfma_f32_16x16x32_bf16 v[76:79], v[164:167], v[196:199], v[76:79]
ds_read_b64_tr_b16 v[160:161], v40 offset:1024
ds_read_b64_tr_b16 v[162:163], v40 offset:7168
s_waitcnt lgkmcnt(6)
v_mfma_f32_16x16x32_bf16 v[80:83], v[168:171], v[192:195], v[80:83]
buffer_load_dwordx4 v49, s[12:15], s44 offen offset:1024 lds
v_mfma_f32_16x16x32_bf16 v[84:87], v[168:171], v[196:199], v[84:87]
ds_read_b64_tr_b16 v[164:165], v43 offset:1024
ds_read_b64_tr_b16 v[166:167], v43 offset:7168
s_waitcnt lgkmcnt(6)
v_mfma_f32_16x16x32_bf16 v[88:91], v[172:175], v[192:195], v[88:91]
buffer_load_dwordx4 v50, s[12:15], s44 offen offset:2048 lds
v_mfma_f32_16x16x32_bf16 v[92:95], v[172:175], v[196:199], v[92:95]
ds_read_b64_tr_b16 v[168:169], v46 offset:1024
ds_read_b64_tr_b16 v[170:171], v46 offset:7168
s_waitcnt lgkmcnt(6)
v_mfma_f32_16x16x32_bf16 v[96:99], v[176:179], v[192:195], v[96:99]
s_add_u32 s45, s41, 3072
ds_read_b64_tr_b16 v[172:173], v37 offset:2048
v_mfma_f32_16x16x32_bf16 v[100:103], v[176:179], v[196:199], v[100:103]
ds_read_b64_tr_b16 v[174:175], v37 offset:8192
s_waitcnt lgkmcnt(6)
v_mfma_f32_16x16x32_bf16 v[104:107], v[160:163], v[192:195], v[104:107]
buffer_load_dwordx4 v[224:227], v15, s[16:19], s45 offen sc1
v_mfma_f32_16x16x32_bf16 v[108:111], v[160:163], v[196:199], v[108:111]
ds_read_b64_tr_b16 v[176:177], v40 offset:2048
ds_read_b64_tr_b16 v[178:179], v40 offset:8192
s_waitcnt lgkmcnt(6)
v_mfma_f32_16x16x32_bf16 v[112:115], v[164:167], v[192:195], v[112:115]
buffer_load_dwordx4 v[228:231], v51, s[16:19], s45 offen sc1
v_mfma_f32_16x16x32_bf16 v[116:119], v[164:167], v[196:199], v[116:119]
ds_read_b64_tr_b16 v[160:161], v43 offset:2048
ds_read_b64_tr_b16 v[162:163], v43 offset:8192
s_waitcnt lgkmcnt(6)
v_mfma_f32_16x16x32_bf16 v[120:123], v[168:171], v[192:195], v[120:123]
ds_read_b64_tr_b16 v[164:165], v46 offset:2048
s_add_u32 s47, s36, s39
s_mul_i32 s47, s47, 18
v_mfma_f32_16x16x32_bf16 v[124:127], v[168:171], v[196:199], v[124:127]
ds_read_b64_tr_b16 v[166:167], v46 offset:8192
s_waitcnt lgkmcnt(6)
v_mfma_f32_16x16x32_bf16 v[128:131], v[172:175], v[192:195], v[128:131]
ds_read_b64_tr_b16 v[168:169], v37 offset:12288
s_add_u32 s47, s47, s38
s_mul_i32 s48, s35, 6
v_mfma_f32_16x16x32_bf16 v[132:135], v[172:175], v[196:199], v[132:135]
ds_read_b64_tr_b16 v[170:171], v37 offset:18432
s_waitcnt lgkmcnt(6)
v_mfma_f32_16x16x32_bf16 v[136:139], v[176:179], v[192:195], v[136:139]
ds_read_b64_tr_b16 v[172:173], v40 offset:12288
s_add_u32 s47, s47, s48
s_lshl_b32 s28, s47, 10
v_mfma_f32_16x16x32_bf16 v[140:143], v[176:179], v[196:199], v[140:143]
ds_read_b64_tr_b16 v[174:175], v40 offset:18432
s_waitcnt lgkmcnt(6)
v_mfma_f32_16x16x32_bf16 v[144:147], v[160:163], v[192:195], v[144:147]
ds_read_b64_tr_b16 v[176:177], v43 offset:12288
s_lshl_b32 s47, s38, 11
s_lshl_b32 s48, s39, 5
v_mfma_f32_16x16x32_bf16 v[148:151], v[160:163], v[196:199], v[148:151]
ds_read_b64_tr_b16 v[178:179], v43 offset:18432
s_waitcnt lgkmcnt(6)
v_mfma_f32_16x16x32_bf16 v[152:155], v[164:167], v[192:195], v[152:155]
ds_read_b64_tr_b16 v[160:161], v46 offset:12288
s_add_u32 s47, s47, s48
s_mov_b32 s53, s47
v_mfma_f32_16x16x32_bf16 v[156:159], v[164:167], v[196:199], v[156:159]
ds_read_b64_tr_b16 v[162:163], v46 offset:18432
s_waitcnt lgkmcnt(6)
s_waitcnt vmcnt(17)
v_mfma_f32_16x16x32_bf16 v[64:67], v[168:171], v[200:203], v[64:67]
s_add_u32 m0, s43, 12288
s_add_u32 s44, s40, 1032192
ds_read_b64_tr_b16 v[164:165], v37 offset:13312
s_waitcnt vmcnt(16)
v_mfma_f32_16x16x32_bf16 v[68:71], v[168:171], v[204:207], v[68:71]
ds_read_b64_tr_b16 v[166:167], v37 offset:19456
s_waitcnt lgkmcnt(6)
v_mfma_f32_16x16x32_bf16 v[72:75], v[172:175], v[200:203], v[72:75]
buffer_load_dwordx4 v48, s[12:15], s44 offen lds
v_mfma_f32_16x16x32_bf16 v[76:79], v[172:175], v[204:207], v[76:79]
ds_read_b64_tr_b16 v[168:169], v40 offset:13312
ds_read_b64_tr_b16 v[170:171], v40 offset:19456
s_waitcnt lgkmcnt(6)
v_mfma_f32_16x16x32_bf16 v[80:83], v[176:179], v[200:203], v[80:83]
buffer_load_dwordx4 v49, s[12:15], s44 offen offset:1024 lds
v_mfma_f32_16x16x32_bf16 v[84:87], v[176:179], v[204:207], v[84:87]
ds_read_b64_tr_b16 v[172:173], v43 offset:13312
ds_read_b64_tr_b16 v[174:175], v43 offset:19456
s_waitcnt lgkmcnt(6)
v_mfma_f32_16x16x32_bf16 v[88:91], v[160:163], v[200:203], v[88:91]
buffer_load_dwordx4 v50, s[12:15], s44 offen offset:2048 lds
v_mfma_f32_16x16x32_bf16 v[92:95], v[160:163], v[204:207], v[92:95]
ds_read_b64_tr_b16 v[176:177], v46 offset:13312
ds_read_b64_tr_b16 v[178:179], v46 offset:19456
s_waitcnt lgkmcnt(6)
v_mfma_f32_16x16x32_bf16 v[96:99], v[164:167], v[200:203], v[96:99]
s_add_u32 s45, s41, 10240
ds_read_b64_tr_b16 v[160:161], v37 offset:14336
v_mfma_f32_16x16x32_bf16 v[100:103], v[164:167], v[204:207], v[100:103]
ds_read_b64_tr_b16 v[162:163], v37 offset:20480
s_waitcnt lgkmcnt(6)
v_mfma_f32_16x16x32_bf16 v[104:107], v[168:171], v[200:203], v[104:107]
buffer_load_dwordx4 v[192:195], v15, s[16:19], s45 offen sc1
v_mfma_f32_16x16x32_bf16 v[108:111], v[168:171], v[204:207], v[108:111]
ds_read_b64_tr_b16 v[164:165], v40 offset:14336
ds_read_b64_tr_b16 v[166:167], v40 offset:20480
s_waitcnt lgkmcnt(6)
v_mfma_f32_16x16x32_bf16 v[112:115], v[172:175], v[200:203], v[112:115]
buffer_load_dwordx4 v[196:199], v51, s[16:19], s45 offen sc1
v_mfma_f32_16x16x32_bf16 v[116:119], v[172:175], v[204:207], v[116:119]
ds_read_b64_tr_b16 v[168:169], v43 offset:14336
ds_read_b64_tr_b16 v[170:171], v43 offset:20480
s_waitcnt lgkmcnt(6)
v_mfma_f32_16x16x32_bf16 v[120:123], v[176:179], v[200:203], v[120:123]
ds_read_b64_tr_b16 v[172:173], v46 offset:14336
s_mul_i32 s38, s98, 3
s_add_u32 s38, s38, 1
v_mfma_f32_16x16x32_bf16 v[124:127], v[176:179], v[204:207], v[124:127]
ds_read_b64_tr_b16 v[174:175], v46 offset:20480
s_waitcnt lgkmcnt(6)
v_mfma_f32_16x16x32_bf16 v[128:131], v[160:163], v[200:203], v[128:131]
ds_read_b64_tr_b16 v[176:177], v37 offset:24576
s_and_b32 s39, s38, 1
s_lshr_b32 s38, s38, 1
v_mfma_f32_16x16x32_bf16 v[132:135], v[160:163], v[204:207], v[132:135]
ds_read_b64_tr_b16 v[178:179], v37 offset:30720
s_waitcnt lgkmcnt(6)
v_mfma_f32_16x16x32_bf16 v[136:139], v[164:167], v[200:203], v[136:139]
ds_read_b64_tr_b16 v[160:161], v40 offset:24576
s_mul_i32 s51, s39, 16*1152
s_lshl_b32 s47, s38, 6
v_mfma_f32_16x16x32_bf16 v[140:143], v[164:167], v[204:207], v[140:143]
ds_read_b64_tr_b16 v[162:163], v40 offset:30720
s_waitcnt lgkmcnt(6)
v_mfma_f32_16x16x32_bf16 v[144:147], v[168:171], v[200:203], v[144:147]
ds_read_b64_tr_b16 v[164:165], v43 offset:24576
s_add_u32 s51, s51, s47
s_add_u32 s51, s51, s37
v_mfma_f32_16x16x32_bf16 v[148:151], v[168:171], v[204:207], v[148:151]
ds_read_b64_tr_b16 v[166:167], v43 offset:30720
s_waitcnt lgkmcnt(6)
v_mfma_f32_16x16x32_bf16 v[152:155], v[172:175], v[200:203], v[152:155]
ds_read_b64_tr_b16 v[168:169], v46 offset:24576
v_add_u32 v25, s51, v23
v_mfma_f32_16x16x32_bf16 v[156:159], v[172:175], v[204:207], v[156:159]
ds_read_b64_tr_b16 v[170:171], v46 offset:30720
global_load_dword v55, v54, s[6:7] sc1
s_waitcnt lgkmcnt(6)
s_waitcnt vmcnt(18)
v_mfma_f32_16x16x32_bf16 v[64:67], v[176:179], v[208:211], v[64:67]
s_add_u32 m0, s43, 24576
s_add_u32 s44, s40, 1069056
ds_read_b64_tr_b16 v[172:173], v37 offset:25600
s_waitcnt vmcnt(17)
v_mfma_f32_16x16x32_bf16 v[68:71], v[176:179], v[212:215], v[68:71]
ds_read_b64_tr_b16 v[174:175], v37 offset:31744
s_waitcnt lgkmcnt(6)
v_mfma_f32_16x16x32_bf16 v[72:75], v[160:163], v[208:211], v[72:75]
buffer_load_dwordx4 v48, s[12:15], s44 offen lds
v_mfma_f32_16x16x32_bf16 v[76:79], v[160:163], v[212:215], v[76:79]
ds_read_b64_tr_b16 v[176:177], v40 offset:25600
ds_read_b64_tr_b16 v[178:179], v40 offset:31744
s_waitcnt lgkmcnt(6)
v_mfma_f32_16x16x32_bf16 v[80:83], v[164:167], v[208:211], v[80:83]
buffer_load_dwordx4 v49, s[12:15], s44 offen offset:1024 lds
v_mfma_f32_16x16x32_bf16 v[84:87], v[164:167], v[212:215], v[84:87]
ds_read_b64_tr_b16 v[160:161], v43 offset:25600
ds_read_b64_tr_b16 v[162:163], v43 offset:31744
s_waitcnt lgkmcnt(6)
v_mfma_f32_16x16x32_bf16 v[88:91], v[168:171], v[208:211], v[88:91]
buffer_load_dwordx4 v50, s[12:15], s44 offen offset:2048 lds
v_mfma_f32_16x16x32_bf16 v[92:95], v[168:171], v[212:215], v[92:95]
ds_read_b64_tr_b16 v[164:165], v46 offset:25600
ds_read_b64_tr_b16 v[166:167], v46 offset:31744
s_waitcnt lgkmcnt(6)
v_mfma_f32_16x16x32_bf16 v[96:99], v[172:175], v[208:211], v[96:99]
s_add_u32 s45, s41, 11264
ds_read_b64_tr_b16 v[168:169], v37 offset:26624
v_mfma_f32_16x16x32_bf16 v[100:103], v[172:175], v[212:215], v[100:103]
ds_read_b64_tr_b16 v[170:171], v37 offset:32768
s_waitcnt lgkmcnt(6)
v_mfma_f32_16x16x32_bf16 v[104:107], v[176:179], v[208:211], v[104:107]
buffer_load_dwordx4 v[200:203], v15, s[16:19], s45 offen sc1
v_mfma_f32_16x16x32_bf16 v[108:111], v[176:179], v[212:215], v[108:111]
ds_read_b64_tr_b16 v[172:173], v40 offset:26624
ds_read_b64_tr_b16 v[174:175], v40 offset:32768
s_waitcnt lgkmcnt(6)
v_mfma_f32_16x16x32_bf16 v[112:115], v[160:163], v[208:211], v[112:115]
buffer_load_dwordx4 v[204:207], v51, s[16:19], s45 offen sc1
v_mfma_f32_16x16x32_bf16 v[116:119], v[160:163], v[212:215], v[116:119]
ds_read_b64_tr_b16 v[176:177], v43 offset:26624
ds_read_b64_tr_b16 v[178:179], v43 offset:32768
s_waitcnt lgkmcnt(6)
v_mfma_f32_16x16x32_bf16 v[120:123], v[164:167], v[208:211], v[120:123]
buffer_load_dwordx4 v[184:187], v25, s[24:27], 0 offen
v_mfma_f32_16x16x32_bf16 v[124:127], v[164:167], v[212:215], v[124:127]
ds_read_b64_tr_b16 v[160:161], v46 offset:26624
ds_read_b64_tr_b16 v[162:163], v46 offset:32768
s_waitcnt lgkmcnt(6)
v_mfma_f32_16x16x32_bf16 v[128:131], v[168:171], v[208:211], v[128:131]
ds_read_b64_tr_b16 v[164:165], v37 offset:36864
v_mfma_f32_16x16x32_bf16 v[132:135], v[168:171], v[212:215], v[132:135]
ds_read_b64_tr_b16 v[166:167], v37 offset:43008
s_waitcnt lgkmcnt(6)
v_mfma_f32_16x16x32_bf16 v[136:139], v[172:175], v[208:211], v[136:139]
ds_read_b64_tr_b16 v[168:169], v40 offset:36864
v_mfma_f32_16x16x32_bf16 v[140:143], v[172:175], v[212:215], v[140:143]
ds_read_b64_tr_b16 v[170:171], v40 offset:43008
s_waitcnt lgkmcnt(6)
v_mfma_f32_16x16x32_bf16 v[144:147], v[176:179], v[208:211], v[144:147]
ds_read_b64_tr_b16 v[172:173], v43 offset:36864
v_mfma_f32_16x16x32_bf16 v[148:151], v[176:179], v[212:215], v[148:151]
ds_read_b64_tr_b16 v[174:175], v43 offset:43008
s_waitcnt lgkmcnt(6)
v_mfma_f32_16x16x32_bf16 v[152:155], v[160:163], v[208:211], v[152:155]
ds_read_b64_tr_b16 v[176:177], v46 offset:36864
v_mfma_f32_16x16x32_bf16 v[156:159], v[160:163], v[212:215], v[156:159]
ds_read_b64_tr_b16 v[178:179], v46 offset:43008
s_waitcnt vmcnt(20)
s_barrier
s_waitcnt lgkmcnt(6)
s_waitcnt vmcnt(19)
v_mfma_f32_16x16x32_bf16 v[64:67], v[164:167], v[216:219], v[64:67]
s_add_u32 m0, s43, 36864
s_add_u32 s44, s40, 147456
ds_read_b64_tr_b16 v[160:161], v37 offset:37888
s_waitcnt vmcnt(18)
v_mfma_f32_16x16x32_bf16 v[68:71], v[164:167], v[220:223], v[68:71]
ds_read_b64_tr_b16 v[162:163], v37 offset:44032
s_waitcnt lgkmcnt(6)
v_mfma_f32_16x16x32_bf16 v[72:75], v[168:171], v[216:219], v[72:75]
buffer_load_dwordx4 v48, s[12:15], s44 offen lds
v_mfma_f32_16x16x32_bf16 v[76:79], v[168:171], v[220:223], v[76:79]
ds_read_b64_tr_b16 v[164:165], v40 offset:37888
ds_read_b64_tr_b16 v[166:167], v40 offset:44032
s_waitcnt lgkmcnt(6)
v_mfma_f32_16x16x32_bf16 v[80:83], v[172:175], v[216:219], v[80:83]
buffer_load_dwordx4 v49, s[12:15], s44 offen offset:1024 lds
v_mfma_f32_16x16x32_bf16 v[84:87], v[172:175], v[220:223], v[84:87]
ds_read_b64_tr_b16 v[168:169], v43 offset:37888
ds_read_b64_tr_b16 v[170:171], v43 offset:44032
s_waitcnt lgkmcnt(6)
v_mfma_f32_16x16x32_bf16 v[88:91], v[176:179], v[216:219], v[88:91]
buffer_load_dwordx4 v50, s[12:15], s44 offen offset:2048 lds
v_mfma_f32_16x16x32_bf16 v[92:95], v[176:179], v[220:223], v[92:95]
ds_read_b64_tr_b16 v[172:173], v46 offset:37888
ds_read_b64_tr_b16 v[174:175], v46 offset:44032
s_waitcnt lgkmcnt(6)
v_mfma_f32_16x16x32_bf16 v[96:99], v[160:163], v[216:219], v[96:99]
s_add_u32 s45, s41, 20480
ds_read_b64_tr_b16 v[176:177], v37 offset:38912
v_mfma_f32_16x16x32_bf16 v[100:103], v[160:163], v[220:223], v[100:103]
ds_read_b64_tr_b16 v[178:179], v37 offset:45056
s_waitcnt lgkmcnt(6)
v_mfma_f32_16x16x32_bf16 v[104:107], v[164:167], v[216:219], v[104:107]
buffer_load_dwordx4 v[208:211], v15, s[16:19], s45 offen sc1
v_mfma_f32_16x16x32_bf16 v[108:111], v[164:167], v[220:223], v[108:111]
ds_read_b64_tr_b16 v[160:161], v40 offset:38912
ds_read_b64_tr_b16 v[162:163], v40 offset:45056
s_waitcnt lgkmcnt(6)
v_mfma_f32_16x16x32_bf16 v[112:115], v[168:171], v[216:219], v[112:115]
buffer_load_dwordx4 v[212:215], v51, s[16:19], s45 offen sc1
v_mfma_f32_16x16x32_bf16 v[116:119], v[168:171], v[220:223], v[116:119]
ds_read_b64_tr_b16 v[164:165], v43 offset:38912
ds_read_b64_tr_b16 v[166:167], v43 offset:45056
s_waitcnt lgkmcnt(6)
v_mfma_f32_16x16x32_bf16 v[120:123], v[172:175], v[216:219], v[120:123]
ds_read_b64_tr_b16 v[168:169], v46 offset:38912
s_add_u32 s47, s36, s39
s_mul_i32 s47, s47, 18
v_mfma_f32_16x16x32_bf16 v[124:127], v[172:175], v[220:223], v[124:127]
ds_read_b64_tr_b16 v[170:171], v46 offset:45056
s_waitcnt lgkmcnt(6)
v_mfma_f32_16x16x32_bf16 v[128:131], v[176:179], v[216:219], v[128:131]
ds_read_b64_tr_b16 v[172:173], v37 offset:49152
s_add_u32 s47, s47, s38
s_mul_i32 s48, s35, 6
v_mfma_f32_16x16x32_bf16 v[132:135], v[176:179], v[220:223], v[132:135]
ds_read_b64_tr_b16 v[174:175], v37 offset:55296
s_waitcnt lgkmcnt(6)
v_mfma_f32_16x16x32_bf16 v[136:139], v[160:163], v[216:219], v[136:139]
ds_read_b64_tr_b16 v[176:177], v40 offset:49152
s_add_u32 s47, s47, s48
s_lshl_b32 s29, s47, 10
v_mfma_f32_16x16x32_bf16 v[140:143], v[160:163], v[220:223], v[140:143]
ds_read_b64_tr_b16 v[178:179], v40 offset:55296
s_waitcnt lgkmcnt(6)
v_mfma_f32_16x16x32_bf16 v[144:147], v[164:167], v[216:219], v[144:147]
ds_read_b64_tr_b16 v[160:161], v43 offset:49152
s_lshl_b32 s47, s38, 11
s_lshl_b32 s48, s39, 5
v_mfma_f32_16x16x32_bf16 v[148:151], v[164:167], v[220:223], v[148:151]
ds_read_b64_tr_b16 v[162:163], v43 offset:55296
s_waitcnt lgkmcnt(6)
v_mfma_f32_16x16x32_bf16 v[152:155], v[168:171], v[216:219], v[152:155]
ds_read_b64_tr_b16 v[164:165], v46 offset:49152
s_add_u32 s47, s47, s48
s_mov_b32 s54, s47
v_mfma_f32_16x16x32_bf16 v[156:159], v[168:171], v[220:223], v[156:159]
ds_read_b64_tr_b16 v[166:167], v46 offset:55296
s_waitcnt lgkmcnt(6)
s_waitcnt vmcnt(18)
v_mfma_f32_16x16x32_bf16 v[64:67], v[172:175], v[224:227], v[64:67]
s_add_u32 m0, s43, 49152
s_add_u32 s44, s40, 184320
ds_read_b64_tr_b16 v[168:169], v37 offset:50176
s_waitcnt vmcnt(17)
v_mfma_f32_16x16x32_bf16 v[68:71], v[172:175], v[228:231], v[68:71]
ds_read_b64_tr_b16 v[170:171], v37 offset:56320
s_waitcnt lgkmcnt(6)
v_mfma_f32_16x16x32_bf16 v[72:75], v[176:179], v[224:227], v[72:75]
buffer_load_dwordx4 v48, s[12:15], s44 offen lds
v_mfma_f32_16x16x32_bf16 v[76:79], v[176:179], v[228:231], v[76:79]
ds_read_b64_tr_b16 v[172:173], v40 offset:50176
ds_read_b64_tr_b16 v[174:175], v40 offset:56320
s_waitcnt lgkmcnt(6)
v_mfma_f32_16x16x32_bf16 v[80:83], v[160:163], v[224:227], v[80:83]
buffer_load_dwordx4 v49, s[12:15], s44 offen offset:1024 lds
v_mfma_f32_16x16x32_bf16 v[84:87], v[160:163], v[228:231], v[84:87]
ds_read_b64_tr_b16 v[176:177], v43 offset:50176
ds_read_b64_tr_b16 v[178:179], v43 offset:56320
s_waitcnt lgkmcnt(6)
v_mfma_f32_16x16x32_bf16 v[88:91], v[164:167], v[224:227], v[88:91]
buffer_load_dwordx4 v50, s[12:15], s44 offen offset:2048 lds
v_mfma_f32_16x16x32_bf16 v[92:95], v[164:167], v[228:231], v[92:95]
ds_read_b64_tr_b16 v[160:161], v46 offset:50176
ds_read_b64_tr_b16 v[162:163], v46 offset:56320
s_waitcnt lgkmcnt(6)
v_mfma_f32_16x16x32_bf16 v[96:99], v[168:171], v[224:227], v[96:99]
s_add_u32 s45, s41, 21504
ds_read_b64_tr_b16 v[164:165], v37 offset:51200
v_mfma_f32_16x16x32_bf16 v[100:103], v[168:171], v[228:231], v[100:103]
ds_read_b64_tr_b16 v[166:167], v37 offset:57344
s_waitcnt lgkmcnt(6)
v_mfma_f32_16x16x32_bf16 v[104:107], v[172:175], v[224:227], v[104:107]
buffer_load_dwordx4 v[216:219], v15, s[16:19], s45 offen sc1
v_mfma_f32_16x16x32_bf16 v[108:111], v[172:175], v[228:231], v[108:111]
ds_read_b64_tr_b16 v[168:169], v40 offset:51200
ds_read_b64_tr_b16 v[170:171], v40 offset:57344
s_waitcnt lgkmcnt(6)
v_mfma_f32_16x16x32_bf16 v[112:115], v[176:179], v[224:227], v[112:115]
buffer_load_dwordx4 v[220:223], v51, s[16:19], s45 offen sc1
v_mfma_f32_16x16x32_bf16 v[116:119], v[176:179], v[228:231], v[116:119]
ds_read_b64_tr_b16 v[172:173], v43 offset:51200
ds_read_b64_tr_b16 v[174:175], v43 offset:57344
s_waitcnt lgkmcnt(6)
v_mfma_f32_16x16x32_bf16 v[120:123], v[160:163], v[224:227], v[120:123]
ds_read_b64_tr_b16 v[176:177], v46 offset:51200
s_mul_i32 s38, s98, 3
s_add_u32 s38, s38, 2
v_mfma_f32_16x16x32_bf16 v[124:127], v[160:163], v[228:231], v[124:127]
ds_read_b64_tr_b16 v[178:179], v46 offset:57344
s_waitcnt lgkmcnt(6)
v_mfma_f32_16x16x32_bf16 v[128:131], v[164:167], v[224:227], v[128:131]
ds_read_b64_tr_b16 v[160:161], v38 offset:0
s_and_b32 s39, s38, 1
s_lshr_b32 s38, s38, 1
v_mfma_f32_16x16x32_bf16 v[132:135], v[164:167], v[228:231], v[132:135]
ds_read_b64_tr_b16 v[162:163], v38 offset:6144
s_waitcnt lgkmcnt(6)
v_mfma_f32_16x16x32_bf16 v[136:139], v[168:171], v[224:227], v[136:139]
ds_read_b64_tr_b16 v[164:165], v41 offset:0
s_mul_i32 s52, s39, 16*1152
s_lshl_b32 s47, s38, 6
v_mfma_f32_16x16x32_bf16 v[140:143], v[168:171], v[228:231], v[140:143]
ds_read_b64_tr_b16 v[166:167], v41 offset:6144
s_waitcnt lgkmcnt(6)
v_mfma_f32_16x16x32_bf16 v[144:147], v[172:175], v[224:227], v[144:147]
ds_read_b64_tr_b16 v[168:169], v44 offset:0
s_add_u32 s52, s52, s47
s_add_u32 s52, s52, s37
v_mfma_f32_16x16x32_bf16 v[148:151], v[172:175], v[228:231], v[148:151]
ds_read_b64_tr_b16 v[170:171], v44 offset:6144
s_waitcnt lgkmcnt(6)
v_mfma_f32_16x16x32_bf16 v[152:155], v[176:179], v[224:227], v[152:155]
ds_read_b64_tr_b16 v[172:173], v47 offset:0
v_add_u32 v26, s52, v23
v_mfma_f32_16x16x32_bf16 v[156:159], v[176:179], v[228:231], v[156:159]
ds_read_b64_tr_b16 v[174:175], v47 offset:6144
s_waitcnt lgkmcnt(6)
s_waitcnt vmcnt(18)
v_mfma_f32_16x16x32_bf16 v[64:67], v[160:163], v[192:195], v[64:67]
s_add_u32 m0, s43, 61440
s_add_u32 s44, s40, 442368
ds_read_b64_tr_b16 v[176:177], v38 offset:1024
s_waitcnt vmcnt(17)
v_mfma_f32_16x16x32_bf16 v[68:71], v[160:163], v[196:199], v[68:71]
ds_read_b64_tr_b16 v[178:179], v38 offset:7168
s_waitcnt lgkmcnt(6)
v_mfma_f32_16x16x32_bf16 v[72:75], v[164:167], v[192:195], v[72:75]
buffer_load_dwordx4 v48, s[12:15], s44 offen lds
v_mfma_f32_16x16x32_bf16 v[76:79], v[164:167], v[196:199], v[76:79]
ds_read_b64_tr_b16 v[160:161], v41 offset:1024
ds_read_b64_tr_b16 v[162:163], v41 offset:7168
s_waitcnt lgkmcnt(6)
v_mfma_f32_16x16x32_bf16 v[80:83], v[168:171], v[192:195], v[80:83]
buffer_load_dwordx4 v49, s[12:15], s44 offen offset:1024 lds
v_mfma_f32_16x16x32_bf16 v[84:87], v[168:171], v[196:199], v[84:87]
ds_read_b64_tr_b16 v[164:165], v44 offset:1024
ds_read_b64_tr_b16 v[166:167], v44 offset:7168
s_waitcnt lgkmcnt(6)
v_mfma_f32_16x16x32_bf16 v[88:91], v[172:175], v[192:195], v[88:91]
buffer_load_dwordx4 v50, s[12:15], s44 offen offset:2048 lds
v_mfma_f32_16x16x32_bf16 v[92:95], v[172:175], v[196:199], v[92:95]
ds_read_b64_tr_b16 v[168:169], v47 offset:1024
ds_read_b64_tr_b16 v[170:171], v47 offset:7168
s_waitcnt lgkmcnt(6)
v_mfma_f32_16x16x32_bf16 v[96:99], v[176:179], v[192:195], v[96:99]
s_add_u32 s45, s41, 28672
ds_read_b64_tr_b16 v[172:173], v38 offset:2048
v_mfma_f32_16x16x32_bf16 v[100:103], v[176:179], v[196:199], v[100:103]
ds_read_b64_tr_b16 v[174:175], v38 offset:8192
s_waitcnt lgkmcnt(6)
v_mfma_f32_16x16x32_bf16 v[104:107], v[160:163], v[192:195], v[104:107]
buffer_load_dwordx4 v[224:227], v15, s[16:19], s45 offen sc1
v_mfma_f32_16x16x32_bf16 v[108:111], v[160:163], v[196:199], v[108:111]
ds_read_b64_tr_b16 v[176:177], v41 offset:2048
ds_read_b64_tr_b16 v[178:179], v41 offset:8192
s_waitcnt lgkmcnt(6)
v_mfma_f32_16x16x32_bf16 v[112:115], v[164:167], v[192:195], v[112:115]
buffer_load_dwordx4 v[228:231], v51, s[16:19], s45 offen sc1
v_mfma_f32_16x16x32_bf16 v[116:119], v[164:167], v[196:199], v[116:119]
ds_read_b64_tr_b16 v[160:161], v44 offset:2048
ds_read_b64_tr_b16 v[162:163], v44 offset:8192
s_waitcnt lgkmcnt(6)
v_mfma_f32_16x16x32_bf16 v[120:123], v[168:171], v[192:195], v[120:123]
buffer_load_dwordx4 v[188:191], v26, s[24:27], 0 offen
v_mfma_f32_16x16x32_bf16 v[124:127], v[168:171], v[196:199], v[124:127]
ds_read_b64_tr_b16 v[164:165], v47 offset:2048
ds_read_b64_tr_b16 v[166:167], v47 offset:8192
s_waitcnt lgkmcnt(6)
v_mfma_f32_16x16x32_bf16 v[128:131], v[172:175], v[192:195], v[128:131]
ds_read_b64_tr_b16 v[168:169], v38 offset:12288
v_mfma_f32_16x16x32_bf16 v[132:135], v[172:175], v[196:199], v[132:135]
ds_read_b64_tr_b16 v[170:171], v38 offset:18432
s_waitcnt lgkmcnt(6)
v_mfma_f32_16x16x32_bf16 v[136:139], v[176:179], v[192:195], v[136:139]
ds_read_b64_tr_b16 v[172:173], v41 offset:12288
v_mfma_f32_16x16x32_bf16 v[140:143], v[176:179], v[196:199], v[140:143]
ds_read_b64_tr_b16 v[174:175], v41 offset:18432
s_waitcnt lgkmcnt(6)
v_mfma_f32_16x16x32_bf16 v[144:147], v[160:163], v[192:195], v[144:147]
ds_read_b64_tr_b16 v[176:177], v44 offset:12288
v_mfma_f32_16x16x32_bf16 v[148:151], v[160:163], v[196:199], v[148:151]
ds_read_b64_tr_b16 v[178:179], v44 offset:18432
s_waitcnt lgkmcnt(6)
v_mfma_f32_16x16x32_bf16 v[152:155], v[164:167], v[192:195], v[152:155]
ds_read_b64_tr_b16 v[160:161], v47 offset:12288
v_mfma_f32_16x16x32_bf16 v[156:159], v[164:167], v[196:199], v[156:159]
ds_read_b64_tr_b16 v[162:163], v47 offset:18432
s_waitcnt lgkmcnt(6)
s_waitcnt vmcnt(18)
v_mfma_f32_16x16x32_bf16 v[64:67], v[168:171], v[200:203], v[64:67]
s_add_u32 m0, s43, 73728
s_add_u32 s44, s40, 479232
ds_read_b64_tr_b16 v[164:165], v38 offset:13312
s_waitcnt vmcnt(17)
v_mfma_f32_16x16x32_bf16 v[68:71], v[168:171], v[204:207], v[68:71]
ds_read_b64_tr_b16 v[166:167], v38 offset:19456
s_waitcnt lgkmcnt(6)
v_mfma_f32_16x16x32_bf16 v[72:75], v[172:175], v[200:203], v[72:75]
buffer_load_dwordx4 v48, s[12:15], s44 offen lds
v_mfma_f32_16x16x32_bf16 v[76:79], v[172:175], v[204:207], v[76:79]
ds_read_b64_tr_b16 v[168:169], v41 offset:13312
ds_read_b64_tr_b16 v[170:171], v41 offset:19456
s_waitcnt lgkmcnt(6)
v_mfma_f32_16x16x32_bf16 v[80:83], v[176:179], v[200:203], v[80:83]
buffer_load_dwordx4 v49, s[12:15], s44 offen offset:1024 lds
v_mfma_f32_16x16x32_bf16 v[84:87], v[176:179], v[204:207], v[84:87]
ds_read_b64_tr_b16 v[172:173], v44 offset:13312
ds_read_b64_tr_b16 v[174:175], v44 offset:19456
s_waitcnt lgkmcnt(6)
v_mfma_f32_16x16x32_bf16 v[88:91], v[160:163], v[200:203], v[88:91]
buffer_load_dwordx4 v50, s[12:15], s44 offen offset:2048 lds
v_mfma_f32_16x16x32_bf16 v[92:95], v[160:163], v[204:207], v[92:95]
ds_read_b64_tr_b16 v[176:177], v47 offset:13312
ds_read_b64_tr_b16 v[178:179], v47 offset:19456
s_waitcnt lgkmcnt(6)
v_mfma_f32_16x16x32_bf16 v[96:99], v[164:167], v[200:203], v[96:99]
s_add_u32 s45, s41, 29696
ds_read_b64_tr_b16 v[160:161], v38 offset:14336
v_mfma_f32_16x16x32_bf16 v[100:103], v[164:167], v[204:207], v[100:103]
ds_read_b64_tr_b16 v[162:163], v38 offset:20480
s_waitcnt lgkmcnt(6)
v_mfma_f32_16x16x32_bf16 v[104:107], v[168:171], v[200:203], v[104:107]
buffer_load_dwordx4 v[192:195], v15, s[16:19], s45 offen sc1
v_mfma_f32_16x16x32_bf16 v[108:111], v[168:171], v[204:207], v[108:111]
ds_read_b64_tr_b16 v[164:165], v41 offset:14336
ds_read_b64_tr_b16 v[166:167], v41 offset:20480
s_waitcnt lgkmcnt(6)
v_mfma_f32_16x16x32_bf16 v[112:115], v[172:175], v[200:203], v[112:115]
buffer_load_dwordx4 v[196:199], v51, s[16:19], s45 offen sc1
v_mfma_f32_16x16x32_bf16 v[116:119], v[172:175], v[204:207], v[116:119]
ds_read_b64_tr_b16 v[168:169], v44 offset:14336
ds_read_b64_tr_b16 v[170:171], v44 offset:20480
s_waitcnt lgkmcnt(6)
v_mfma_f32_16x16x32_bf16 v[120:123], v[176:179], v[200:203], v[120:123]
ds_read_b64_tr_b16 v[172:173], v47 offset:14336
s_add_u32 s47, s36, s39
s_mul_i32 s47, s47, 18
v_mfma_f32_16x16x32_bf16 v[124:127], v[176:179], v[204:207], v[124:127]
ds_read_b64_tr_b16 v[174:175], v47 offset:20480
s_waitcnt lgkmcnt(6)
v_mfma_f32_16x16x32_bf16 v[128:131], v[160:163], v[200:203], v[128:131]
ds_read_b64_tr_b16 v[176:177], v38 offset:24576
s_add_u32 s47, s47, s38
s_mul_i32 s48, s35, 6
v_mfma_f32_16x16x32_bf16 v[132:135], v[160:163], v[204:207], v[132:135]
ds_read_b64_tr_b16 v[178:179], v38 offset:30720
s_waitcnt lgkmcnt(6)
v_mfma_f32_16x16x32_bf16 v[136:139], v[164:167], v[200:203], v[136:139]
ds_read_b64_tr_b16 v[160:161], v41 offset:24576
s_add_u32 s47, s47, s48
s_lshl_b32 s30, s47, 10
v_mfma_f32_16x16x32_bf16 v[140:143], v[164:167], v[204:207], v[140:143]
ds_read_b64_tr_b16 v[162:163], v41 offset:30720
s_waitcnt lgkmcnt(6)
v_mfma_f32_16x16x32_bf16 v[144:147], v[168:171], v[200:203], v[144:147]
ds_read_b64_tr_b16 v[164:165], v44 offset:24576
s_lshl_b32 s47, s38, 11
s_lshl_b32 s48, s39, 5
v_mfma_f32_16x16x32_bf16 v[148:151], v[168:171], v[204:207], v[148:151]
ds_read_b64_tr_b16 v[166:167], v44 offset:30720
s_waitcnt lgkmcnt(6)
v_mfma_f32_16x16x32_bf16 v[152:155], v[172:175], v[200:203], v[152:155]
ds_read_b64_tr_b16 v[168:169], v47 offset:24576
s_add_u32 s47, s47, s48
s_mov_b32 s59, s47
v_mfma_f32_16x16x32_bf16 v[156:159], v[172:175], v[204:207], v[156:159]
ds_read_b64_tr_b16 v[170:171], v47 offset:30720
s_waitcnt vmcnt(18)
s_barrier
v_cmp_ne_u32 vcc, s100, v55
s_mov_b32 s56, 0x40000
s_nop 3
s_cbranch_vccz FCD_10
FC_10:
global_load_dword v55, v54, s[6:7] sc1
s_waitcnt vmcnt(0)
v_cmp_ne_u32 vcc, s100, v55
s_sub_u32 s56, s56, 1
s_cmp_eq_u32 s56, 0
s_cbranch_scc1 FCD_10
s_nop 1
s_cbranch_vccnz FC_10
FCD_10:
s_waitcnt lgkmcnt(6)
s_waitcnt vmcnt(17)
v_mfma_f32_16x16x32_bf16 v[64:67], v[176:179], v[208:211], v[64:67]
s_add_u32 m0, s43, 86016
s_add_u32 s44, s40, 811008
ds_read_b64_tr_b16 v[172:173], v38 offset:25600
s_waitcnt vmcnt(16)
v_mfma_f32_16x16x32_bf16 v[68:71], v[176:179], v[212:215], v[68:71]
ds_read_b64_tr_b16 v[174:175], v38 offset:31744
s_waitcnt lgkmcnt(6)
v_mfma_f32_16x16x32_bf16 v[72:75], v[160:163], v[208:211], v[72:75]
buffer_load_dwordx4 v48, s[12:15], s44 offen lds
v_mfma_f32_16x16x32_bf16 v[76:79], v[160:163], v[212:215], v[76:79]
ds_read_b64_tr_b16 v[176:177], v41 offset:25600
ds_read_b64_tr_b16 v[178:179], v41 offset:31744
s_waitcnt lgkmcnt(6)
v_mfma_f32_16x16x32_bf16 v[80:83], v[164:167], v[208:211], v[80:83]
buffer_load_dwordx4 v49, s[12:15], s44 offen offset:1024 lds
v_mfma_f32_16x16x32_bf16 v[84:87], v[164:167], v[212:215], v[84:87]
ds_read_b64_tr_b16 v[160:161], v44 offset:25600
ds_read_b64_tr_b16 v[162:163], v44 offset:31744
s_waitcnt lgkmcnt(6)
v_mfma_f32_16x16x32_bf16 v[88:91], v[168:171], v[208:211], v[88:91]
buffer_load_dwordx4 v50, s[12:15], s44 offen offset:2048 lds
v_mfma_f32_16x16x32_bf16 v[92:95], v[168:171], v[212:215], v[92:95]
ds_read_b64_tr_b16 v[164:165], v47 offset:25600
ds_read_b64_tr_b16 v[166:167], v47 offset:31744
s_waitcnt lgkmcnt(6)
v_mfma_f32_16x16x32_bf16 v[96:99], v[172:175], v[208:211], v[96:99]
s_add_u32 s45, s41, 4096
ds_read_b64_tr_b16 v[168:169], v38 offset:26624
v_mfma_f32_16x16x32_bf16 v[100:103], v[172:175], v[212:215], v[100:103]
ds_read_b64_tr_b16 v[170:171], v38 offset:32768
s_waitcnt lgkmcnt(6)
v_mfma_f32_16x16x32_bf16 v[104:107], v[176:179], v[208:211], v[104:107]
buffer_load_dwordx4 v[200:203], v15, s[16:19], s45 offen sc1
v_mfma_f32_16x16x32_bf16 v[108:111], v[176:179], v[212:215], v[108:111]
ds_read_b64_tr_b16 v[172:173], v41 offset:26624
ds_read_b64_tr_b16 v[174:175], v41 offset:32768
s_waitcnt lgkmcnt(6)
v_mfma_f32_16x16x32_bf16 v[112:115], v[160:163], v[208:211], v[112:115]
buffer_load_dwordx4 v[204:207], v51, s[16:19], s45 offen sc1
v_mfma_f32_16x16x32_bf16 v[116:119], v[160:163], v[212:215], v[116:119]
ds_read_b64_tr_b16 v[176:177], v44 offset:26624
ds_read_b64_tr_b16 v[178:179], v44 offset:32768
s_waitcnt lgkmcnt(6)
v_mfma_f32_16x16x32_bf16 v[120:123], v[164:167], v[208:211], v[120:123]
ds_read_b64_tr_b16 v[160:161], v47 offset:26624
v_bfe_u32 v27, v21, 4, 1
v_lshlrev_b32 v27, 4, v27
v_mfma_f32_16x16x32_bf16 v[124:127], v[164:167], v[212:215], v[124:127]
ds_read_b64_tr_b16 v[162:163], v47 offset:32768
s_waitcnt lgkmcnt(6)
v_mfma_f32_16x16x32_bf16 v[128:131], v[168:171], v[208:211], v[128:131]
ds_read_b64_tr_b16 v[164:165], v36 offset:0
v_lshrrev_b32 v28, 5, v21
v_lshl_add_u32 v27, v28, 3, v27
v_mfma_f32_16x16x32_bf16 v[132:135], v[168:171], v[212:215], v[132:135]
ds_read_b64_tr_b16 v[166:167], v36 offset:6144
s_waitcnt lgkmcnt(6)
v_mfma_f32_16x16x32_bf16 v[136:139], v[172:175], v[208:211], v[136:139]
ds_read_b64_tr_b16 v[168:169], v39 offset:0
v_bfe_u32 v28, v21, 2, 2
v_add_u32 v27, v27, v28
v_mfma_f32_16x16x32_bf16 v[140:143], v[172:175], v[212:215], v[140:143]
ds_read_b64_tr_b16 v[170:171], v39 offset:6144
s_waitcnt lgkmcnt(6)
v_mfma_f32_16x16x32_bf16 v[144:147], v[176:179], v[208:211], v[144:147]
ds_read_b64_tr_b16 v[172:173], v42 offset:0
v_lshlrev_b32 v27, 6, v27
v_and_b32 v28, 3, v21
v_mfma_f32_16x16x32_bf16 v[148:151], v[176:179], v[212:215], v[148:151]
ds_read_b64_tr_b16 v[174:175], v42 offset:6144
s_waitcnt lgkmcnt(6)
v_mfma_f32_16x16x32_bf16 v[152:155], v[160:163], v[208:211], v[152:155]
ds_read_b64_tr_b16 v[176:177], v45 offset:0
v_lshl_add_u32 v27, v28, 3, v27
v_add_u32 v29, s53, v27
v_mfma_f32_16x16x32_bf16 v[156:159], v[160:163], v[212:215], v[156:159]
ds_read_b64_tr_b16 v[178:179], v45 offset:6144
s_waitcnt lgkmcnt(6)
s_waitcnt vmcnt(17)
v_mfma_f32_16x16x32_bf16 v[64:67], v[164:167], v[216:219], v[64:67]
s_add_u32 m0, s43, 98304
s_add_u32 s44, s40, 847872
ds_read_b64_tr_b16 v[160:161], v36 offset:1024
s_waitcnt vmcnt(16)
v_mfma_f32_16x16x32_bf16 v[68:71], v[164:167], v[220:223], v[68:71]
ds_read_b64_tr_b16 v[162:163], v36 offset:7168
s_waitcnt lgkmcnt(6)
v_mfma_f32_16x16x32_bf16 v[72:75], v[168:171], v[216:219], v[72:75]
buffer_load_dwordx4 v48, s[12:15], s44 offen lds
v_mfma_f32_16x16x32_bf16 v[76:79], v[168:171], v[220:223], v[76:79]
ds_read_b64_tr_b16 v[164:165], v39 offset:1024
ds_read_b64_tr_b16 v[166:167], v39 offset:7168
s_waitcnt lgkmcnt(6)
v_mfma_f32_16x16x32_bf16 v[80:83], v[172:175], v[216:219], v[80:83]
buffer_load_dwordx4 v49, s[12:15], s44 offen offset:1024 lds
v_mfma_f32_16x16x32_bf16 v[84:87], v[172:175], v[220:223], v[84:87]
ds_read_b64_tr_b16 v[168:169], v42 offset:1024
ds_read_b64_tr_b16 v[170:171], v42 offset:7168
s_waitcnt lgkmcnt(6)
v_mfma_f32_16x16x32_bf16 v[88:91], v[176:179], v[216:219], v[88:91]
buffer_load_dwordx4 v50, s[12:15], s44 offen offset:2048 lds
v_mfma_f32_16x16x32_bf16 v[92:95], v[176:179], v[220:223], v[92:95]
ds_read_b64_tr_b16 v[172:173], v45 offset:1024
ds_read_b64_tr_b16 v[174:175], v45 offset:7168
s_waitcnt lgkmcnt(6)
v_mfma_f32_16x16x32_bf16 v[96:99], v[160:163], v[216:219], v[96:99]
s_add_u32 s45, s41, 5120
ds_read_b64_tr_b16 v[176:177], v36 offset:2048
v_mfma_f32_16x16x32_bf16 v[100:103], v[160:163], v[220:223], v[100:103]
ds_read_b64_tr_b16 v[178:179], v36 offset:8192
s_waitcnt lgkmcnt(6)
v_mfma_f32_16x16x32_bf16 v[104:107], v[164:167], v[216:219], v[104:107]
buffer_load_dwordx4 v[208:211], v15, s[16:19], s45 offen sc1
v_mfma_f32_16x16x32_bf16 v[108:111], v[164:167], v[220:223], v[108:111]
ds_read_b64_tr_b16 v[160:161], v39 offset:2048
ds_read_b64_tr_b16 v[162:163], v39 offset:8192
s_waitcnt lgkmcnt(6)
v_mfma_f32_16x16x32_bf16 v[112:115], v[168:171], v[216:219], v[112:115]
buffer_load_dwordx4 v[212:215], v51, s[16:19], s45 offen sc1
v_mfma_f32_16x16x32_bf16 v[116:119], v[168:171], v[220:223], v[116:119]
ds_read_b64_tr_b16 v[164:165], v42 offset:2048
ds_read_b64_tr_b16 v[166:167], v42 offset:8192
s_waitcnt lgkmcnt(6)
v_mfma_f32_16x16x32_bf16 v[120:123], v[172:175], v[216:219], v[120:123]
ds_read_b64_tr_b16 v[168:169], v45 offset:2048
v_add_u32 v30, s54, v27
v_add_u32 v31, s59, v27
v_mfma_f32_16x16x32_bf16 v[124:127], v[172:175], v[220:223], v[124:127]
ds_read_b64_tr_b16 v[170:171], v45 offset:8192
s_waitcnt lgkmcnt(6)
v_mfma_f32_16x16x32_bf16 v[128:131], v[176:179], v[216:219], v[128:131]
ds_read_b64_tr_b16 v[172:173], v36 offset:12288
v_lshrrev_b32 v28, 2, v21
v_lshlrev_b32 v28, 12, v28
v_mfma_f32_16x16x32_bf16 v[132:135], v[176:179], v[220:223], v[132:135]
ds_read_b64_tr_b16 v[174:175], v36 offset:18432
s_waitcnt lgkmcnt(6)
v_mfma_f32_16x16x32_bf16 v[136:139], v[160:163], v[216:219], v[136:139]
ds_read_b64_tr_b16 v[176:177], v39 offset:12288
v_and_b32 v32, 3, v21
v_lshl_add_u32 v32, v32, 4, v28
v_mfma_f32_16x16x32_bf16 v[140:143], v[160:163], v[220:223], v[140:143]
ds_read_b64_tr_b16 v[178:179], v39 offset:18432
s_waitcnt lgkmcnt(6)
v_mfma_f32_16x16x32_bf16 v[144:147], v[164:167], v[216:219], v[144:147]
ds_read_b64_tr_b16 v[160:161], v42 offset:12288
s_mul_i32 s47, s35, 192
s_mul_i32 s48, s98, 48
v_mfma_f32_16x16x32_bf16 v[148:151], v[164:167], v[220:223], v[148:151]
ds_read_b64_tr_b16 v[162:163], v42 offset:18432
s_waitcnt lgkmcnt(6)
v_mfma_f32_16x16x32_bf16 v[152:155], v[168:171], v[216:219], v[152:155]
ds_read_b64_tr_b16 v[164:165], v45 offset:12288
s_add_u32 s47, s47, s48
s_lshl_b32 s47, s47, 12
v_mfma_f32_16x16x32_bf16 v[156:159], v[168:171], v[220:223], v[156:159]
ds_read_b64_tr_b16 v[166:167], v45 offset:18432
s_waitcnt lgkmcnt(6)
s_waitcnt vmcnt(17)
v_mfma_f32_16x16x32_bf16 v[64:67], v[172:175], v[224:227], v[64:67]
s_add_u32 m0, s43, 110592
s_add_u32 s44, s40, 1105920
ds_read_b64_tr_b16 v[168:169], v36 offset:13312
s_waitcnt vmcnt(16)
v_mfma_f32_16x16x32_bf16 v[68:71], v[172:175], v[228:231], v[68:71]
ds_read_b64_tr_b16 v[170:171], v36 offset:19456
s_waitcnt lgkmcnt(6)
v_mfma_f32_16x16x32_bf16 v[72:75], v[176:179], v[224:227], v[72:75]
buffer_load_dwordx4 v48, s[12:15], s44 offen lds
v_mfma_f32_16x16x32_bf16 v[76:79], v[176:179], v[228:231], v[76:79]
ds_read_b64_tr_b16 v[172:173], v39 offset:13312
ds_read_b64_tr_b16 v[174:175], v39 offset:19456
s_waitcnt lgkmcnt(6)
v_mfma_f32_16x16x32_bf16 v[80:83], v[160:163], v[224:227], v[80:83]
buffer_load_dwordx4 v49, s[12:15], s44 offen offset:1024 lds
v_mfma_f32_16x16x32_bf16 v[84:87], v[160:163], v[228:231], v[84:87]
ds_read_b64_tr_b16 v[176:177], v42 offset:13312
ds_read_b64_tr_b16 v[178:179], v42 offset:19456
s_waitcnt lgkmcnt(6)
v_mfma_f32_16x16x32_bf16 v[88:91], v[164:167], v[224:227], v[88:91]
buffer_load_dwordx4 v50, s[12:15], s44 offen offset:2048 lds
v_mfma_f32_16x16x32_bf16 v[92:95], v[164:167], v[228:231], v[92:95]
ds_read_b64_tr_b16 v[160:161], v45 offset:13312
ds_read_b64_tr_b16 v[162:163], v45 offset:19456
s_waitcnt lgkmcnt(6)
v_mfma_f32_16x16x32_bf16 v[96:99], v[168:171], v[224:227], v[96:99]
s_add_u32 s45, s41, 12288
ds_read_b64_tr_b16 v[164:165], v36 offset:14336
v_mfma_f32_16x16x32_bf16 v[100:103], v[168:171], v[228:231], v[100:103]
ds_read_b64_tr_b16 v[166:167], v36 offset:20480
s_waitcnt lgkmcnt(6)
v_mfma_f32_16x16x32_bf16 v[104:107], v[172:175], v[224:227], v[104:107]
buffer_load_dwordx4 v[216:219], v15, s[16:19], s45 offen sc1
v_mfma_f32_16x16x32_bf16 v[108:111], v[172:175], v[228:231], v[108:111]
ds_read_b64_tr_b16 v[168:169], v39 offset:14336
ds_read_b64_tr_b16 v[170:171], v39 offset:20480
s_waitcnt lgkmcnt(6)
v_mfma_f32_16x16x32_bf16 v[112:115], v[176:179], v[224:227], v[112:115]
buffer_load_dwordx4 v[220:223], v51, s[16:19], s45 offen sc1
v_mfma_f32_16x16x32_bf16 v[116:119], v[176:179], v[228:231], v[116:119]
ds_read_b64_tr_b16 v[172:173], v42 offset:14336
ds_read_b64_tr_b16 v[174:175], v42 offset:20480
s_waitcnt lgkmcnt(6)
v_mfma_f32_16x16x32_bf16 v[120:123], v[160:163], v[224:227], v[120:123]
ds_read_b64_tr_b16 v[176:177], v45 offset:14336
s_lshl_b32 s48, s34, 8
v_mfma_f32_16x16x32_bf16 v[124:127], v[160:163], v[228:231], v[124:127]
ds_read_b64_tr_b16 v[178:179], v45 offset:20480
s_waitcnt lgkmcnt(6)
v_mfma_f32_16x16x32_bf16 v[128:131], v[164:167], v[224:227], v[128:131]
ds_read_b64_tr_b16 v[160:161], v36 offset:24576
s_add_u32 s47, s47, s48
v_mfma_f32_16x16x32_bf16 v[132:135], v[164:167], v[228:231], v[132:135]
ds_read_b64_tr_b16 v[162:163], v36 offset:30720
s_waitcnt lgkmcnt(6)
v_mfma_f32_16x16x32_bf16 v[136:139], v[168:171], v[224:227], v[136:139]
ds_read_b64_tr_b16 v[164:165], v39 offset:24576
s_lshl_b32 s48, s33, 6
v_mfma_f32_16x16x32_bf16 v[140:143], v[168:171], v[228:231], v[140:143]
ds_read_b64_tr_b16 v[166:167], v39 offset:30720
s_waitcnt lgkmcnt(6)
v_mfma_f32_16x16x32_bf16 v[144:147], v[172:175], v[224:227], v[144:147]
ds_read_b64_tr_b16 v[168:169], v42 offset:24576
s_add_u32 s47, s47, s48
v_mfma_f32_16x16x32_bf16 v[148:151], v[172:175], v[228:231], v[148:151]
ds_read_b64_tr_b16 v[170:171], v42 offset:30720
s_waitcnt lgkmcnt(6)
v_mfma_f32_16x16x32_bf16 v[152:155], v[176:179], v[224:227], v[152:155]
ds_read_b64_tr_b16 v[172:173], v45 offset:24576
s_mul_i32 s49, s98, 3072
v_mfma_f32_16x16x32_bf16 v[156:159], v[176:179], v[228:231], v[156:159]
ds_read_b64_tr_b16 v[174:175], v45 offset:30720
s_waitcnt lgkmcnt(6)
s_waitcnt vmcnt(16)
v_mfma_f32_16x16x32_bf16 v[64:67], v[160:163], v[192:195], v[64:67]
s_add_u32 m0, s43, 122880
s_add_u32 s44, s40, 1142784
ds_read_b64_tr_b16 v[176:177], v36 offset:25600
s_waitcnt vmcnt(15)
v_mfma_f32_16x16x32_bf16 v[68:71], v[160:163], v[196:199], v[68:71]
ds_read_b64_tr_b16 v[178:179], v36 offset:31744
s_waitcnt lgkmcnt(6)
v_mfma_f32_16x16x32_bf16 v[72:75], v[164:167], v[192:195], v[72:75]
buffer_load_dwordx4 v48, s[12:15], s44 offen lds
v_mfma_f32_16x16x32_bf16 v[76:79], v[164:167], v[196:199], v[76:79]
ds_read_b64_tr_b16 v[160:161], v39 offset:25600
ds_read_b64_tr_b16 v[162:163], v39 offset:31744
s_waitcnt lgkmcnt(6)
v_mfma_f32_16x16x32_bf16 v[80:83], v[168:171], v[192:195], v[80:83]
buffer_load_dwordx4 v49, s[12:15], s44 offen offset:1024 lds
v_mfma_f32_16x16x32_bf16 v[84:87], v[168:171], v[196:199], v[84:87]
ds_read_b64_tr_b16 v[164:165], v42 offset:25600
ds_read_b64_tr_b16 v[166:167], v42 offset:31744
s_waitcnt lgkmcnt(6)
v_mfma_f32_16x16x32_bf16 v[88:91], v[172:175], v[192:195], v[88:91]
buffer_load_dwordx4 v50, s[12:15], s44 offen offset:2048 lds
v_mfma_f32_16x16x32_bf16 v[92:95], v[172:175], v[196:199], v[92:95]
ds_read_b64_tr_b16 v[168:169], v45 offset:25600
ds_read_b64_tr_b16 v[170:171], v45 offset:31744
s_waitcnt lgkmcnt(6)
v_mfma_f32_16x16x32_bf16 v[96:99], v[176:179], v[192:195], v[96:99]
s_add_u32 s45, s41, 13312
ds_read_b64_tr_b16 v[172:173], v36 offset:26624
v_mfma_f32_16x16x32_bf16 v[100:103], v[176:179], v[196:199], v[100:103]
ds_read_b64_tr_b16 v[174:175], v36 offset:32768
s_waitcnt lgkmcnt(6)
v_mfma_f32_16x16x32_bf16 v[104:107], v[160:163], v[192:195], v[104:107]
buffer_load_dwordx4 v[224:227], v15, s[16:19], s45 offen sc1
v_mfma_f32_16x16x32_bf16 v[108:111], v[160:163], v[196:199], v[108:111]
ds_read_b64_tr_b16 v[176:177], v39 offset:26624
ds_read_b64_tr_b16 v[178:179], v39 offset:32768
s_waitcnt lgkmcnt(6)
v_mfma_f32_16x16x32_bf16 v[112:115], v[164:167], v[192:195], v[112:115]
buffer_load_dwordx4 v[228:231], v51, s[16:19], s45 offen sc1
v_mfma_f32_16x16x32_bf16 v[116:119], v[164:167], v[196:199], v[116:119]
ds_read_b64_tr_b16 v[160:161], v42 offset:26624
ds_read_b64_tr_b16 v[162:163], v42 offset:32768
s_waitcnt lgkmcnt(6)
v_mfma_f32_16x16x32_bf16 v[120:123], v[168:171], v[192:195], v[120:123]
ds_read_b64_tr_b16 v[164:165], v45 offset:26624
v_mfma_f32_16x16x32_bf16 v[124:127], v[168:171], v[196:199], v[124:127]
ds_read_b64_tr_b16 v[166:167], v45 offset:32768
s_waitcnt lgkmcnt(6)
v_mfma_f32_16x16x32_bf16 v[128:131], v[172:175], v[192:195], v[128:131]
ds_read_b64_tr_b16 v[168:169], v36 offset:36864
v_mfma_f32_16x16x32_bf16 v[132:135], v[172:175], v[196:199], v[132:135]
ds_read_b64_tr_b16 v[170:171], v36 offset:43008
s_waitcnt lgkmcnt(6)
v_mfma_f32_16x16x32_bf16 v[136:139], v[176:179], v[192:195], v[136:139]
ds_read_b64_tr_b16 v[172:173], v39 offset:36864
v_mfma_f32_16x16x32_bf16 v[140:143], v[176:179], v[196:199], v[140:143]
ds_read_b64_tr_b16 v[174:175], v39 offset:43008
s_waitcnt lgkmcnt(6)
v_mfma_f32_16x16x32_bf16 v[144:147], v[160:163], v[192:195], v[144:147]
ds_read_b64_tr_b16 v[176:177], v42 offset:36864
v_mfma_f32_16x16x32_bf16 v[148:151], v[160:163], v[196:199], v[148:151]
ds_read_b64_tr_b16 v[178:179], v42 offset:43008
s_waitcnt lgkmcnt(6)
v_mfma_f32_16x16x32_bf16 v[152:155], v[164:167], v[192:195], v[152:155]
ds_read_b64_tr_b16 v[160:161], v45 offset:36864
v_mfma_f32_16x16x32_bf16 v[156:159], v[164:167], v[196:199], v[156:159]
ds_read_b64_tr_b16 v[162:163], v45 offset:43008
s_waitcnt vmcnt(17)
s_barrier
global_load_dword v59, v58, s[6:7] sc1
s_waitcnt lgkmcnt(6)
s_waitcnt vmcnt(17)
v_mfma_f32_16x16x32_bf16 v[64:67], v[168:171], v[200:203], v[64:67]
s_add_u32 m0, s43, 135168
s_add_u32 s44, s40, 221184
ds_read_b64_tr_b16 v[164:165], v36 offset:37888
s_waitcnt vmcnt(16)
v_mfma_f32_16x16x32_bf16 v[68:71], v[168:171], v[204:207], v[68:71]
ds_read_b64_tr_b16 v[166:167], v36 offset:44032
s_waitcnt lgkmcnt(6)
v_mfma_f32_16x16x32_bf16 v[72:75], v[172:175], v[200:203], v[72:75]
buffer_load_dwordx4 v48, s[12:15], s44 offen lds
v_mfma_f32_16x16x32_bf16 v[76:79], v[172:175], v[204:207], v[76:79]
ds_read_b64_tr_b16 v[168:169], v39 offset:37888
ds_read_b64_tr_b16 v[170:171], v39 offset:44032
s_waitcnt lgkmcnt(6)
v_mfma_f32_16x16x32_bf16 v[80:83], v[176:179], v[200:203], v[80:83]
buffer_load_dwordx4 v49, s[12:15], s44 offen offset:1024 lds
v_mfma_f32_16x16x32_bf16 v[84:87], v[176:179], v[204:207], v[84:87]
ds_read_b64_tr_b16 v[172:173], v42 offset:37888
ds_read_b64_tr_b16 v[174:175], v42 offset:44032
s_waitcnt lgkmcnt(6)
v_mfma_f32_16x16x32_bf16 v[88:91], v[160:163], v[200:203], v[88:91]
buffer_load_dwordx4 v50, s[12:15], s44 offen offset:2048 lds
v_mfma_f32_16x16x32_bf16 v[92:95], v[160:163], v[204:207], v[92:95]
ds_read_b64_tr_b16 v[176:177], v45 offset:37888
ds_read_b64_tr_b16 v[178:179], v45 offset:44032
s_waitcnt lgkmcnt(6)
v_mfma_f32_16x16x32_bf16 v[96:99], v[164:167], v[200:203], v[96:99]
s_add_u32 s45, s41, 22528
ds_read_b64_tr_b16 v[160:161], v36 offset:38912
v_mfma_f32_16x16x32_bf16 v[100:103], v[164:167], v[204:207], v[100:103]
ds_read_b64_tr_b16 v[162:163], v36 offset:45056
s_waitcnt lgkmcnt(6)
v_mfma_f32_16x16x32_bf16 v[104:107], v[168:171], v[200:203], v[104:107]
buffer_load_dwordx4 v[192:195], v15, s[16:19], s45 offen sc1
v_mfma_f32_16x16x32_bf16 v[108:111], v[168:171], v[204:207], v[108:111]
ds_read_b64_tr_b16 v[164:165], v39 offset:38912
ds_read_b64_tr_b16 v[166:167], v39 offset:45056
s_waitcnt lgkmcnt(6)
v_mfma_f32_16x16x32_bf16 v[112:115], v[172:175], v[200:203], v[112:115]
buffer_load_dwordx4 v[196:199], v51, s[16:19], s45 offen sc1
v_mfma_f32_16x16x32_bf16 v[116:119], v[172:175], v[204:207], v[116:119]
ds_read_b64_tr_b16 v[168:169], v42 offset:38912
ds_read_b64_tr_b16 v[170:171], v42 offset:45056
s_waitcnt lgkmcnt(6)
v_mfma_f32_16x16x32_bf16 v[120:123], v[176:179], v[200:203], v[120:123]
ds_read_b64_tr_b16 v[172:173], v45 offset:38912
v_mfma_f32_16x16x32_bf16 v[124:127], v[176:179], v[204:207], v[124:127]
ds_read_b64_tr_b16 v[174:175], v45 offset:45056
s_waitcnt lgkmcnt(6)
v_mfma_f32_16x16x32_bf16 v[128:131], v[160:163], v[200:203], v[128:131]
ds_read_b64_tr_b16 v[176:177], v36 offset:49152
v_mfma_f32_16x16x32_bf16 v[132:135], v[160:163], v[204:207], v[132:135]
ds_read_b64_tr_b16 v[178:179], v36 offset:55296
s_waitcnt lgkmcnt(6)
v_mfma_f32_16x16x32_bf16 v[136:139], v[164:167], v[200:203], v[136:139]
ds_read_b64_tr_b16 v[160:161], v39 offset:49152
v_mfma_f32_16x16x32_bf16 v[140:143], v[164:167], v[204:207], v[140:143]
ds_read_b64_tr_b16 v[162:163], v39 offset:55296
s_waitcnt lgkmcnt(6)
v_mfma_f32_16x16x32_bf16 v[144:147], v[168:171], v[200:203], v[144:147]
ds_read_b64_tr_b16 v[164:165], v42 offset:49152
v_mfma_f32_16x16x32_bf16 v[148:151], v[168:171], v[204:207], v[148:151]
ds_read_b64_tr_b16 v[166:167], v42 offset:55296
s_waitcnt lgkmcnt(6)
v_mfma_f32_16x16x32_bf16 v[152:155], v[172:175], v[200:203], v[152:155]
ds_read_b64_tr_b16 v[168:169], v45 offset:49152
v_mfma_f32_16x16x32_bf16 v[156:159], v[172:175], v[204:207], v[156:159]
ds_read_b64_tr_b16 v[170:171], v45 offset:55296
s_waitcnt lgkmcnt(6)
s_waitcnt vmcnt(17)
v_mfma_f32_16x16x32_bf16 v[64:67], v[176:179], v[208:211], v[64:67]
s_add_u32 m0, s43, 147456
s_add_u32 s44, s40, 258048
ds_read_b64_tr_b16 v[172:173], v36 offset:50176
s_waitcnt vmcnt(16)
v_mfma_f32_16x16x32_bf16 v[68:71], v[176:179], v[212:215], v[68:71]
ds_read_b64_tr_b16 v[174:175], v36 offset:56320
s_waitcnt lgkmcnt(6)
v_mfma_f32_16x16x32_bf16 v[72:75], v[160:163], v[208:211], v[72:75]
buffer_load_dwordx4 v48, s[12:15], s44 offen lds
v_mfma_f32_16x16x32_bf16 v[76:79], v[160:163], v[212:215], v[76:79]
ds_read_b64_tr_b16 v[176:177], v39 offset:50176
ds_read_b64_tr_b16 v[178:179], v39 offset:56320
s_waitcnt lgkmcnt(6)
v_mfma_f32_16x16x32_bf16 v[80:83], v[164:167], v[208:211], v[80:83]
buffer_load_dwordx4 v49, s[12:15], s44 offen offset:1024 lds
v_mfma_f32_16x16x32_bf16 v[84:87], v[164:167], v[212:215], v[84:87]
ds_read_b64_tr_b16 v[160:161], v42 offset:50176
ds_read_b64_tr_b16 v[162:163], v42 offset:56320
s_waitcnt lgkmcnt(6)
v_mfma_f32_16x16x32_bf16 v[88:91], v[168:171], v[208:211], v[88:91]
buffer_load_dwordx4 v50, s[12:15], s44 offen offset:2048 lds
v_mfma_f32_16x16x32_bf16 v[92:95], v[168:171], v[212:215], v[92:95]
ds_read_b64_tr_b16 v[164:165], v45 offset:50176
ds_read_b64_tr_b16 v[166:167], v45 offset:56320
s_waitcnt lgkmcnt(6)
v_mfma_f32_16x16x32_bf16 v[96:99], v[172:175], v[208:211], v[96:99]
s_add_u32 s45, s41, 23552
ds_read_b64_tr_b16 v[168:169], v36 offset:51200
v_mfma_f32_16x16x32_bf16 v[100:103], v[172:175], v[212:215], v[100:103]
ds_read_b64_tr_b16 v[170:171], v36 offset:57344
s_waitcnt lgkmcnt(6)
v_mfma_f32_16x16x32_bf16 v[104:107], v[176:179], v[208:211], v[104:107]
buffer_load_dwordx4 v[200:203], v15, s[16:19], s45 offen sc1
v_mfma_f32_16x16x32_bf16 v[108:111], v[176:179], v[212:215], v[108:111]
ds_read_b64_tr_b16 v[172:173], v39 offset:51200
ds_read_b64_tr_b16 v[174:175], v39 offset:57344
s_waitcnt lgkmcnt(6)
v_mfma_f32_16x16x32_bf16 v[112:115], v[160:163], v[208:211], v[112:115]
buffer_load_dwordx4 v[204:207], v51, s[16:19], s45 offen sc1
v_mfma_f32_16x16x32_bf16 v[116:119], v[160:163], v[212:215], v[116:119]
ds_read_b64_tr_b16 v[176:177], v42 offset:51200
ds_read_b64_tr_b16 v[178:179], v42 offset:57344
s_waitcnt lgkmcnt(6)
v_mfma_f32_16x16x32_bf16 v[120:123], v[164:167], v[208:211], v[120:123]
ds_read_b64_tr_b16 v[160:161], v45 offset:51200
v_mfma_f32_16x16x32_bf16 v[124:127], v[164:167], v[212:215], v[124:127]
ds_read_b64_tr_b16 v[162:163], v45 offset:57344
s_waitcnt lgkmcnt(6)
v_mfma_f32_16x16x32_bf16 v[128:131], v[168:171], v[208:211], v[128:131]
ds_read_b64_tr_b16 v[164:165], v37 offset:0
v_mfma_f32_16x16x32_bf16 v[132:135], v[168:171], v[212:215], v[132:135]
ds_read_b64_tr_b16 v[166:167], v37 offset:6144
s_waitcnt lgkmcnt(6)
v_mfma_f32_16x16x32_bf16 v[136:139], v[172:175], v[208:211], v[136:139]
ds_read_b64_tr_b16 v[168:169], v40 offset:0
v_mfma_f32_16x16x32_bf16 v[140:143], v[172:175], v[212:215], v[140:143]
ds_read_b64_tr_b16 v[170:171], v40 offset:6144
s_waitcnt lgkmcnt(6)
v_mfma_f32_16x16x32_bf16 v[144:147], v[176:179], v[208:211], v[144:147]
ds_read_b64_tr_b16 v[172:173], v43 offset:0
v_mfma_f32_16x16x32_bf16 v[148:151], v[176:179], v[212:215], v[148:151]
ds_read_b64_tr_b16 v[174:175], v43 offset:6144
s_waitcnt lgkmcnt(6)
v_mfma_f32_16x16x32_bf16 v[152:155], v[160:163], v[208:211], v[152:155]
ds_read_b64_tr_b16 v[176:177], v46 offset:0
v_mfma_f32_16x16x32_bf16 v[156:159], v[160:163], v[212:215], v[156:159]
ds_read_b64_tr_b16 v[178:179], v46 offset:6144
s_waitcnt lgkmcnt(6)
s_waitcnt vmcnt(17)
v_mfma_f32_16x16x32_bf16 v[64:67], v[164:167], v[216:219], v[64:67]
s_add_u32 m0, s43, 0
s_add_u32 s44, s40, 516096
ds_read_b64_tr_b16 v[160:161], v37 offset:1024
s_waitcnt vmcnt(16)
v_mfma_f32_16x16x32_bf16 v[68:71], v[164:167], v[220:223], v[68:71]
ds_read_b64_tr_b16 v[162:163], v37 offset:7168
s_waitcnt lgkmcnt(6)
v_mfma_f32_16x16x32_bf16 v[72:75], v[168:171], v[216:219], v[72:75]
buffer_load_dwordx4 v48, s[12:15], s44 offen lds
v_mfma_f32_16x16x32_bf16 v[76:79], v[168:171], v[220:223], v[76:79]
ds_read_b64_tr_b16 v[164:165], v40 offset:1024
ds_read_b64_tr_b16 v[166:167], v40 offset:7168
s_waitcnt lgkmcnt(6)
v_mfma_f32_16x16x32_bf16 v[80:83], v[172:175], v[216:219], v[80:83]
buffer_load_dwordx4 v49, s[12:15], s44 offen offset:1024 lds
v_mfma_f32_16x16x32_bf16 v[84:87], v[172:175], v[220:223], v[84:87]
ds_read_b64_tr_b16 v[168:169], v43 offset:1024
ds_read_b64_tr_b16 v[170:171], v43 offset:7168
s_waitcnt lgkmcnt(6)
v_mfma_f32_16x16x32_bf16 v[88:91], v[176:179], v[216:219], v[88:91]
buffer_load_dwordx4 v50, s[12:15], s44 offen offset:2048 lds
v_mfma_f32_16x16x32_bf16 v[92:95], v[176:179], v[220:223], v[92:95]
ds_read_b64_tr_b16 v[172:173], v46 offset:1024
ds_read_b64_tr_b16 v[174:175], v46 offset:7168
s_waitcnt lgkmcnt(6)
v_mfma_f32_16x16x32_bf16 v[96:99], v[160:163], v[216:219], v[96:99]
s_add_u32 s45, s41, 30720
ds_read_b64_tr_b16 v[176:177], v37 offset:2048
v_mfma_f32_16x16x32_bf16 v[100:103], v[160:163], v[220:223], v[100:103]
ds_read_b64_tr_b16 v[178:179], v37 offset:8192
s_waitcnt lgkmcnt(6)
v_mfma_f32_16x16x32_bf16 v[104:107], v[164:167], v[216:219], v[104:107]
buffer_load_dwordx4 v[208:211], v15, s[16:19], s45 offen sc1
v_mfma_f32_16x16x32_bf16 v[108:111], v[164:167], v[220:223], v[108:111]
ds_read_b64_tr_b16 v[160:161], v40 offset:2048
ds_read_b64_tr_b16 v[162:163], v40 offset:8192
s_waitcnt lgkmcnt(6)
v_mfma_f32_16x16x32_bf16 v[112:115], v[168:171], v[216:219], v[112:115]
buffer_load_dwordx4 v[212:215], v51, s[16:19], s45 offen sc1
v_mfma_f32_16x16x32_bf16 v[116:119], v[168:171], v[220:223], v[116:119]
ds_read_b64_tr_b16 v[164:165], v43 offset:2048
ds_read_b64_tr_b16 v[166:167], v43 offset:8192
s_waitcnt lgkmcnt(6)
v_mfma_f32_16x16x32_bf16 v[120:123], v[172:175], v[216:219], v[120:123]
ds_read_b64_tr_b16 v[168:169], v46 offset:2048
v_mfma_f32_16x16x32_bf16 v[124:127], v[172:175], v[220:223], v[124:127]
ds_read_b64_tr_b16 v[170:171], v46 offset:8192
s_waitcnt lgkmcnt(6)
v_mfma_f32_16x16x32_bf16 v[128:131], v[176:179], v[216:219], v[128:131]
ds_read_b64_tr_b16 v[172:173], v37 offset:12288
v_mfma_f32_16x16x32_bf16 v[132:135], v[176:179], v[220:223], v[132:135]
ds_read_b64_tr_b16 v[174:175], v37 offset:18432
s_waitcnt lgkmcnt(6)
v_mfma_f32_16x16x32_bf16 v[136:139], v[160:163], v[216:219], v[136:139]
ds_read_b64_tr_b16 v[176:177], v40 offset:12288
v_mfma_f32_16x16x32_bf16 v[140:143], v[160:163], v[220:223], v[140:143]
ds_read_b64_tr_b16 v[178:179], v40 offset:18432
s_waitcnt lgkmcnt(6)
v_mfma_f32_16x16x32_bf16 v[144:147], v[164:167], v[216:219], v[144:147]
ds_read_b64_tr_b16 v[160:161], v43 offset:12288
v_mfma_f32_16x16x32_bf16 v[148:151], v[164:167], v[220:223], v[148:151]
ds_read_b64_tr_b16 v[162:163], v43 offset:18432
s_waitcnt lgkmcnt(6)
v_mfma_f32_16x16x32_bf16 v[152:155], v[168:171], v[216:219], v[152:155]
ds_read_b64_tr_b16 v[164:165], v46 offset:12288
v_mfma_f32_16x16x32_bf16 v[156:159], v[168:171], v[220:223], v[156:159]
ds_read_b64_tr_b16 v[166:167], v46 offset:18432
s_waitcnt lgkmcnt(6)
s_waitcnt vmcnt(17)
v_mfma_f32_16x16x32_bf16 v[64:67], v[172:175], v[224:227], v[64:67]
s_add_u32 m0, s43, 12288
s_add_u32 s44, s40, 552960
ds_read_b64_tr_b16 v[168:169], v37 offset:13312
s_waitcnt vmcnt(16)
v_mfma_f32_16x16x32_bf16 v[68:71], v[172:175], v[228:231], v[68:71]
ds_read_b64_tr_b16 v[170:171], v37 offset:19456
s_waitcnt lgkmcnt(6)
v_mfma_f32_16x16x32_bf16 v[72:75], v[176:179], v[224:227], v[72:75]
buffer_load_dwordx4 v48, s[12:15], s44 offen lds
v_mfma_f32_16x16x32_bf16 v[76:79], v[176:179], v[228:231], v[76:79]
ds_read_b64_tr_b16 v[172:173], v40 offset:13312
ds_read_b64_tr_b16 v[174:175], v40 offset:19456
s_waitcnt lgkmcnt(6)
v_mfma_f32_16x16x32_bf16 v[80:83], v[160:163], v[224:227], v[80:83]
buffer_load_dwordx4 v49, s[12:15], s44 offen offset:1024 lds
v_mfma_f32_16x16x32_bf16 v[84:87], v[160:163], v[228:231], v[84:87]
ds_read_b64_tr_b16 v[176:177], v43 offset:13312
ds_read_b64_tr_b16 v[178:179], v43 offset:19456
s_waitcnt lgkmcnt(6)
v_mfma_f32_16x16x32_bf16 v[88:91], v[164:167], v[224:227], v[88:91]
buffer_load_dwordx4 v50, s[12:15], s44 offen offset:2048 lds
v_mfma_f32_16x16x32_bf16 v[92:95], v[164:167], v[228:231], v[92:95]
ds_read_b64_tr_b16 v[160:161], v46 offset:13312
ds_read_b64_tr_b16 v[162:163], v46 offset:19456
s_waitcnt lgkmcnt(6)
v_mfma_f32_16x16x32_bf16 v[96:99], v[168:171], v[224:227], v[96:99]
s_add_u32 s45, s41, 31744
ds_read_b64_tr_b16 v[164:165], v37 offset:14336
v_mfma_f32_16x16x32_bf16 v[100:103], v[168:171], v[228:231], v[100:103]
ds_read_b64_tr_b16 v[166:167], v37 offset:20480
s_waitcnt lgkmcnt(6)
v_mfma_f32_16x16x32_bf16 v[104:107], v[172:175], v[224:227], v[104:107]
buffer_load_dwordx4 v[216:219], v15, s[16:19], s45 offen sc1
v_mfma_f32_16x16x32_bf16 v[108:111], v[172:175], v[228:231], v[108:111]
ds_read_b64_tr_b16 v[168:169], v40 offset:14336
ds_read_b64_tr_b16 v[170:171], v40 offset:20480
s_waitcnt lgkmcnt(6)
v_mfma_f32_16x16x32_bf16 v[112:115], v[176:179], v[224:227], v[112:115]
buffer_load_dwordx4 v[220:223], v51, s[16:19], s45 offen sc1
v_mfma_f32_16x16x32_bf16 v[116:119], v[176:179], v[228:231], v[116:119]
ds_read_b64_tr_b16 v[172:173], v43 offset:14336
ds_read_b64_tr_b16 v[174:175], v43 offset:20480
s_waitcnt lgkmcnt(6)
v_mfma_f32_16x16x32_bf16 v[120:123], v[160:163], v[224:227], v[120:123]
ds_read_b64_tr_b16 v[176:177], v46 offset:14336
v_mfma_f32_16x16x32_bf16 v[124:127], v[160:163], v[228:231], v[124:127]
ds_read_b64_tr_b16 v[178:179], v46 offset:20480
s_waitcnt lgkmcnt(6)
v_mfma_f32_16x16x32_bf16 v[128:131], v[164:167], v[224:227], v[128:131]
ds_read_b64_tr_b16 v[160:161], v37 offset:24576
v_mfma_f32_16x16x32_bf16 v[132:135], v[164:167], v[228:231], v[132:135]
ds_read_b64_tr_b16 v[162:163], v37 offset:30720
s_waitcnt lgkmcnt(6)
v_mfma_f32_16x16x32_bf16 v[136:139], v[168:171], v[224:227], v[136:139]
ds_read_b64_tr_b16 v[164:165], v40 offset:24576
v_mfma_f32_16x16x32_bf16 v[140:143], v[168:171], v[228:231], v[140:143]
ds_read_b64_tr_b16 v[166:167], v40 offset:30720
s_waitcnt lgkmcnt(6)
v_mfma_f32_16x16x32_bf16 v[144:147], v[172:175], v[224:227], v[144:147]
ds_read_b64_tr_b16 v[168:169], v43 offset:24576
v_mfma_f32_16x16x32_bf16 v[148:151], v[172:175], v[228:231], v[148:151]
ds_read_b64_tr_b16 v[170:171], v43 offset:30720
s_waitcnt lgkmcnt(6)
v_mfma_f32_16x16x32_bf16 v[152:155], v[176:179], v[224:227], v[152:155]
ds_read_b64_tr_b16 v[172:173], v46 offset:24576
v_mfma_f32_16x16x32_bf16 v[156:159], v[176:179], v[228:231], v[156:159]
ds_read_b64_tr_b16 v[174:175], v46 offset:30720
s_waitcnt vmcnt(17)
s_barrier
v_cmp_ne_u32 vcc, s100, v59
s_mov_b32 s56, 0x40000
s_nop 3
s_cbranch_vccz FCD_11
FC_11:
global_load_dword v59, v58, s[6:7] sc1
s_waitcnt vmcnt(0)
v_cmp_ne_u32 vcc, s100, v59
s_sub_u32 s56, s56, 1
s_cmp_eq_u32 s56, 0
s_cbranch_scc1 FCD_11
s_nop 1
s_cbranch_vccnz FC_11
FCD_11:
s_waitcnt lgkmcnt(6)
s_waitcnt vmcnt(16)
v_mfma_f32_16x16x32_bf16 v[64:67], v[160:163], v[192:195], v[64:67]
s_add_u32 m0, s43, 24576
s_add_u32 s44, s40, 884736
ds_read_b64_tr_b16 v[176:177], v37 offset:25600
s_waitcnt vmcnt(15)
v_mfma_f32_16x16x32_bf16 v[68:71], v[160:163], v[196:199], v[68:71]
ds_read_b64_tr_b16 v[178:179], v37 offset:31744
s_waitcnt lgkmcnt(6)
v_mfma_f32_16x16x32_bf16 v[72:75], v[164:167], v[192:195], v[72:75]
buffer_load_dwordx4 v48, s[12:15], s44 offen lds
v_mfma_f32_16x16x32_bf16 v[76:79], v[164:167], v[196:199], v[76:79]
ds_read_b64_tr_b16 v[160:161], v40 offset:25600
ds_read_b64_tr_b16 v[162:163], v40 offset:31744
s_waitcnt lgkmcnt(6)
v_mfma_f32_16x16x32_bf16 v[80:83], v[168:171], v[192:195], v[80:83]
buffer_load_dwordx4 v49, s[12:15], s44 offen offset:1024 lds
v_mfma_f32_16x16x32_bf16 v[84:87], v[168:171], v[196:199], v[84:87]
ds_read_b64_tr_b16 v[164:165], v43 offset:25600
ds_read_b64_tr_b16 v[166:167], v43 offset:31744
s_waitcnt lgkmcnt(6)
v_mfma_f32_16x16x32_bf16 v[88:91], v[172:175], v[192:195], v[88:91]
buffer_load_dwordx4 v50, s[12:15], s44 offen offset:2048 lds
v_mfma_f32_16x16x32_bf16 v[92:95], v[172:175], v[196:199], v[92:95]
ds_read_b64_tr_b16 v[168:169], v46 offset:25600
ds_read_b64_tr_b16 v[170:171], v46 offset:31744
s_waitcnt lgkmcnt(6)
v_mfma_f32_16x16x32_bf16 v[96:99], v[176:179], v[192:195], v[96:99]
s_add_u32 s45, s41, 6144
ds_read_b64_tr_b16 v[172:173], v37 offset:26624
v_mfma_f32_16x16x32_bf16 v[100:103], v[176:179], v[196:199], v[100:103]
ds_read_b64_tr_b16 v[174:175], v37 offset:32768
s_waitcnt lgkmcnt(6)
v_mfma_f32_16x16x32_bf16 v[104:107], v[160:163], v[192:195], v[104:107]
buffer_load_dwordx4 v[224:227], v15, s[16:19], s45 offen sc1
v_mfma_f32_16x16x32_bf16 v[108:111], v[160:163], v[196:199], v[108:111]
ds_read_b64_tr_b16 v[176:177], v40 offset:26624
ds_read_b64_tr_b16 v[178:179], v40 offset:32768
s_waitcnt lgkmcnt(6)
v_mfma_f32_16x16x32_bf16 v[112:115], v[164:167], v[192:195], v[112:115]
buffer_load_dwordx4 v[228:231], v51, s[16:19], s45 offen sc1
v_mfma_f32_16x16x32_bf16 v[116:119], v[164:167], v[196:199], v[116:119]
ds_read_b64_tr_b16 v[160:161], v43 offset:26624
ds_read_b64_tr_b16 v[162:163], v43 offset:32768
s_waitcnt lgkmcnt(6)
v_mfma_f32_16x16x32_bf16 v[120:123], v[168:171], v[192:195], v[120:123]
ds_read_b64_tr_b16 v[164:165], v46 offset:26624
v_mfma_f32_16x16x32_bf16 v[124:127], v[168:171], v[196:199], v[124:127]
ds_read_b64_tr_b16 v[166:167], v46 offset:32768
s_waitcnt lgkmcnt(6)
v_mfma_f32_16x16x32_bf16 v[128:131], v[172:175], v[192:195], v[128:131]
ds_read_b64_tr_b16 v[168:169], v37 offset:36864
v_mfma_f32_16x16x32_bf16 v[132:135], v[172:175], v[196:199], v[132:135]
ds_read_b64_tr_b16 v[170:171], v37 offset:43008
s_waitcnt lgkmcnt(6)
v_mfma_f32_16x16x32_bf16 v[136:139], v[176:179], v[192:195], v[136:139]
ds_read_b64_tr_b16 v[172:173], v40 offset:36864
v_mfma_f32_16x16x32_bf16 v[140:143], v[176:179], v[196:199], v[140:143]
ds_read_b64_tr_b16 v[174:175], v40 offset:43008
s_waitcnt lgkmcnt(6)
v_mfma_f32_16x16x32_bf16 v[144:147], v[160:163], v[192:195], v[144:147]
ds_read_b64_tr_b16 v[176:177], v43 offset:36864
v_mfma_f32_16x16x32_bf16 v[148:151], v[160:163], v[196:199], v[148:151]
ds_read_b64_tr_b16 v[178:179], v43 offset:43008
s_waitcnt lgkmcnt(6)
v_mfma_f32_16x16x32_bf16 v[152:155], v[164:167], v[192:195], v[152:155]
ds_read_b64_tr_b16 v[160:161], v46 offset:36864
v_mfma_f32_16x16x32_bf16 v[156:159], v[164:167], v[196:199], v[156:159]
ds_read_b64_tr_b16 v[162:163], v46 offset:43008
s_waitcnt lgkmcnt(6)
s_waitcnt vmcnt(16)
v_mfma_f32_16x16x32_bf16 v[64:67], v[168:171], v[200:203], v[64:67]
s_add_u32 m0, s43, 36864
s_add_u32 s44, s40, 921600
ds_read_b64_tr_b16 v[164:165], v37 offset:37888
s_waitcnt vmcnt(15)
v_mfma_f32_16x16x32_bf16 v[68:71], v[168:171], v[204:207], v[68:71]
ds_read_b64_tr_b16 v[166:167], v37 offset:44032
s_waitcnt lgkmcnt(6)
v_mfma_f32_16x16x32_bf16 v[72:75], v[172:175], v[200:203], v[72:75]
buffer_load_dwordx4 v48, s[12:15], s44 offen lds
v_mfma_f32_16x16x32_bf16 v[76:79], v[172:175], v[204:207], v[76:79]
ds_read_b64_tr_b16 v[168:169], v40 offset:37888
ds_read_b64_tr_b16 v[170:171], v40 offset:44032
s_waitcnt lgkmcnt(6)
v_mfma_f32_16x16x32_bf16 v[80:83], v[176:179], v[200:203], v[80:83]
buffer_load_dwordx4 v49, s[12:15], s44 offen offset:1024 lds
v_mfma_f32_16x16x32_bf16 v[84:87], v[176:179], v[204:207], v[84:87]
ds_read_b64_tr_b16 v[172:173], v43 offset:37888
ds_read_b64_tr_b16 v[174:175], v43 offset:44032
s_waitcnt lgkmcnt(6)
v_mfma_f32_16x16x32_bf16 v[88:91], v[160:163], v[200:203], v[88:91]
buffer_load_dwordx4 v50, s[12:15], s44 offen offset:2048 lds
v_mfma_f32_16x16x32_bf16 v[92:95], v[160:163], v[204:207], v[92:95]
ds_read_b64_tr_b16 v[176:177], v46 offset:37888
ds_read_b64_tr_b16 v[178:179], v46 offset:44032
s_waitcnt lgkmcnt(6)
v_mfma_f32_16x16x32_bf16 v[96:99], v[164:167], v[200:203], v[96:99]
s_add_u32 s45, s41, 7168
ds_read_b64_tr_b16 v[160:161], v37 offset:38912
v_mfma_f32_16x16x32_bf16 v[100:103], v[164:167], v[204:207], v[100:103]
ds_read_b64_tr_b16 v[162:163], v37 offset:45056
s_waitcnt lgkmcnt(6)
v_mfma_f32_16x16x32_bf16 v[104:107], v[168:171], v[200:203], v[104:107]
buffer_load_dwordx4 v[192:195], v15, s[16:19], s45 offen sc1
v_mfma_f32_16x16x32_bf16 v[108:111], v[168:171], v[204:207], v[108:111]
ds_read_b64_tr_b16 v[164:165], v40 offset:38912
ds_read_b64_tr_b16 v[166:167], v40 offset:45056
s_waitcnt lgkmcnt(6)
v_mfma_f32_16x16x32_bf16 v[112:115], v[172:175], v[200:203], v[112:115]
buffer_load_dwordx4 v[196:199], v51, s[16:19], s45 offen sc1
v_mfma_f32_16x16x32_bf16 v[116:119], v[172:175], v[204:207], v[116:119]
ds_read_b64_tr_b16 v[168:169], v43 offset:38912
ds_read_b64_tr_b16 v[170:171], v43 offset:45056
s_waitcnt lgkmcnt(6)
v_mfma_f32_16x16x32_bf16 v[120:123], v[176:179], v[200:203], v[120:123]
ds_read_b64_tr_b16 v[172:173], v46 offset:38912
v_mfma_f32_16x16x32_bf16 v[124:127], v[176:179], v[204:207], v[124:127]
ds_read_b64_tr_b16 v[174:175], v46 offset:45056
s_waitcnt lgkmcnt(6)
v_mfma_f32_16x16x32_bf16 v[128:131], v[160:163], v[200:203], v[128:131]
ds_read_b64_tr_b16 v[176:177], v37 offset:49152
v_mfma_f32_16x16x32_bf16 v[132:135], v[160:163], v[204:207], v[132:135]
ds_read_b64_tr_b16 v[178:179], v37 offset:55296
s_waitcnt lgkmcnt(6)
v_mfma_f32_16x16x32_bf16 v[136:139], v[164:167], v[200:203], v[136:139]
ds_read_b64_tr_b16 v[160:161], v40 offset:49152
v_mfma_f32_16x16x32_bf16 v[140:143], v[164:167], v[204:207], v[140:143]
ds_read_b64_tr_b16 v[162:163], v40 offset:55296
s_waitcnt lgkmcnt(6)
v_mfma_f32_16x16x32_bf16 v[144:147], v[168:171], v[200:203], v[144:147]
ds_read_b64_tr_b16 v[164:165], v43 offset:49152
v_mfma_f32_16x16x32_bf16 v[148:151], v[168:171], v[204:207], v[148:151]
ds_read_b64_tr_b16 v[166:167], v43 offset:55296
s_waitcnt lgkmcnt(6)
v_mfma_f32_16x16x32_bf16 v[152:155], v[172:175], v[200:203], v[152:155]
ds_read_b64_tr_b16 v[168:169], v46 offset:49152
v_mfma_f32_16x16x32_bf16 v[156:159], v[172:175], v[204:207], v[156:159]
ds_read_b64_tr_b16 v[170:171], v46 offset:55296
s_waitcnt lgkmcnt(6)
s_waitcnt vmcnt(16)
v_mfma_f32_16x16x32_bf16 v[64:67], v[176:179], v[208:211], v[64:67]
s_add_u32 m0, s43, 49152
s_add_u32 s44, s40, 1179648
ds_read_b64_tr_b16 v[172:173], v37 offset:50176
s_waitcnt vmcnt(15)
v_mfma_f32_16x16x32_bf16 v[68:71], v[176:179], v[212:215], v[68:71]
ds_read_b64_tr_b16 v[174:175], v37 offset:56320
s_waitcnt lgkmcnt(6)
v_mfma_f32_16x16x32_bf16 v[72:75], v[160:163], v[208:211], v[72:75]
buffer_load_dwordx4 v48, s[12:15], s44 offen lds
v_mfma_f32_16x16x32_bf16 v[76:79], v[160:163], v[212:215], v[76:79]
ds_read_b64_tr_b16 v[176:177], v40 offset:50176
ds_read_b64_tr_b16 v[178:179], v40 offset:56320
s_waitcnt lgkmcnt(6)
v_mfma_f32_16x16x32_bf16 v[80:83], v[164:167], v[208:211], v[80:83]
buffer_load_dwordx4 v49, s[12:15], s44 offen offset:1024 lds
v_mfma_f32_16x16x32_bf16 v[84:87], v[164:167], v[212:215], v[84:87]
ds_read_b64_tr_b16 v[160:161], v43 offset:50176
ds_read_b64_tr_b16 v[162:163], v43 offset:56320
s_waitcnt lgkmcnt(6)
v_mfma_f32_16x16x32_bf16 v[88:91], v[168:171], v[208:211], v[88:91]
buffer_load_dwordx4 v50, s[12:15], s44 offen offset:2048 lds
v_mfma_f32_16x16x32_bf16 v[92:95], v[168:171], v[212:215], v[92:95]
ds_read_b64_tr_b16 v[164:165], v46 offset:50176
ds_read_b64_tr_b16 v[166:167], v46 offset:56320
s_waitcnt lgkmcnt(6)
v_mfma_f32_16x16x32_bf16 v[96:99], v[172:175], v[208:211], v[96:99]
s_add_u32 s45, s41, 14336
ds_read_b64_tr_b16 v[168:169], v37 offset:51200
v_mfma_f32_16x16x32_bf16 v[100:103], v[172:175], v[212:215], v[100:103]
ds_read_b64_tr_b16 v[170:171], v37 offset:57344
s_waitcnt lgkmcnt(6)
v_mfma_f32_16x16x32_bf16 v[104:107], v[176:179], v[208:211], v[104:107]
buffer_load_dwordx4 v[200:203], v15, s[16:19], s45 offen sc1
v_mfma_f32_16x16x32_bf16 v[108:111], v[176:179], v[212:215], v[108:111]
ds_read_b64_tr_b16 v[172:173], v40 offset:51200
ds_read_b64_tr_b16 v[174:175], v40 offset:57344
s_waitcnt lgkmcnt(6)
v_mfma_f32_16x16x32_bf16 v[112:115], v[160:163], v[208:211], v[112:115]
buffer_load_dwordx4 v[204:207], v51, s[16:19], s45 offen sc1
v_mfma_f32_16x16x32_bf16 v[116:119], v[160:163], v[212:215], v[116:119]
ds_read_b64_tr_b16 v[176:177], v43 offset:51200
ds_read_b64_tr_b16 v[178:179], v43 offset:57344
s_waitcnt lgkmcnt(6)
v_mfma_f32_16x16x32_bf16 v[120:123], v[164:167], v[208:211], v[120:123]
ds_read_b64_tr_b16 v[160:161], v46 offset:51200
v_mfma_f32_16x16x32_bf16 v[124:127], v[164:167], v[212:215], v[124:127]
ds_read_b64_tr_b16 v[162:163], v46 offset:57344
s_waitcnt lgkmcnt(6)
v_mfma_f32_16x16x32_bf16 v[128:131], v[168:171], v[208:211], v[128:131]
ds_read_b64_tr_b16 v[164:165], v38 offset:0
v_mfma_f32_16x16x32_bf16 v[132:135], v[168:171], v[212:215], v[132:135]
ds_read_b64_tr_b16 v[166:167], v38 offset:6144
s_waitcnt lgkmcnt(6)
v_mfma_f32_16x16x32_bf16 v[136:139], v[172:175], v[208:211], v[136:139]
ds_read_b64_tr_b16 v[168:169], v41 offset:0
v_mfma_f32_16x16x32_bf16 v[140:143], v[172:175], v[212:215], v[140:143]
ds_read_b64_tr_b16 v[170:171], v41 offset:6144
s_waitcnt lgkmcnt(6)
v_mfma_f32_16x16x32_bf16 v[144:147], v[176:179], v[208:211], v[144:147]
ds_read_b64_tr_b16 v[172:173], v44 offset:0
v_mfma_f32_16x16x32_bf16 v[148:151], v[176:179], v[212:215], v[148:151]
ds_read_b64_tr_b16 v[174:175], v44 offset:6144
s_waitcnt lgkmcnt(6)
v_mfma_f32_16x16x32_bf16 v[152:155], v[160:163], v[208:211], v[152:155]
ds_read_b64_tr_b16 v[176:177], v47 offset:0
v_mfma_f32_16x16x32_bf16 v[156:159], v[160:163], v[212:215], v[156:159]
ds_read_b64_tr_b16 v[178:179], v47 offset:6144
s_waitcnt lgkmcnt(6)
s_waitcnt vmcnt(16)
v_mfma_f32_16x16x32_bf16 v[64:67], v[164:167], v[216:219], v[64:67]
s_add_u32 m0, s43, 61440
s_add_u32 s44, s40, 1216512
ds_read_b64_tr_b16 v[160:161], v38 offset:1024
s_waitcnt vmcnt(15)
v_mfma_f32_16x16x32_bf16 v[68:71], v[164:167], v[220:223], v[68:71]
ds_read_b64_tr_b16 v[162:163], v38 offset:7168
s_waitcnt lgkmcnt(6)
v_mfma_f32_16x16x32_bf16 v[72:75], v[168:171], v[216:219], v[72:75]
buffer_load_dwordx4 v48, s[12:15], s44 offen lds
v_mfma_f32_16x16x32_bf16 v[76:79], v[168:171], v[220:223], v[76:79]
ds_read_b64_tr_b16 v[164:165], v41 offset:1024
ds_read_b64_tr_b16 v[166:167], v41 offset:7168
s_waitcnt lgkmcnt(6)
v_mfma_f32_16x16x32_bf16 v[80:83], v[172:175], v[216:219], v[80:83]
buffer_load_dwordx4 v49, s[12:15], s44 offen offset:1024 lds
v_mfma_f32_16x16x32_bf16 v[84:87], v[172:175], v[220:223], v[84:87]
ds_read_b64_tr_b16 v[168:169], v44 offset:1024
ds_read_b64_tr_b16 v[170:171], v44 offset:7168
s_waitcnt lgkmcnt(6)
v_mfma_f32_16x16x32_bf16 v[88:91], v[176:179], v[216:219], v[88:91]
buffer_load_dwordx4 v50, s[12:15], s44 offen offset:2048 lds
v_mfma_f32_16x16x32_bf16 v[92:95], v[176:179], v[220:223], v[92:95]
ds_read_b64_tr_b16 v[172:173], v47 offset:1024
ds_read_b64_tr_b16 v[174:175], v47 offset:7168
s_waitcnt lgkmcnt(6)
v_mfma_f32_16x16x32_bf16 v[96:99], v[160:163], v[216:219], v[96:99]
s_add_u32 s45, s41, 15360
ds_read_b64_tr_b16 v[176:177], v38 offset:2048
v_mfma_f32_16x16x32_bf16 v[100:103], v[160:163], v[220:223], v[100:103]
ds_read_b64_tr_b16 v[178:179], v38 offset:8192
s_waitcnt lgkmcnt(6)
v_mfma_f32_16x16x32_bf16 v[104:107], v[164:167], v[216:219], v[104:107]
buffer_load_dwordx4 v[208:211], v15, s[16:19], s45 offen sc1
v_mfma_f32_16x16x32_bf16 v[108:111], v[164:167], v[220:223], v[108:111]
ds_read_b64_tr_b16 v[160:161], v41 offset:2048
ds_read_b64_tr_b16 v[162:163], v41 offset:8192
s_waitcnt lgkmcnt(6)
v_mfma_f32_16x16x32_bf16 v[112:115], v[168:171], v[216:219], v[112:115]
buffer_load_dwordx4 v[212:215], v51, s[16:19], s45 offen sc1
v_mfma_f32_16x16x32_bf16 v[116:119], v[168:171], v[220:223], v[116:119]
ds_read_b64_tr_b16 v[164:165], v44 offset:2048
ds_read_b64_tr_b16 v[166:167], v44 offset:8192
s_waitcnt lgkmcnt(6)
v_mfma_f32_16x16x32_bf16 v[120:123], v[172:175], v[216:219], v[120:123]
ds_read_b64_tr_b16 v[168:169], v47 offset:2048
v_mfma_f32_16x16x32_bf16 v[124:127], v[172:175], v[220:223], v[124:127]
ds_read_b64_tr_b16 v[170:171], v47 offset:8192
s_waitcnt lgkmcnt(6)
v_mfma_f32_16x16x32_bf16 v[128:131], v[176:179], v[216:219], v[128:131]
ds_read_b64_tr_b16 v[172:173], v38 offset:12288
v_mfma_f32_16x16x32_bf16 v[132:135], v[176:179], v[220:223], v[132:135]
ds_read_b64_tr_b16 v[174:175], v38 offset:18432
s_waitcnt lgkmcnt(6)
v_mfma_f32_16x16x32_bf16 v[136:139], v[160:163], v[216:219], v[136:139]
ds_read_b64_tr_b16 v[176:177], v41 offset:12288
v_mfma_f32_16x16x32_bf16 v[140:143], v[160:163], v[220:223], v[140:143]
ds_read_b64_tr_b16 v[178:179], v41 offset:18432
s_waitcnt lgkmcnt(6)
v_mfma_f32_16x16x32_bf16 v[144:147], v[164:167], v[216:219], v[144:147]
ds_read_b64_tr_b16 v[160:161], v44 offset:12288
v_mfma_f32_16x16x32_bf16 v[148:151], v[164:167], v[220:223], v[148:151]
ds_read_b64_tr_b16 v[162:163], v44 offset:18432
s_waitcnt lgkmcnt(6)
v_mfma_f32_16x16x32_bf16 v[152:155], v[168:171], v[216:219], v[152:155]
ds_read_b64_tr_b16 v[164:165], v47 offset:12288
v_mfma_f32_16x16x32_bf16 v[156:159], v[168:171], v[220:223], v[156:159]
ds_read_b64_tr_b16 v[166:167], v47 offset:18432
s_waitcnt vmcnt(17)
s_barrier
s_waitcnt lgkmcnt(6)
s_waitcnt vmcnt(16)
v_mfma_f32_16x16x32_bf16 v[64:67], v[172:175], v[224:227], v[64:67]
s_add_u32 m0, s43, 73728
s_add_u32 s44, s40, 589824
ds_read_b64_tr_b16 v[168:169], v38 offset:13312
s_waitcnt vmcnt(15)
v_mfma_f32_16x16x32_bf16 v[68:71], v[172:175], v[228:231], v[68:71]
ds_read_b64_tr_b16 v[170:171], v38 offset:19456
s_waitcnt lgkmcnt(6)
v_mfma_f32_16x16x32_bf16 v[72:75], v[176:179], v[224:227], v[72:75]
buffer_load_dwordx4 v48, s[12:15], s44 offen lds
v_mfma_f32_16x16x32_bf16 v[76:79], v[176:179], v[228:231], v[76:79]
ds_read_b64_tr_b16 v[172:173], v41 offset:13312
ds_read_b64_tr_b16 v[174:175], v41 offset:19456
s_waitcnt lgkmcnt(6)
v_mfma_f32_16x16x32_bf16 v[80:83], v[160:163], v[224:227], v[80:83]
buffer_load_dwordx4 v49, s[12:15], s44 offen offset:1024 lds
v_mfma_f32_16x16x32_bf16 v[84:87], v[160:163], v[228:231], v[84:87]
ds_read_b64_tr_b16 v[176:177], v44 offset:13312
ds_read_b64_tr_b16 v[178:179], v44 offset:19456
s_waitcnt lgkmcnt(6)
v_mfma_f32_16x16x32_bf16 v[88:91], v[164:167], v[224:227], v[88:91]
buffer_load_dwordx4 v50, s[12:15], s44 offen offset:2048 lds
v_mfma_f32_16x16x32_bf16 v[92:95], v[164:167], v[228:231], v[92:95]
ds_read_b64_tr_b16 v[160:161], v47 offset:13312
ds_read_b64_tr_b16 v[162:163], v47 offset:19456
s_waitcnt lgkmcnt(6)
v_mfma_f32_16x16x32_bf16 v[96:99], v[168:171], v[224:227], v[96:99]
s_add_u32 s45, s41, 24576
ds_read_b64_tr_b16 v[164:165], v38 offset:14336
v_mfma_f32_16x16x32_bf16 v[100:103], v[168:171], v[228:231], v[100:103]
ds_read_b64_tr_b16 v[166:167], v38 offset:20480
s_waitcnt lgkmcnt(6)
v_mfma_f32_16x16x32_bf16 v[104:107], v[172:175], v[224:227], v[104:107]
buffer_load_dwordx4 v[216:219], v15, s[16:19], s45 offen sc1
v_mfma_f32_16x16x32_bf16 v[108:111], v[172:175], v[228:231], v[108:111]
ds_read_b64_tr_b16 v[168:169], v41 offset:14336
ds_read_b64_tr_b16 v[170:171], v41 offset:20480
s_waitcnt lgkmcnt(6)
v_mfma_f32_16x16x32_bf16 v[112:115], v[176:179], v[224:227], v[112:115]
buffer_load_dwordx4 v[220:223], v51, s[16:19], s45 offen sc1
v_mfma_f32_16x16x32_bf16 v[116:119], v[176:179], v[228:231], v[116:119]
ds_read_b64_tr_b16 v[172:173], v44 offset:14336
ds_read_b64_tr_b16 v[174:175], v44 offset:20480
s_waitcnt lgkmcnt(6)
v_mfma_f32_16x16x32_bf16 v[120:123], v[160:163], v[224:227], v[120:123]
ds_read_b64_tr_b16 v[176:177], v47 offset:14336
v_mfma_f32_16x16x32_bf16 v[124:127], v[160:163], v[228:231], v[124:127]
ds_read_b64_tr_b16 v[178:179], v47 offset:20480
s_waitcnt lgkmcnt(6)
v_mfma_f32_16x16x32_bf16 v[128:131], v[164:167], v[224:227], v[128:131]
ds_read_b64_tr_b16 v[160:161], v38 offset:24576
v_mfma_f32_16x16x32_bf16 v[132:135], v[164:167], v[228:231], v[132:135]
ds_read_b64_tr_b16 v[162:163], v38 offset:30720
s_waitcnt lgkmcnt(6)
v_mfma_f32_16x16x32_bf16 v[136:139], v[168:171], v[224:227], v[136:139]
ds_read_b64_tr_b16 v[164:165], v41 offset:24576
v_mfma_f32_16x16x32_bf16 v[140:143], v[168:171], v[228:231], v[140:143]
ds_read_b64_tr_b16 v[166:167], v41 offset:30720
s_waitcnt lgkmcnt(6)
v_mfma_f32_16x16x32_bf16 v[144:147], v[172:175], v[224:227], v[144:147]
ds_read_b64_tr_b16 v[168:169], v44 offset:24576
v_mfma_f32_16x16x32_bf16 v[148:151], v[172:175], v[228:231], v[148:151]
ds_read_b64_tr_b16 v[170:171], v44 offset:30720
s_waitcnt lgkmcnt(6)
v_mfma_f32_16x16x32_bf16 v[152:155], v[176:179], v[224:227], v[152:155]
ds_read_b64_tr_b16 v[172:173], v47 offset:24576
v_mfma_f32_16x16x32_bf16 v[156:159], v[176:179], v[228:231], v[156:159]
ds_read_b64_tr_b16 v[174:175], v47 offset:30720
s_waitcnt lgkmcnt(6)
s_waitcnt vmcnt(16)
v_mfma_f32_16x16x32_bf16 v[64:67], v[160:163], v[192:195], v[64:67]
s_add_u32 m0, s43, 86016
s_add_u32 s44, s40, 626688
ds_read_b64_tr_b16 v[176:177], v38 offset:25600
s_waitcnt vmcnt(15)
v_mfma_f32_16x16x32_bf16 v[68:71], v[160:163], v[196:199], v[68:71]
ds_read_b64_tr_b16 v[178:179], v38 offset:31744
s_waitcnt lgkmcnt(6)
v_mfma_f32_16x16x32_bf16 v[72:75], v[164:167], v[192:195], v[72:75]
buffer_load_dwordx4 v48, s[12:15], s44 offen lds
v_mfma_f32_16x16x32_bf16 v[76:79], v[164:167], v[196:199], v[76:79]
ds_read_b64_tr_b16 v[160:161], v41 offset:25600
ds_read_b64_tr_b16 v[162:163], v41 offset:31744
s_waitcnt lgkmcnt(6)
v_mfma_f32_16x16x32_bf16 v[80:83], v[168:171], v[192:195], v[80:83]
buffer_load_dwordx4 v49, s[12:15], s44 offen offset:1024 lds
v_mfma_f32_16x16x32_bf16 v[84:87], v[168:171], v[196:199], v[84:87]
ds_read_b64_tr_b16 v[164:165], v44 offset:25600
ds_read_b64_tr_b16 v[166:167], v44 offset:31744
s_waitcnt lgkmcnt(6)
v_mfma_f32_16x16x32_bf16 v[88:91], v[172:175], v[192:195], v[88:91]
buffer_load_dwordx4 v50, s[12:15], s44 offen offset:2048 lds
v_mfma_f32_16x16x32_bf16 v[92:95], v[172:175], v[196:199], v[92:95]
ds_read_b64_tr_b16 v[168:169], v47 offset:25600
ds_read_b64_tr_b16 v[170:171], v47 offset:31744
s_waitcnt lgkmcnt(6)
v_mfma_f32_16x16x32_bf16 v[96:99], v[176:179], v[192:195], v[96:99]
s_add_u32 s45, s41, 25600
ds_read_b64_tr_b16 v[172:173], v38 offset:26624
v_mfma_f32_16x16x32_bf16 v[100:103], v[176:179], v[196:199], v[100:103]
ds_read_b64_tr_b16 v[174:175], v38 offset:32768
s_waitcnt lgkmcnt(6)
v_mfma_f32_16x16x32_bf16 v[104:107], v[160:163], v[192:195], v[104:107]
buffer_load_dwordx4 v[224:227], v15, s[16:19], s45 offen sc1
v_mfma_f32_16x16x32_bf16 v[108:111], v[160:163], v[196:199], v[108:111]
ds_read_b64_tr_b16 v[176:177], v41 offset:26624
ds_read_b64_tr_b16 v[178:179], v41 offset:32768
s_waitcnt lgkmcnt(6)
v_mfma_f32_16x16x32_bf16 v[112:115], v[164:167], v[192:195], v[112:115]
buffer_load_dwordx4 v[228:231], v51, s[16:19], s45 offen sc1
v_mfma_f32_16x16x32_bf16 v[116:119], v[164:167], v[196:199], v[116:119]
ds_read_b64_tr_b16 v[160:161], v44 offset:26624
ds_read_b64_tr_b16 v[162:163], v44 offset:32768
s_waitcnt lgkmcnt(6)
v_mfma_f32_16x16x32_bf16 v[120:123], v[168:171], v[192:195], v[120:123]
ds_read_b64_tr_b16 v[164:165], v47 offset:26624
v_mfma_f32_16x16x32_bf16 v[124:127], v[168:171], v[196:199], v[124:127]
ds_read_b64_tr_b16 v[166:167], v47 offset:32768
s_waitcnt lgkmcnt(6)
v_mfma_f32_16x16x32_bf16 v[128:131], v[172:175], v[192:195], v[128:131]
ds_read_b64_tr_b16 v[168:169], v36 offset:0
v_mfma_f32_16x16x32_bf16 v[132:135], v[172:175], v[196:199], v[132:135]
ds_read_b64_tr_b16 v[170:171], v36 offset:6144
s_waitcnt lgkmcnt(6)
v_mfma_f32_16x16x32_bf16 v[136:139], v[176:179], v[192:195], v[136:139]
ds_read_b64_tr_b16 v[172:173], v39 offset:0
v_mfma_f32_16x16x32_bf16 v[140:143], v[176:179], v[196:199], v[140:143]
ds_read_b64_tr_b16 v[174:175], v39 offset:6144
s_waitcnt lgkmcnt(6)
v_mfma_f32_16x16x32_bf16 v[144:147], v[160:163], v[192:195], v[144:147]
ds_read_b64_tr_b16 v[176:177], v42 offset:0
v_mfma_f32_16x16x32_bf16 v[148:151], v[160:163], v[196:199], v[148:151]
ds_read_b64_tr_b16 v[178:179], v42 offset:6144
s_waitcnt lgkmcnt(6)
v_mfma_f32_16x16x32_bf16 v[152:155], v[164:167], v[192:195], v[152:155]
ds_read_b64_tr_b16 v[160:161], v45 offset:0
v_mfma_f32_16x16x32_bf16 v[156:159], v[164:167], v[196:199], v[156:159]
ds_read_b64_tr_b16 v[162:163], v45 offset:6144
s_waitcnt lgkmcnt(6)
s_waitcnt vmcnt(16)
v_mfma_f32_16x16x32_bf16 v[64:67], v[168:171], v[200:203], v[64:67]
s_add_u32 m0, s43, 98304
s_add_u32 s44, s40, 1253376
ds_read_b64_tr_b16 v[164:165], v36 offset:1024
s_waitcnt vmcnt(15)
v_mfma_f32_16x16x32_bf16 v[68:71], v[168:171], v[204:207], v[68:71]
ds_read_b64_tr_b16 v[166:167], v36 offset:7168
s_waitcnt lgkmcnt(6)
v_mfma_f32_16x16x32_bf16 v[72:75], v[172:175], v[200:203], v[72:75]
buffer_load_dwordx4 v48, s[12:15], s44 offen lds
v_mfma_f32_16x16x32_bf16 v[76:79], v[172:175], v[204:207], v[76:79]
ds_read_b64_tr_b16 v[168:169], v39 offset:1024
ds_read_b64_tr_b16 v[170:171], v39 offset:7168
s_waitcnt lgkmcnt(6)
v_mfma_f32_16x16x32_bf16 v[80:83], v[176:179], v[200:203], v[80:83]
buffer_load_dwordx4 v49, s[12:15], s44 offen offset:1024 lds
v_mfma_f32_16x16x32_bf16 v[84:87], v[176:179], v[204:207], v[84:87]
ds_read_b64_tr_b16 v[172:173], v42 offset:1024
ds_read_b64_tr_b16 v[174:175], v42 offset:7168
s_waitcnt lgkmcnt(6)
v_mfma_f32_16x16x32_bf16 v[88:91], v[160:163], v[200:203], v[88:91]
buffer_load_dwordx4 v50, s[12:15], s44 offen offset:2048 lds
v_mfma_f32_16x16x32_bf16 v[92:95], v[160:163], v[204:207], v[92:95]
ds_read_b64_tr_b16 v[176:177], v45 offset:1024
ds_read_b64_tr_b16 v[178:179], v45 offset:7168
s_waitcnt lgkmcnt(6)
v_mfma_f32_16x16x32_bf16 v[96:99], v[164:167], v[200:203], v[96:99]
s_add_u32 s45, s41, 32768
ds_read_b64_tr_b16 v[160:161], v36 offset:2048
v_mfma_f32_16x16x32_bf16 v[100:103], v[164:167], v[204:207], v[100:103]
ds_read_b64_tr_b16 v[162:163], v36 offset:8192
s_waitcnt lgkmcnt(6)
v_mfma_f32_16x16x32_bf16 v[104:107], v[168:171], v[200:203], v[104:107]
buffer_load_dwordx4 v[192:195], v15, s[16:19], s45 offen sc1
v_mfma_f32_16x16x32_bf16 v[108:111], v[168:171], v[204:207], v[108:111]
ds_read_b64_tr_b16 v[164:165], v39 offset:2048
ds_read_b64_tr_b16 v[166:167], v39 offset:8192
s_waitcnt lgkmcnt(6)
v_mfma_f32_16x16x32_bf16 v[112:115], v[172:175], v[200:203], v[112:115]
buffer_load_dwordx4 v[196:199], v51, s[16:19], s45 offen sc1
v_mfma_f32_16x16x32_bf16 v[116:119], v[172:175], v[204:207], v[116:119]
ds_read_b64_tr_b16 v[168:169], v42 offset:2048
ds_read_b64_tr_b16 v[170:171], v42 offset:8192
s_waitcnt lgkmcnt(6)
v_mfma_f32_16x16x32_bf16 v[120:123], v[176:179], v[200:203], v[120:123]
ds_read_b64_tr_b16 v[172:173], v45 offset:2048
v_mfma_f32_16x16x32_bf16 v[124:127], v[176:179], v[204:207], v[124:127]
ds_read_b64_tr_b16 v[174:175], v45 offset:8192
s_waitcnt lgkmcnt(6)
v_mfma_f32_16x16x32_bf16 v[128:131], v[160:163], v[200:203], v[128:131]
ds_read_b64_tr_b16 v[176:177], v36 offset:12288
v_mfma_f32_16x16x32_bf16 v[132:135], v[160:163], v[204:207], v[132:135]
ds_read_b64_tr_b16 v[178:179], v36 offset:18432
s_waitcnt lgkmcnt(6)
v_mfma_f32_16x16x32_bf16 v[136:139], v[164:167], v[200:203], v[136:139]
ds_read_b64_tr_b16 v[160:161], v39 offset:12288
v_mfma_f32_16x16x32_bf16 v[140:143], v[164:167], v[204:207], v[140:143]
ds_read_b64_tr_b16 v[162:163], v39 offset:18432
s_waitcnt lgkmcnt(6)
v_mfma_f32_16x16x32_bf16 v[144:147], v[168:171], v[200:203], v[144:147]
ds_read_b64_tr_b16 v[164:165], v42 offset:12288
v_mfma_f32_16x16x32_bf16 v[148:151], v[168:171], v[204:207], v[148:151]
ds_read_b64_tr_b16 v[166:167], v42 offset:18432
s_waitcnt lgkmcnt(6)
v_mfma_f32_16x16x32_bf16 v[152:155], v[172:175], v[200:203], v[152:155]
ds_read_b64_tr_b16 v[168:169], v45 offset:12288
v_mfma_f32_16x16x32_bf16 v[156:159], v[172:175], v[204:207], v[156:159]
ds_read_b64_tr_b16 v[170:171], v45 offset:18432
s_waitcnt lgkmcnt(6)
s_waitcnt vmcnt(16)
v_mfma_f32_16x16x32_bf16 v[64:67], v[176:179], v[208:211], v[64:67]
s_add_u32 m0, s43, 110592
s_add_u32 s44, s40, 1290240
ds_read_b64_tr_b16 v[172:173], v36 offset:13312
s_waitcnt vmcnt(15)
v_mfma_f32_16x16x32_bf16 v[68:71], v[176:179], v[212:215], v[68:71]
ds_read_b64_tr_b16 v[174:175], v36 offset:19456
s_waitcnt lgkmcnt(6)
v_mfma_f32_16x16x32_bf16 v[72:75], v[160:163], v[208:211], v[72:75]
buffer_load_dwordx4 v48, s[12:15], s44 offen lds
v_mfma_f32_16x16x32_bf16 v[76:79], v[160:163], v[212:215], v[76:79]
ds_read_b64_tr_b16 v[176:177], v39 offset:13312
ds_read_b64_tr_b16 v[178:179], v39 offset:19456
s_waitcnt lgkmcnt(6)
v_mfma_f32_16x16x32_bf16 v[80:83], v[164:167], v[208:211], v[80:83]
buffer_load_dwordx4 v49, s[12:15], s44 offen offset:1024 lds
v_mfma_f32_16x16x32_bf16 v[84:87], v[164:167], v[212:215], v[84:87]
ds_read_b64_tr_b16 v[160:161], v42 offset:13312
ds_read_b64_tr_b16 v[162:163], v42 offset:19456
s_waitcnt lgkmcnt(6)
v_mfma_f32_16x16x32_bf16 v[88:91], v[168:171], v[208:211], v[88:91]
buffer_load_dwordx4 v50, s[12:15], s44 offen offset:2048 lds
v_mfma_f32_16x16x32_bf16 v[92:95], v[168:171], v[212:215], v[92:95]
ds_read_b64_tr_b16 v[164:165], v45 offset:13312
ds_read_b64_tr_b16 v[166:167], v45 offset:19456
s_waitcnt lgkmcnt(6)
v_mfma_f32_16x16x32_bf16 v[96:99], v[172:175], v[208:211], v[96:99]
s_add_u32 s45, s41, 33792
ds_read_b64_tr_b16 v[168:169], v36 offset:14336
v_mfma_f32_16x16x32_bf16 v[100:103], v[172:175], v[212:215], v[100:103]
ds_read_b64_tr_b16 v[170:171], v36 offset:20480
s_waitcnt lgkmcnt(6)
v_mfma_f32_16x16x32_bf16 v[104:107], v[176:179], v[208:211], v[104:107]
buffer_load_dwordx4 v[200:203], v15, s[16:19], s45 offen sc1
v_mfma_f32_16x16x32_bf16 v[108:111], v[176:179], v[212:215], v[108:111]
ds_read_b64_tr_b16 v[172:173], v39 offset:14336
ds_read_b64_tr_b16 v[174:175], v39 offset:20480
s_waitcnt lgkmcnt(6)
v_mfma_f32_16x16x32_bf16 v[112:115], v[160:163], v[208:211], v[112:115]
buffer_load_dwordx4 v[204:207], v51, s[16:19], s45 offen sc1
v_mfma_f32_16x16x32_bf16 v[116:119], v[160:163], v[212:215], v[116:119]
ds_read_b64_tr_b16 v[176:177], v42 offset:14336
ds_read_b64_tr_b16 v[178:179], v42 offset:20480
s_waitcnt lgkmcnt(6)
v_mfma_f32_16x16x32_bf16 v[120:123], v[164:167], v[208:211], v[120:123]
ds_read_b64_tr_b16 v[160:161], v45 offset:14336
v_mfma_f32_16x16x32_bf16 v[124:127], v[164:167], v[212:215], v[124:127]
ds_read_b64_tr_b16 v[162:163], v45 offset:20480
s_waitcnt lgkmcnt(6)
v_mfma_f32_16x16x32_bf16 v[128:131], v[168:171], v[208:211], v[128:131]
ds_read_b64_tr_b16 v[164:165], v36 offset:24576
v_mfma_f32_16x16x32_bf16 v[132:135], v[168:171], v[212:215], v[132:135]
ds_read_b64_tr_b16 v[166:167], v36 offset:30720
s_waitcnt lgkmcnt(6)
v_mfma_f32_16x16x32_bf16 v[136:139], v[172:175], v[208:211], v[136:139]
ds_read_b64_tr_b16 v[168:169], v39 offset:24576
v_mfma_f32_16x16x32_bf16 v[140:143], v[172:175], v[212:215], v[140:143]
ds_read_b64_tr_b16 v[170:171], v39 offset:30720
s_waitcnt lgkmcnt(6)
v_mfma_f32_16x16x32_bf16 v[144:147], v[176:179], v[208:211], v[144:147]
ds_read_b64_tr_b16 v[172:173], v42 offset:24576
v_mfma_f32_16x16x32_bf16 v[148:151], v[176:179], v[212:215], v[148:151]
ds_read_b64_tr_b16 v[174:175], v42 offset:30720
s_waitcnt lgkmcnt(6)
v_mfma_f32_16x16x32_bf16 v[152:155], v[160:163], v[208:211], v[152:155]
ds_read_b64_tr_b16 v[176:177], v45 offset:24576
v_mfma_f32_16x16x32_bf16 v[156:159], v[160:163], v[212:215], v[156:159]
ds_read_b64_tr_b16 v[178:179], v45 offset:30720
s_waitcnt vmcnt(17)
s_barrier
s_waitcnt lgkmcnt(6)
s_waitcnt vmcnt(16)
v_mfma_f32_16x16x32_bf16 v[64:67], v[164:167], v[216:219], v[64:67]
s_add_u32 s45, s41, 16384
ds_read_b64_tr_b16 v[160:161], v36 offset:25600
s_waitcnt vmcnt(15)
v_mfma_f32_16x16x32_bf16 v[68:71], v[164:167], v[220:223], v[68:71]
ds_read_b64_tr_b16 v[162:163], v36 offset:31744
s_waitcnt lgkmcnt(6)
v_mfma_f32_16x16x32_bf16 v[72:75], v[168:171], v[216:219], v[72:75]
buffer_load_dwordx4 v[208:211], v15, s[16:19], s45 offen sc1
v_mfma_f32_16x16x32_bf16 v[76:79], v[168:171], v[220:223], v[76:79]
ds_read_b64_tr_b16 v[164:165], v39 offset:25600
ds_read_b64_tr_b16 v[166:167], v39 offset:31744
s_waitcnt lgkmcnt(6)
v_mfma_f32_16x16x32_bf16 v[80:83], v[172:175], v[216:219], v[80:83]
buffer_load_dwordx4 v[212:215], v51, s[16:19], s45 offen sc1
v_mfma_f32_16x16x32_bf16 v[84:87], v[172:175], v[220:223], v[84:87]
ds_read_b64_tr_b16 v[168:169], v42 offset:25600
ds_read_b64_tr_b16 v[170:171], v42 offset:31744
s_waitcnt lgkmcnt(6)
v_mfma_f32_16x16x32_bf16 v[88:91], v[176:179], v[216:219], v[88:91]
ds_read_b64_tr_b16 v[172:173], v45 offset:25600
v_mfma_f32_16x16x32_bf16 v[92:95], v[176:179], v[220:223], v[92:95]
ds_read_b64_tr_b16 v[174:175], v45 offset:31744
s_waitcnt lgkmcnt(6)
v_mfma_f32_16x16x32_bf16 v[96:99], v[160:163], v[216:219], v[96:99]
ds_read_b64_tr_b16 v[176:177], v36 offset:26624
v_mfma_f32_16x16x32_bf16 v[100:103], v[160:163], v[220:223], v[100:103]
ds_read_b64_tr_b16 v[178:179], v36 offset:32768
s_waitcnt lgkmcnt(6)
v_mfma_f32_16x16x32_bf16 v[104:107], v[164:167], v[216:219], v[104:107]
ds_read_b64_tr_b16 v[160:161], v39 offset:26624
v_mfma_f32_16x16x32_bf16 v[108:111], v[164:167], v[220:223], v[108:111]
ds_read_b64_tr_b16 v[162:163], v39 offset:32768
s_waitcnt lgkmcnt(6)
v_mfma_f32_16x16x32_bf16 v[112:115], v[168:171], v[216:219], v[112:115]
ds_read_b64_tr_b16 v[164:165], v42 offset:26624
v_mfma_f32_16x16x32_bf16 v[116:119], v[168:171], v[220:223], v[116:119]
ds_read_b64_tr_b16 v[166:167], v42 offset:32768
s_waitcnt lgkmcnt(6)
v_mfma_f32_16x16x32_bf16 v[120:123], v[172:175], v[216:219], v[120:123]
ds_read_b64_tr_b16 v[168:169], v45 offset:26624
v_mfma_f32_16x16x32_bf16 v[124:127], v[172:175], v[220:223], v[124:127]
ds_read_b64_tr_b16 v[170:171], v45 offset:32768
s_waitcnt lgkmcnt(6)
v_mfma_f32_16x16x32_bf16 v[128:131], v[176:179], v[216:219], v[128:131]
ds_read_b64_tr_b16 v[172:173], v36 offset:36864
v_mfma_f32_16x16x32_bf16 v[132:135], v[176:179], v[220:223], v[132:135]
ds_read_b64_tr_b16 v[174:175], v36 offset:43008
s_waitcnt lgkmcnt(6)
v_mfma_f32_16x16x32_bf16 v[136:139], v[160:163], v[216:219], v[136:139]
ds_read_b64_tr_b16 v[176:177], v39 offset:36864
v_mfma_f32_16x16x32_bf16 v[140:143], v[160:163], v[220:223], v[140:143]
ds_read_b64_tr_b16 v[178:179], v39 offset:43008
s_waitcnt lgkmcnt(6)
v_mfma_f32_16x16x32_bf16 v[144:147], v[164:167], v[216:219], v[144:147]
ds_read_b64_tr_b16 v[160:161], v42 offset:36864
v_mfma_f32_16x16x32_bf16 v[148:151], v[164:167], v[220:223], v[148:151]
ds_read_b64_tr_b16 v[162:163], v42 offset:43008
s_waitcnt lgkmcnt(6)
v_mfma_f32_16x16x32_bf16 v[152:155], v[168:171], v[216:219], v[152:155]
ds_read_b64_tr_b16 v[164:165], v45 offset:36864
v_mfma_f32_16x16x32_bf16 v[156:159], v[168:171], v[220:223], v[156:159]
ds_read_b64_tr_b16 v[166:167], v45 offset:43008
s_waitcnt lgkmcnt(6)
s_waitcnt vmcnt(13)
v_mfma_f32_16x16x32_bf16 v[64:67], v[172:175], v[224:227], v[64:67]
s_add_u32 s45, s41, 17408
ds_read_b64_tr_b16 v[168:169], v36 offset:37888
s_waitcnt vmcnt(12)
v_mfma_f32_16x16x32_bf16 v[68:71], v[172:175], v[228:231], v[68:71]
ds_read_b64_tr_b16 v[170:171], v36 offset:44032
s_waitcnt lgkmcnt(6)
v_mfma_f32_16x16x32_bf16 v[72:75], v[176:179], v[224:227], v[72:75]
buffer_load_dwordx4 v[216:219], v15, s[16:19], s45 offen sc1
v_mfma_f32_16x16x32_bf16 v[76:79], v[176:179], v[228:231], v[76:79]
ds_read_b64_tr_b16 v[172:173], v39 offset:37888
ds_read_b64_tr_b16 v[174:175], v39 offset:44032
s_waitcnt lgkmcnt(6)
v_mfma_f32_16x16x32_bf16 v[80:83], v[160:163], v[224:227], v[80:83]
buffer_load_dwordx4 v[220:223], v51, s[16:19], s45 offen sc1
v_mfma_f32_16x16x32_bf16 v[84:87], v[160:163], v[228:231], v[84:87]
ds_read_b64_tr_b16 v[176:177], v42 offset:37888
ds_read_b64_tr_b16 v[178:179], v42 offset:44032
s_waitcnt lgkmcnt(6)
v_mfma_f32_16x16x32_bf16 v[88:91], v[164:167], v[224:227], v[88:91]
ds_read_b64_tr_b16 v[160:161], v45 offset:37888
v_mfma_f32_16x16x32_bf16 v[92:95], v[164:167], v[228:231], v[92:95]
ds_read_b64_tr_b16 v[162:163], v45 offset:44032
s_waitcnt lgkmcnt(6)
v_mfma_f32_16x16x32_bf16 v[96:99], v[168:171], v[224:227], v[96:99]
ds_read_b64_tr_b16 v[164:165], v36 offset:38912
v_mfma_f32_16x16x32_bf16 v[100:103], v[168:171], v[228:231], v[100:103]
ds_read_b64_tr_b16 v[166:167], v36 offset:45056
s_waitcnt lgkmcnt(6)
v_mfma_f32_16x16x32_bf16 v[104:107], v[172:175], v[224:227], v[104:107]
ds_read_b64_tr_b16 v[168:169], v39 offset:38912
v_mfma_f32_16x16x32_bf16 v[108:111], v[172:175], v[228:231], v[108:111]
ds_read_b64_tr_b16 v[170:171], v39 offset:45056
s_waitcnt lgkmcnt(6)
v_mfma_f32_16x16x32_bf16 v[112:115], v[176:179], v[224:227], v[112:115]
ds_read_b64_tr_b16 v[172:173], v42 offset:38912
v_mfma_f32_16x16x32_bf16 v[116:119], v[176:179], v[228:231], v[116:119]
ds_read_b64_tr_b16 v[174:175], v42 offset:45056
s_waitcnt lgkmcnt(6)
v_mfma_f32_16x16x32_bf16 v[120:123], v[160:163], v[224:227], v[120:123]
ds_read_b64_tr_b16 v[176:177], v45 offset:38912
v_mfma_f32_16x16x32_bf16 v[124:127], v[160:163], v[228:231], v[124:127]
ds_read_b64_tr_b16 v[178:179], v45 offset:45056
s_waitcnt lgkmcnt(6)
v_mfma_f32_16x16x32_bf16 v[128:131], v[164:167], v[224:227], v[128:131]
ds_read_b64_tr_b16 v[160:161], v36 offset:49152
v_mfma_f32_16x16x32_bf16 v[132:135], v[164:167], v[228:231], v[132:135]
ds_read_b64_tr_b16 v[162:163], v36 offset:55296
s_waitcnt lgkmcnt(6)
v_mfma_f32_16x16x32_bf16 v[136:139], v[168:171], v[224:227], v[136:139]
ds_read_b64_tr_b16 v[164:165], v39 offset:49152
v_mfma_f32_16x16x32_bf16 v[140:143], v[168:171], v[228:231], v[140:143]
ds_read_b64_tr_b16 v[166:167], v39 offset:55296
s_waitcnt lgkmcnt(6)
v_mfma_f32_16x16x32_bf16 v[144:147], v[172:175], v[224:227], v[144:147]
ds_read_b64_tr_b16 v[168:169], v42 offset:49152
v_mfma_f32_16x16x32_bf16 v[148:151], v[172:175], v[228:231], v[148:151]
ds_read_b64_tr_b16 v[170:171], v42 offset:55296
s_waitcnt lgkmcnt(6)
v_mfma_f32_16x16x32_bf16 v[152:155], v[176:179], v[224:227], v[152:155]
ds_read_b64_tr_b16 v[172:173], v45 offset:49152
v_mfma_f32_16x16x32_bf16 v[156:159], v[176:179], v[228:231], v[156:159]
ds_read_b64_tr_b16 v[174:175], v45 offset:55296
s_waitcnt lgkmcnt(6)
s_waitcnt vmcnt(10)
v_mfma_f32_16x16x32_bf16 v[64:67], v[160:163], v[192:195], v[64:67]
s_add_u32 s45, s41, 34816
ds_read_b64_tr_b16 v[176:177], v36 offset:50176
s_waitcnt vmcnt(9)
v_mfma_f32_16x16x32_bf16 v[68:71], v[160:163], v[196:199], v[68:71]
ds_read_b64_tr_b16 v[178:179], v36 offset:56320
s_waitcnt lgkmcnt(6)
v_mfma_f32_16x16x32_bf16 v[72:75], v[164:167], v[192:195], v[72:75]
buffer_load_dwordx4 v[224:227], v15, s[16:19], s45 offen sc1
v_mfma_f32_16x16x32_bf16 v[76:79], v[164:167], v[196:199], v[76:79]
ds_read_b64_tr_b16 v[160:161], v39 offset:50176
ds_read_b64_tr_b16 v[162:163], v39 offset:56320
s_waitcnt lgkmcnt(6)
v_mfma_f32_16x16x32_bf16 v[80:83], v[168:171], v[192:195], v[80:83]
buffer_load_dwordx4 v[228:231], v51, s[16:19], s45 offen sc1
v_mfma_f32_16x16x32_bf16 v[84:87], v[168:171], v[196:199], v[84:87]
ds_read_b64_tr_b16 v[164:165], v42 offset:50176
ds_read_b64_tr_b16 v[166:167], v42 offset:56320
s_waitcnt lgkmcnt(6)
v_mfma_f32_16x16x32_bf16 v[88:91], v[172:175], v[192:195], v[88:91]
ds_read_b64_tr_b16 v[168:169], v45 offset:50176
v_mfma_f32_16x16x32_bf16 v[92:95], v[172:175], v[196:199], v[92:95]
ds_read_b64_tr_b16 v[170:171], v45 offset:56320
s_waitcnt lgkmcnt(6)
v_mfma_f32_16x16x32_bf16 v[96:99], v[176:179], v[192:195], v[96:99]
ds_read_b64_tr_b16 v[172:173], v36 offset:51200
v_mfma_f32_16x16x32_bf16 v[100:103], v[176:179], v[196:199], v[100:103]
ds_read_b64_tr_b16 v[174:175], v36 offset:57344
s_waitcnt lgkmcnt(6)
v_mfma_f32_16x16x32_bf16 v[104:107], v[160:163], v[192:195], v[104:107]
ds_read_b64_tr_b16 v[176:177], v39 offset:51200
v_mfma_f32_16x16x32_bf16 v[108:111], v[160:163], v[196:199], v[108:111]
ds_read_b64_tr_b16 v[178:179], v39 offset:57344
s_waitcnt lgkmcnt(6)
v_mfma_f32_16x16x32_bf16 v[112:115], v[164:167], v[192:195], v[112:115]
ds_read_b64_tr_b16 v[160:161], v42 offset:51200
v_mfma_f32_16x16x32_bf16 v[116:119], v[164:167], v[196:199], v[116:119]
ds_read_b64_tr_b16 v[162:163], v42 offset:57344
s_waitcnt lgkmcnt(6)
v_mfma_f32_16x16x32_bf16 v[120:123], v[168:171], v[192:195], v[120:123]
ds_read_b64_tr_b16 v[164:165], v45 offset:51200
v_mfma_f32_16x16x32_bf16 v[124:127], v[168:171], v[196:199], v[124:127]
ds_read_b64_tr_b16 v[166:167], v45 offset:57344
s_waitcnt lgkmcnt(6)
v_mfma_f32_16x16x32_bf16 v[128:131], v[172:175], v[192:195], v[128:131]
ds_read_b64_tr_b16 v[168:169], v37 offset:0
v_mfma_f32_16x16x32_bf16 v[132:135], v[172:175], v[196:199], v[132:135]
ds_read_b64_tr_b16 v[170:171], v37 offset:6144
s_waitcnt lgkmcnt(6)
v_mfma_f32_16x16x32_bf16 v[136:139], v[176:179], v[192:195], v[136:139]
ds_read_b64_tr_b16 v[172:173], v40 offset:0
v_mfma_f32_16x16x32_bf16 v[140:143], v[176:179], v[196:199], v[140:143]
ds_read_b64_tr_b16 v[174:175], v40 offset:6144
s_waitcnt lgkmcnt(6)
v_mfma_f32_16x16x32_bf16 v[144:147], v[160:163], v[192:195], v[144:147]
ds_read_b64_tr_b16 v[176:177], v43 offset:0
v_mfma_f32_16x16x32_bf16 v[148:151], v[160:163], v[196:199], v[148:151]
ds_read_b64_tr_b16 v[178:179], v43 offset:6144
s_waitcnt lgkmcnt(6)
v_mfma_f32_16x16x32_bf16 v[152:155], v[164:167], v[192:195], v[152:155]
ds_read_b64_tr_b16 v[160:161], v46 offset:0
v_mfma_f32_16x16x32_bf16 v[156:159], v[164:167], v[196:199], v[156:159]
ds_read_b64_tr_b16 v[162:163], v46 offset:6144
s_waitcnt lgkmcnt(6)
s_waitcnt vmcnt(7)
v_mfma_f32_16x16x32_bf16 v[64:67], v[168:171], v[200:203], v[64:67]
s_add_u32 s45, s41, 35840
ds_read_b64_tr_b16 v[164:165], v37 offset:1024
s_waitcnt vmcnt(6)
v_mfma_f32_16x16x32_bf16 v[68:71], v[168:171], v[204:207], v[68:71]
ds_read_b64_tr_b16 v[166:167], v37 offset:7168
s_waitcnt lgkmcnt(6)
v_mfma_f32_16x16x32_bf16 v[72:75], v[172:175], v[200:203], v[72:75]
buffer_load_dwordx4 v[192:195], v15, s[16:19], s45 offen sc1
v_mfma_f32_16x16x32_bf16 v[76:79], v[172:175], v[204:207], v[76:79]
ds_read_b64_tr_b16 v[168:169], v40 offset:1024
ds_read_b64_tr_b16 v[170:171], v40 offset:7168
s_waitcnt lgkmcnt(6)
v_mfma_f32_16x16x32_bf16 v[80:83], v[176:179], v[200:203], v[80:83]
buffer_load_dwordx4 v[196:199], v51, s[16:19], s45 offen sc1
v_mfma_f32_16x16x32_bf16 v[84:87], v[176:179], v[204:207], v[84:87]
ds_read_b64_tr_b16 v[172:173], v43 offset:1024
ds_read_b64_tr_b16 v[174:175], v43 offset:7168
s_waitcnt lgkmcnt(6)
v_mfma_f32_16x16x32_bf16 v[88:91], v[160:163], v[200:203], v[88:91]
ds_read_b64_tr_b16 v[176:177], v46 offset:1024
v_mfma_f32_16x16x32_bf16 v[92:95], v[160:163], v[204:207], v[92:95]
ds_read_b64_tr_b16 v[178:179], v46 offset:7168
s_waitcnt lgkmcnt(6)
v_mfma_f32_16x16x32_bf16 v[96:99], v[164:167], v[200:203], v[96:99]
ds_read_b64_tr_b16 v[160:161], v37 offset:2048
v_mfma_f32_16x16x32_bf16 v[100:103], v[164:167], v[204:207], v[100:103]
ds_read_b64_tr_b16 v[162:163], v37 offset:8192
s_waitcnt lgkmcnt(6)
v_mfma_f32_16x16x32_bf16 v[104:107], v[168:171], v[200:203], v[104:107]
ds_read_b64_tr_b16 v[164:165], v40 offset:2048
v_mfma_f32_16x16x32_bf16 v[108:111], v[168:171], v[204:207], v[108:111]
ds_read_b64_tr_b16 v[166:167], v40 offset:8192
s_waitcnt lgkmcnt(6)
v_mfma_f32_16x16x32_bf16 v[112:115], v[172:175], v[200:203], v[112:115]
ds_read_b64_tr_b16 v[168:169], v43 offset:2048
v_mfma_f32_16x16x32_bf16 v[116:119], v[172:175], v[204:207], v[116:119]
ds_read_b64_tr_b16 v[170:171], v43 offset:8192
s_waitcnt lgkmcnt(6)
v_mfma_f32_16x16x32_bf16 v[120:123], v[176:179], v[200:203], v[120:123]
ds_read_b64_tr_b16 v[172:173], v46 offset:2048
v_mfma_f32_16x16x32_bf16 v[124:127], v[176:179], v[204:207], v[124:127]
ds_read_b64_tr_b16 v[174:175], v46 offset:8192
s_waitcnt lgkmcnt(6)
v_mfma_f32_16x16x32_bf16 v[128:131], v[160:163], v[200:203], v[128:131]
ds_read_b64_tr_b16 v[176:177], v37 offset:12288
v_mfma_f32_16x16x32_bf16 v[132:135], v[160:163], v[204:207], v[132:135]
ds_read_b64_tr_b16 v[178:179], v37 offset:18432
s_waitcnt lgkmcnt(6)
v_mfma_f32_16x16x32_bf16 v[136:139], v[164:167], v[200:203], v[136:139]
ds_read_b64_tr_b16 v[160:161], v40 offset:12288
v_mfma_f32_16x16x32_bf16 v[140:143], v[164:167], v[204:207], v[140:143]
ds_read_b64_tr_b16 v[162:163], v40 offset:18432
s_waitcnt lgkmcnt(6)
v_mfma_f32_16x16x32_bf16 v[144:147], v[168:171], v[200:203], v[144:147]
ds_read_b64_tr_b16 v[164:165], v43 offset:12288
v_mfma_f32_16x16x32_bf16 v[148:151], v[168:171], v[204:207], v[148:151]
ds_read_b64_tr_b16 v[166:167], v43 offset:18432
s_waitcnt lgkmcnt(6)
v_mfma_f32_16x16x32_bf16 v[152:155], v[172:175], v[200:203], v[152:155]
ds_read_b64_tr_b16 v[168:169], v46 offset:12288
v_mfma_f32_16x16x32_bf16 v[156:159], v[172:175], v[204:207], v[156:159]
ds_read_b64_tr_b16 v[170:171], v46 offset:18432
s_barrier
s_waitcnt lgkmcnt(6)
s_waitcnt vmcnt(7)
v_mfma_f32_16x16x32_bf16 v[64:67], v[176:179], v[208:211], v[64:67]
ds_read_b64_tr_b16 v[172:173], v37 offset:13312
s_waitcnt vmcnt(6)
v_mfma_f32_16x16x32_bf16 v[68:71], v[176:179], v[212:215], v[68:71]
ds_read_b64_tr_b16 v[174:175], v37 offset:19456
s_waitcnt lgkmcnt(6)
v_mfma_f32_16x16x32_bf16 v[72:75], v[160:163], v[208:211], v[72:75]
ds_read_b64_tr_b16 v[176:177], v40 offset:13312
v_mfma_f32_16x16x32_bf16 v[76:79], v[160:163], v[212:215], v[76:79]
ds_read_b64_tr_b16 v[178:179], v40 offset:19456
s_waitcnt lgkmcnt(6)
v_mfma_f32_16x16x32_bf16 v[80:83], v[164:167], v[208:211], v[80:83]
ds_read_b64_tr_b16 v[160:161], v43 offset:13312
v_mfma_f32_16x16x32_bf16 v[84:87], v[164:167], v[212:215], v[84:87]
ds_read_b64_tr_b16 v[162:163], v43 offset:19456
s_waitcnt lgkmcnt(6)
v_mfma_f32_16x16x32_bf16 v[88:91], v[168:171], v[208:211], v[88:91]
ds_read_b64_tr_b16 v[164:165], v46 offset:13312
v_mfma_f32_16x16x32_bf16 v[92:95], v[168:171], v[212:215], v[92:95]
ds_read_b64_tr_b16 v[166:167], v46 offset:19456
s_waitcnt lgkmcnt(6)
v_mfma_f32_16x16x32_bf16 v[96:99], v[172:175], v[208:211], v[96:99]
ds_read_b64_tr_b16 v[168:169], v37 offset:14336
v_mfma_f32_16x16x32_bf16 v[100:103], v[172:175], v[212:215], v[100:103]
ds_read_b64_tr_b16 v[170:171], v37 offset:20480
s_waitcnt lgkmcnt(6)
v_mfma_f32_16x16x32_bf16 v[104:107], v[176:179], v[208:211], v[104:107]
ds_read_b64_tr_b16 v[172:173], v40 offset:14336
v_mfma_f32_16x16x32_bf16 v[108:111], v[176:179], v[212:215], v[108:111]
ds_read_b64_tr_b16 v[174:175], v40 offset:20480
s_waitcnt lgkmcnt(6)
v_mfma_f32_16x16x32_bf16 v[112:115], v[160:163], v[208:211], v[112:115]
ds_read_b64_tr_b16 v[176:177], v43 offset:14336
v_mfma_f32_16x16x32_bf16 v[116:119], v[160:163], v[212:215], v[116:119]
ds_read_b64_tr_b16 v[178:179], v43 offset:20480
s_waitcnt lgkmcnt(6)
v_mfma_f32_16x16x32_bf16 v[120:123], v[164:167], v[208:211], v[120:123]
ds_read_b64_tr_b16 v[160:161], v46 offset:14336
v_mfma_f32_16x16x32_bf16 v[124:127], v[164:167], v[212:215], v[124:127]
ds_read_b64_tr_b16 v[162:163], v46 offset:20480
s_waitcnt lgkmcnt(6)
v_mfma_f32_16x16x32_bf16 v[128:131], v[168:171], v[208:211], v[128:131]
ds_read_b64_tr_b16 v[164:165], v37 offset:24576
v_mfma_f32_16x16x32_bf16 v[132:135], v[168:171], v[212:215], v[132:135]
ds_read_b64_tr_b16 v[166:167], v37 offset:30720
s_waitcnt lgkmcnt(6)
v_mfma_f32_16x16x32_bf16 v[136:139], v[172:175], v[208:211], v[136:139]
ds_read_b64_tr_b16 v[168:169], v40 offset:24576
v_mfma_f32_16x16x32_bf16 v[140:143], v[172:175], v[212:215], v[140:143]
ds_read_b64_tr_b16 v[170:171], v40 offset:30720
s_waitcnt lgkmcnt(6)
v_mfma_f32_16x16x32_bf16 v[144:147], v[176:179], v[208:211], v[144:147]
ds_read_b64_tr_b16 v[172:173], v43 offset:24576
v_mfma_f32_16x16x32_bf16 v[148:151], v[176:179], v[212:215], v[148:151]
ds_read_b64_tr_b16 v[174:175], v43 offset:30720
s_waitcnt lgkmcnt(6)
v_mfma_f32_16x16x32_bf16 v[152:155], v[160:163], v[208:211], v[152:155]
ds_read_b64_tr_b16 v[176:177], v46 offset:24576
v_mfma_f32_16x16x32_bf16 v[156:159], v[160:163], v[212:215], v[156:159]
ds_read_b64_tr_b16 v[178:179], v46 offset:30720
s_waitcnt lgkmcnt(6)
s_waitcnt vmcnt(5)
v_mfma_f32_16x16x32_bf16 v[64:67], v[164:167], v[216:219], v[64:67]
ds_read_b64_tr_b16 v[160:161], v37 offset:25600
s_waitcnt vmcnt(4)
v_mfma_f32_16x16x32_bf16 v[68:71], v[164:167], v[220:223], v[68:71]
ds_read_b64_tr_b16 v[162:163], v37 offset:31744
s_waitcnt lgkmcnt(6)
v_mfma_f32_16x16x32_bf16 v[72:75], v[168:171], v[216:219], v[72:75]
ds_read_b64_tr_b16 v[164:165], v40 offset:25600
v_mfma_f32_16x16x32_bf16 v[76:79], v[168:171], v[220:223], v[76:79]
ds_read_b64_tr_b16 v[166:167], v40 offset:31744
s_waitcnt lgkmcnt(6)
v_mfma_f32_16x16x32_bf16 v[80:83], v[172:175], v[216:219], v[80:83]
ds_read_b64_tr_b16 v[168:169], v43 offset:25600
v_mfma_f32_16x16x32_bf16 v[84:87], v[172:175], v[220:223], v[84:87]
ds_read_b64_tr_b16 v[170:171], v43 offset:31744
s_waitcnt lgkmcnt(6)
v_mfma_f32_16x16x32_bf16 v[88:91], v[176:179], v[216:219], v[88:91]
ds_read_b64_tr_b16 v[172:173], v46 offset:25600
v_mfma_f32_16x16x32_bf16 v[92:95], v[176:179], v[220:223], v[92:95]
ds_read_b64_tr_b16 v[174:175], v46 offset:31744
s_waitcnt lgkmcnt(6)
v_mfma_f32_16x16x32_bf16 v[96:99], v[160:163], v[216:219], v[96:99]
ds_read_b64_tr_b16 v[176:177], v37 offset:26624
v_mfma_f32_16x16x32_bf16 v[100:103], v[160:163], v[220:223], v[100:103]
ds_read_b64_tr_b16 v[178:179], v37 offset:32768
s_waitcnt lgkmcnt(6)
v_mfma_f32_16x16x32_bf16 v[104:107], v[164:167], v[216:219], v[104:107]
ds_read_b64_tr_b16 v[160:161], v40 offset:26624
v_mfma_f32_16x16x32_bf16 v[108:111], v[164:167], v[220:223], v[108:111]
ds_read_b64_tr_b16 v[162:163], v40 offset:32768
s_waitcnt lgkmcnt(6)
v_mfma_f32_16x16x32_bf16 v[112:115], v[168:171], v[216:219], v[112:115]
ds_read_b64_tr_b16 v[164:165], v43 offset:26624
v_mfma_f32_16x16x32_bf16 v[116:119], v[168:171], v[220:223], v[116:119]
ds_read_b64_tr_b16 v[166:167], v43 offset:32768
s_waitcnt lgkmcnt(6)
v_mfma_f32_16x16x32_bf16 v[120:123], v[172:175], v[216:219], v[120:123]
ds_read_b64_tr_b16 v[168:169], v46 offset:26624
v_mfma_f32_16x16x32_bf16 v[124:127], v[172:175], v[220:223], v[124:127]
ds_read_b64_tr_b16 v[170:171], v46 offset:32768
s_waitcnt lgkmcnt(6)
v_mfma_f32_16x16x32_bf16 v[128:131], v[176:179], v[216:219], v[128:131]
ds_read_b64_tr_b16 v[172:173], v37 offset:36864
v_mfma_f32_16x16x32_bf16 v[132:135], v[176:179], v[220:223], v[132:135]
ds_read_b64_tr_b16 v[174:175], v37 offset:43008
s_waitcnt lgkmcnt(6)
v_mfma_f32_16x16x32_bf16 v[136:139], v[160:163], v[216:219], v[136:139]
ds_read_b64_tr_b16 v[176:177], v40 offset:36864
v_mfma_f32_16x16x32_bf16 v[140:143], v[160:163], v[220:223], v[140:143]
ds_read_b64_tr_b16 v[178:179], v40 offset:43008
s_waitcnt lgkmcnt(6)
v_mfma_f32_16x16x32_bf16 v[144:147], v[164:167], v[216:219], v[144:147]
ds_read_b64_tr_b16 v[160:161], v43 offset:36864
v_mfma_f32_16x16x32_bf16 v[148:151], v[164:167], v[220:223], v[148:151]
ds_read_b64_tr_b16 v[162:163], v43 offset:43008
s_waitcnt lgkmcnt(6)
v_mfma_f32_16x16x32_bf16 v[152:155], v[168:171], v[216:219], v[152:155]
ds_read_b64_tr_b16 v[164:165], v46 offset:36864
v_mfma_f32_16x16x32_bf16 v[156:159], v[168:171], v[220:223], v[156:159]
ds_read_b64_tr_b16 v[166:167], v46 offset:43008
s_waitcnt lgkmcnt(6)
s_waitcnt vmcnt(3)
v_mfma_f32_16x16x32_bf16 v[64:67], v[172:175], v[224:227], v[64:67]
ds_read_b64_tr_b16 v[168:169], v37 offset:37888
s_waitcnt vmcnt(2)
v_mfma_f32_16x16x32_bf16 v[68:71], v[172:175], v[228:231], v[68:71]
ds_read_b64_tr_b16 v[170:171], v37 offset:44032
s_waitcnt lgkmcnt(6)
v_mfma_f32_16x16x32_bf16 v[72:75], v[176:179], v[224:227], v[72:75]
ds_read_b64_tr_b16 v[172:173], v40 offset:37888
v_mfma_f32_16x16x32_bf16 v[76:79], v[176:179], v[228:231], v[76:79]
ds_read_b64_tr_b16 v[174:175], v40 offset:44032
s_waitcnt lgkmcnt(6)
v_mfma_f32_16x16x32_bf16 v[80:83], v[160:163], v[224:227], v[80:83]
ds_read_b64_tr_b16 v[176:177], v43 offset:37888
v_mfma_f32_16x16x32_bf16 v[84:87], v[160:163], v[228:231], v[84:87]
ds_read_b64_tr_b16 v[178:179], v43 offset:44032
s_waitcnt lgkmcnt(6)
v_mfma_f32_16x16x32_bf16 v[88:91], v[164:167], v[224:227], v[88:91]
ds_read_b64_tr_b16 v[160:161], v46 offset:37888
v_mfma_f32_16x16x32_bf16 v[92:95], v[164:167], v[228:231], v[92:95]
ds_read_b64_tr_b16 v[162:163], v46 offset:44032
s_waitcnt lgkmcnt(6)
v_mfma_f32_16x16x32_bf16 v[96:99], v[168:171], v[224:227], v[96:99]
ds_read_b64_tr_b16 v[164:165], v37 offset:38912
v_mfma_f32_16x16x32_bf16 v[100:103], v[168:171], v[228:231], v[100:103]
ds_read_b64_tr_b16 v[166:167], v37 offset:45056
s_waitcnt lgkmcnt(6)
v_mfma_f32_16x16x32_bf16 v[104:107], v[172:175], v[224:227], v[104:107]
ds_read_b64_tr_b16 v[168:169], v40 offset:38912
v_mfma_f32_16x16x32_bf16 v[108:111], v[172:175], v[228:231], v[108:111]
ds_read_b64_tr_b16 v[170:171], v40 offset:45056
s_waitcnt lgkmcnt(6)
v_mfma_f32_16x16x32_bf16 v[112:115], v[176:179], v[224:227], v[112:115]
ds_read_b64_tr_b16 v[172:173], v43 offset:38912
v_mfma_f32_16x16x32_bf16 v[116:119], v[176:179], v[228:231], v[116:119]
ds_read_b64_tr_b16 v[174:175], v43 offset:45056
s_waitcnt lgkmcnt(6)
v_mfma_f32_16x16x32_bf16 v[120:123], v[160:163], v[224:227], v[120:123]
ds_read_b64_tr_b16 v[176:177], v46 offset:38912
v_mfma_f32_16x16x32_bf16 v[124:127], v[160:163], v[228:231], v[124:127]
ds_read_b64_tr_b16 v[178:179], v46 offset:45056
s_waitcnt lgkmcnt(6)
v_mfma_f32_16x16x32_bf16 v[128:131], v[164:167], v[224:227], v[128:131]
ds_read_b64_tr_b16 v[160:161], v37 offset:49152
v_mfma_f32_16x16x32_bf16 v[132:135], v[164:167], v[228:231], v[132:135]
ds_read_b64_tr_b16 v[162:163], v37 offset:55296
s_waitcnt lgkmcnt(6)
v_mfma_f32_16x16x32_bf16 v[136:139], v[168:171], v[224:227], v[136:139]
ds_read_b64_tr_b16 v[164:165], v40 offset:49152
v_mfma_f32_16x16x32_bf16 v[140:143], v[168:171], v[228:231], v[140:143]
ds_read_b64_tr_b16 v[166:167], v40 offset:55296
s_waitcnt lgkmcnt(6)
v_mfma_f32_16x16x32_bf16 v[144:147], v[172:175], v[224:227], v[144:147]
ds_read_b64_tr_b16 v[168:169], v43 offset:49152
v_mfma_f32_16x16x32_bf16 v[148:151], v[172:175], v[228:231], v[148:151]
ds_read_b64_tr_b16 v[170:171], v43 offset:55296
s_waitcnt lgkmcnt(6)
v_mfma_f32_16x16x32_bf16 v[152:155], v[176:179], v[224:227], v[152:155]
ds_read_b64_tr_b16 v[172:173], v46 offset:49152
v_mfma_f32_16x16x32_bf16 v[156:159], v[176:179], v[228:231], v[156:159]
ds_read_b64_tr_b16 v[174:175], v46 offset:55296
s_waitcnt lgkmcnt(6)
s_waitcnt vmcnt(1)
v_mfma_f32_16x16x32_bf16 v[64:67], v[160:163], v[192:195], v[64:67]
ds_read_b64_tr_b16 v[176:177], v37 offset:50176
s_waitcnt vmcnt(0)
v_mfma_f32_16x16x32_bf16 v[68:71], v[160:163], v[196:199], v[68:71]
ds_read_b64_tr_b16 v[178:179], v37 offset:56320
s_waitcnt lgkmcnt(6)
v_mfma_f32_16x16x32_bf16 v[72:75], v[164:167], v[192:195], v[72:75]
ds_read_b64_tr_b16 v[160:161], v40 offset:50176
v_mfma_f32_16x16x32_bf16 v[76:79], v[164:167], v[196:199], v[76:79]
ds_read_b64_tr_b16 v[162:163], v40 offset:56320
s_waitcnt lgkmcnt(6)
v_mfma_f32_16x16x32_bf16 v[80:83], v[168:171], v[192:195], v[80:83]
ds_read_b64_tr_b16 v[164:165], v43 offset:50176
v_mfma_f32_16x16x32_bf16 v[84:87], v[168:171], v[196:199], v[84:87]
ds_read_b64_tr_b16 v[166:167], v43 offset:56320
s_waitcnt lgkmcnt(6)
v_mfma_f32_16x16x32_bf16 v[88:91], v[172:175], v[192:195], v[88:91]
ds_read_b64_tr_b16 v[168:169], v46 offset:50176
v_mfma_f32_16x16x32_bf16 v[92:95], v[172:175], v[196:199], v[92:95]
ds_read_b64_tr_b16 v[170:171], v46 offset:56320
s_waitcnt lgkmcnt(6)
v_mfma_f32_16x16x32_bf16 v[96:99], v[176:179], v[192:195], v[96:99]
ds_read_b64_tr_b16 v[172:173], v37 offset:51200
v_mfma_f32_16x16x32_bf16 v[100:103], v[176:179], v[196:199], v[100:103]
ds_read_b64_tr_b16 v[174:175], v37 offset:57344
s_waitcnt lgkmcnt(6)
v_mfma_f32_16x16x32_bf16 v[104:107], v[160:163], v[192:195], v[104:107]
ds_read_b64_tr_b16 v[176:177], v40 offset:51200
v_mfma_f32_16x16x32_bf16 v[108:111], v[160:163], v[196:199], v[108:111]
ds_read_b64_tr_b16 v[178:179], v40 offset:57344
s_waitcnt lgkmcnt(6)
v_mfma_f32_16x16x32_bf16 v[112:115], v[164:167], v[192:195], v[112:115]
ds_read_b64_tr_b16 v[160:161], v43 offset:51200
v_mfma_f32_16x16x32_bf16 v[116:119], v[164:167], v[196:199], v[116:119]
ds_read_b64_tr_b16 v[162:163], v43 offset:57344
s_waitcnt lgkmcnt(6)
v_mfma_f32_16x16x32_bf16 v[120:123], v[168:171], v[192:195], v[120:123]
ds_read_b64_tr_b16 v[164:165], v46 offset:51200
v_mfma_f32_16x16x32_bf16 v[124:127], v[168:171], v[196:199], v[124:127]
ds_read_b64_tr_b16 v[166:167], v46 offset:57344
s_waitcnt lgkmcnt(6)
v_mfma_f32_16x16x32_bf16 v[128:131], v[172:175], v[192:195], v[128:131]
v_mfma_f32_16x16x32_bf16 v[132:135], v[172:175], v[196:199], v[132:135]
s_waitcnt lgkmcnt(4)
v_mfma_f32_16x16x32_bf16 v[136:139], v[176:179], v[192:195], v[136:139]
v_mfma_f32_16x16x32_bf16 v[140:143], v[176:179], v[196:199], v[140:143]
s_waitcnt lgkmcnt(2)
v_mfma_f32_16x16x32_bf16 v[144:147], v[160:163], v[192:195], v[144:147]
v_mfma_f32_16x16x32_bf16 v[148:151], v[160:163], v[196:199], v[148:151]
s_waitcnt lgkmcnt(0)
v_mfma_f32_16x16x32_bf16 v[152:155], v[164:167], v[192:195], v[152:155]
v_mfma_f32_16x16x32_bf16 v[156:159], v[164:167], v[196:199], v[156:159]
s_barrier
s_nop 3
v_cvt_pk_bf16_f32 v192, v64, v65
v_cvt_pk_bf16_f32 v193, v66, v67
v_cvt_pk_bf16_f32 v194, v72, v73
v_cvt_pk_bf16_f32 v195, v74, v75
v_cvt_pk_bf16_f32 v196, v80, v81
v_cvt_pk_bf16_f32 v197, v82, v83
v_cvt_pk_bf16_f32 v198, v88, v89
v_cvt_pk_bf16_f32 v199, v90, v91
v_cvt_pk_bf16_f32 v200, v96, v97
v_cvt_pk_bf16_f32 v201, v98, v99
v_cvt_pk_bf16_f32 v202, v104, v105
v_cvt_pk_bf16_f32 v203, v106, v107
v_cvt_pk_bf16_f32 v204, v112, v113
v_cvt_pk_bf16_f32 v205, v114, v115
v_cvt_pk_bf16_f32 v206, v120, v121
v_cvt_pk_bf16_f32 v207, v122, v123
v_cvt_pk_bf16_f32 v208, v128, v129
v_cvt_pk_bf16_f32 v209, v130, v131
v_cvt_pk_bf16_f32 v210, v136, v137
v_cvt_pk_bf16_f32 v211, v138, v139
v_cvt_pk_bf16_f32 v212, v144, v145
v_cvt_pk_bf16_f32 v213, v146, v147
v_cvt_pk_bf16_f32 v214, v152, v153
v_cvt_pk_bf16_f32 v215, v154, v155
v_cvt_pk_bf16_f32 v216, v68, v69
v_cvt_pk_bf16_f32 v217, v70, v71
v_cvt_pk_bf16_f32 v218, v76, v77
v_cvt_pk_bf16_f32 v219, v78, v79
v_cvt_pk_bf16_f32 v220, v84, v85
v_cvt_pk_bf16_f32 v221, v86, v87
v_cvt_pk_bf16_f32 v222, v92, v93
v_cvt_pk_bf16_f32 v223, v94, v95
v_cvt_pk_bf16_f32 v224, v100, v101
v_cvt_pk_bf16_f32 v225, v102, v103
v_cvt_pk_bf16_f32 v226, v108, v109
v_cvt_pk_bf16_f32 v227, v110, v111
v_cvt_pk_bf16_f32 v228, v116, v117
v_cvt_pk_bf16_f32 v229, v118, v119
v_cvt_pk_bf16_f32 v230, v124, v125
v_cvt_pk_bf16_f32 v231, v126, v127
v_cvt_pk_bf16_f32 v232, v132, v133
v_cvt_pk_bf16_f32 v233, v134, v135
v_cvt_pk_bf16_f32 v234, v140, v141
v_cvt_pk_bf16_f32 v235, v142, v143
v_cvt_pk_bf16_f32 v236, v148, v149
v_cvt_pk_bf16_f32 v237, v150, v151
v_cvt_pk_bf16_f32 v238, v156, v157
v_cvt_pk_bf16_f32 v239, v158, v159
v_permlane16_swap_b32 v192, v194
v_permlane16_swap_b32 v193, v195
v_permlane16_swap_b32 v196, v198
v_permlane16_swap_b32 v197, v199
v_permlane16_swap_b32 v200, v202
v_permlane16_swap_b32 v201, v203
v_permlane16_swap_b32 v204, v206
v_permlane16_swap_b32 v205, v207
v_permlane16_swap_b32 v208, v210
v_permlane16_swap_b32 v209, v211
v_permlane16_swap_b32 v212, v214
v_permlane16_swap_b32 v213, v215
v_permlane16_swap_b32 v216, v218
v_permlane16_swap_b32 v217, v219
v_permlane16_swap_b32 v220, v222
v_permlane16_swap_b32 v221, v223
v_permlane16_swap_b32 v224, v226
v_permlane16_swap_b32 v225, v227
v_permlane16_swap_b32 v228, v230
v_permlane16_swap_b32 v229, v231
v_permlane16_swap_b32 v232, v234
v_permlane16_swap_b32 v233, v235
v_permlane16_swap_b32 v236, v238
v_permlane16_swap_b32 v237, v239
s_cmp_eq_u32 s98, s33
s_cbranch_scc1 G2_OWN
s_add_u32 s44, s46, 0
buffer_store_dwordx4 v[192:195], v15, s[8:11], s44 offen sc1
s_add_u32 s44, s46, 1024
buffer_store_dwordx4 v[196:199], v15, s[8:11], s44 offen sc1
s_add_u32 s44, s46, 2048
buffer_store_dwordx4 v[200:203], v15, s[8:11], s44 offen sc1
s_add_u32 s44, s46, 3072
buffer_store_dwordx4 v[204:207], v15, s[8:11], s44 offen sc1
s_add_u32 s44, s46, 4096
buffer_store_dwordx4 v[208:211], v15, s[8:11], s44 offen sc1
s_add_u32 s44, s46, 5120
buffer_store_dwordx4 v[212:215], v15, s[8:11], s44 offen sc1
s_add_u32 s46, s46, 18432
s_add_u32 s44, s46, 0
buffer_store_dwordx4 v[216:219], v15, s[8:11], s44 offen sc1
s_add_u32 s44, s46, 1024
buffer_store_dwordx4 v[220:223], v15, s[8:11], s44 offen sc1
s_add_u32 s44, s46, 2048
buffer_store_dwordx4 v[224:227], v15, s[8:11], s44 offen sc1
s_add_u32 s44, s46, 3072
buffer_store_dwordx4 v[228:231], v15, s[8:11], s44 offen sc1
s_add_u32 s44, s46, 4096
buffer_store_dwordx4 v[232:235], v15, s[8:11], s44 offen sc1
s_add_u32 s44, s46, 5120
buffer_store_dwordx4 v[236:239], v15, s[8:11], s44 offen sc1
s_branch G2_OWN_DONE
G2_OWN:
ds_write_b128 v15, v[192:195] offset:16384
ds_write_b128 v15, v[196:199] offset:18432
ds_write_b128 v15, v[200:203] offset:20480
ds_write_b128 v15, v[204:207] offset:22528
ds_write_b128 v15, v[208:211] offset:24576
ds_write_b128 v15, v[212:215] offset:26624
ds_write_b128 v15, v[216:219] offset:17408
ds_write_b128 v15, v[220:223] offset:19456
ds_write_b128 v15, v[224:227] offset:21504
ds_write_b128 v15, v[228:231] offset:23552
ds_write_b128 v15, v[232:235] offset:25600
ds_write_b128 v15, v[236:239] offset:27648
s_waitcnt lgkmcnt(0)
G2_OWN_DONE:
s_add_u32 s58, s6, 9699328
s_addc_u32 s59, s7, 0
s_mov_b32 s12, s58
s_mov_b32 s13, s59
s_mov_b32 s14, 2359296
s_mov_b32 s15, 0x00020000
s_waitcnt vmcnt(0)
s_barrier
s_cmp_lg_u32 s98, 0
s_cbranch_scc1 SIG_12
s_lshl_b32 s56, s2, 7
s_add_u32 s56, s56, 40894476
v_mov_b32 v60, s56
v_mov_b32 v61, s100
s_mov_b64 exec, 1
global_store_dword v60, v61, s[6:7] sc1
s_mov_b64 exec, -1
SIG_12:
s_mov_b32 s36, 0x00003f80
s_mov_b32 s37, 0x3f800000
s_mul_i32 s38, s98, 3072
v_add_u32 v33, s38, v15
ds_read_b128 v[92:95], v33 offset:16384
ds_read_b128 v[108:111], v33 offset:17408
ds_read_b128 v[124:127], v33 offset:18432
s_waitcnt lgkmcnt(2)
v_dot2_f32_bf16 v208, v180, s36, 0
v_dot2_f32_bf16 v209, v180, s37, 0
v_dot2_f32_bf16 v210, v181, s36, 0
v_dot2_f32_bf16 v211, v181, s37, 0
v_dot2_f32_bf16 v212, v182, s36, 0
v_dot2_f32_bf16 v213, v182, s37, 0
v_dot2_f32_bf16 v214, v183, s36, 0
v_dot2_f32_bf16 v215, v183, s37, 0
v_dot2_f32_bf16 v208, v92, s36, v208
v_dot2_f32_bf16 v209, v92, s37, v209
v_dot2_f32_bf16 v210, v93, s36, v210
v_dot2_f32_bf16 v211, v93, s37, v211
v_dot2_f32_bf16 v212, v94, s36, v212
v_dot2_f32_bf16 v213, v94, s37, v213
v_dot2_f32_bf16 v214, v95, s36, v214
v_dot2_f32_bf16 v215, v95, s37, v215
s_waitcnt lgkmcnt(1)
v_dot2_f32_bf16 v216, v184, s36, 0
v_dot2_f32_bf16 v217, v184, s37, 0
v_dot2_f32_bf16 v218, v185, s36, 0
v_dot2_f32_bf16 v219, v185, s37, 0
v_dot2_f32_bf16 v220, v186, s36, 0
v_dot2_f32_bf16 v221, v186, s37, 0
v_dot2_f32_bf16 v222, v187, s36, 0
v_dot2_f32_bf16 v223, v187, s37, 0
v_dot2_f32_bf16 v216, v108, s36, v216
v_dot2_f32_bf16 v217, v108, s37, v217
v_dot2_f32_bf16 v218, v109, s36, v218
v_dot2_f32_bf16 v219, v109, s37, v219
v_dot2_f32_bf16 v220, v110, s36, v220
v_dot2_f32_bf16 v221, v110, s37, v221
v_dot2_f32_bf16 v222, v111, s36, v222
v_dot2_f32_bf16 v223, v111, s37, v223
s_waitcnt lgkmcnt(0)
v_dot2_f32_bf16 v224, v188, s36, 0
v_dot2_f32_bf16 v225, v188, s37, 0
v_dot2_f32_bf16 v226, v189, s36, 0
v_dot2_f32_bf16 v227, v189, s37, 0
v_dot2_f32_bf16 v228, v190, s36, 0
v_dot2_f32_bf16 v229, v190, s37, 0
v_dot2_f32_bf16 v230, v191, s36, 0
v_dot2_f32_bf16 v231, v191, s37, 0
v_dot2_f32_bf16 v224, v124, s36, v224
v_dot2_f32_bf16 v225, v124, s37, v225
v_dot2_f32_bf16 v226, v125, s36, v226
v_dot2_f32_bf16 v227, v125, s37, v227
v_dot2_f32_bf16 v228, v126, s36, v228
v_dot2_f32_bf16 v229, v126, s37, v229
v_dot2_f32_bf16 v230, v127, s36, v230
v_dot2_f32_bf16 v231, v127, s37, v231
s_cmp_lg_u32 s98, 0
s_cbranch_scc1 POLLD_13
v_and_b32 v52, 63, v0
v_add_u32 v52, 192, v52
v_lshlrev_b32 v52, 7, v52
v_add_u32 v52, 16, v52
v_add_u32 v52, 40894464, v52
v_and_b32 v53, 3, v0
v_lshlrev_b32 v53, 1, v53
s_lshl_b32 s38, s97, 3
s_and_b32 s39, s96, 1
s_add_u32 s38, s38, s39
v_add_u32 v53, s38, v53
v_lshlrev_b32 v53, 7, v53
v_add_u32 v53, 12, v53
v_add_u32 v53, 40894464, v53
s_mov_b32 s56, 0x40000
POLL_13:
global_load_dword v56, v52, s[6:7] sc1
global_load_dword v57, v53, s[6:7] sc1
s_waitcnt vmcnt(0)
v_cmp_ne_u32 vcc, s100, v56
v_cmp_ne_u32 s[58:59], s100, v57
s_nop 0
s_or_b64 vcc, vcc, s[58:59]
s_sub_u32 s56, s56, 1
s_cmp_eq_u32 s56, 0
s_cbranch_scc1 POLLD_13
s_nop 1
s_cbranch_vccnz POLL_13
POLLD_13:
s_barrier
s_add_u32 m0, s49, 0
s_add_u32 s41, s47, 0
buffer_load_dwordx4 v32, s[12:15], s41 offen sc1 lds
s_add_u32 m0, s49, 1024
s_add_u32 s41, s47, 65536
buffer_load_dwordx4 v32, s[12:15], s41 offen sc1 lds
s_add_u32 m0, s49, 2048
s_add_u32 s41, s47, 131072
buffer_load_dwordx4 v32, s[12:15], s41 offen sc1 lds
s_add_u32 s38, s33, 1
s_and_b32 s38, s38, 3
s_mul_i32 s43, s38, 2359296
s_add_u32 s38, s33, 2
s_and_b32 s38, s38, 3
s_mul_i32 s44, s38, 2359296
s_add_u32 s38, s33, 3
s_and_b32 s38, s38, 3
s_mul_i32 s45, s38, 2359296
s_add_u32 s41, s28, s43
buffer_load_dwordx4 v[80:83], v15, s[8:11], s41 offen sc1
s_add_u32 s41, s28, s44
buffer_load_dwordx4 v[84:87], v15, s[8:11], s41 offen sc1
s_add_u32 s41, s28, s45
buffer_load_dwordx4 v[88:91], v15, s[8:11], s41 offen sc1
s_add_u32 s41, s29, s43
buffer_load_dwordx4 v[96:99], v15, s[8:11], s41 offen sc1
s_add_u32 s41, s29, s44
buffer_load_dwordx4 v[100:103], v15, s[8:11], s41 offen sc1
s_add_u32 s41, s29, s45
buffer_load_dwordx4 v[104:107], v15, s[8:11], s41 offen sc1
s_add_u32 s41, s30, s43
buffer_load_dwordx4 v[112:115], v15, s[8:11], s41 offen sc1
s_add_u32 s41, s30, s44
buffer_load_dwordx4 v[116:119], v15, s[8:11], s41 offen sc1
s_add_u32 s41, s30, s45
buffer_load_dwordx4 v[120:123], v15, s[8:11], s41 offen sc1
s_waitcnt vmcnt(9)
s_barrier
ds_read_b64_tr_b16 v[128:129], v29
ds_read_b64_tr_b16 v[130:131], v29 offset:256
ds_read_b64_tr_b16 v[132:133], v30
ds_read_b64_tr_b16 v[134:135], v30 offset:256
ds_read_b64_tr_b16 v[136:137], v31
ds_read_b64_tr_b16 v[138:139], v31 offset:256
s_waitcnt vmcnt(6) lgkmcnt(0)
v_dot2_f32_bf16 v208, v80, s36, v208
v_dot2_f32_bf16 v209, v80, s37, v209
v_dot2_f32_bf16 v210, v81, s36, v210
v_dot2_f32_bf16 v211, v81, s37, v211
v_dot2_f32_bf16 v212, v82, s36, v212
v_dot2_f32_bf16 v213, v82, s37, v213
v_dot2_f32_bf16 v214, v83, s36, v214
v_dot2_f32_bf16 v215, v83, s37, v215
v_dot2_f32_bf16 v208, v84, s36, v208
v_dot2_f32_bf16 v209, v84, s37, v209
v_dot2_f32_bf16 v210, v85, s36, v210
v_dot2_f32_bf16 v211, v85, s37, v211
v_dot2_f32_bf16 v212, v86, s36, v212
v_dot2_f32_bf16 v213, v86, s37, v213
v_dot2_f32_bf16 v214, v87, s36, v214
v_dot2_f32_bf16 v215, v87, s37, v215
v_dot2_f32_bf16 v208, v88, s36, v208
v_dot2_f32_bf16 v209, v88, s37, v209
v_dot2_f32_bf16 v210, v89, s36, v210
v_dot2_f32_bf16 v211, v89, s37, v211
v_dot2_f32_bf16 v212, v90, s36, v212
v_dot2_f32_bf16 v213, v90, s37, v213
v_dot2_f32_bf16 v214, v91, s36, v214
v_dot2_f32_bf16 v215, v91, s37, v215
v_dot2_f32_bf16 v208, v128, s36, v208
v_dot2_f32_bf16 v209, v128, s37, v209
v_dot2_f32_bf16 v210, v129, s36, v210
v_dot2_f32_bf16 v211, v129, s37, v211
v_dot2_f32_bf16 v212, v130, s36, v212
v_dot2_f32_bf16 v213, v130, s37, v213
v_dot2_f32_bf16 v214, v131, s36, v214
v_dot2_f32_bf16 v215, v131, s37, v215
v_cvt_pk_bf16_f32 v152, v208, v209
v_cvt_pk_bf16_f32 v153, v210, v211
v_cvt_pk_bf16_f32 v154, v212, v213
v_cvt_pk_bf16_f32 v155, v214, v215
buffer_store_dwordx4 v[152:155], v24, s[20:23], 0 offen
s_waitcnt vmcnt(3) lgkmcnt(0)
v_dot2_f32_bf16 v216, v96, s36, v216
v_dot2_f32_bf16 v217, v96, s37, v217
v_dot2_f32_bf16 v218, v97, s36, v218
v_dot2_f32_bf16 v219, v97, s37, v219
v_dot2_f32_bf16 v220, v98, s36, v220
v_dot2_f32_bf16 v221, v98, s37, v221
v_dot2_f32_bf16 v222, v99, s36, v222
v_dot2_f32_bf16 v223, v99, s37, v223
v_dot2_f32_bf16 v216, v100, s36, v216
v_dot2_f32_bf16 v217, v100, s37, v217
v_dot2_f32_bf16 v218, v101, s36, v218
v_dot2_f32_bf16 v219, v101, s37, v219
v_dot2_f32_bf16 v220, v102, s36, v220
v_dot2_f32_bf16 v221, v102, s37, v221
v_dot2_f32_bf16 v222, v103, s36, v222
v_dot2_f32_bf16 v223, v103, s37, v223
v_dot2_f32_bf16 v216, v104, s36, v216
v_dot2_f32_bf16 v217, v104, s37, v217
v_dot2_f32_bf16 v218, v105, s36, v218
v_dot2_f32_bf16 v219, v105, s37, v219
v_dot2_f32_bf16 v220, v106, s36, v220
v_dot2_f32_bf16 v221, v106, s37, v221
v_dot2_f32_bf16 v222, v107, s36, v222
v_dot2_f32_bf16 v223, v107, s37, v223
v_dot2_f32_bf16 v216, v132, s36, v216
v_dot2_f32_bf16 v217, v132, s37, v217
v_dot2_f32_bf16 v218, v133, s36, v218
v_dot2_f32_bf16 v219, v133, s37, v219
v_dot2_f32_bf16 v220, v134, s36, v220
v_dot2_f32_bf16 v221, v134, s37, v221
v_dot2_f32_bf16 v222, v135, s36, v222
v_dot2_f32_bf16 v223, v135, s37, v223
v_cvt_pk_bf16_f32 v156, v216, v217
v_cvt_pk_bf16_f32 v157, v218, v219
v_cvt_pk_bf16_f32 v158, v220, v221
v_cvt_pk_bf16_f32 v159, v222, v223
buffer_store_dwordx4 v[156:159], v25, s[20:23], 0 offen
s_waitcnt vmcnt(0) lgkmcnt(0)
v_dot2_f32_bf16 v224, v112, s36, v224
v_dot2_f32_bf16 v225, v112, s37, v225
v_dot2_f32_bf16 v226, v113, s36, v226
v_dot2_f32_bf16 v227, v113, s37, v227
v_dot2_f32_bf16 v228, v114, s36, v228
v_dot2_f32_bf16 v229, v114, s37, v229
v_dot2_f32_bf16 v230, v115, s36, v230
v_dot2_f32_bf16 v231, v115, s37, v231
v_dot2_f32_bf16 v224, v116, s36, v224
v_dot2_f32_bf16 v225, v116, s37, v225
v_dot2_f32_bf16 v226, v117, s36, v226
v_dot2_f32_bf16 v227, v117, s37, v227
v_dot2_f32_bf16 v228, v118, s36, v228
v_dot2_f32_bf16 v229, v118, s37, v229
v_dot2_f32_bf16 v230, v119, s36, v230
v_dot2_f32_bf16 v231, v119, s37, v231
v_dot2_f32_bf16 v224, v120, s36, v224
v_dot2_f32_bf16 v225, v120, s37, v225
v_dot2_f32_bf16 v226, v121, s36, v226
v_dot2_f32_bf16 v227, v121, s37, v227
v_dot2_f32_bf16 v228, v122, s36, v228
v_dot2_f32_bf16 v229, v122, s37, v229
v_dot2_f32_bf16 v230, v123, s36, v230
v_dot2_f32_bf16 v231, v123, s37, v231
v_dot2_f32_bf16 v224, v136, s36, v224
v_dot2_f32_bf16 v225, v136, s37, v225
v_dot2_f32_bf16 v226, v137, s36, v226
v_dot2_f32_bf16 v227, v137, s37, v227
v_dot2_f32_bf16 v228, v138, s36, v228
v_dot2_f32_bf16 v229, v138, s37, v229
v_dot2_f32_bf16 v230, v139, s36, v230
v_dot2_f32_bf16 v231, v139, s37, v231
v_cvt_pk_bf16_f32 v160, v224, v225
v_cvt_pk_bf16_f32 v161, v226, v227
v_cvt_pk_bf16_f32 v162, v228, v229
v_cvt_pk_bf16_f32 v163, v230, v231
buffer_store_dwordx4 v[160:163], v26, s[20:23], 0 offen
s_endpgm
KF_CONV:
v_and_b32 v49, 63, v0
v_lshrrev_b32 v51, 4, v49
v_mov_b32 v54, 0
v_mov_b32 v55, 0
v_lshlrev_b32 v50, 3, v49
s_lshl_b32 s36, s98, 9
v_add_u32 v50, s36, v50
v_add_u32 v50, 66560, v50
ds_write_b64 v50, v[54:55]
ds_write_b64 v50, v[54:55] offset:18432
v_and_b32 v50, 15, v49
v_lshlrev_b32 v50, 2, v50
v_mul_u32_u24 v51, 4160, v51
v_add_u32 v50, v50, v51
v_add_u32 v50, s41, v50
ds_write_b32 v50, v54 offset:4096
v_and_b32 v50, 15, v49
v_lshlrev_b32 v50, 2, v50
s_mul_i32 s36, s98, 4160
s_add_u32 s36, s36, 107520
v_add_u32 v50, s36, v50
ds_write_b32 v50, v54
s_add_u32 s56, s6, 4718592
s_addc_u32 s57, s7, 0
s_mov_b32 s8, s56
s_mov_b32 s9, s57
s_mov_b32 s10, 4866048
s_mov_b32 s11, 0x00020000
s_add_u32 s56, s6, 2359296
s_addc_u32 s57, s7, 0
s_mov_b32 s12, s56
s_mov_b32 s13, s57
s_mov_b32 s14, 2359296
s_mov_b32 s15, 0x00020000
s_waitcnt vmcnt(1)
v_cmp_ne_u32 vcc, s100, v53
s_mov_b32 s56, 0x40000
s_nop 3
s_cbranch_vccz FCD_14
FC_14:
global_load_dword v53, v52, s[6:7] sc1
s_waitcnt vmcnt(0)
v_cmp_ne_u32 vcc, s100, v53
s_sub_u32 s56, s56, 1
s_cmp_eq_u32 s56, 0
s_cbranch_scc1 FCD_14
s_nop 1
s_cbranch_vccnz FC_14
FCD_14:
s_barrier
s_add_u32 m0, s46, 68608
s_add_u32 s42, s44, 0
buffer_load_dwordx4 v40, s[12:15], s42 offen sc1 lds
s_add_u32 m0, s46, 69632
s_add_u32 s42, s44, 147456
buffer_load_dwordx4 v40, s[12:15], s42 offen sc1 lds
s_add_u32 m0, s46, 70656
s_add_u32 s42, s44, 294912
buffer_load_dwordx4 v40, s[12:15], s42 offen sc1 lds
s_add_u32 m0, s46, 71680
s_add_u32 s42, s44, 442368
buffer_load_dwordx4 v40, s[12:15], s42 offen sc1 lds
s_add_u32 m0, s41, 3072
s_add_u32 s42, s43, 7300
buffer_load_dwordx4 v15, s[8:11], s42 offen sc1 lds
s_add_u32 m0, s41, 7232
s_add_u32 s42, s43, 3076
buffer_load_dwordx4 v15, s[8:11], s42 offen sc1 lds
s_add_u32 m0, s41, 11392
s_add_u32 s42, s43, 7296
buffer_load_dwordx4 v15, s[8:11], s42 offen sc1 lds
s_add_u32 m0, s41, 15552
s_add_u32 s42, s43, 3072
buffer_load_dwordx4 v15, s[8:11], s42 offen sc1 lds
s_nop 7
v_mul_f32 v180, v180, v24
v_mul_f32 v181, v181, v25
v_mul_f32 v182, v182, v26
v_mul_f32 v183, v183, v27
v_cvt_pk_bf16_f32 v34, v180, v181
v_cvt_pk_bf16_f32 v35, v182, v183
s_add_u32 s55, s29, 6144
buffer_store_dwordx4 v[32:35], v15, s[16:19], s55 offen sc1
v_mul_f32 v20, s26, v136
v_mul_f32 v21, s26, v137
v_mul_f32 v22, s26, v138
v_mul_f32 v23, s26, v139
v_exp_f32 v20, v20
v_exp_f32 v21, v21
v_exp_f32 v22, v22
v_exp_f32 v23, v23
v_mul_f32 v168, v136, v168
v_mul_f32 v169, v137, v169
v_mul_f32 v170, v138, v170
v_mul_f32 v171, v139, v171
v_add_f32 v20, 1.0, v20
v_add_f32 v21, 1.0, v21
v_add_f32 v22, 1.0, v22
v_add_f32 v23, 1.0, v23
v_rcp_f32 v20, v20
v_rcp_f32 v21, v21
v_rcp_f32 v22, v22
v_rcp_f32 v23, v23
v_mul_f32 v168, v168, v20
v_mul_f32 v169, v169, v21
v_mul_f32 v170, v170, v22
v_mul_f32 v171, v171, v23
v_cvt_pk_bf16_f32 v28, v168, v169
v_cvt_pk_bf16_f32 v29, v170, v171
v_mul_f32 v24, s26, v152
v_mul_f32 v25, s26, v153
v_mul_f32 v26, s26, v154
v_mul_f32 v27, s26, v155
v_exp_f32 v24, v24
v_exp_f32 v25, v25
v_exp_f32 v26, v26
v_exp_f32 v27, v27
v_mul_f32 v184, v152, v184
v_mul_f32 v185, v153, v185
v_mul_f32 v186, v154, v186
v_mul_f32 v187, v155, v187
v_add_f32 v24, 1.0, v24
v_add_f32 v25, 1.0, v25
v_add_f32 v26, 1.0, v26
v_add_f32 v27, 1.0, v27
v_rcp_f32 v24, v24
v_rcp_f32 v25, v25
v_rcp_f32 v26, v26
v_rcp_f32 v27, v27
v_mul_f32 v184, v184, v24
v_mul_f32 v185, v185, v25
v_mul_f32 v186, v186, v26
v_mul_f32 v187, v187, v27
v_cvt_pk_bf16_f32 v30, v184, v185
v_cvt_pk_bf16_f32 v31, v186, v187
s_add_u32 s55, s30, 6144
buffer_store_dwordx4 v[28:31], v15, s[16:19], s55 offen sc1
v_mul_f32 v20, s26, v140
v_mul_f32 v21, s26, v141
v_mul_f32 v22, s26, v142
v_mul_f32 v23, s26, v143
v_exp_f32 v20, v20
v_exp_f32 v21, v21
v_exp_f32 v22, v22
v_exp_f32 v23, v23
v_mul_f32 v172, v140, v172
v_mul_f32 v173, v141, v173
v_mul_f32 v174, v142, v174
v_mul_f32 v175, v143, v175
v_add_f32 v20, 1.0, v20
v_add_f32 v21, 1.0, v21
v_add_f32 v22, 1.0, v22
v_add_f32 v23, 1.0, v23
v_rcp_f32 v20, v20
v_rcp_f32 v21, v21
v_rcp_f32 v22, v22
v_rcp_f32 v23, v23
v_mul_f32 v172, v172, v20
v_mul_f32 v173, v173, v21
v_mul_f32 v174, v174, v22
v_mul_f32 v175, v175, v23
v_cvt_pk_bf16_f32 v32, v172, v173
v_cvt_pk_bf16_f32 v33, v174, v175
v_mul_f32 v24, s26, v156
v_mul_f32 v25, s26, v157
v_mul_f32 v26, s26, v158
v_mul_f32 v27, s26, v159
v_exp_f32 v24, v24
v_exp_f32 v25, v25
v_exp_f32 v26, v26
v_exp_f32 v27, v27
v_mul_f32 v188, v156, v188
v_mul_f32 v189, v157, v189
v_mul_f32 v190, v158, v190
v_mul_f32 v191, v159, v191
v_add_f32 v24, 1.0, v24
v_add_f32 v25, 1.0, v25
v_add_f32 v26, 1.0, v26
v_add_f32 v27, 1.0, v27
v_rcp_f32 v24, v24
v_rcp_f32 v25, v25
v_rcp_f32 v26, v26
v_rcp_f32 v27, v27
v_mul_f32 v188, v188, v24
v_mul_f32 v189, v189, v25
v_mul_f32 v190, v190, v26
v_mul_f32 v191, v191, v27
v_cvt_pk_bf16_f32 v34, v188, v189
v_cvt_pk_bf16_f32 v35, v190, v191
s_add_u32 s55, s31, 6144
buffer_store_dwordx4 v[32:35], v15, s[16:19], s55 offen sc1
v_mul_f32 v20, s26, v64
v_mul_f32 v21, s26, v65
v_mul_f32 v22, s26, v66
v_mul_f32 v23, s26, v67
v_exp_f32 v20, v20
v_exp_f32 v21, v21
v_exp_f32 v22, v22
v_exp_f32 v23, v23
v_mul_f32 v96, v64, v96
v_mul_f32 v97, v65, v97
v_mul_f32 v98, v66, v98
v_mul_f32 v99, v67, v99
v_add_f32 v20, 1.0, v20
v_add_f32 v21, 1.0, v21
v_add_f32 v22, 1.0, v22
v_add_f32 v23, 1.0, v23
v_rcp_f32 v20, v20
v_rcp_f32 v21, v21
v_rcp_f32 v22, v22
v_rcp_f32 v23, v23
v_mul_f32 v96, v96, v20
v_mul_f32 v97, v97, v21
v_mul_f32 v98, v98, v22
v_mul_f32 v99, v99, v23
v_cvt_pk_bf16_f32 v28, v96, v97
v_cvt_pk_bf16_f32 v29, v98, v99
v_mul_f32 v24, s26, v80
v_mul_f32 v25, s26, v81
v_mul_f32 v26, s26, v82
v_mul_f32 v27, s26, v83
v_exp_f32 v24, v24
v_exp_f32 v25, v25
v_exp_f32 v26, v26
v_exp_f32 v27, v27
v_mul_f32 v112, v80, v112
v_mul_f32 v113, v81, v113
v_mul_f32 v114, v82, v114
v_mul_f32 v115, v83, v115
v_add_f32 v24, 1.0, v24
v_add_f32 v25, 1.0, v25
v_add_f32 v26, 1.0, v26
v_add_f32 v27, 1.0, v27
v_rcp_f32 v24, v24
v_rcp_f32 v25, v25
v_rcp_f32 v26, v26
v_rcp_f32 v27, v27
v_mul_f32 v112, v112, v24
v_mul_f32 v113, v113, v25
v_mul_f32 v114, v114, v26
v_mul_f32 v115, v115, v27
v_cvt_pk_bf16_f32 v30, v112, v113
v_cvt_pk_bf16_f32 v31, v114, v115
buffer_store_dwordx4 v[28:31], v15, s[16:19], s23 offen sc1
v_mul_f32 v20, s26, v68
v_mul_f32 v21, s26, v69
v_mul_f32 v22, s26, v70
v_mul_f32 v23, s26, v71
v_exp_f32 v20, v20
v_exp_f32 v21, v21
v_exp_f32 v22, v22
v_exp_f32 v23, v23
v_mul_f32 v100, v68, v100
v_mul_f32 v101, v69, v101
v_mul_f32 v102, v70, v102
v_mul_f32 v103, v71, v103
v_add_f32 v20, 1.0, v20
v_add_f32 v21, 1.0, v21
v_add_f32 v22, 1.0, v22
v_add_f32 v23, 1.0, v23
v_rcp_f32 v20, v20
v_rcp_f32 v21, v21
v_rcp_f32 v22, v22
v_rcp_f32 v23, v23
v_mul_f32 v100, v100, v20
v_mul_f32 v101, v101, v21
v_mul_f32 v102, v102, v22
v_mul_f32 v103, v103, v23
v_cvt_pk_bf16_f32 v32, v100, v101
v_cvt_pk_bf16_f32 v33, v102, v103
v_mul_f32 v24, s26, v84
v_mul_f32 v25, s26, v85
v_mul_f32 v26, s26, v86
v_mul_f32 v27, s26, v87
v_exp_f32 v24, v24
v_exp_f32 v25, v25
v_exp_f32 v26, v26
v_exp_f32 v27, v27
v_mul_f32 v116, v84, v116
v_mul_f32 v117, v85, v117
v_mul_f32 v118, v86, v118
v_mul_f32 v119, v87, v119
v_add_f32 v24, 1.0, v24
v_add_f32 v25, 1.0, v25
v_add_f32 v26, 1.0, v26
v_add_f32 v27, 1.0, v27
v_rcp_f32 v24, v24
v_rcp_f32 v25, v25
v_rcp_f32 v26, v26
v_rcp_f32 v27, v27
v_mul_f32 v116, v116, v24
v_mul_f32 v117, v117, v25
v_mul_f32 v118, v118, v26
v_mul_f32 v119, v119, v27
v_cvt_pk_bf16_f32 v34, v116, v117
v_cvt_pk_bf16_f32 v35, v118, v119
buffer_store_dwordx4 v[32:35], v15, s[16:19], s24 offen sc1
s_add_u32 m0, s41, 2048
s_add_u32 s42, s43, 6276
buffer_load_dwordx4 v15, s[8:11], s42 offen sc1 lds
s_add_u32 m0, s41, 6208
s_add_u32 s42, s43, 2052
buffer_load_dwordx4 v15, s[8:11], s42 offen sc1 lds
s_add_u32 m0, s41, 10368
s_add_u32 s42, s43, 6272
buffer_load_dwordx4 v15, s[8:11], s42 offen sc1 lds
s_add_u32 m0, s41, 14528
s_add_u32 s42, s43, 2048
buffer_load_dwordx4 v15, s[8:11], s42 offen sc1 lds
s_add_u32 m0, s46, 87040
s_add_u32 s42, s44, 4096
buffer_load_dwordx4 v40, s[12:15], s42 offen sc1 lds
s_add_u32 m0, s46, 88064
s_add_u32 s42, s44, 151552
buffer_load_dwordx4 v40, s[12:15], s42 offen sc1 lds
s_add_u32 m0, s46, 89088
s_add_u32 s42, s44, 299008
buffer_load_dwordx4 v40, s[12:15], s42 offen sc1 lds
s_add_u32 m0, s46, 90112
s_add_u32 s42, s44, 446464
buffer_load_dwordx4 v40, s[12:15], s42 offen sc1 lds
s_waitcnt vmcnt(17)
s_waitcnt lgkmcnt(0)
s_barrier
s_add_u32 s56, s6, 9699328
s_addc_u32 s57, s7, 0
s_mov_b32 s16, s56
s_mov_b32 s17, s57
s_mov_b32 s18, 2359296
s_mov_b32 s19, 0x00020000
ds_read_b128 a[224:227], v41 offset:16128
ds_read_b128 a[192:195], v41 offset:14080
ds_read_b128 a[160:163], v41 offset:12032
ds_read_b128 a[128:131], v41 offset:9984
ds_read_b128 a[96:99], v41 offset:7936
ds_read_b128 a[64:67], v41 offset:5888
ds_read_b128 a[32:35], v41 offset:3840
ds_read_b128 a[0:3], v41 offset:1792
s_waitcnt vmcnt(13)
ds_read_b64 v[224:225], v36 offset:4032
ds_read_b64 v[226:227], v36 offset:4040
ds_read_b64 v[228:229], v36 offset:3968
ds_read_b64 v[230:231], v36 offset:3976
ds_read_b64 v[232:233], v36 offset:3904
ds_read_b64 v[234:235], v36 offset:3912
ds_read_b64 v[236:237], v36 offset:3840
ds_read_b64 v[238:239], v36 offset:3848
ds_read_b64 v[240:241], v36 offset:3776
ds_read_b64 v[242:243], v36 offset:3784
ds_read_b64 v[244:245], v36 offset:3712
ds_read_b64 v[246:247], v36 offset:3720
ds_read_b64 v[248:249], v36 offset:3648
ds_read_b64 v[250:251], v36 offset:3656
s_waitcnt lgkmcnt(12)
v_mfma_f32_16x16x32_bf16 v[220:223], v[224:227], a[224:227], 0
ds_read_b64 v[252:253], v36 offset:3584
ds_read_b64 v[254:255], v36 offset:3592
v_mfma_f32_16x16x32_bf16 v[216:219], v[224:227], a[192:195], 0
ds_read_b128 a[228:231], v44 offset:15872
ds_read_b128 a[196:199], v44 offset:13824
v_mfma_f32_16x16x32_bf16 v[212:215], v[224:227], a[160:163], 0
ds_read_b128 a[164:167], v44 offset:11776
v_mfma_f32_16x16x32_bf16 v[208:211], v[224:227], a[128:131], 0
ds_read_b128 a[132:135], v44 offset:9728
v_mfma_f32_16x16x32_bf16 v[204:207], v[224:227], a[96:99], 0
ds_read_b128 a[100:103], v44 offset:7680
v_mfma_f32_16x16x32_bf16 v[200:203], v[224:227], a[64:67], 0
ds_read_b128 a[68:71], v44 offset:5632
v_mfma_f32_16x16x32_bf16 v[196:199], v[224:227], a[32:35], 0
ds_read_b128 a[36:39], v44 offset:3584
v_mfma_f32_16x16x32_bf16 v[192:195], v[224:227], a[0:3], 0
ds_read_b128 a[4:7], v44 offset:1536
s_waitcnt lgkmcnt(15)
s_waitcnt lgkmcnt(0)
v_mfma_f32_16x16x32_bf16 v[192:195], v[228:231], a[4:7], v[192:195]
ds_read_b64 v[224:225], v36 offset:3520
ds_read_b64 v[226:227], v36 offset:3528
v_mfma_f32_16x16x32_bf16 v[196:199], v[228:231], a[36:39], v[196:199]
ds_read_b128 a[232:235], v43 offset:15616
ds_read_b128 a[200:203], v43 offset:13568
v_mfma_f32_16x16x32_bf16 v[200:203], v[228:231], a[68:71], v[200:203]
ds_read_b128 a[168:171], v43 offset:11520
v_mfma_f32_16x16x32_bf16 v[204:207], v[228:231], a[100:103], v[204:207]
ds_read_b128 a[136:139], v43 offset:9472
v_mfma_f32_16x16x32_bf16 v[208:211], v[228:231], a[132:135], v[208:211]
ds_read_b128 a[104:107], v43 offset:7424
v_mfma_f32_16x16x32_bf16 v[212:215], v[228:231], a[164:167], v[212:215]
ds_read_b128 a[72:75], v43 offset:5376
v_mfma_f32_16x16x32_bf16 v[216:219], v[228:231], a[196:199], v[216:219]
ds_read_b128 a[40:43], v43 offset:3328
v_mfma_f32_16x16x32_bf16 v[220:223], v[228:231], a[228:231], v[220:223]
ds_read_b128 a[8:11], v43 offset:1280
s_waitcnt lgkmcnt(0)
v_mfma_f32_16x16x32_bf16 v[192:195], v[232:235], a[8:11], v[192:195]
ds_read_b64 v[228:229], v36 offset:3456
ds_read_b64 v[230:231], v36 offset:3464
v_mfma_f32_16x16x32_bf16 v[196:199], v[232:235], a[40:43], v[196:199]
ds_read_b128 a[236:239], v42 offset:15360
ds_read_b128 a[204:207], v42 offset:13312
v_mfma_f32_16x16x32_bf16 v[200:203], v[232:235], a[72:75], v[200:203]
ds_read_b128 a[172:175], v42 offset:11264
v_mfma_f32_16x16x32_bf16 v[204:207], v[232:235], a[104:107], v[204:207]
ds_read_b128 a[140:143], v42 offset:9216
v_mfma_f32_16x16x32_bf16 v[208:211], v[232:235], a[136:139], v[208:211]
ds_read_b128 a[108:111], v42 offset:7168
v_mfma_f32_16x16x32_bf16 v[212:215], v[232:235], a[168:171], v[212:215]
ds_read_b128 a[76:79], v42 offset:5120
v_mfma_f32_16x16x32_bf16 v[216:219], v[232:235], a[200:203], v[216:219]
ds_read_b128 a[44:47], v42 offset:3072
v_mfma_f32_16x16x32_bf16 v[220:223], v[232:235], a[232:235], v[220:223]
ds_read_b128 a[12:15], v42 offset:1024
s_waitcnt lgkmcnt(0)
v_mfma_f32_16x16x32_bf16 v[192:195], v[236:239], a[12:15], v[192:195]
ds_read_b64 v[232:233], v36 offset:3392
ds_read_b64 v[234:235], v36 offset:3400
v_mfma_f32_16x16x32_bf16 v[196:199], v[236:239], a[44:47], v[196:199]
ds_read_b128 a[240:243], v41 offset:15104
ds_read_b128 a[208:211], v41 offset:13056
v_mfma_f32_16x16x32_bf16 v[200:203], v[236:239], a[76:79], v[200:203]
ds_read_b128 a[176:179], v41 offset:11008
v_mfma_f32_16x16x32_bf16 v[204:207], v[236:239], a[108:111], v[204:207]
ds_read_b128 a[144:147], v41 offset:8960
v_mfma_f32_16x16x32_bf16 v[208:211], v[236:239], a[140:143], v[208:211]
ds_read_b128 a[112:115], v41 offset:6912
v_mfma_f32_16x16x32_bf16 v[212:215], v[236:239], a[172:175], v[212:215]
ds_read_b128 a[80:83], v41 offset:4864
v_mfma_f32_16x16x32_bf16 v[216:219], v[236:239], a[204:207], v[216:219]
ds_read_b128 a[48:51], v41 offset:2816
v_mfma_f32_16x16x32_bf16 v[220:223], v[236:239], a[236:239], v[220:223]
ds_read_b128 a[16:19], v41 offset:768
s_waitcnt lgkmcnt(0)
v_mfma_f32_16x16x32_bf16 v[192:195], v[240:243], a[16:19], v[192:195]
ds_read_b64 v[236:237], v36 offset:3328
ds_read_b64 v[238:239], v36 offset:3336
v_mfma_f32_16x16x32_bf16 v[196:199], v[240:243], a[48:51], v[196:199]
ds_read_b128 a[244:247], v44 offset:14848
ds_read_b128 a[212:215], v44 offset:12800
v_mfma_f32_16x16x32_bf16 v[200:203], v[240:243], a[80:83], v[200:203]
ds_read_b128 a[180:183], v44 offset:10752
v_mfma_f32_16x16x32_bf16 v[204:207], v[240:243], a[112:115], v[204:207]
ds_read_b128 a[148:151], v44 offset:8704
v_mfma_f32_16x16x32_bf16 v[208:211], v[240:243], a[144:147], v[208:211]
ds_read_b128 a[116:119], v44 offset:6656
v_mfma_f32_16x16x32_bf16 v[212:215], v[240:243], a[176:179], v[212:215]
ds_read_b128 a[84:87], v44 offset:4608
v_mfma_f32_16x16x32_bf16 v[216:219], v[240:243], a[208:211], v[216:219]
ds_read_b128 a[52:55], v44 offset:2560
v_mfma_f32_16x16x32_bf16 v[220:223], v[240:243], a[240:243], v[220:223]
ds_read_b128 a[20:23], v44 offset:512
s_waitcnt lgkmcnt(0)
v_mfma_f32_16x16x32_bf16 v[192:195], v[244:247], a[20:23], v[192:195]
ds_read_b64 v[240:241], v36 offset:3264
ds_read_b64 v[242:243], v36 offset:3272
v_mfma_f32_16x16x32_bf16 v[196:199], v[244:247], a[52:55], v[196:199]
ds_read_b128 a[248:251], v43 offset:14592
ds_read_b128 a[216:219], v43 offset:12544
v_mfma_f32_16x16x32_bf16 v[200:203], v[244:247], a[84:87], v[200:203]
ds_read_b128 a[184:187], v43 offset:10496
v_mfma_f32_16x16x32_bf16 v[204:207], v[244:247], a[116:119], v[204:207]
ds_read_b128 a[152:155], v43 offset:8448
v_mfma_f32_16x16x32_bf16 v[208:211], v[244:247], a[148:151], v[208:211]
ds_read_b128 a[120:123], v43 offset:6400
v_mfma_f32_16x16x32_bf16 v[212:215], v[244:247], a[180:183], v[212:215]
ds_read_b128 a[88:91], v43 offset:4352
v_mfma_f32_16x16x32_bf16 v[216:219], v[244:247], a[212:215], v[216:219]
ds_read_b128 a[56:59], v43 offset:2304
v_mfma_f32_16x16x32_bf16 v[220:223], v[244:247], a[244:247], v[220:223]
ds_read_b128 a[24:27], v43 offset:256
s_waitcnt lgkmcnt(0)
v_mfma_f32_16x16x32_bf16 v[192:195], v[248:251], a[24:27], v[192:195]
ds_read_b64 v[244:245], v36 offset:3200
ds_read_b64 v[246:247], v36 offset:3208
v_mfma_f32_16x16x32_bf16 v[196:199], v[248:251], a[56:59], v[196:199]
ds_read_b128 a[252:255], v42 offset:14336
ds_read_b128 a[220:223], v42 offset:12288
v_mfma_f32_16x16x32_bf16 v[200:203], v[248:251], a[88:91], v[200:203]
ds_read_b128 a[188:191], v42 offset:10240
v_mfma_f32_16x16x32_bf16 v[204:207], v[248:251], a[120:123], v[204:207]
ds_read_b128 a[156:159], v42 offset:8192
v_mfma_f32_16x16x32_bf16 v[208:211], v[248:251], a[152:155], v[208:211]
ds_read_b128 a[124:127], v42 offset:6144
v_mfma_f32_16x16x32_bf16 v[212:215], v[248:251], a[184:187], v[212:215]
ds_read_b128 a[92:95], v42 offset:4096
v_mfma_f32_16x16x32_bf16 v[216:219], v[248:251], a[216:219], v[216:219]
ds_read_b128 a[60:63], v42 offset:2048
v_mfma_f32_16x16x32_bf16 v[220:223], v[248:251], a[248:251], v[220:223]
ds_read_b128 a[28:31], v42 offset:0
s_waitcnt lgkmcnt(0)
v_mfma_f32_16x16x32_bf16 v[192:195], v[252:255], a[28:31], v[192:195]
ds_read_b64 v[248:249], v36 offset:3136
v_mfma_f32_16x16x32_bf16 v[196:199], v[252:255], a[60:63], v[196:199]
ds_read_b64 v[250:251], v36 offset:3144
v_mfma_f32_16x16x32_bf16 v[200:203], v[252:255], a[92:95], v[200:203]
s_add_u32 m0, s41, 1024
s_add_u32 s42, s43, 5252
v_mfma_f32_16x16x32_bf16 v[204:207], v[252:255], a[124:127], v[204:207]
buffer_load_dwordx4 v15, s[8:11], s42 offen sc1 lds
v_mfma_f32_16x16x32_bf16 v[208:211], v[252:255], a[156:159], v[208:211]
s_add_u32 m0, s41, 5184
s_add_u32 s42, s43, 1028
v_mfma_f32_16x16x32_bf16 v[212:215], v[252:255], a[188:191], v[212:215]
buffer_load_dwordx4 v15, s[8:11], s42 offen sc1 lds
v_mfma_f32_16x16x32_bf16 v[216:219], v[252:255], a[220:223], v[216:219]
s_add_u32 m0, s41, 9344
s_add_u32 s42, s43, 5248
v_mfma_f32_16x16x32_bf16 v[220:223], v[252:255], a[252:255], v[220:223]
s_barrier
v_mfma_f32_16x16x32_bf16 v[196:199], v[224:227], a[0:3], v[196:199]
ds_read_b64 v[252:253], v36 offset:3072
v_mfma_f32_16x16x32_bf16 v[200:203], v[224:227], a[32:35], v[200:203]
ds_read_b64 v[254:255], v36 offset:3080
v_mfma_f32_16x16x32_bf16 v[204:207], v[224:227], a[64:67], v[204:207]
v_cvt_pk_bf16_f32 v46, v192, v193
v_mfma_f32_16x16x32_bf16 v[208:211], v[224:227], a[96:99], v[208:211]
v_cvt_pk_bf16_f32 v47, v194, v195
v_mfma_f32_16x16x32_bf16 v[212:215], v[224:227], a[128:131], v[212:215]
s_add_u32 s50, s45, 0
buffer_store_dwordx2 v[46:47], v39, s[16:19], s50 offen offset:0 sc1
v_mfma_f32_16x16x32_bf16 v[216:219], v[224:227], a[160:163], v[216:219]
buffer_load_dwordx4 v15, s[8:11], s42 offen sc1 lds
v_mfma_f32_16x16x32_bf16 v[220:223], v[224:227], a[192:195], v[220:223]
v_mfma_f32_16x16x32_bf16 v[196:199], v[228:231], a[4:7], v[196:199]
s_waitcnt vmcnt(8)
ds_read_b64 v[224:225], v36 offset:3008
v_mfma_f32_16x16x32_bf16 v[200:203], v[228:231], a[36:39], v[200:203]
ds_read_b64 v[226:227], v36 offset:3016
v_mfma_f32_16x16x32_bf16 v[204:207], v[228:231], a[68:71], v[204:207]
s_add_u32 m0, s41, 13504
s_add_u32 s42, s43, 1024
v_mfma_f32_16x16x32_bf16 v[208:211], v[228:231], a[100:103], v[208:211]
buffer_load_dwordx4 v15, s[8:11], s42 offen sc1 lds
v_mfma_f32_16x16x32_bf16 v[212:215], v[228:231], a[132:135], v[212:215]
s_add_u32 m0, s41, 0
s_add_u32 s42, s43, 4228
v_mfma_f32_16x16x32_bf16 v[216:219], v[228:231], a[164:167], v[216:219]
buffer_load_dwordx4 v15, s[8:11], s42 offen sc1 lds
v_mfma_f32_16x16x32_bf16 v[220:223], v[228:231], a[196:199], v[220:223]
v_mfma_f32_16x16x32_bf16 v[196:199], v[232:235], a[8:11], v[196:199]
ds_read_b64 v[228:229], v36 offset:2944
v_mfma_f32_16x16x32_bf16 v[200:203], v[232:235], a[40:43], v[200:203]
ds_read_b64 v[230:231], v36 offset:2952
v_mfma_f32_16x16x32_bf16 v[204:207], v[232:235], a[72:75], v[204:207]
s_add_u32 m0, s41, 4160
s_add_u32 s42, s43, 4
v_mfma_f32_16x16x32_bf16 v[208:211], v[232:235], a[104:107], v[208:211]
buffer_load_dwordx4 v15, s[8:11], s42 offen sc1 lds
v_mfma_f32_16x16x32_bf16 v[212:215], v[232:235], a[136:139], v[212:215]
s_add_u32 m0, s41, 8320
s_add_u32 s42, s43, 4224
v_mfma_f32_16x16x32_bf16 v[216:219], v[232:235], a[168:171], v[216:219]
buffer_load_dwordx4 v15, s[8:11], s42 offen sc1 lds
v_mfma_f32_16x16x32_bf16 v[220:223], v[232:235], a[200:203], v[220:223]
v_mfma_f32_16x16x32_bf16 v[196:199], v[236:239], a[12:15], v[196:199]
ds_read_b64 v[232:233], v36 offset:2880
v_mfma_f32_16x16x32_bf16 v[200:203], v[236:239], a[44:47], v[200:203]
ds_read_b64 v[234:235], v36 offset:2888
v_mfma_f32_16x16x32_bf16 v[204:207], v[236:239], a[76:79], v[204:207]
s_add_u32 m0, s41, 12480
s_add_u32 s42, s43, 0
v_mfma_f32_16x16x32_bf16 v[208:211], v[236:239], a[108:111], v[208:211]
buffer_load_dwordx4 v15, s[8:11], s42 offen sc1 lds
v_mfma_f32_16x16x32_bf16 v[212:215], v[236:239], a[140:143], v[212:215]
s_add_u32 m0, s46, 68608
s_add_u32 s42, s48, 0
v_mfma_f32_16x16x32_bf16 v[216:219], v[236:239], a[172:175], v[216:219]
buffer_load_dwordx4 v40, s[12:15], s42 offen sc1 lds
v_mfma_f32_16x16x32_bf16 v[220:223], v[236:239], a[204:207], v[220:223]
v_mfma_f32_16x16x32_bf16 v[196:199], v[240:243], a[16:19], v[196:199]
ds_read_b64 v[236:237], v36 offset:2816
v_mfma_f32_16x16x32_bf16 v[200:203], v[240:243], a[48:51], v[200:203]
ds_read_b64 v[238:239], v36 offset:2824
v_mfma_f32_16x16x32_bf16 v[204:207], v[240:243], a[80:83], v[204:207]
s_add_u32 m0, s46, 69632
s_add_u32 s42, s48, 147456
v_mfma_f32_16x16x32_bf16 v[208:211], v[240:243], a[112:115], v[208:211]
buffer_load_dwordx4 v40, s[12:15], s42 offen sc1 lds
v_mfma_f32_16x16x32_bf16 v[212:215], v[240:243], a[144:147], v[212:215]
s_add_u32 m0, s46, 70656
s_add_u32 s42, s48, 294912
v_mfma_f32_16x16x32_bf16 v[216:219], v[240:243], a[176:179], v[216:219]
buffer_load_dwordx4 v40, s[12:15], s42 offen sc1 lds
v_mfma_f32_16x16x32_bf16 v[220:223], v[240:243], a[208:211], v[220:223]
s_barrier
s_cmp_lg_u32 s98, 0
s_cbranch_scc1 SIG_15
s_lshl_b32 s56, s2, 7
s_add_u32 s56, s56, 40894472
v_mov_b32 v60, s56
v_mov_b32 v61, s100
s_mov_b64 exec, 1
global_store_dword v60, v61, s[6:7] sc1
s_mov_b64 exec, -1
SIG_15:
v_mfma_f32_16x16x32_bf16 v[196:199], v[244:247], a[20:23], v[196:199]
ds_read_b64 v[240:241], v36 offset:2752
v_mfma_f32_16x16x32_bf16 v[200:203], v[244:247], a[52:55], v[200:203]
ds_read_b64 v[242:243], v36 offset:2760
v_mfma_f32_16x16x32_bf16 v[204:207], v[244:247], a[84:87], v[204:207]
s_add_u32 m0, s46, 71680
s_add_u32 s42, s48, 442368
v_mfma_f32_16x16x32_bf16 v[208:211], v[244:247], a[116:119], v[208:211]
buffer_load_dwordx4 v40, s[12:15], s42 offen sc1 lds
v_mfma_f32_16x16x32_bf16 v[212:215], v[244:247], a[148:151], v[212:215]
v_mfma_f32_16x16x32_bf16 v[216:219], v[244:247], a[180:183], v[216:219]
v_mfma_f32_16x16x32_bf16 v[220:223], v[244:247], a[212:215], v[220:223]
s_waitcnt lgkmcnt(12)
v_mfma_f32_16x16x32_bf16 v[196:199], v[248:251], a[24:27], v[196:199]
ds_read_b64 v[244:245], v36 offset:2688
v_mfma_f32_16x16x32_bf16 v[200:203], v[248:251], a[56:59], v[200:203]
ds_read_b64 v[246:247], v36 offset:2696
v_mfma_f32_16x16x32_bf16 v[204:207], v[248:251], a[88:91], v[204:207]
v_mfma_f32_16x16x32_bf16 v[208:211], v[248:251], a[120:123], v[208:211]
v_mfma_f32_16x16x32_bf16 v[212:215], v[248:251], a[152:155], v[212:215]
v_mfma_f32_16x16x32_bf16 v[216:219], v[248:251], a[184:187], v[216:219]
v_mfma_f32_16x16x32_bf16 v[220:223], v[248:251], a[216:219], v[220:223]
s_waitcnt lgkmcnt(12)
v_mfma_f32_16x16x32_bf16 v[196:199], v[252:255], a[28:31], v[196:199]
ds_read_b64 v[248:249], v36 offset:2624
v_mfma_f32_16x16x32_bf16 v[200:203], v[252:255], a[60:63], v[200:203]
ds_read_b64 v[250:251], v36 offset:2632
v_mfma_f32_16x16x32_bf16 v[204:207], v[252:255], a[92:95], v[204:207]
v_mfma_f32_16x16x32_bf16 v[208:211], v[252:255], a[124:127], v[208:211]
v_mfma_f32_16x16x32_bf16 v[212:215], v[252:255], a[156:159], v[212:215]
v_mfma_f32_16x16x32_bf16 v[216:219], v[252:255], a[188:191], v[216:219]
v_mfma_f32_16x16x32_bf16 v[220:223], v[252:255], a[220:223], v[220:223]
s_waitcnt lgkmcnt(12)
v_mfma_f32_16x16x32_bf16 v[200:203], v[224:227], a[0:3], v[200:203]
ds_read_b64 v[252:253], v36 offset:2560
v_mfma_f32_16x16x32_bf16 v[204:207], v[224:227], a[32:35], v[204:207]
ds_read_b64 v[254:255], v36 offset:2568
v_mfma_f32_16x16x32_bf16 v[208:211], v[224:227], a[64:67], v[208:211]
v_cvt_pk_bf16_f32 v48, v196, v197
v_mfma_f32_16x16x32_bf16 v[212:215], v[224:227], a[96:99], v[212:215]
v_cvt_pk_bf16_f32 v49, v198, v199
v_mfma_f32_16x16x32_bf16 v[216:219], v[224:227], a[128:131], v[216:219]
s_add_u32 s50, s45, 0
buffer_store_dwordx2 v[48:49], v39, s[16:19], s50 offen offset:512 sc1
v_mfma_f32_16x16x32_bf16 v[220:223], v[224:227], a[160:163], v[220:223]
s_waitcnt lgkmcnt(12)
v_mfma_f32_16x16x32_bf16 v[200:203], v[228:231], a[4:7], v[200:203]
ds_read_b64 v[224:225], v36 offset:2496
v_mfma_f32_16x16x32_bf16 v[204:207], v[228:231], a[36:39], v[204:207]
ds_read_b64 v[226:227], v36 offset:2504
v_mfma_f32_16x16x32_bf16 v[208:211], v[228:231], a[68:71], v[208:211]
s_add_u32 m0, s41, 3072
s_add_u32 s42, s43, 2169988
v_mfma_f32_16x16x32_bf16 v[212:215], v[228:231], a[100:103], v[212:215]
buffer_load_dwordx4 v15, s[8:11], s42 offen sc1 lds
v_mfma_f32_16x16x32_bf16 v[216:219], v[228:231], a[132:135], v[216:219]
s_add_u32 m0, s41, 7232
s_add_u32 s42, s43, 2165764
v_mfma_f32_16x16x32_bf16 v[220:223], v[228:231], a[164:167], v[220:223]
s_waitcnt lgkmcnt(12)
v_mfma_f32_16x16x32_bf16 v[200:203], v[232:235], a[8:11], v[200:203]
ds_read_b64 v[228:229], v36 offset:2432
v_mfma_f32_16x16x32_bf16 v[204:207], v[232:235], a[40:43], v[204:207]
ds_read_b64 v[230:231], v36 offset:2440
v_mfma_f32_16x16x32_bf16 v[208:211], v[232:235], a[72:75], v[208:211]
buffer_load_dwordx4 v15, s[8:11], s42 offen sc1 lds
v_mfma_f32_16x16x32_bf16 v[212:215], v[232:235], a[104:107], v[212:215]
s_add_u32 m0, s41, 11392
s_add_u32 s42, s43, 2169984
v_mfma_f32_16x16x32_bf16 v[216:219], v[232:235], a[136:139], v[216:219]
buffer_load_dwordx4 v15, s[8:11], s42 offen sc1 lds
v_mfma_f32_16x16x32_bf16 v[220:223], v[232:235], a[168:171], v[220:223]
s_waitcnt lgkmcnt(12)
v_mfma_f32_16x16x32_bf16 v[200:203], v[236:239], a[12:15], v[200:203]
ds_read_b64 v[232:233], v36 offset:2368
v_mfma_f32_16x16x32_bf16 v[204:207], v[236:239], a[44:47], v[204:207]
ds_read_b64 v[234:235], v36 offset:2376
v_mfma_f32_16x16x32_bf16 v[208:211], v[236:239], a[76:79], v[208:211]
s_add_u32 m0, s41, 15552
s_add_u32 s42, s43, 2165760
v_mfma_f32_16x16x32_bf16 v[212:215], v[236:239], a[108:111], v[212:215]
buffer_load_dwordx4 v15, s[8:11], s42 offen sc1 lds
v_mfma_f32_16x16x32_bf16 v[216:219], v[236:239], a[140:143], v[216:219]
v_mfma_f32_16x16x32_bf16 v[220:223], v[236:239], a[172:175], v[220:223]
s_waitcnt lgkmcnt(12)
v_mfma_f32_16x16x32_bf16 v[200:203], v[240:243], a[16:19], v[200:203]
ds_read_b64 v[236:237], v36 offset:2304
v_mfma_f32_16x16x32_bf16 v[204:207], v[240:243], a[48:51], v[204:207]
ds_read_b64 v[238:239], v36 offset:2312
v_mfma_f32_16x16x32_bf16 v[208:211], v[240:243], a[80:83], v[208:211]
v_mfma_f32_16x16x32_bf16 v[212:215], v[240:243], a[112:115], v[212:215]
v_mfma_f32_16x16x32_bf16 v[216:219], v[240:243], a[144:147], v[216:219]
v_mfma_f32_16x16x32_bf16 v[220:223], v[240:243], a[176:179], v[220:223]
s_waitcnt vmcnt(18)
s_barrier
ds_read_b128 a[224:227], v41 offset:34560
ds_read_b128 a[228:231], v44 offset:34304
s_waitcnt lgkmcnt(14)
v_mfma_f32_16x16x32_bf16 v[200:203], v[244:247], a[20:23], v[200:203]
ds_read_b64 v[240:241], v36 offset:2240
v_mfma_f32_16x16x32_bf16 v[204:207], v[244:247], a[52:55], v[204:207]
ds_read_b64 v[242:243], v36 offset:2248
v_mfma_f32_16x16x32_bf16 v[208:211], v[244:247], a[84:87], v[208:211]
v_mfma_f32_16x16x32_bf16 v[212:215], v[244:247], a[116:119], v[212:215]
v_mfma_f32_16x16x32_bf16 v[216:219], v[244:247], a[148:151], v[216:219]
v_mfma_f32_16x16x32_bf16 v[220:223], v[244:247], a[180:183], v[220:223]
ds_read_b128 a[232:235], v43 offset:34048
ds_read_b128 a[236:239], v42 offset:33792
s_waitcnt lgkmcnt(15)
v_mfma_f32_16x16x32_bf16 v[200:203], v[248:251], a[24:27], v[200:203]
ds_read_b64 v[244:245], v36 offset:2176
v_mfma_f32_16x16x32_bf16 v[204:207], v[248:251], a[56:59], v[204:207]
ds_read_b64 v[246:247], v36 offset:2184
v_mfma_f32_16x16x32_bf16 v[208:211], v[248:251], a[88:91], v[208:211]
v_mfma_f32_16x16x32_bf16 v[212:215], v[248:251], a[120:123], v[212:215]
v_mfma_f32_16x16x32_bf16 v[216:219], v[248:251], a[152:155], v[216:219]
v_mfma_f32_16x16x32_bf16 v[220:223], v[248:251], a[184:187], v[220:223]
ds_read_b128 a[240:243], v41 offset:33536
ds_read_b128 a[244:247], v44 offset:33280
s_waitcnt lgkmcnt(15)
v_mfma_f32_16x16x32_bf16 v[200:203], v[252:255], a[28:31], v[200:203]
ds_read_b64 v[248:249], v36 offset:2112
v_mfma_f32_16x16x32_bf16 v[204:207], v[252:255], a[60:63], v[204:207]
ds_read_b64 v[250:251], v36 offset:2120
v_mfma_f32_16x16x32_bf16 v[208:211], v[252:255], a[92:95], v[208:211]
v_mfma_f32_16x16x32_bf16 v[212:215], v[252:255], a[124:127], v[212:215]
v_mfma_f32_16x16x32_bf16 v[216:219], v[252:255], a[156:159], v[216:219]
v_mfma_f32_16x16x32_bf16 v[220:223], v[252:255], a[188:191], v[220:223]
ds_read_b128 a[248:251], v43 offset:33024
ds_read_b128 a[252:255], v42 offset:32768
v_mfma_f32_16x16x32_bf16 v[204:207], v[224:227], a[0:3], v[204:207]
ds_read_b64 v[252:253], v36 offset:2048
v_mfma_f32_16x16x32_bf16 v[208:211], v[224:227], a[32:35], v[208:211]
ds_read_b64 v[254:255], v36 offset:2056
v_mfma_f32_16x16x32_bf16 v[212:215], v[224:227], a[64:67], v[212:215]
v_cvt_pk_bf16_f32 v46, v200, v201
v_mfma_f32_16x16x32_bf16 v[216:219], v[224:227], a[96:99], v[216:219]
v_cvt_pk_bf16_f32 v47, v202, v203
v_mfma_f32_16x16x32_bf16 v[220:223], v[224:227], a[128:131], v[220:223]
ds_read_b128 a[192:195], v41 offset:32512
ds_read_b128 a[196:199], v44 offset:32256
s_waitcnt lgkmcnt(15)
v_mfma_f32_16x16x32_bf16 v[204:207], v[228:231], a[4:7], v[204:207]
s_waitcnt vmcnt(13)
ds_read_b64 v[224:225], v36 offset:1984
v_mfma_f32_16x16x32_bf16 v[208:211], v[228:231], a[36:39], v[208:211]
ds_read_b64 v[226:227], v36 offset:1992
v_mfma_f32_16x16x32_bf16 v[212:215], v[228:231], a[68:71], v[212:215]
s_add_u32 s50, s45, 0
buffer_store_dwordx2 v[46:47], v39, s[16:19], s50 offen offset:1024 sc1
v_mfma_f32_16x16x32_bf16 v[216:219], v[228:231], a[100:103], v[216:219]
v_mfma_f32_16x16x32_bf16 v[220:223], v[228:231], a[132:135], v[220:223]
ds_read_b128 a[200:203], v43 offset:32000
ds_read_b128 a[204:207], v42 offset:31744
v_mfma_f32_16x16x32_bf16 v[204:207], v[232:235], a[8:11], v[204:207]
ds_read_b64 v[228:229], v36 offset:1920
v_mfma_f32_16x16x32_bf16 v[208:211], v[232:235], a[40:43], v[208:211]
ds_read_b64 v[230:231], v36 offset:1928
v_mfma_f32_16x16x32_bf16 v[212:215], v[232:235], a[72:75], v[212:215]
v_mfma_f32_16x16x32_bf16 v[216:219], v[232:235], a[104:107], v[216:219]
v_mfma_f32_16x16x32_bf16 v[220:223], v[232:235], a[136:139], v[220:223]
ds_read_b128 a[208:211], v41 offset:31488
ds_read_b128 a[212:215], v44 offset:31232
v_mfma_f32_16x16x32_bf16 v[204:207], v[236:239], a[12:15], v[204:207]
ds_read_b64 v[232:233], v36 offset:1856
v_mfma_f32_16x16x32_bf16 v[208:211], v[236:239], a[44:47], v[208:211]
ds_read_b64 v[234:235], v36 offset:1864
v_mfma_f32_16x16x32_bf16 v[212:215], v[236:239], a[76:79], v[212:215]
v_mfma_f32_16x16x32_bf16 v[216:219], v[236:239], a[108:111], v[216:219]
v_mfma_f32_16x16x32_bf16 v[220:223], v[236:239], a[140:143], v[220:223]
ds_read_b128 a[216:219], v43 offset:30976
ds_read_b128 a[220:223], v42 offset:30720
s_waitcnt lgkmcnt(15)
v_mfma_f32_16x16x32_bf16 v[204:207], v[240:243], a[16:19], v[204:207]
ds_read_b64 v[236:237], v36 offset:1792
v_mfma_f32_16x16x32_bf16 v[208:211], v[240:243], a[48:51], v[208:211]
ds_read_b64 v[238:239], v36 offset:1800
v_mfma_f32_16x16x32_bf16 v[212:215], v[240:243], a[80:83], v[212:215]
v_mfma_f32_16x16x32_bf16 v[216:219], v[240:243], a[112:115], v[216:219]
v_mfma_f32_16x16x32_bf16 v[220:223], v[240:243], a[144:147], v[220:223]
ds_read_b128 a[160:163], v41 offset:30464
ds_read_b128 a[164:167], v44 offset:30208
v_mfma_f32_16x16x32_bf16 v[204:207], v[244:247], a[20:23], v[204:207]
ds_read_b64 v[240:241], v36 offset:1728
v_mfma_f32_16x16x32_bf16 v[208:211], v[244:247], a[52:55], v[208:211]
ds_read_b64 v[242:243], v36 offset:1736
v_mfma_f32_16x16x32_bf16 v[212:215], v[244:247], a[84:87], v[212:215]
v_mfma_f32_16x16x32_bf16 v[216:219], v[244:247], a[116:119], v[216:219]
v_mfma_f32_16x16x32_bf16 v[220:223], v[244:247], a[148:151], v[220:223]
ds_read_b128 a[168:171], v43 offset:29952
ds_read_b128 a[172:175], v42 offset:29696
v_mfma_f32_16x16x32_bf16 v[204:207], v[248:251], a[24:27], v[204:207]
ds_read_b64 v[244:245], v36 offset:1664
v_mfma_f32_16x16x32_bf16 v[208:211], v[248:251], a[56:59], v[208:211]
ds_read_b64 v[246:247], v36 offset:1672
v_mfma_f32_16x16x32_bf16 v[212:215], v[248:251], a[88:91], v[212:215]
v_mfma_f32_16x16x32_bf16 v[216:219], v[248:251], a[120:123], v[216:219]
v_mfma_f32_16x16x32_bf16 v[220:223], v[248:251], a[152:155], v[220:223]
ds_read_b128 a[176:179], v41 offset:29440
ds_read_b128 a[180:183], v44 offset:29184
s_waitcnt lgkmcnt(15)
v_mfma_f32_16x16x32_bf16 v[204:207], v[252:255], a[28:31], v[204:207]
ds_read_b64 v[248:249], v36 offset:1600
v_mfma_f32_16x16x32_bf16 v[208:211], v[252:255], a[60:63], v[208:211]
ds_read_b64 v[250:251], v36 offset:1608
v_mfma_f32_16x16x32_bf16 v[212:215], v[252:255], a[92:95], v[212:215]
v_mfma_f32_16x16x32_bf16 v[216:219], v[252:255], a[124:127], v[216:219]
v_mfma_f32_16x16x32_bf16 v[220:223], v[252:255], a[156:159], v[220:223]
ds_read_b128 a[184:187], v43 offset:28928
ds_read_b128 a[188:191], v42 offset:28672
v_mfma_f32_16x16x32_bf16 v[208:211], v[224:227], a[0:3], v[208:211]
ds_read_b64 v[252:253], v36 offset:1536
v_mfma_f32_16x16x32_bf16 v[212:215], v[224:227], a[32:35], v[212:215]
ds_read_b64 v[254:255], v36 offset:1544
v_mfma_f32_16x16x32_bf16 v[216:219], v[224:227], a[64:67], v[216:219]
v_cvt_pk_bf16_f32 v48, v204, v205
v_mfma_f32_16x16x32_bf16 v[220:223], v[224:227], a[96:99], v[220:223]
ds_read_b128 a[128:131], v41 offset:28416
ds_read_b128 a[132:135], v44 offset:28160
v_mfma_f32_16x16x32_bf16 v[208:211], v[228:231], a[4:7], v[208:211]
ds_read_b64 v[224:225], v36 offset:1472
v_mfma_f32_16x16x32_bf16 v[212:215], v[228:231], a[36:39], v[212:215]
ds_read_b64 v[226:227], v36 offset:1480
v_mfma_f32_16x16x32_bf16 v[216:219], v[228:231], a[68:71], v[216:219]
v_cvt_pk_bf16_f32 v49, v206, v207
v_mfma_f32_16x16x32_bf16 v[220:223], v[228:231], a[100:103], v[220:223]
ds_read_b128 a[136:139], v43 offset:27904
ds_read_b128 a[140:143], v42 offset:27648
s_waitcnt lgkmcnt(15)
v_mfma_f32_16x16x32_bf16 v[208:211], v[232:235], a[8:11], v[208:211]
ds_read_b64 v[228:229], v36 offset:1408
v_mfma_f32_16x16x32_bf16 v[212:215], v[232:235], a[40:43], v[212:215]
ds_read_b64 v[230:231], v36 offset:1416
v_mfma_f32_16x16x32_bf16 v[216:219], v[232:235], a[72:75], v[216:219]
s_add_u32 s50, s45, 0
buffer_store_dwordx2 v[48:49], v39, s[16:19], s50 offen offset:1536 sc1
v_mfma_f32_16x16x32_bf16 v[220:223], v[232:235], a[104:107], v[220:223]
ds_read_b128 a[144:147], v41 offset:27392
ds_read_b128 a[148:151], v44 offset:27136
v_mfma_f32_16x16x32_bf16 v[208:211], v[236:239], a[12:15], v[208:211]
ds_read_b64 v[232:233], v36 offset:1344
v_mfma_f32_16x16x32_bf16 v[212:215], v[236:239], a[44:47], v[212:215]
ds_read_b64 v[234:235], v36 offset:1352
v_mfma_f32_16x16x32_bf16 v[216:219], v[236:239], a[76:79], v[216:219]
s_add_u32 m0, s41, 2048
s_add_u32 s42, s43, 2168964
v_mfma_f32_16x16x32_bf16 v[220:223], v[236:239], a[108:111], v[220:223]
ds_read_b128 a[152:155], v43 offset:26880
ds_read_b128 a[156:159], v42 offset:26624
v_mfma_f32_16x16x32_bf16 v[208:211], v[240:243], a[16:19], v[208:211]
ds_read_b64 v[236:237], v36 offset:1280
v_mfma_f32_16x16x32_bf16 v[212:215], v[240:243], a[48:51], v[212:215]
ds_read_b64 v[238:239], v36 offset:1288
v_mfma_f32_16x16x32_bf16 v[216:219], v[240:243], a[80:83], v[216:219]
buffer_load_dwordx4 v15, s[8:11], s42 offen sc1 lds
v_mfma_f32_16x16x32_bf16 v[220:223], v[240:243], a[112:115], v[220:223]
ds_read_b128 a[96:99], v41 offset:26368
ds_read_b128 a[100:103], v44 offset:26112
s_waitcnt lgkmcnt(15)
v_mfma_f32_16x16x32_bf16 v[208:211], v[244:247], a[20:23], v[208:211]
ds_read_b64 v[240:241], v36 offset:1216
v_mfma_f32_16x16x32_bf16 v[212:215], v[244:247], a[52:55], v[212:215]
ds_read_b64 v[242:243], v36 offset:1224
v_mfma_f32_16x16x32_bf16 v[216:219], v[244:247], a[84:87], v[216:219]
s_add_u32 m0, s41, 6208
s_add_u32 s42, s43, 2164740
v_mfma_f32_16x16x32_bf16 v[220:223], v[244:247], a[116:119], v[220:223]
ds_read_b128 a[104:107], v43 offset:25856
ds_read_b128 a[108:111], v42 offset:25600
v_mfma_f32_16x16x32_bf16 v[208:211], v[248:251], a[24:27], v[208:211]
ds_read_b64 v[244:245], v36 offset:1152
v_mfma_f32_16x16x32_bf16 v[212:215], v[248:251], a[56:59], v[212:215]
ds_read_b64 v[246:247], v36 offset:1160
v_mfma_f32_16x16x32_bf16 v[216:219], v[248:251], a[88:91], v[216:219]
buffer_load_dwordx4 v15, s[8:11], s42 offen sc1 lds
v_mfma_f32_16x16x32_bf16 v[220:223], v[248:251], a[120:123], v[220:223]
ds_read_b128 a[112:115], v41 offset:25344
ds_read_b128 a[116:119], v44 offset:25088
v_mfma_f32_16x16x32_bf16 v[208:211], v[252:255], a[28:31], v[208:211]
ds_read_b64 v[248:249], v36 offset:1088
v_mfma_f32_16x16x32_bf16 v[212:215], v[252:255], a[60:63], v[212:215]
ds_read_b64 v[250:251], v36 offset:1096
v_mfma_f32_16x16x32_bf16 v[216:219], v[252:255], a[92:95], v[216:219]
s_add_u32 m0, s41, 10368
s_add_u32 s42, s43, 2168960
v_mfma_f32_16x16x32_bf16 v[220:223], v[252:255], a[124:127], v[220:223]
ds_read_b128 a[120:123], v43 offset:24832
ds_read_b128 a[124:127], v42 offset:24576
s_waitcnt lgkmcnt(15)
v_mfma_f32_16x16x32_bf16 v[212:215], v[224:227], a[0:3], v[212:215]
ds_read_b64 v[252:253], v36 offset:1024
v_mfma_f32_16x16x32_bf16 v[216:219], v[224:227], a[32:35], v[216:219]
ds_read_b64 v[254:255], v36 offset:1032
v_mfma_f32_16x16x32_bf16 v[220:223], v[224:227], a[64:67], v[220:223]
ds_read_b128 a[64:67], v41 offset:24320
v_mfma_f32_16x16x32_bf16 v[212:215], v[228:231], a[4:7], v[212:215]
s_waitcnt vmcnt(13)
ds_read_b64 v[224:225], v36 offset:960
v_mfma_f32_16x16x32_bf16 v[216:219], v[228:231], a[36:39], v[216:219]
ds_read_b64 v[226:227], v36 offset:968
v_mfma_f32_16x16x32_bf16 v[220:223], v[228:231], a[68:71], v[220:223]
ds_read_b128 a[68:71], v44 offset:24064
v_mfma_f32_16x16x32_bf16 v[212:215], v[232:235], a[8:11], v[212:215]
ds_read_b64 v[228:229], v36 offset:896
v_mfma_f32_16x16x32_bf16 v[216:219], v[232:235], a[40:43], v[216:219]
ds_read_b64 v[230:231], v36 offset:904
v_mfma_f32_16x16x32_bf16 v[220:223], v[232:235], a[72:75], v[220:223]
ds_read_b128 a[72:75], v43 offset:23808
s_waitcnt lgkmcnt(15)
v_mfma_f32_16x16x32_bf16 v[212:215], v[236:239], a[12:15], v[212:215]
ds_read_b64 v[232:233], v36 offset:832
v_mfma_f32_16x16x32_bf16 v[216:219], v[236:239], a[44:47], v[216:219]
ds_read_b64 v[234:235], v36 offset:840
v_mfma_f32_16x16x32_bf16 v[220:223], v[236:239], a[76:79], v[220:223]
ds_read_b128 a[76:79], v42 offset:23552
v_mfma_f32_16x16x32_bf16 v[212:215], v[240:243], a[16:19], v[212:215]
ds_read_b64 v[236:237], v36 offset:768
v_mfma_f32_16x16x32_bf16 v[216:219], v[240:243], a[48:51], v[216:219]
ds_read_b64 v[238:239], v36 offset:776
v_mfma_f32_16x16x32_bf16 v[220:223], v[240:243], a[80:83], v[220:223]
ds_read_b128 a[80:83], v41 offset:23296
v_mfma_f32_16x16x32_bf16 v[212:215], v[244:247], a[20:23], v[212:215]
ds_read_b64 v[240:241], v36 offset:704
v_mfma_f32_16x16x32_bf16 v[216:219], v[244:247], a[52:55], v[216:219]
ds_read_b64 v[242:243], v36 offset:712
v_mfma_f32_16x16x32_bf16 v[220:223], v[244:247], a[84:87], v[220:223]
ds_read_b128 a[84:87], v44 offset:23040
s_waitcnt lgkmcnt(15)
v_mfma_f32_16x16x32_bf16 v[212:215], v[248:251], a[24:27], v[212:215]
ds_read_b64 v[244:245], v36 offset:640
v_mfma_f32_16x16x32_bf16 v[216:219], v[248:251], a[56:59], v[216:219]
ds_read_b64 v[246:247], v36 offset:648
v_mfma_f32_16x16x32_bf16 v[220:223], v[248:251], a[88:91], v[220:223]
ds_read_b128 a[88:91], v43 offset:22784
v_mfma_f32_16x16x32_bf16 v[212:215], v[252:255], a[28:31], v[212:215]
ds_read_b64 v[248:249], v36 offset:576
v_mfma_f32_16x16x32_bf16 v[216:219], v[252:255], a[60:63], v[216:219]
ds_read_b64 v[250:251], v36 offset:584
v_mfma_f32_16x16x32_bf16 v[220:223], v[252:255], a[92:95], v[220:223]
ds_read_b128 a[92:95], v42 offset:22528
s_waitcnt lgkmcnt(15)
v_mfma_f32_16x16x32_bf16 v[216:219], v[224:227], a[0:3], v[216:219]
ds_read_b64 v[252:253], v36 offset:512
v_mfma_f32_16x16x32_bf16 v[220:223], v[224:227], a[32:35], v[220:223]
ds_read_b64 v[254:255], v36 offset:520
ds_read_b128 a[32:35], v41 offset:22272
v_mfma_f32_16x16x32_bf16 v[216:219], v[228:231], a[4:7], v[216:219]
ds_read_b64 v[224:225], v36 offset:448
v_mfma_f32_16x16x32_bf16 v[220:223], v[228:231], a[36:39], v[220:223]
ds_read_b64 v[226:227], v36 offset:456
ds_read_b128 a[36:39], v44 offset:22016
s_waitcnt lgkmcnt(15)
v_mfma_f32_16x16x32_bf16 v[216:219], v[232:235], a[8:11], v[216:219]
ds_read_b64 v[228:229], v36 offset:384
v_mfma_f32_16x16x32_bf16 v[220:223], v[232:235], a[40:43], v[220:223]
ds_read_b64 v[230:231], v36 offset:392
ds_read_b128 a[40:43], v43 offset:21760
v_mfma_f32_16x16x32_bf16 v[216:219], v[236:239], a[12:15], v[216:219]
ds_read_b64 v[232:233], v36 offset:320
v_mfma_f32_16x16x32_bf16 v[220:223], v[236:239], a[44:47], v[220:223]
ds_read_b64 v[234:235], v36 offset:328
ds_read_b128 a[44:47], v42 offset:21504
s_waitcnt lgkmcnt(15)
v_mfma_f32_16x16x32_bf16 v[216:219], v[240:243], a[16:19], v[216:219]
ds_read_b64 v[236:237], v36 offset:256
v_mfma_f32_16x16x32_bf16 v[220:223], v[240:243], a[48:51], v[220:223]
ds_read_b64 v[238:239], v36 offset:264
ds_read_b128 a[48:51], v41 offset:21248
v_mfma_f32_16x16x32_bf16 v[216:219], v[244:247], a[20:23], v[216:219]
ds_read_b64 v[240:241], v36 offset:192
v_mfma_f32_16x16x32_bf16 v[220:223], v[244:247], a[52:55], v[220:223]
ds_read_b64 v[242:243], v36 offset:200
ds_read_b128 a[52:55], v44 offset:20992
s_waitcnt lgkmcnt(15)
v_mfma_f32_16x16x32_bf16 v[216:219], v[248:251], a[24:27], v[216:219]
ds_read_b64 v[244:245], v36 offset:128
v_mfma_f32_16x16x32_bf16 v[220:223], v[248:251], a[56:59], v[220:223]
ds_read_b64 v[246:247], v36 offset:136
ds_read_b128 a[56:59], v43 offset:20736
v_mfma_f32_16x16x32_bf16 v[216:219], v[252:255], a[28:31], v[216:219]
ds_read_b64 v[248:249], v36 offset:64
v_mfma_f32_16x16x32_bf16 v[220:223], v[252:255], a[60:63], v[220:223]
ds_read_b64 v[250:251], v36 offset:72
ds_read_b128 a[60:63], v42 offset:20480
s_waitcnt lgkmcnt(15)
v_mfma_f32_16x16x32_bf16 v[220:223], v[224:227], a[0:3], v[220:223]
ds_read_b64 v[252:253], v36 offset:0
ds_read_b64 v[254:255], v36 offset:8
ds_read_b128 a[0:3], v41 offset:20224
v_mfma_f32_16x16x32_bf16 v[220:223], v[228:231], a[4:7], v[220:223]
s_waitcnt vmcnt(4)
ds_read_b64 v[224:225], v36 offset:4032
ds_read_b64 v[226:227], v36 offset:4040
ds_read_b128 a[4:7], v44 offset:19968
s_waitcnt lgkmcnt(15)
v_mfma_f32_16x16x32_bf16 v[220:223], v[232:235], a[8:11], v[220:223]
ds_read_b64 v[228:229], v36 offset:3968
ds_read_b64 v[230:231], v36 offset:3976
ds_read_b128 a[8:11], v43 offset:19712
v_mfma_f32_16x16x32_bf16 v[220:223], v[236:239], a[12:15], v[220:223]
ds_read_b64 v[232:233], v36 offset:3904
ds_read_b64 v[234:235], v36 offset:3912
ds_read_b128 a[12:15], v42 offset:19456
s_waitcnt lgkmcnt(15)
v_mfma_f32_16x16x32_bf16 v[220:223], v[240:243], a[16:19], v[220:223]
ds_read_b64 v[236:237], v36 offset:3840
ds_read_b64 v[238:239], v36 offset:3848
ds_read_b128 a[16:19], v41 offset:19200
v_mfma_f32_16x16x32_bf16 v[220:223], v[244:247], a[20:23], v[220:223]
ds_read_b64 v[240:241], v36 offset:3776
ds_read_b64 v[242:243], v36 offset:3784
ds_read_b128 a[20:23], v44 offset:18944
s_waitcnt lgkmcnt(15)
v_mfma_f32_16x16x32_bf16 v[220:223], v[248:251], a[24:27], v[220:223]
ds_read_b64 v[244:245], v36 offset:3712
ds_read_b64 v[246:247], v36 offset:3720
ds_read_b128 a[24:27], v43 offset:18688
v_mfma_f32_16x16x32_bf16 v[220:223], v[252:255], a[28:31], v[220:223]
ds_read_b64 v[248:249], v36 offset:3648
ds_read_b64 v[250:251], v36 offset:3656
ds_read_b128 a[28:31], v42 offset:18432
buffer_load_dwordx4 v15, s[8:11], s42 offen sc1 lds
s_add_u32 m0, s41, 14528
s_add_u32 s42, s43, 2164736
buffer_load_dwordx4 v15, s[8:11], s42 offen sc1 lds
s_add_u32 m0, s41, 1024
s_add_u32 s42, s43, 2167940
buffer_load_dwordx4 v15, s[8:11], s42 offen sc1 lds
s_add_u32 m0, s41, 5184
s_add_u32 s42, s43, 2163716
buffer_load_dwordx4 v15, s[8:11], s42 offen sc1 lds
s_add_u32 m0, s41, 9344
s_add_u32 s42, s43, 2167936
buffer_load_dwordx4 v15, s[8:11], s42 offen sc1 lds
s_add_u32 m0, s41, 13504
s_add_u32 s42, s43, 2163712
buffer_load_dwordx4 v15, s[8:11], s42 offen sc1 lds
s_add_u32 m0, s41, 0
s_add_u32 s42, s43, 2166916
buffer_load_dwordx4 v15, s[8:11], s42 offen sc1 lds
s_add_u32 m0, s41, 4160
s_add_u32 s42, s43, 2162692
buffer_load_dwordx4 v15, s[8:11], s42 offen sc1 lds
s_add_u32 m0, s41, 8320
s_add_u32 s42, s43, 2166912
buffer_load_dwordx4 v15, s[8:11], s42 offen sc1 lds
s_add_u32 m0, s41, 12480
s_add_u32 s42, s43, 2162688
buffer_load_dwordx4 v15, s[8:11], s42 offen sc1 lds
s_nop 7
v_cvt_pk_bf16_f32 v46, v208, v209
v_cvt_pk_bf16_f32 v47, v210, v211
s_add_u32 s50, s45, 0
buffer_store_dwordx2 v[46:47], v39, s[16:19], s50 offen offset:2048 sc1
v_cvt_pk_bf16_f32 v48, v212, v213
v_cvt_pk_bf16_f32 v49, v214, v215
s_add_u32 s50, s45, 0
buffer_store_dwordx2 v[48:49], v39, s[16:19], s50 offen offset:2560 sc1
v_cvt_pk_bf16_f32 v46, v216, v217
v_cvt_pk_bf16_f32 v47, v218, v219
s_add_u32 s50, s45, 0
buffer_store_dwordx2 v[46:47], v39, s[16:19], s50 offen offset:3072 sc1
v_cvt_pk_bf16_f32 v48, v220, v221
v_cvt_pk_bf16_f32 v49, v222, v223
s_add_u32 s50, s45, 0
buffer_store_dwordx2 v[48:49], v39, s[16:19], s50 offen offset:3584 sc1
s_waitcnt lgkmcnt(15)
v_mfma_f32_16x16x32_bf16 v[196:199], v[224:227], a[32:35], 0
ds_read_b64 v[252:253], v36 offset:3584
v_mfma_f32_16x16x32_bf16 v[200:203], v[224:227], a[64:67], 0
ds_read_b64 v[254:255], v36 offset:3592
v_mfma_f32_16x16x32_bf16 v[204:207], v[224:227], a[96:99], 0
v_mfma_f32_16x16x32_bf16 v[208:211], v[224:227], a[128:131], 0
v_mfma_f32_16x16x32_bf16 v[212:215], v[224:227], a[160:163], 0
v_mfma_f32_16x16x32_bf16 v[216:219], v[224:227], a[192:195], 0
v_mfma_f32_16x16x32_bf16 v[192:195], v[224:227], a[0:3], 0
v_mfma_f32_16x16x32_bf16 v[220:223], v[224:227], a[224:227], 0
v_mfma_f32_16x16x32_bf16 v[192:195], v[228:231], a[4:7], v[192:195]
ds_read_b64 v[224:225], v36 offset:3520
v_mfma_f32_16x16x32_bf16 v[196:199], v[228:231], a[36:39], v[196:199]
ds_read_b64 v[226:227], v36 offset:3528
v_mfma_f32_16x16x32_bf16 v[200:203], v[228:231], a[68:71], v[200:203]
s_mul_i32 s51, s98, 4160
s_add_u32 m0, s51, 103424
s_add_u32 s42, s47, 0
v_mfma_f32_16x16x32_bf16 v[204:207], v[228:231], a[100:103], v[204:207]
buffer_load_dwordx4 v15, s[8:11], s42 offen sc1 lds
v_mfma_f32_16x16x32_bf16 v[208:211], v[228:231], a[132:135], v[208:211]
s_mul_i32 s51, s98, 4160
s_add_u32 m0, s51, 104448
s_add_u32 s42, s47, 1024
v_mfma_f32_16x16x32_bf16 v[212:215], v[228:231], a[164:167], v[212:215]
buffer_load_dwordx4 v15, s[8:11], s42 offen sc1 lds
v_mfma_f32_16x16x32_bf16 v[216:219], v[228:231], a[196:199], v[216:219]
s_mul_i32 s51, s98, 4160
s_add_u32 m0, s51, 105472
s_add_u32 s42, s47, 2048
v_mfma_f32_16x16x32_bf16 v[220:223], v[228:231], a[228:231], v[220:223]
s_waitcnt lgkmcnt(15)
v_mfma_f32_16x16x32_bf16 v[192:195], v[232:235], a[8:11], v[192:195]
ds_read_b64 v[228:229], v36 offset:3456
v_mfma_f32_16x16x32_bf16 v[196:199], v[232:235], a[40:43], v[196:199]
ds_read_b64 v[230:231], v36 offset:3464
v_mfma_f32_16x16x32_bf16 v[200:203], v[232:235], a[72:75], v[200:203]
buffer_load_dwordx4 v15, s[8:11], s42 offen sc1 lds
v_mfma_f32_16x16x32_bf16 v[204:207], v[232:235], a[104:107], v[204:207]
s_mul_i32 s51, s98, 4160
s_add_u32 m0, s51, 106496
s_add_u32 s42, s47, 3072
v_mfma_f32_16x16x32_bf16 v[208:211], v[232:235], a[136:139], v[208:211]
buffer_load_dwordx4 v15, s[8:11], s42 offen sc1 lds
v_mfma_f32_16x16x32_bf16 v[212:215], v[232:235], a[168:171], v[212:215]
v_mfma_f32_16x16x32_bf16 v[216:219], v[232:235], a[200:203], v[216:219]
v_mfma_f32_16x16x32_bf16 v[220:223], v[232:235], a[232:235], v[220:223]
s_waitcnt lgkmcnt(15)
v_mfma_f32_16x16x32_bf16 v[192:195], v[236:239], a[12:15], v[192:195]
ds_read_b64 v[232:233], v36 offset:3392
v_mfma_f32_16x16x32_bf16 v[196:199], v[236:239], a[44:47], v[196:199]
ds_read_b64 v[234:235], v36 offset:3400
v_mfma_f32_16x16x32_bf16 v[200:203], v[236:239], a[76:79], v[200:203]
v_mfma_f32_16x16x32_bf16 v[204:207], v[236:239], a[108:111], v[204:207]
v_mfma_f32_16x16x32_bf16 v[208:211], v[236:239], a[140:143], v[208:211]
v_mfma_f32_16x16x32_bf16 v[212:215], v[236:239], a[172:175], v[212:215]
v_mfma_f32_16x16x32_bf16 v[216:219], v[236:239], a[204:207], v[216:219]
v_mfma_f32_16x16x32_bf16 v[220:223], v[236:239], a[236:239], v[220:223]
s_waitcnt lgkmcnt(15)
v_mfma_f32_16x16x32_bf16 v[192:195], v[240:243], a[16:19], v[192:195]
ds_read_b64 v[236:237], v36 offset:3328
v_mfma_f32_16x16x32_bf16 v[196:199], v[240:243], a[48:51], v[196:199]
ds_read_b64 v[238:239], v36 offset:3336
v_mfma_f32_16x16x32_bf16 v[200:203], v[240:243], a[80:83], v[200:203]
v_mfma_f32_16x16x32_bf16 v[204:207], v[240:243], a[112:115], v[204:207]
v_mfma_f32_16x16x32_bf16 v[208:211], v[240:243], a[144:147], v[208:211]
v_mfma_f32_16x16x32_bf16 v[212:215], v[240:243], a[176:179], v[212:215]
v_mfma_f32_16x16x32_bf16 v[216:219], v[240:243], a[208:211], v[216:219]
v_mfma_f32_16x16x32_bf16 v[220:223], v[240:243], a[240:243], v[220:223]
s_waitcnt lgkmcnt(14)
v_mfma_f32_16x16x32_bf16 v[192:195], v[244:247], a[20:23], v[192:195]
ds_read_b64 v[240:241], v36 offset:3264
v_mfma_f32_16x16x32_bf16 v[196:199], v[244:247], a[52:55], v[196:199]
ds_read_b64 v[242:243], v36 offset:3272
v_mfma_f32_16x16x32_bf16 v[200:203], v[244:247], a[84:87], v[200:203]
v_mfma_f32_16x16x32_bf16 v[204:207], v[244:247], a[116:119], v[204:207]
v_mfma_f32_16x16x32_bf16 v[208:211], v[244:247], a[148:151], v[208:211]
v_mfma_f32_16x16x32_bf16 v[212:215], v[244:247], a[180:183], v[212:215]
v_mfma_f32_16x16x32_bf16 v[216:219], v[244:247], a[212:215], v[216:219]
v_mfma_f32_16x16x32_bf16 v[220:223], v[244:247], a[244:247], v[220:223]
s_waitcnt lgkmcnt(13)
v_mfma_f32_16x16x32_bf16 v[192:195], v[248:251], a[24:27], v[192:195]
ds_read_b64 v[244:245], v36 offset:3200
v_mfma_f32_16x16x32_bf16 v[196:199], v[248:251], a[56:59], v[196:199]
ds_read_b64 v[246:247], v36 offset:3208
v_mfma_f32_16x16x32_bf16 v[200:203], v[248:251], a[88:91], v[200:203]
v_mfma_f32_16x16x32_bf16 v[204:207], v[248:251], a[120:123], v[204:207]
v_mfma_f32_16x16x32_bf16 v[208:211], v[248:251], a[152:155], v[208:211]
v_mfma_f32_16x16x32_bf16 v[212:215], v[248:251], a[184:187], v[212:215]
v_mfma_f32_16x16x32_bf16 v[216:219], v[248:251], a[216:219], v[216:219]
v_mfma_f32_16x16x32_bf16 v[220:223], v[248:251], a[248:251], v[220:223]
s_waitcnt lgkmcnt(12)
v_mfma_f32_16x16x32_bf16 v[192:195], v[252:255], a[28:31], v[192:195]
ds_read_b64 v[248:249], v36 offset:3136
v_mfma_f32_16x16x32_bf16 v[196:199], v[252:255], a[60:63], v[196:199]
ds_read_b64 v[250:251], v36 offset:3144
v_mfma_f32_16x16x32_bf16 v[200:203], v[252:255], a[92:95], v[200:203]
v_mfma_f32_16x16x32_bf16 v[204:207], v[252:255], a[124:127], v[204:207]
v_mfma_f32_16x16x32_bf16 v[208:211], v[252:255], a[156:159], v[208:211]
v_mfma_f32_16x16x32_bf16 v[212:215], v[252:255], a[188:191], v[212:215]
v_mfma_f32_16x16x32_bf16 v[216:219], v[252:255], a[220:223], v[216:219]
v_mfma_f32_16x16x32_bf16 v[220:223], v[252:255], a[252:255], v[220:223]
s_waitcnt lgkmcnt(12)
v_mfma_f32_16x16x32_bf16 v[196:199], v[224:227], a[0:3], v[196:199]
ds_read_b64 v[252:253], v36 offset:3072
v_mfma_f32_16x16x32_bf16 v[200:203], v[224:227], a[32:35], v[200:203]
ds_read_b64 v[254:255], v36 offset:3080
v_mfma_f32_16x16x32_bf16 v[204:207], v[224:227], a[64:67], v[204:207]
v_cvt_pk_bf16_f32 v46, v192, v193
v_mfma_f32_16x16x32_bf16 v[208:211], v[224:227], a[96:99], v[208:211]
v_cvt_pk_bf16_f32 v47, v194, v195
v_mfma_f32_16x16x32_bf16 v[212:215], v[224:227], a[128:131], v[212:215]
s_add_u32 s50, s45, 1048576
buffer_store_dwordx2 v[46:47], v39, s[16:19], s50 offen offset:0 sc1
v_mfma_f32_16x16x32_bf16 v[216:219], v[224:227], a[160:163], v[216:219]
v_mfma_f32_16x16x32_bf16 v[220:223], v[224:227], a[192:195], v[220:223]
s_waitcnt lgkmcnt(12)
v_mfma_f32_16x16x32_bf16 v[196:199], v[228:231], a[4:7], v[196:199]
s_waitcnt vmcnt(17)
ds_read_b64 v[224:225], v36 offset:3008
v_mfma_f32_16x16x32_bf16 v[200:203], v[228:231], a[36:39], v[200:203]
ds_read_b64 v[226:227], v36 offset:3016
v_mfma_f32_16x16x32_bf16 v[204:207], v[228:231], a[68:71], v[204:207]
v_mfma_f32_16x16x32_bf16 v[208:211], v[228:231], a[100:103], v[208:211]
v_mfma_f32_16x16x32_bf16 v[212:215], v[228:231], a[132:135], v[212:215]
v_mfma_f32_16x16x32_bf16 v[216:219], v[228:231], a[164:167], v[216:219]
v_mfma_f32_16x16x32_bf16 v[220:223], v[228:231], a[196:199], v[220:223]
s_waitcnt lgkmcnt(12)
v_mfma_f32_16x16x32_bf16 v[196:199], v[232:235], a[8:11], v[196:199]
ds_read_b64 v[228:229], v36 offset:2944
v_mfma_f32_16x16x32_bf16 v[200:203], v[232:235], a[40:43], v[200:203]
ds_read_b64 v[230:231], v36 offset:2952
v_mfma_f32_16x16x32_bf16 v[204:207], v[232:235], a[72:75], v[204:207]
v_mfma_f32_16x16x32_bf16 v[208:211], v[232:235], a[104:107], v[208:211]
v_mfma_f32_16x16x32_bf16 v[212:215], v[232:235], a[136:139], v[212:215]
v_mfma_f32_16x16x32_bf16 v[216:219], v[232:235], a[168:171], v[216:219]
v_mfma_f32_16x16x32_bf16 v[220:223], v[232:235], a[200:203], v[220:223]
s_waitcnt lgkmcnt(12)
v_mfma_f32_16x16x32_bf16 v[196:199], v[236:239], a[12:15], v[196:199]
ds_read_b64 v[232:233], v36 offset:2880
v_mfma_f32_16x16x32_bf16 v[200:203], v[236:239], a[44:47], v[200:203]
ds_read_b64 v[234:235], v36 offset:2888
v_mfma_f32_16x16x32_bf16 v[204:207], v[236:239], a[76:79], v[204:207]
v_mfma_f32_16x16x32_bf16 v[208:211], v[236:239], a[108:111], v[208:211]
v_mfma_f32_16x16x32_bf16 v[212:215], v[236:239], a[140:143], v[212:215]
v_mfma_f32_16x16x32_bf16 v[216:219], v[236:239], a[172:175], v[216:219]
v_mfma_f32_16x16x32_bf16 v[220:223], v[236:239], a[204:207], v[220:223]
s_waitcnt lgkmcnt(12)
v_mfma_f32_16x16x32_bf16 v[196:199], v[240:243], a[16:19], v[196:199]
ds_read_b64 v[236:237], v36 offset:2816
v_mfma_f32_16x16x32_bf16 v[200:203], v[240:243], a[48:51], v[200:203]
ds_read_b64 v[238:239], v36 offset:2824
v_mfma_f32_16x16x32_bf16 v[204:207], v[240:243], a[80:83], v[204:207]
v_mfma_f32_16x16x32_bf16 v[208:211], v[240:243], a[112:115], v[208:211]
v_mfma_f32_16x16x32_bf16 v[212:215], v[240:243], a[144:147], v[212:215]
v_mfma_f32_16x16x32_bf16 v[216:219], v[240:243], a[176:179], v[216:219]
v_mfma_f32_16x16x32_bf16 v[220:223], v[240:243], a[208:211], v[220:223]
s_waitcnt lgkmcnt(12)
v_mfma_f32_16x16x32_bf16 v[196:199], v[244:247], a[20:23], v[196:199]
ds_read_b64 v[240:241], v36 offset:2752
v_mfma_f32_16x16x32_bf16 v[200:203], v[244:247], a[52:55], v[200:203]
ds_read_b64 v[242:243], v36 offset:2760
v_mfma_f32_16x16x32_bf16 v[204:207], v[244:247], a[84:87], v[204:207]
v_mfma_f32_16x16x32_bf16 v[208:211], v[244:247], a[116:119], v[208:211]
v_mfma_f32_16x16x32_bf16 v[212:215], v[244:247], a[148:151], v[212:215]
v_mfma_f32_16x16x32_bf16 v[216:219], v[244:247], a[180:183], v[216:219]
v_mfma_f32_16x16x32_bf16 v[220:223], v[244:247], a[212:215], v[220:223]
s_waitcnt lgkmcnt(12)
v_mfma_f32_16x16x32_bf16 v[196:199], v[248:251], a[24:27], v[196:199]
ds_read_b64 v[244:245], v36 offset:2688
v_mfma_f32_16x16x32_bf16 v[200:203], v[248:251], a[56:59], v[200:203]
ds_read_b64 v[246:247], v36 offset:2696
v_mfma_f32_16x16x32_bf16 v[204:207], v[248:251], a[88:91], v[204:207]
v_mfma_f32_16x16x32_bf16 v[208:211], v[248:251], a[120:123], v[208:211]
v_mfma_f32_16x16x32_bf16 v[212:215], v[248:251], a[152:155], v[212:215]
v_mfma_f32_16x16x32_bf16 v[216:219], v[248:251], a[184:187], v[216:219]
v_mfma_f32_16x16x32_bf16 v[220:223], v[248:251], a[216:219], v[220:223]
s_waitcnt lgkmcnt(12)
v_mfma_f32_16x16x32_bf16 v[196:199], v[252:255], a[28:31], v[196:199]
ds_read_b64 v[248:249], v36 offset:2624
v_mfma_f32_16x16x32_bf16 v[200:203], v[252:255], a[60:63], v[200:203]
ds_read_b64 v[250:251], v36 offset:2632
v_mfma_f32_16x16x32_bf16 v[204:207], v[252:255], a[92:95], v[204:207]
v_mfma_f32_16x16x32_bf16 v[208:211], v[252:255], a[124:127], v[208:211]
v_mfma_f32_16x16x32_bf16 v[212:215], v[252:255], a[156:159], v[212:215]
v_mfma_f32_16x16x32_bf16 v[216:219], v[252:255], a[188:191], v[216:219]
v_mfma_f32_16x16x32_bf16 v[220:223], v[252:255], a[220:223], v[220:223]
s_waitcnt vmcnt(1)
s_barrier
s_waitcnt lgkmcnt(12)
v_mfma_f32_16x16x32_bf16 v[200:203], v[224:227], a[0:3], v[200:203]
ds_read_b64 v[252:253], v36 offset:2560
v_mfma_f32_16x16x32_bf16 v[204:207], v[224:227], a[32:35], v[204:207]
ds_read_b64 v[254:255], v36 offset:2568
v_mfma_f32_16x16x32_bf16 v[208:211], v[224:227], a[64:67], v[208:211]
ds_read_b128 a[252:255], v38 offset:15360
v_mfma_f32_16x16x32_bf16 v[212:215], v[224:227], a[96:99], v[212:215]
v_cvt_pk_bf16_f32 v48, v196, v197
v_mfma_f32_16x16x32_bf16 v[216:219], v[224:227], a[128:131], v[216:219]
v_cvt_pk_bf16_f32 v49, v198, v199
v_mfma_f32_16x16x32_bf16 v[220:223], v[224:227], a[160:163], v[220:223]
s_waitcnt lgkmcnt(13)
v_mfma_f32_16x16x32_bf16 v[200:203], v[228:231], a[4:7], v[200:203]
ds_read_b64 v[224:225], v36 offset:2496
v_mfma_f32_16x16x32_bf16 v[204:207], v[228:231], a[36:39], v[204:207]
ds_read_b64 v[226:227], v36 offset:2504
v_mfma_f32_16x16x32_bf16 v[208:211], v[228:231], a[68:71], v[208:211]
ds_read_b128 a[248:251], v38 offset:13312
v_mfma_f32_16x16x32_bf16 v[212:215], v[228:231], a[100:103], v[212:215]
s_add_u32 s50, s45, 1048576
buffer_store_dwordx2 v[48:49], v39, s[16:19], s50 offen offset:512 sc1
v_mfma_f32_16x16x32_bf16 v[216:219], v[228:231], a[132:135], v[216:219]
v_mfma_f32_16x16x32_bf16 v[220:223], v[228:231], a[164:167], v[220:223]
s_waitcnt lgkmcnt(14)
v_mfma_f32_16x16x32_bf16 v[200:203], v[232:235], a[8:11], v[200:203]
ds_read_b64 v[228:229], v36 offset:2432
v_mfma_f32_16x16x32_bf16 v[204:207], v[232:235], a[40:43], v[204:207]
ds_read_b64 v[230:231], v36 offset:2440
v_mfma_f32_16x16x32_bf16 v[208:211], v[232:235], a[72:75], v[208:211]
ds_read_b128 a[244:247], v38 offset:11264
v_mfma_f32_16x16x32_bf16 v[212:215], v[232:235], a[104:107], v[212:215]
v_mfma_f32_16x16x32_bf16 v[216:219], v[232:235], a[136:139], v[216:219]
v_mfma_f32_16x16x32_bf16 v[220:223], v[232:235], a[168:171], v[220:223]
s_waitcnt lgkmcnt(15)
v_mfma_f32_16x16x32_bf16 v[200:203], v[236:239], a[12:15], v[200:203]
ds_read_b64 v[232:233], v36 offset:2368
v_mfma_f32_16x16x32_bf16 v[204:207], v[236:239], a[44:47], v[204:207]
ds_read_b64 v[234:235], v36 offset:2376
v_mfma_f32_16x16x32_bf16 v[208:211], v[236:239], a[76:79], v[208:211]
ds_read_b128 a[240:243], v38 offset:9216
v_mfma_f32_16x16x32_bf16 v[212:215], v[236:239], a[108:111], v[212:215]
v_mfma_f32_16x16x32_bf16 v[216:219], v[236:239], a[140:143], v[216:219]
v_mfma_f32_16x16x32_bf16 v[220:223], v[236:239], a[172:175], v[220:223]
s_waitcnt lgkmcnt(15)
v_mfma_f32_16x16x32_bf16 v[200:203], v[240:243], a[16:19], v[200:203]
ds_read_b64 v[236:237], v36 offset:2304
v_mfma_f32_16x16x32_bf16 v[204:207], v[240:243], a[48:51], v[204:207]
ds_read_b64 v[238:239], v36 offset:2312
v_mfma_f32_16x16x32_bf16 v[208:211], v[240:243], a[80:83], v[208:211]
ds_read_b128 a[236:239], v38 offset:7168
v_mfma_f32_16x16x32_bf16 v[212:215], v[240:243], a[112:115], v[212:215]
v_mfma_f32_16x16x32_bf16 v[216:219], v[240:243], a[144:147], v[216:219]
v_mfma_f32_16x16x32_bf16 v[220:223], v[240:243], a[176:179], v[220:223]
s_waitcnt lgkmcnt(15)
v_mfma_f32_16x16x32_bf16 v[200:203], v[244:247], a[20:23], v[200:203]
ds_read_b64 v[240:241], v36 offset:2240
v_mfma_f32_16x16x32_bf16 v[204:207], v[244:247], a[52:55], v[204:207]
ds_read_b64 v[242:243], v36 offset:2248
v_mfma_f32_16x16x32_bf16 v[208:211], v[244:247], a[84:87], v[208:211]
ds_read_b128 a[232:235], v38 offset:5120
v_mfma_f32_16x16x32_bf16 v[212:215], v[244:247], a[116:119], v[212:215]
v_mfma_f32_16x16x32_bf16 v[216:219], v[244:247], a[148:151], v[216:219]
v_mfma_f32_16x16x32_bf16 v[220:223], v[244:247], a[180:183], v[220:223]
v_mfma_f32_16x16x32_bf16 v[200:203], v[248:251], a[24:27], v[200:203]
ds_read_b64 v[244:245], v36 offset:2176
v_mfma_f32_16x16x32_bf16 v[204:207], v[248:251], a[56:59], v[204:207]
ds_read_b64 v[246:247], v36 offset:2184
v_mfma_f32_16x16x32_bf16 v[208:211], v[248:251], a[88:91], v[208:211]
ds_read_b128 a[228:231], v38 offset:3072
v_mfma_f32_16x16x32_bf16 v[212:215], v[248:251], a[120:123], v[212:215]
v_mfma_f32_16x16x32_bf16 v[216:219], v[248:251], a[152:155], v[216:219]
v_mfma_f32_16x16x32_bf16 v[220:223], v[248:251], a[184:187], v[220:223]
s_waitcnt lgkmcnt(15)
v_mfma_f32_16x16x32_bf16 v[200:203], v[252:255], a[28:31], v[200:203]
ds_read_b64 v[248:249], v36 offset:2112
v_mfma_f32_16x16x32_bf16 v[204:207], v[252:255], a[60:63], v[204:207]
ds_read_b64 v[250:251], v36 offset:2120
v_mfma_f32_16x16x32_bf16 v[208:211], v[252:255], a[92:95], v[208:211]
ds_read_b128 a[224:227], v38 offset:1024
v_mfma_f32_16x16x32_bf16 v[212:215], v[252:255], a[124:127], v[212:215]
v_mfma_f32_16x16x32_bf16 v[216:219], v[252:255], a[156:159], v[216:219]
v_mfma_f32_16x16x32_bf16 v[220:223], v[252:255], a[188:191], v[220:223]
v_mfma_f32_16x16x32_bf16 v[204:207], v[224:227], a[0:3], v[204:207]
ds_read_b64 v[252:253], v36 offset:2048
v_mfma_f32_16x16x32_bf16 v[208:211], v[224:227], a[32:35], v[208:211]
ds_read_b64 v[254:255], v36 offset:2056
v_mfma_f32_16x16x32_bf16 v[212:215], v[224:227], a[64:67], v[212:215]
ds_read_b128 a[220:223], v38 offset:14336
v_mfma_f32_16x16x32_bf16 v[216:219], v[224:227], a[96:99], v[216:219]
v_cvt_pk_bf16_f32 v46, v200, v201
v_mfma_f32_16x16x32_bf16 v[220:223], v[224:227], a[128:131], v[220:223]
s_waitcnt lgkmcnt(15)
v_mfma_f32_16x16x32_bf16 v[204:207], v[228:231], a[4:7], v[204:207]
ds_read_b64 v[224:225], v36 offset:1984
v_mfma_f32_16x16x32_bf16 v[208:211], v[228:231], a[36:39], v[208:211]
ds_read_b64 v[226:227], v36 offset:1992
v_mfma_f32_16x16x32_bf16 v[212:215], v[228:231], a[68:71], v[212:215]
ds_read_b128 a[216:219], v38 offset:12288
v_mfma_f32_16x16x32_bf16 v[216:219], v[228:231], a[100:103], v[216:219]
v_cvt_pk_bf16_f32 v47, v202, v203
v_mfma_f32_16x16x32_bf16 v[220:223], v[228:231], a[132:135], v[220:223]
v_mfma_f32_16x16x32_bf16 v[204:207], v[232:235], a[8:11], v[204:207]
ds_read_b64 v[228:229], v36 offset:1920
v_mfma_f32_16x16x32_bf16 v[208:211], v[232:235], a[40:43], v[208:211]
ds_read_b64 v[230:231], v36 offset:1928
v_mfma_f32_16x16x32_bf16 v[212:215], v[232:235], a[72:75], v[212:215]
ds_read_b128 a[212:215], v38 offset:10240
v_mfma_f32_16x16x32_bf16 v[216:219], v[232:235], a[104:107], v[216:219]
s_add_u32 s50, s45, 1048576
buffer_store_dwordx2 v[46:47], v39, s[16:19], s50 offen offset:1024 sc1
v_mfma_f32_16x16x32_bf16 v[220:223], v[232:235], a[136:139], v[220:223]
s_waitcnt lgkmcnt(15)
v_mfma_f32_16x16x32_bf16 v[204:207], v[236:239], a[12:15], v[204:207]
ds_read_b64 v[232:233], v36 offset:1856
v_mfma_f32_16x16x32_bf16 v[208:211], v[236:239], a[44:47], v[208:211]
ds_read_b64 v[234:235], v36 offset:1864
v_mfma_f32_16x16x32_bf16 v[212:215], v[236:239], a[76:79], v[212:215]
ds_read_b128 a[208:211], v38 offset:8192
v_mfma_f32_16x16x32_bf16 v[216:219], v[236:239], a[108:111], v[216:219]
v_mfma_f32_16x16x32_bf16 v[220:223], v[236:239], a[140:143], v[220:223]
v_mfma_f32_16x16x32_bf16 v[204:207], v[240:243], a[16:19], v[204:207]
ds_read_b64 v[236:237], v36 offset:1792
v_mfma_f32_16x16x32_bf16 v[208:211], v[240:243], a[48:51], v[208:211]
ds_read_b64 v[238:239], v36 offset:1800
v_mfma_f32_16x16x32_bf16 v[212:215], v[240:243], a[80:83], v[212:215]
ds_read_b128 a[204:207], v38 offset:6144
v_mfma_f32_16x16x32_bf16 v[216:219], v[240:243], a[112:115], v[216:219]
v_mfma_f32_16x16x32_bf16 v[220:223], v[240:243], a[144:147], v[220:223]
s_waitcnt lgkmcnt(15)
v_mfma_f32_16x16x32_bf16 v[204:207], v[244:247], a[20:23], v[204:207]
ds_read_b64 v[240:241], v36 offset:1728
v_mfma_f32_16x16x32_bf16 v[208:211], v[244:247], a[52:55], v[208:211]
ds_read_b64 v[242:243], v36 offset:1736
v_mfma_f32_16x16x32_bf16 v[212:215], v[244:247], a[84:87], v[212:215]
ds_read_b128 a[200:203], v38 offset:4096
v_mfma_f32_16x16x32_bf16 v[216:219], v[244:247], a[116:119], v[216:219]
v_mfma_f32_16x16x32_bf16 v[220:223], v[244:247], a[148:151], v[220:223]
v_mfma_f32_16x16x32_bf16 v[204:207], v[248:251], a[24:27], v[204:207]
ds_read_b64 v[244:245], v36 offset:1664
v_mfma_f32_16x16x32_bf16 v[208:211], v[248:251], a[56:59], v[208:211]
ds_read_b64 v[246:247], v36 offset:1672
v_mfma_f32_16x16x32_bf16 v[212:215], v[248:251], a[88:91], v[212:215]
ds_read_b128 a[196:199], v38 offset:2048
v_mfma_f32_16x16x32_bf16 v[216:219], v[248:251], a[120:123], v[216:219]
v_mfma_f32_16x16x32_bf16 v[220:223], v[248:251], a[152:155], v[220:223]
s_waitcnt lgkmcnt(15)
v_mfma_f32_16x16x32_bf16 v[204:207], v[252:255], a[28:31], v[204:207]
ds_read_b64 v[248:249], v36 offset:1600
v_mfma_f32_16x16x32_bf16 v[208:211], v[252:255], a[60:63], v[208:211]
ds_read_b64 v[250:251], v36 offset:1608
v_mfma_f32_16x16x32_bf16 v[212:215], v[252:255], a[92:95], v[212:215]
ds_read_b128 a[192:195], v38 offset:0
v_mfma_f32_16x16x32_bf16 v[216:219], v[252:255], a[124:127], v[216:219]
v_mfma_f32_16x16x32_bf16 v[220:223], v[252:255], a[156:159], v[220:223]
v_mfma_f32_16x16x32_bf16 v[208:211], v[224:227], a[0:3], v[208:211]
ds_read_b64 v[252:253], v36 offset:1536
v_mfma_f32_16x16x32_bf16 v[212:215], v[224:227], a[32:35], v[212:215]
ds_read_b64 v[254:255], v36 offset:1544
v_mfma_f32_16x16x32_bf16 v[216:219], v[224:227], a[64:67], v[216:219]
v_cvt_pk_bf16_f32 v48, v204, v205
v_mfma_f32_16x16x32_bf16 v[220:223], v[224:227], a[96:99], v[220:223]
s_waitcnt lgkmcnt(15)
v_mfma_f32_16x16x32_bf16 v[208:211], v[228:231], a[4:7], v[208:211]
ds_read_b64 v[224:225], v36 offset:1472
v_mfma_f32_16x16x32_bf16 v[212:215], v[228:231], a[36:39], v[212:215]
ds_read_b64 v[226:227], v36 offset:1480
v_mfma_f32_16x16x32_bf16 v[216:219], v[228:231], a[68:71], v[216:219]
v_cvt_pk_bf16_f32 v49, v206, v207
v_mfma_f32_16x16x32_bf16 v[220:223], v[228:231], a[100:103], v[220:223]
v_mfma_f32_16x16x32_bf16 v[208:211], v[232:235], a[8:11], v[208:211]
ds_read_b64 v[228:229], v36 offset:1408
v_mfma_f32_16x16x32_bf16 v[212:215], v[232:235], a[40:43], v[212:215]
ds_read_b64 v[230:231], v36 offset:1416
v_mfma_f32_16x16x32_bf16 v[216:219], v[232:235], a[72:75], v[216:219]
s_add_u32 s50, s45, 1048576
buffer_store_dwordx2 v[48:49], v39, s[16:19], s50 offen offset:1536 sc1
v_mfma_f32_16x16x32_bf16 v[220:223], v[232:235], a[104:107], v[220:223]
s_waitcnt lgkmcnt(15)
v_mfma_f32_16x16x32_bf16 v[208:211], v[236:239], a[12:15], v[208:211]
ds_read_b64 v[232:233], v36 offset:1344
v_mfma_f32_16x16x32_bf16 v[212:215], v[236:239], a[44:47], v[212:215]
ds_read_b64 v[234:235], v36 offset:1352
v_mfma_f32_16x16x32_bf16 v[216:219], v[236:239], a[76:79], v[216:219]
v_mfma_f32_16x16x32_bf16 v[220:223], v[236:239], a[108:111], v[220:223]
s_waitcnt lgkmcnt(15)
v_mfma_f32_16x16x32_bf16 v[208:211], v[240:243], a[16:19], v[208:211]
ds_read_b64 v[236:237], v36 offset:1280
v_mfma_f32_16x16x32_bf16 v[212:215], v[240:243], a[48:51], v[212:215]
ds_read_b64 v[238:239], v36 offset:1288
v_mfma_f32_16x16x32_bf16 v[216:219], v[240:243], a[80:83], v[216:219]
v_mfma_f32_16x16x32_bf16 v[220:223], v[240:243], a[112:115], v[220:223]
s_waitcnt lgkmcnt(14)
v_mfma_f32_16x16x32_bf16 v[208:211], v[244:247], a[20:23], v[208:211]
ds_read_b64 v[240:241], v36 offset:1216
v_mfma_f32_16x16x32_bf16 v[212:215], v[244:247], a[52:55], v[212:215]
ds_read_b64 v[242:243], v36 offset:1224
v_mfma_f32_16x16x32_bf16 v[216:219], v[244:247], a[84:87], v[216:219]
v_mfma_f32_16x16x32_bf16 v[220:223], v[244:247], a[116:119], v[220:223]
s_waitcnt lgkmcnt(13)
v_mfma_f32_16x16x32_bf16 v[208:211], v[248:251], a[24:27], v[208:211]
ds_read_b64 v[244:245], v36 offset:1152
v_mfma_f32_16x16x32_bf16 v[212:215], v[248:251], a[56:59], v[212:215]
ds_read_b64 v[246:247], v36 offset:1160
v_mfma_f32_16x16x32_bf16 v[216:219], v[248:251], a[88:91], v[216:219]
v_mfma_f32_16x16x32_bf16 v[220:223], v[248:251], a[120:123], v[220:223]
s_waitcnt lgkmcnt(12)
v_mfma_f32_16x16x32_bf16 v[208:211], v[252:255], a[28:31], v[208:211]
ds_read_b64 v[248:249], v36 offset:1088
v_mfma_f32_16x16x32_bf16 v[212:215], v[252:255], a[60:63], v[212:215]
ds_read_b64 v[250:251], v36 offset:1096
v_mfma_f32_16x16x32_bf16 v[216:219], v[252:255], a[92:95], v[216:219]
v_mfma_f32_16x16x32_bf16 v[220:223], v[252:255], a[124:127], v[220:223]
s_waitcnt lgkmcnt(12)
v_mfma_f32_16x16x32_bf16 v[212:215], v[224:227], a[0:3], v[212:215]
ds_read_b64 v[252:253], v36 offset:1024
v_mfma_f32_16x16x32_bf16 v[216:219], v[224:227], a[32:35], v[216:219]
ds_read_b64 v[254:255], v36 offset:1032
v_mfma_f32_16x16x32_bf16 v[220:223], v[224:227], a[64:67], v[220:223]
s_waitcnt lgkmcnt(12)
v_mfma_f32_16x16x32_bf16 v[212:215], v[228:231], a[4:7], v[212:215]
ds_read_b64 v[224:225], v36 offset:960
v_mfma_f32_16x16x32_bf16 v[216:219], v[228:231], a[36:39], v[216:219]
ds_read_b64 v[226:227], v36 offset:968
v_mfma_f32_16x16x32_bf16 v[220:223], v[228:231], a[68:71], v[220:223]
s_waitcnt lgkmcnt(12)
v_mfma_f32_16x16x32_bf16 v[212:215], v[232:235], a[8:11], v[212:215]
ds_read_b64 v[228:229], v36 offset:896
v_mfma_f32_16x16x32_bf16 v[216:219], v[232:235], a[40:43], v[216:219]
ds_read_b64 v[230:231], v36 offset:904
v_mfma_f32_16x16x32_bf16 v[220:223], v[232:235], a[72:75], v[220:223]
s_waitcnt lgkmcnt(12)
v_mfma_f32_16x16x32_bf16 v[212:215], v[236:239], a[12:15], v[212:215]
ds_read_b64 v[232:233], v36 offset:832
v_mfma_f32_16x16x32_bf16 v[216:219], v[236:239], a[44:47], v[216:219]
ds_read_b64 v[234:235], v36 offset:840
v_mfma_f32_16x16x32_bf16 v[220:223], v[236:239], a[76:79], v[220:223]
s_waitcnt lgkmcnt(12)
v_mfma_f32_16x16x32_bf16 v[212:215], v[240:243], a[16:19], v[212:215]
ds_read_b64 v[236:237], v36 offset:768
v_mfma_f32_16x16x32_bf16 v[216:219], v[240:243], a[48:51], v[216:219]
ds_read_b64 v[238:239], v36 offset:776
v_mfma_f32_16x16x32_bf16 v[220:223], v[240:243], a[80:83], v[220:223]
s_waitcnt lgkmcnt(12)
v_mfma_f32_16x16x32_bf16 v[212:215], v[244:247], a[20:23], v[212:215]
ds_read_b64 v[240:241], v36 offset:704
v_mfma_f32_16x16x32_bf16 v[216:219], v[244:247], a[52:55], v[216:219]
ds_read_b64 v[242:243], v36 offset:712
v_mfma_f32_16x16x32_bf16 v[220:223], v[244:247], a[84:87], v[220:223]
s_waitcnt lgkmcnt(12)
v_mfma_f32_16x16x32_bf16 v[212:215], v[248:251], a[24:27], v[212:215]
ds_read_b64 v[244:245], v36 offset:640
v_mfma_f32_16x16x32_bf16 v[216:219], v[248:251], a[56:59], v[216:219]
ds_read_b64 v[246:247], v36 offset:648
v_mfma_f32_16x16x32_bf16 v[220:223], v[248:251], a[88:91], v[220:223]
s_waitcnt lgkmcnt(12)
v_mfma_f32_16x16x32_bf16 v[212:215], v[252:255], a[28:31], v[212:215]
ds_read_b64 v[248:249], v36 offset:576
v_mfma_f32_16x16x32_bf16 v[216:219], v[252:255], a[60:63], v[216:219]
ds_read_b64 v[250:251], v36 offset:584
v_mfma_f32_16x16x32_bf16 v[220:223], v[252:255], a[92:95], v[220:223]
s_waitcnt lgkmcnt(12)
v_mfma_f32_16x16x32_bf16 v[216:219], v[224:227], a[0:3], v[216:219]
ds_read_b64 v[252:253], v36 offset:512
v_mfma_f32_16x16x32_bf16 v[220:223], v[224:227], a[32:35], v[220:223]
ds_read_b64 v[254:255], v36 offset:520
s_waitcnt lgkmcnt(12)
v_mfma_f32_16x16x32_bf16 v[216:219], v[228:231], a[4:7], v[216:219]
ds_read_b64 v[224:225], v36 offset:448
v_mfma_f32_16x16x32_bf16 v[220:223], v[228:231], a[36:39], v[220:223]
ds_read_b64 v[226:227], v36 offset:456
s_waitcnt lgkmcnt(12)
v_mfma_f32_16x16x32_bf16 v[216:219], v[232:235], a[8:11], v[216:219]
ds_read_b64 v[228:229], v36 offset:384
v_mfma_f32_16x16x32_bf16 v[220:223], v[232:235], a[40:43], v[220:223]
ds_read_b64 v[230:231], v36 offset:392
s_waitcnt lgkmcnt(12)
v_mfma_f32_16x16x32_bf16 v[216:219], v[236:239], a[12:15], v[216:219]
ds_read_b64 v[232:233], v36 offset:320
v_mfma_f32_16x16x32_bf16 v[220:223], v[236:239], a[44:47], v[220:223]
ds_read_b64 v[234:235], v36 offset:328
s_waitcnt lgkmcnt(12)
v_mfma_f32_16x16x32_bf16 v[216:219], v[240:243], a[16:19], v[216:219]
ds_read_b64 v[236:237], v36 offset:256
v_mfma_f32_16x16x32_bf16 v[220:223], v[240:243], a[48:51], v[220:223]
ds_read_b64 v[238:239], v36 offset:264
s_waitcnt lgkmcnt(12)
v_mfma_f32_16x16x32_bf16 v[216:219], v[244:247], a[20:23], v[216:219]
ds_read_b64 v[240:241], v36 offset:192
v_mfma_f32_16x16x32_bf16 v[220:223], v[244:247], a[52:55], v[220:223]
ds_read_b64 v[242:243], v36 offset:200
s_waitcnt lgkmcnt(12)
v_mfma_f32_16x16x32_bf16 v[216:219], v[248:251], a[24:27], v[216:219]
ds_read_b64 v[244:245], v36 offset:128
v_mfma_f32_16x16x32_bf16 v[220:223], v[248:251], a[56:59], v[220:223]
ds_read_b64 v[246:247], v36 offset:136
s_waitcnt lgkmcnt(12)
v_mfma_f32_16x16x32_bf16 v[216:219], v[252:255], a[28:31], v[216:219]
ds_read_b64 v[248:249], v36 offset:64
v_mfma_f32_16x16x32_bf16 v[220:223], v[252:255], a[60:63], v[220:223]
ds_read_b64 v[250:251], v36 offset:72
s_waitcnt lgkmcnt(12)
v_mfma_f32_16x16x32_bf16 v[220:223], v[224:227], a[0:3], v[220:223]
ds_read_b64 v[252:253], v36 offset:0
ds_read_b64 v[254:255], v36 offset:8
s_waitcnt lgkmcnt(12)
v_mfma_f32_16x16x32_bf16 v[220:223], v[228:231], a[4:7], v[220:223]
s_waitcnt lgkmcnt(10)
v_mfma_f32_16x16x32_bf16 v[220:223], v[232:235], a[8:11], v[220:223]
s_waitcnt lgkmcnt(8)
v_mfma_f32_16x16x32_bf16 v[220:223], v[236:239], a[12:15], v[220:223]
s_waitcnt lgkmcnt(6)
v_mfma_f32_16x16x32_bf16 v[220:223], v[240:243], a[16:19], v[220:223]
s_waitcnt lgkmcnt(4)
v_mfma_f32_16x16x32_bf16 v[220:223], v[244:247], a[20:23], v[220:223]
s_waitcnt lgkmcnt(2)
v_mfma_f32_16x16x32_bf16 v[220:223], v[248:251], a[24:27], v[220:223]
s_waitcnt lgkmcnt(0)
v_mfma_f32_16x16x32_bf16 v[220:223], v[252:255], a[28:31], v[220:223]
s_nop 7
v_cvt_pk_bf16_f32 v46, v208, v209
v_cvt_pk_bf16_f32 v47, v210, v211
s_add_u32 s50, s45, 1048576
buffer_store_dwordx2 v[46:47], v39, s[16:19], s50 offen offset:2048 sc1
v_cvt_pk_bf16_f32 v48, v212, v213
v_cvt_pk_bf16_f32 v49, v214, v215
s_add_u32 s50, s45, 1048576
buffer_store_dwordx2 v[48:49], v39, s[16:19], s50 offen offset:2560 sc1
v_cvt_pk_bf16_f32 v46, v216, v217
v_cvt_pk_bf16_f32 v47, v218, v219
s_add_u32 s50, s45, 1048576
buffer_store_dwordx2 v[46:47], v39, s[16:19], s50 offen offset:3072 sc1
v_cvt_pk_bf16_f32 v48, v220, v221
v_cvt_pk_bf16_f32 v49, v222, v223
s_add_u32 s50, s45, 1048576
buffer_store_dwordx2 v[48:49], v39, s[16:19], s50 offen offset:3584 sc1
ds_read_b64 v[224:225], v37 offset:4032
ds_read_b64 v[226:227], v37 offset:4040
ds_read_b64 v[228:229], v37 offset:3776
ds_read_b64 v[230:231], v37 offset:3784
ds_read_b64 v[232:233], v37 offset:3520
ds_read_b64 v[234:235], v37 offset:3528
ds_read_b64 v[236:237], v37 offset:3264
ds_read_b64 v[238:239], v37 offset:3272
ds_read_b64 v[240:241], v37 offset:3008
ds_read_b64 v[242:243], v37 offset:3016
s_waitcnt lgkmcnt(8)
v_mfma_f32_16x16x32_bf16 v[192:195], v[224:227], a[224:227], 0
ds_read_b64 v[244:245], v37 offset:2752
ds_read_b64 v[246:247], v37 offset:2760
v_mfma_f32_16x16x32_bf16 v[196:199], v[224:227], a[228:231], 0
v_mfma_f32_16x16x32_bf16 v[200:203], v[224:227], a[232:235], 0
v_mfma_f32_16x16x32_bf16 v[204:207], v[224:227], a[236:239], 0
v_mfma_f32_16x16x32_bf16 v[208:211], v[224:227], a[240:243], 0
v_mfma_f32_16x16x32_bf16 v[212:215], v[224:227], a[244:247], 0
v_mfma_f32_16x16x32_bf16 v[216:219], v[224:227], a[248:251], 0
v_mfma_f32_16x16x32_bf16 v[220:223], v[224:227], a[252:255], 0
s_waitcnt lgkmcnt(8)
v_mfma_f32_16x16x32_bf16 v[192:195], v[228:231], a[192:195], v[192:195]
ds_read_b64 v[248:249], v37 offset:2496
ds_read_b64 v[250:251], v37 offset:2504
v_mfma_f32_16x16x32_bf16 v[196:199], v[228:231], a[196:199], v[196:199]
v_mfma_f32_16x16x32_bf16 v[200:203], v[228:231], a[200:203], v[200:203]
v_mfma_f32_16x16x32_bf16 v[204:207], v[228:231], a[204:207], v[204:207]
v_mfma_f32_16x16x32_bf16 v[208:211], v[228:231], a[208:211], v[208:211]
v_mfma_f32_16x16x32_bf16 v[212:215], v[228:231], a[212:215], v[212:215]
v_mfma_f32_16x16x32_bf16 v[216:219], v[228:231], a[216:219], v[216:219]
v_mfma_f32_16x16x32_bf16 v[220:223], v[228:231], a[220:223], v[220:223]
s_waitcnt lgkmcnt(8)
v_mfma_f32_16x16x32_bf16 v[196:199], v[232:235], a[224:227], v[196:199]
ds_read_b64 v[252:253], v37 offset:2240
ds_read_b64 v[254:255], v37 offset:2248
v_mfma_f32_16x16x32_bf16 v[200:203], v[232:235], a[228:231], v[200:203]
v_mfma_f32_16x16x32_bf16 v[204:207], v[232:235], a[232:235], v[204:207]
v_mfma_f32_16x16x32_bf16 v[208:211], v[232:235], a[236:239], v[208:211]
v_mfma_f32_16x16x32_bf16 v[212:215], v[232:235], a[240:243], v[212:215]
v_mfma_f32_16x16x32_bf16 v[216:219], v[232:235], a[244:247], v[216:219]
v_mfma_f32_16x16x32_bf16 v[220:223], v[232:235], a[248:251], v[220:223]
s_waitcnt lgkmcnt(8)
v_mfma_f32_16x16x32_bf16 v[196:199], v[236:239], a[192:195], v[196:199]
ds_read_b64 v[224:225], v37 offset:1984
ds_read_b64 v[226:227], v37 offset:1992
v_mfma_f32_16x16x32_bf16 v[200:203], v[236:239], a[196:199], v[200:203]
v_mfma_f32_16x16x32_bf16 v[204:207], v[236:239], a[200:203], v[204:207]
v_mfma_f32_16x16x32_bf16 v[208:211], v[236:239], a[204:207], v[208:211]
v_mfma_f32_16x16x32_bf16 v[212:215], v[236:239], a[208:211], v[212:215]
v_mfma_f32_16x16x32_bf16 v[216:219], v[236:239], a[212:215], v[216:219]
v_mfma_f32_16x16x32_bf16 v[220:223], v[236:239], a[216:219], v[220:223]
s_waitcnt lgkmcnt(8)
v_mfma_f32_16x16x32_bf16 v[200:203], v[240:243], a[224:227], v[200:203]
ds_read_b64 v[228:229], v37 offset:1728
ds_read_b64 v[230:231], v37 offset:1736
v_mfma_f32_16x16x32_bf16 v[204:207], v[240:243], a[228:231], v[204:207]
v_mfma_f32_16x16x32_bf16 v[208:211], v[240:243], a[232:235], v[208:211]
v_mfma_f32_16x16x32_bf16 v[212:215], v[240:243], a[236:239], v[212:215]
v_mfma_f32_16x16x32_bf16 v[216:219], v[240:243], a[240:243], v[216:219]
v_mfma_f32_16x16x32_bf16 v[220:223], v[240:243], a[244:247], v[220:223]
s_waitcnt lgkmcnt(8)
v_mfma_f32_16x16x32_bf16 v[200:203], v[244:247], a[192:195], v[200:203]
ds_read_b64 v[232:233], v37 offset:1472
ds_read_b64 v[234:235], v37 offset:1480
v_mfma_f32_16x16x32_bf16 v[204:207], v[244:247], a[196:199], v[204:207]
v_mfma_f32_16x16x32_bf16 v[208:211], v[244:247], a[200:203], v[208:211]
v_mfma_f32_16x16x32_bf16 v[212:215], v[244:247], a[204:207], v[212:215]
v_mfma_f32_16x16x32_bf16 v[216:219], v[244:247], a[208:211], v[216:219]
v_mfma_f32_16x16x32_bf16 v[220:223], v[244:247], a[212:215], v[220:223]
s_waitcnt lgkmcnt(8)
v_mfma_f32_16x16x32_bf16 v[204:207], v[248:251], a[224:227], v[204:207]
ds_read_b64 v[236:237], v37 offset:1216
ds_read_b64 v[238:239], v37 offset:1224
v_mfma_f32_16x16x32_bf16 v[208:211], v[248:251], a[228:231], v[208:211]
v_mfma_f32_16x16x32_bf16 v[212:215], v[248:251], a[232:235], v[212:215]
v_mfma_f32_16x16x32_bf16 v[216:219], v[248:251], a[236:239], v[216:219]
v_mfma_f32_16x16x32_bf16 v[220:223], v[248:251], a[240:243], v[220:223]
s_waitcnt lgkmcnt(8)
v_mfma_f32_16x16x32_bf16 v[204:207], v[252:255], a[192:195], v[204:207]
ds_read_b64 v[240:241], v37 offset:960
ds_read_b64 v[242:243], v37 offset:968
v_mfma_f32_16x16x32_bf16 v[208:211], v[252:255], a[196:199], v[208:211]
v_mfma_f32_16x16x32_bf16 v[212:215], v[252:255], a[200:203], v[212:215]
v_mfma_f32_16x16x32_bf16 v[216:219], v[252:255], a[204:207], v[216:219]
v_mfma_f32_16x16x32_bf16 v[220:223], v[252:255], a[208:211], v[220:223]
s_waitcnt lgkmcnt(8)
v_mfma_f32_16x16x32_bf16 v[208:211], v[224:227], a[224:227], v[208:211]
ds_read_b64 v[244:245], v37 offset:704
ds_read_b64 v[246:247], v37 offset:712
v_mfma_f32_16x16x32_bf16 v[212:215], v[224:227], a[228:231], v[212:215]
v_mfma_f32_16x16x32_bf16 v[216:219], v[224:227], a[232:235], v[216:219]
v_mfma_f32_16x16x32_bf16 v[220:223], v[224:227], a[236:239], v[220:223]
s_waitcnt lgkmcnt(8)
v_mfma_f32_16x16x32_bf16 v[208:211], v[228:231], a[192:195], v[208:211]
ds_read_b64 v[248:249], v37 offset:448
ds_read_b64 v[250:251], v37 offset:456
v_mfma_f32_16x16x32_bf16 v[212:215], v[228:231], a[196:199], v[212:215]
v_mfma_f32_16x16x32_bf16 v[216:219], v[228:231], a[200:203], v[216:219]
v_mfma_f32_16x16x32_bf16 v[220:223], v[228:231], a[204:207], v[220:223]
s_waitcnt lgkmcnt(8)
v_mfma_f32_16x16x32_bf16 v[212:215], v[232:235], a[224:227], v[212:215]
ds_read_b64 v[252:253], v37 offset:192
ds_read_b64 v[254:255], v37 offset:200
v_mfma_f32_16x16x32_bf16 v[216:219], v[232:235], a[228:231], v[216:219]
v_mfma_f32_16x16x32_bf16 v[220:223], v[232:235], a[232:235], v[220:223]
s_waitcnt lgkmcnt(8)
v_mfma_f32_16x16x32_bf16 v[212:215], v[236:239], a[192:195], v[212:215]
v_mfma_f32_16x16x32_bf16 v[216:219], v[236:239], a[196:199], v[216:219]
v_mfma_f32_16x16x32_bf16 v[220:223], v[236:239], a[200:203], v[220:223]
s_waitcnt lgkmcnt(6)
v_mfma_f32_16x16x32_bf16 v[216:219], v[240:243], a[224:227], v[216:219]
v_mfma_f32_16x16x32_bf16 v[220:223], v[240:243], a[228:231], v[220:223]
s_waitcnt lgkmcnt(4)
v_mfma_f32_16x16x32_bf16 v[216:219], v[244:247], a[192:195], v[216:219]
v_mfma_f32_16x16x32_bf16 v[220:223], v[244:247], a[196:199], v[220:223]
s_waitcnt lgkmcnt(2)
v_mfma_f32_16x16x32_bf16 v[220:223], v[248:251], a[224:227], v[220:223]
s_waitcnt lgkmcnt(0)
v_mfma_f32_16x16x32_bf16 v[220:223], v[252:255], a[192:195], v[220:223]
s_barrier
s_lshl_b32 s36, s98, 13
v_add_u32 v49, s36, v15
s_nop 3
ds_write_b128 v49, v[192:195] offset:0
ds_write_b128 v49, v[196:199] offset:1024
ds_write_b128 v49, v[200:203] offset:2048
ds_write_b128 v49, v[204:207] offset:3072
ds_write_b128 v49, v[208:211] offset:4096
ds_write_b128 v49, v[212:215] offset:5120
ds_write_b128 v49, v[216:219] offset:6144
ds_write_b128 v49, v[220:223] offset:7168
s_lshl_b32 s36, s98, 11
v_add_u32 v50, s36, v15
s_waitcnt lgkmcnt(0)
s_barrier
ds_read_b128 v[96:99], v50 offset:0
ds_read_b128 v[100:103], v50 offset:8192
ds_read_b128 v[104:107], v50 offset:16384
ds_read_b128 v[108:111], v50 offset:24576
ds_read_b128 v[112:115], v50 offset:1024
ds_read_b128 v[116:119], v50 offset:9216
ds_read_b128 v[120:123], v50 offset:17408
ds_read_b128 v[124:127], v50 offset:25600
s_waitcnt lgkmcnt(4)
v_add_f32 v96, v96, v100
v_add_f32 v104, v104, v108
v_add_f32 v97, v97, v101
v_add_f32 v105, v105, v109
v_add_f32 v98, v98, v102
v_add_f32 v106, v106, v110
v_add_f32 v99, v99, v103
v_add_f32 v107, v107, v111
v_add_f32 v96, v96, v104
v_add_f32 v97, v97, v105
v_add_f32 v98, v98, v106
v_add_f32 v99, v99, v107
v_cvt_pk_bf16_f32 v46, v96, v97
v_cvt_pk_bf16_f32 v47, v98, v99
buffer_store_dwordx2 v[46:47], v39, s[16:19], s49 offen offset:0 sc1
s_waitcnt lgkmcnt(0)
v_add_f32 v112, v112, v116
v_add_f32 v120, v120, v124
v_add_f32 v113, v113, v117
v_add_f32 v121, v121, v125
v_add_f32 v114, v114, v118
v_add_f32 v122, v122, v126
v_add_f32 v115, v115, v119
v_add_f32 v123, v123, v127
v_add_f32 v112, v112, v120
v_add_f32 v113, v113, v121
v_add_f32 v114, v114, v122
v_add_f32 v115, v115, v123
v_cvt_pk_bf16_f32 v48, v112, v113
v_cvt_pk_bf16_f32 v49, v114, v115
buffer_store_dwordx2 v[48:49], v39, s[16:19], s49 offen offset:512 sc1
s_waitcnt vmcnt(0)
s_barrier
s_cmp_lg_u32 s98, 0
s_cbranch_scc1 SIG_16
s_lshl_b32 s56, s2, 7
s_add_u32 s56, s56, 40894480
v_mov_b32 v60, s56
v_mov_b32 v61, s100
s_mov_b64 exec, 1
global_store_dword v60, v61, s[6:7] sc1
s_mov_b64 exec, -1
SIG_16:
KF_EXIT:
s_endpgm
.section .rodata,"a"
.p2align 6
.amdhsa_kernel parallel_sum__ssm_conv_s4d__swiglu_ffn__prompt_kernel
  .amdhsa_next_free_vgpr 512
  .amdhsa_next_free_sgpr 102
  .amdhsa_accum_offset 256
  .amdhsa_group_segment_fixed_size 0
  .amdhsa_kernarg_size 112
  .amdhsa_user_sgpr_count 2
  .amdhsa_user_sgpr_kernarg_segment_ptr 1
  .amdhsa_system_sgpr_workgroup_id_x 1
  .amdhsa_float_denorm_mode_32 3
.end_amdhsa_kernel
```
